```python
import torch

def _softmax(x, axis=-1):
    return torch.softmax(x, dim=axis)

def _gelu(x):
    return torch.nn.functional.gelu(x, approximate='tanh')

def _silu(x):
    return torch.nn.functional.silu(x)

def _sigmoid(x):
    return torch.sigmoid(x)

def _layernorm(x, axis=-1, eps=1e-05):
    m = x.mean(dim=axis, keepdim=True)
    v = x.var(dim=axis, keepdim=True, unbiased=False)
    return (x - m) / torch.sqrt(v + eps)

def _scatter_add(tgt, idx, src, axis=0):
    return tgt.clone().index_add_(axis, idx, src)

def _segment_sum(src, seg, n):
    out = torch.zeros((n,) + src.shape[1:], dtype=src.dtype)
    return out.index_add_(0, seg, src)

def _pad(x, pw):
    flat = tuple((v for pair in reversed(pw) for v in pair))
    return torch.nn.functional.pad(x, flat)
kernel_name = 'adaLN_cond__gqa_block_cached__mixer_gmlp__prompt'

def setup_inputs():

    _w = lambda a: (lambda t: t.to(torch.bfloat16) if t.is_floating_point() else t)(torch.as_tensor(a))

    def _A_setup():
        B, Sq, D = (1, 2048, 448)
        Hq, Hkv, Sk, Dh = (16, 8, 2048, 256)
        assert Hq % Hkv == 0, (Hq, Hkv)
        return {'x': _w((lambda *s: torch.randn(*s, dtype=torch.bfloat16) * 0.05)(B, Sq, D)), 'k_cache': _w((lambda *s: torch.randn(*s, dtype=torch.bfloat16) * 3.2)(B, Hkv, Sk, Dh)), 'v_cache': _w((lambda *s: torch.randn(*s, dtype=torch.bfloat16) * 0.4)(B, Hkv, Sk, Dh)), 'wq': _w((lambda *s: torch.randn(*s, dtype=torch.bfloat16) * 3.2)(D, Hq * Dh) * D ** (-0.5)), 'wo': _w((lambda *s: torch.randn(*s, dtype=torch.bfloat16) * 0.4)(Hq * Dh, D) * (Hq * Dh) ** (-0.5))}
    _A_in = _A_setup()

    def _B_setup():
        B, S, D, F = (1, 2048, 448, 1792)
        Fh = F // 2
        return {'x': _w((lambda *s: torch.randn(*s, dtype=torch.bfloat16) * 0.05)(B, S, D)), 'w_in': _w((lambda *s: torch.randn(*s, dtype=torch.bfloat16) * 0.8)(D, 2 * Fh)), 'w_sp': _w(0.01 * (lambda *s: torch.randn(*s, dtype=torch.bfloat16) * 0.8)(S, S)), 'b_sp': _w(1.0 + 0.01 * (lambda *s: torch.randn(*s, dtype=torch.bfloat16) * 0.05)(S)), 'w_out': _w((lambda *s: torch.randn(*s, dtype=torch.bfloat16) * 0.05)(Fh, D))}
    _B_in = _B_setup()
    return {'A_x': _A_in['x'], 'A_k_cache': _A_in['k_cache'], 'A_v_cache': _A_in['v_cache'], 'A_wq': _A_in['wq'], 'A_wo': _A_in['wo'], 'B_x': _B_in['x'], 'B_w_in': _B_in['w_in'], 'B_w_sp': _B_in['w_sp'], 'B_b_sp': _B_in['b_sp'], 'B_w_out': _B_in['w_out'], 'c': _w((lambda *s: torch.randn(*s, dtype=torch.bfloat16) * 0.1)(1, 448) * 8.0), 'w_mod': _w((lambda *s: torch.randn(*s, dtype=torch.bfloat16) * 0.1)(448, 6 * 448) * 448 ** (-0.5) * 8.0)}

def reference(A_x, A_k_cache, A_v_cache, A_wq, A_wo, B_x, B_w_in, B_w_sp, B_b_sp, B_w_out, c, w_mod):

    def _A_ref(x, k_cache, v_cache, wq, wo):
        B, Sq, D = x.shape
        Hq, Dh = (16, 256)
        Hkv = k_cache.shape[1]
        rep = Hq // Hkv
        q = (lambda x, *d: x.permute(*d))((x @ wq).reshape(B, Sq, Hq, Dh), 0, 2, 1, 3)
        k = (lambda x, n, axis: torch.repeat_interleave(x, n, dim=axis))(k_cache, rep, axis=1)
        v = (lambda x, n, axis: torch.repeat_interleave(x, n, dim=axis))(v_cache, rep, axis=1)
        scores = torch.einsum('bhqd,bhkd->bhqk', q, k) * Dh ** (-0.5)
        p = _softmax(scores, axis=-1)
        o = torch.einsum('bhqk,bhkd->bhqd', p, v)
        return (lambda x, *d: x.permute(*d))(o, 0, 2, 1, 3).reshape(B, Sq, Hq * Dh) @ wo

    def _B_ref(x, w_in, w_sp, b_sp, w_out):
        B, S, D = x.shape
        F = w_in.shape[-1]
        Fh = F // 2
        z = _gelu(torch.einsum('bsd,df->bsf', x, w_in))
        z1 = z[..., :Fh].clone()
        z2 = _layernorm(z[..., Fh:], axis=-1)
        g = torch.einsum('ts,bsf->btf', w_sp, z2) + b_sp[None, :, None]
        return torch.einsum('bsf,fd->bsd', z1 * g, w_out)
    x = A_x
    mod = (_silu(c) @ w_mod).reshape(c.shape[0], 6, 1, -1)
    sa, ca, ga, sb, cb, gb = (mod[:, 0].clone(), mod[:, 1].clone(), mod[:, 2].clone(), mod[:, 3].clone(), mod[:, 4].clone(), mod[:, 5].clone())
    h = _layernorm(x, axis=-1) * (1 + ca) + sa
    x = x + ga * _A_ref(h, A_k_cache, A_v_cache, A_wq, A_wo)
    h = _layernorm(x, axis=-1) * (1 + cb) + sb
    x = x + gb * _B_ref(h, B_w_in, B_w_sp, B_b_sp, B_w_out)
    return x
```

```asm
; @launch grid=(256,1,1) block=(256,1,1) lds=163840
.amdgcn_target "amdgcn-amd-amdhsa--gfx950"
.text
.globl adaLN_cond__gqa_block_cached__mixer_gmlp__prompt_kernel
.p2align 8
.type adaLN_cond__gqa_block_cached__mixer_gmlp__prompt_kernel,@function
adaLN_cond__gqa_block_cached__mixer_gmlp__prompt_kernel:
    s_cmp_ge_u32 s2, 256
    s_cbranch_scc1 L_endadaLN_cond__gqa_block_cached__mixer_gmlp__prompt_kernel
    s_load_dwordx4 s[52:55], s[0:1], 80
    s_load_dwordx2 s[50:51], s[0:1], 0
    s_load_dwordx8 s[4:11], s[0:1], 8
    s_load_dwordx4 s[56:59], s[0:1], 104
    v_lshrrev_b32 v1, 6, v0
    s_nop 0
    v_readfirstlane_b32 s28, v1
    s_and_b32 s29, s2, 7
    s_lshr_b32 s30, s2, 3
    v_and_b32 v1, 63, v0
    v_lshlrev_b32 v12, 4, v1
    s_lshr_b32 s48, s28, 1
    s_and_b32 s14, s28, 1
    s_lshl_b32 s49, s30, 2
    s_lshl_b32 s14, s14, 1
    s_add_u32 s49, s49, s14
    v_mov_b32 v2, 0x40000000
    v_cmp_gt_u32 vcc, 56, v1
    s_nop 1
    v_cndmask_b32 v19, v2, v12, vcc
    v_add_u32 v18, 144, v19
    v_add_u32 v17, 288, v19
    v_add_u32 v16, 432, v19
    s_lshl_b32 s14, s30, 2
    s_add_u32 s14, s14, s28
    s_mul_i32 s14, s14, 14336
    s_mul_i32 s15, s28, 16640
    s_add_u32 s15, s15, 66560
    s_waitcnt lgkmcnt(0)
    s_load_dwordx2 s[100:101], s[58:59], 32768
    s_mov_b32 s24, s58
    s_mov_b32 s25, s59
    s_mov_b32 s26, 41943040
    s_mov_b32 s27, 0x20000
    s_mov_b32 s92, s56
    s_mov_b32 s93, s57
    s_mov_b32 s94, 256
    s_mov_b32 s95, 0x20000
    s_mov_b32 s20, s54
    s_mov_b32 s21, s55
    s_mov_b32 s22, 2408448
    s_mov_b32 s23, 0x20000
    s_mov_b32 s44, s52
    s_mov_b32 s45, s53
    s_mov_b32 s46, 896
    s_mov_b32 s47, 0x20000
    s_mov_b32 s16, s50
    s_mov_b32 s17, s51
    s_mov_b32 s18, 1835440
    s_mov_b32 s19, 0x20000
    s_sub_u32 s16, s16, 432
    s_subb_u32 s17, s17, 0
    s_mov_b32 s31, 0
    v_and_b32 v127, 31, v0
    v_lshlrev_b32 v125, 3, v127
    s_mov_b32 s32, 0x40000000
    s_mov_b32 s33, 0x40000000
    v_and_b32 v44, 3, v0
    v_lshrrev_b32 v45, 2, v0
    v_mul_u32_u24 v46, 14, v45
    v_mul_u32_u24 v47, 37632, v45
    v_lshl_add_u32 v47, v44, 4, v47
    s_lshl_b32 s12, s2, 6
    v_and_b32 v46, -4, v46
    s_cmp_ge_u32 s2, 28
    s_cbranch_scc1 L_mod1radaLN_cond__gqa_block_cached__mixer_gmlp__prompt_kernel
    buffer_load_dwordx4 v[72:75], v47, s[20:23], s12 offen
    s_add_u32 s12, s12, 5376
    buffer_load_dwordx4 v[76:79], v47, s[20:23], s12 offen
    s_add_u32 s12, s12, 5376
    buffer_load_dwordx4 v[80:83], v47, s[20:23], s12 offen
    s_add_u32 s12, s12, 5376
    buffer_load_dwordx4 v[84:87], v47, s[20:23], s12 offen
    s_add_u32 s12, s12, 5376
    buffer_load_dwordx4 v[88:91], v47, s[20:23], s12 offen
    s_add_u32 s12, s12, 5376
    buffer_load_dwordx4 v[92:95], v47, s[20:23], s12 offen
    s_add_u32 s12, s12, 5376
    buffer_load_dwordx4 v[96:99], v47, s[20:23], s12 offen
    buffer_load_dwordx4 v[100:103], v46, s[44:47], 0 offen
L_mod1radaLN_cond__gqa_block_cached__mixer_gmlp__prompt_kernel:
    s_add_u32 m0, s15, 0
    s_nop 0
    buffer_load_dwordx4 v16, s[16:19], s14 offen offset:0 lds
    buffer_load_dwordx4 v17, s[16:19], s14 offen offset:1040 lds
    buffer_load_dwordx4 v18, s[16:19], s14 offen offset:2080 lds
    buffer_load_dwordx4 v19, s[16:19], s14 offen offset:3120 lds
    s_add_u32 s14, s14, 3584
    s_add_u32 m0, s15, 4160
    s_nop 0
    buffer_load_dwordx4 v16, s[16:19], s14 offen offset:0 lds
    buffer_load_dwordx4 v17, s[16:19], s14 offen offset:1040 lds
    buffer_load_dwordx4 v18, s[16:19], s14 offen offset:2080 lds
    buffer_load_dwordx4 v19, s[16:19], s14 offen offset:3120 lds
    s_add_u32 s14, s14, 3584
    s_add_u32 m0, s15, 8320
    s_nop 0
    buffer_load_dwordx4 v16, s[16:19], s14 offen offset:0 lds
    buffer_load_dwordx4 v17, s[16:19], s14 offen offset:1040 lds
    buffer_load_dwordx4 v18, s[16:19], s14 offen offset:2080 lds
    buffer_load_dwordx4 v19, s[16:19], s14 offen offset:3120 lds
    s_add_u32 s14, s14, 3584
    s_add_u32 m0, s15, 12480
    s_nop 0
    buffer_load_dwordx4 v16, s[16:19], s14 offen offset:0 lds
    buffer_load_dwordx4 v17, s[16:19], s14 offen offset:1040 lds
    buffer_load_dwordx4 v18, s[16:19], s14 offen offset:2080 lds
    buffer_load_dwordx4 v19, s[16:19], s14 offen offset:3120 lds
    s_add_u32 s14, s14, 3584
    s_mul_i32 s35, s28, 4160
    v_bfe_u32 v1, v0, 5, 1
    v_and_b32 v2, 31, v0
    v_lshlrev_b32 v15, 1, v1
    v_xor_b32 v2, v2, v15
    v_lshlrev_b32 v1, 3, v1
    v_add_u32 v1, s28, v1
    v_lshlrev_b32 v1, 13, v1
    v_lshl_add_u32 v4, v2, 4, v1
    v_add_u32 v5, 130048, v4
    v_add_u32 v6, 30720, v4
    v_add_u32 v7, 160768, v4
    s_mul_i32 s52, s48, 896
    s_add_u32 s52, s52, 149760
    v_bfe_u32 v1, v0, 2, 2
    v_mul_u32_u24 v1, 4160, v1
    v_and_b32 v2, 3, v0
    v_lshl_add_u32 v1, v2, 3, v1
    v_bfe_u32 v2, v0, 4, 2
    v_lshl_add_u32 v1, v2, 9, v1
    v_lshlrev_b32 v3, 5, v2
    v_add_u32 v3, s52, v3
    v_and_b32 v120, 15, v0
    v_mul_u32_u24 v120, 1040, v120
    v_lshl_add_u32 v120, v2, 4, v120
    s_and_b32 s14, s28, 1
    s_mul_i32 s14, s14, 33280
    s_mul_i32 s15, s48, 448
    s_add_u32 s14, s14, s15
    s_add_u32 s14, s14, 66560
    v_add_u32 v120, s14, v120
    v_bfe_u32 v2, v0, 4, 1
    v_lshl_add_u32 v15, v2, 5, v1
    s_mul_i32 s14, s48, 16640
    v_add_u32 v8, s14, v15
    v_xor_b32 v9, 32, v8
    v_add_u32 v10, 66560, v8
    v_add_u32 v11, 66560, v9
    s_lshl_b32 s14, s28, 12
    s_add_u32 s14, s14, 133120
    v_add_u32 v13, s14, v12
    v_xor_b32 v14, 0x2000, v13
    s_cmp_ge_u32 s2, 28
    s_cbranch_scc1 L_mod2ruadaLN_cond__gqa_block_cached__mixer_gmlp__prompt_kernel
    s_mov_b32 s13, 3216550459
    v_bfe_u32 v45, v0, 2, 1
    v_lshlrev_b32 v45, 4, v45
    s_waitcnt vmcnt(16)
    v_alignbit_b32 v100, v101, v100, v45
    v_alignbit_b32 v101, v102, v101, v45
    v_alignbit_b32 v102, v103, v102, v45
    v_alignbit_b32 v103, v103, v103, v45
    v_lshlrev_b32 v20, 16, v100
    v_and_b32 v21, 0xffff0000, v100
    v_lshlrev_b32 v22, 16, v101
    v_and_b32 v23, 0xffff0000, v101
    v_lshlrev_b32 v24, 16, v102
    v_and_b32 v25, 0xffff0000, v102
    v_lshlrev_b32 v26, 16, v103
    v_mul_f32 v28, s13, v20
    v_mul_f32 v29, s13, v21
    v_mul_f32 v30, s13, v22
    v_mul_f32 v31, s13, v23
    v_mul_f32 v32, s13, v24
    v_mul_f32 v33, s13, v25
    v_mul_f32 v34, s13, v26
    v_exp_f32 v28, v28
    v_exp_f32 v29, v29
    v_exp_f32 v30, v30
    v_exp_f32 v31, v31
    v_exp_f32 v32, v32
    v_exp_f32 v33, v33
    v_exp_f32 v34, v34
    v_add_f32 v28, 1.0, v28
    v_add_f32 v29, 1.0, v29
    v_add_f32 v30, 1.0, v30
    v_add_f32 v31, 1.0, v31
    v_add_f32 v32, 1.0, v32
    v_add_f32 v33, 1.0, v33
    v_add_f32 v34, 1.0, v34
    v_rcp_f32 v28, v28
    v_rcp_f32 v29, v29
    v_rcp_f32 v30, v30
    v_rcp_f32 v31, v31
    v_rcp_f32 v32, v32
    v_rcp_f32 v33, v33
    v_rcp_f32 v34, v34
    v_mul_f32 v28, v28, v20
    v_cvt_pk_bf16_f32 v28, v28, v28
    v_lshlrev_b32 v52, 16, v28
    v_mul_f32 v29, v29, v21
    v_cvt_pk_bf16_f32 v29, v29, v29
    v_lshlrev_b32 v54, 16, v29
    v_mul_f32 v30, v30, v22
    v_cvt_pk_bf16_f32 v30, v30, v30
    v_lshlrev_b32 v56, 16, v30
    v_mul_f32 v31, v31, v23
    v_cvt_pk_bf16_f32 v31, v31, v31
    v_lshlrev_b32 v58, 16, v31
    v_mul_f32 v32, v32, v24
    v_cvt_pk_bf16_f32 v32, v32, v32
    v_lshlrev_b32 v60, 16, v32
    v_mul_f32 v33, v33, v25
    v_cvt_pk_bf16_f32 v33, v33, v33
    v_lshlrev_b32 v62, 16, v33
    v_mul_f32 v34, v34, v26
    v_cvt_pk_bf16_f32 v34, v34, v34
    v_lshlrev_b32 v64, 16, v34
    v_lshlrev_b32 v20, 16, v72
    v_and_b32 v21, 0xffff0000, v72
    v_pk_mul_f32 v[36:37], v[20:21], v[52:53] op_sel_hi:[1,0]
    v_lshlrev_b32 v22, 16, v73
    v_and_b32 v23, 0xffff0000, v73
    v_pk_mul_f32 v[38:39], v[22:23], v[52:53] op_sel_hi:[1,0]
    v_lshlrev_b32 v24, 16, v74
    v_and_b32 v25, 0xffff0000, v74
    v_pk_mul_f32 v[40:41], v[24:25], v[52:53] op_sel_hi:[1,0]
    v_lshlrev_b32 v26, 16, v75
    v_and_b32 v27, 0xffff0000, v75
    v_pk_mul_f32 v[42:43], v[26:27], v[52:53] op_sel_hi:[1,0]
    v_lshlrev_b32 v20, 16, v76
    v_and_b32 v21, 0xffff0000, v76
    v_pk_fma_f32 v[36:37], v[20:21], v[54:55], v[36:37] op_sel_hi:[1,0,1]
    v_lshlrev_b32 v22, 16, v77
    v_and_b32 v23, 0xffff0000, v77
    v_pk_fma_f32 v[38:39], v[22:23], v[54:55], v[38:39] op_sel_hi:[1,0,1]
    v_lshlrev_b32 v24, 16, v78
    v_and_b32 v25, 0xffff0000, v78
    v_pk_fma_f32 v[40:41], v[24:25], v[54:55], v[40:41] op_sel_hi:[1,0,1]
    v_lshlrev_b32 v26, 16, v79
    v_and_b32 v27, 0xffff0000, v79
    v_pk_fma_f32 v[42:43], v[26:27], v[54:55], v[42:43] op_sel_hi:[1,0,1]
    v_lshlrev_b32 v20, 16, v80
    v_and_b32 v21, 0xffff0000, v80
    v_pk_fma_f32 v[36:37], v[20:21], v[56:57], v[36:37] op_sel_hi:[1,0,1]
    v_lshlrev_b32 v22, 16, v81
    v_and_b32 v23, 0xffff0000, v81
    v_pk_fma_f32 v[38:39], v[22:23], v[56:57], v[38:39] op_sel_hi:[1,0,1]
    v_lshlrev_b32 v24, 16, v82
    v_and_b32 v25, 0xffff0000, v82
    v_pk_fma_f32 v[40:41], v[24:25], v[56:57], v[40:41] op_sel_hi:[1,0,1]
    v_lshlrev_b32 v26, 16, v83
    v_and_b32 v27, 0xffff0000, v83
    v_pk_fma_f32 v[42:43], v[26:27], v[56:57], v[42:43] op_sel_hi:[1,0,1]
    v_lshlrev_b32 v20, 16, v84
    v_and_b32 v21, 0xffff0000, v84
    v_pk_fma_f32 v[36:37], v[20:21], v[58:59], v[36:37] op_sel_hi:[1,0,1]
    v_lshlrev_b32 v22, 16, v85
    v_and_b32 v23, 0xffff0000, v85
    v_pk_fma_f32 v[38:39], v[22:23], v[58:59], v[38:39] op_sel_hi:[1,0,1]
    v_lshlrev_b32 v24, 16, v86
    v_and_b32 v25, 0xffff0000, v86
    v_pk_fma_f32 v[40:41], v[24:25], v[58:59], v[40:41] op_sel_hi:[1,0,1]
    v_lshlrev_b32 v26, 16, v87
    v_and_b32 v27, 0xffff0000, v87
    v_pk_fma_f32 v[42:43], v[26:27], v[58:59], v[42:43] op_sel_hi:[1,0,1]
    v_lshlrev_b32 v20, 16, v88
    v_and_b32 v21, 0xffff0000, v88
    v_pk_fma_f32 v[36:37], v[20:21], v[60:61], v[36:37] op_sel_hi:[1,0,1]
    v_lshlrev_b32 v22, 16, v89
    v_and_b32 v23, 0xffff0000, v89
    v_pk_fma_f32 v[38:39], v[22:23], v[60:61], v[38:39] op_sel_hi:[1,0,1]
    v_lshlrev_b32 v24, 16, v90
    v_and_b32 v25, 0xffff0000, v90
    v_pk_fma_f32 v[40:41], v[24:25], v[60:61], v[40:41] op_sel_hi:[1,0,1]
    v_lshlrev_b32 v26, 16, v91
    v_and_b32 v27, 0xffff0000, v91
    v_pk_fma_f32 v[42:43], v[26:27], v[60:61], v[42:43] op_sel_hi:[1,0,1]
    v_lshlrev_b32 v20, 16, v92
    v_and_b32 v21, 0xffff0000, v92
    v_pk_fma_f32 v[36:37], v[20:21], v[62:63], v[36:37] op_sel_hi:[1,0,1]
    v_lshlrev_b32 v22, 16, v93
    v_and_b32 v23, 0xffff0000, v93
    v_pk_fma_f32 v[38:39], v[22:23], v[62:63], v[38:39] op_sel_hi:[1,0,1]
    v_lshlrev_b32 v24, 16, v94
    v_and_b32 v25, 0xffff0000, v94
    v_pk_fma_f32 v[40:41], v[24:25], v[62:63], v[40:41] op_sel_hi:[1,0,1]
    v_lshlrev_b32 v26, 16, v95
    v_and_b32 v27, 0xffff0000, v95
    v_pk_fma_f32 v[42:43], v[26:27], v[62:63], v[42:43] op_sel_hi:[1,0,1]
    v_lshlrev_b32 v20, 16, v96
    v_and_b32 v21, 0xffff0000, v96
    v_pk_fma_f32 v[36:37], v[20:21], v[64:65], v[36:37] op_sel_hi:[1,0,1]
    v_lshlrev_b32 v22, 16, v97
    v_and_b32 v23, 0xffff0000, v97
    v_pk_fma_f32 v[38:39], v[22:23], v[64:65], v[38:39] op_sel_hi:[1,0,1]
    v_lshlrev_b32 v24, 16, v98
    v_and_b32 v25, 0xffff0000, v98
    v_pk_fma_f32 v[40:41], v[24:25], v[64:65], v[40:41] op_sel_hi:[1,0,1]
    v_lshlrev_b32 v26, 16, v99
    v_and_b32 v27, 0xffff0000, v99
    v_pk_fma_f32 v[42:43], v[26:27], v[64:65], v[42:43] op_sel_hi:[1,0,1]
    v_add_f32_dpp v36, v36, v36 row_ror:4 row_mask:0xf bank_mask:0xf
    v_add_f32_dpp v37, v37, v37 row_ror:4 row_mask:0xf bank_mask:0xf
    v_add_f32_dpp v38, v38, v38 row_ror:4 row_mask:0xf bank_mask:0xf
    v_add_f32_dpp v39, v39, v39 row_ror:4 row_mask:0xf bank_mask:0xf
    v_add_f32_dpp v40, v40, v40 row_ror:4 row_mask:0xf bank_mask:0xf
    v_add_f32_dpp v41, v41, v41 row_ror:4 row_mask:0xf bank_mask:0xf
    v_add_f32_dpp v42, v42, v42 row_ror:4 row_mask:0xf bank_mask:0xf
    v_add_f32_dpp v43, v43, v43 row_ror:4 row_mask:0xf bank_mask:0xf
    v_add_f32_dpp v36, v36, v36 row_ror:8 row_mask:0xf bank_mask:0xf
    v_add_f32_dpp v37, v37, v37 row_ror:8 row_mask:0xf bank_mask:0xf
    v_add_f32_dpp v38, v38, v38 row_ror:8 row_mask:0xf bank_mask:0xf
    v_add_f32_dpp v39, v39, v39 row_ror:8 row_mask:0xf bank_mask:0xf
    v_add_f32_dpp v40, v40, v40 row_ror:8 row_mask:0xf bank_mask:0xf
    v_add_f32_dpp v41, v41, v41 row_ror:8 row_mask:0xf bank_mask:0xf
    v_add_f32_dpp v42, v42, v42 row_ror:8 row_mask:0xf bank_mask:0xf
    v_add_f32_dpp v43, v43, v43 row_ror:8 row_mask:0xf bank_mask:0xf
    v_lshrrev_b32 v45, 4, v0
    v_lshlrev_b32 v45, 7, v45
    v_and_b32 v44, 3, v0
    v_lshl_add_u32 v44, v44, 5, v45
    v_add_u32 v44, 153856, v44
    ds_write_b128 v44, v[36:39]
    ds_write_b128 v44, v[40:43] offset:16
    v_lshlrev_b32 v45, 2, v0
    v_add_u32 v45, 153856, v45
    s_waitcnt lgkmcnt(0)
    s_barrier
    s_cmp_lg_u32 s28, 0
    s_cbranch_scc1 L_mod2ruadaLN_cond__gqa_block_cached__mixer_gmlp__prompt_kernel
    ds_read_b32 v72, v45 offset:0
    ds_read_b32 v73, v45 offset:256
    ds_read_b32 v74, v45 offset:512
    ds_read_b32 v75, v45 offset:768
    ds_read_b32 v76, v45 offset:1024
    ds_read_b32 v77, v45 offset:1280
    ds_read_b32 v78, v45 offset:1536
    ds_read_b32 v79, v45 offset:1792
    s_waitcnt lgkmcnt(3)
    v_add_f32 v72, v72, v76
    s_waitcnt lgkmcnt(2)
    v_add_f32 v73, v73, v77
    s_waitcnt lgkmcnt(1)
    v_add_f32 v74, v74, v78
    s_waitcnt lgkmcnt(0)
    v_add_f32 v75, v75, v79
    v_add_f32 v72, v72, v74
    v_add_f32 v73, v73, v75
    v_add_f32 v72, v72, v73
    v_mov_b32 v73, v72
    s_nop 1
    v_permlane32_swap_b32 v72, v73
    v_add_f32 v72, v72, v73
    v_cvt_pk_bf16_f32 v72, v72, v72
    v_lshlrev_b32 v72, 16, v72
    v_add_f32 v73, 1.0, v72
    v_cvt_pk_bf16_f32 v73, v73, v73
    v_lshlrev_b32 v73, 16, v73
    s_sub_u32 s12, s2, 14
    s_cmp_lt_u32 s12, 14
    s_cselect_b64 vcc, -1, 0
    v_cndmask_b32 v72, v72, v73, vcc
    s_add_u32 s12, s100, 1
    s_add_u32 s13, s101, 1
    s_and_b32 s13, s13, 0xffff
    v_or_b32 v72, s13, v72
    v_mov_b32 v73, s12
    s_lshl_b32 s33, s2, 8
    s_add_u32 s33, s33, 16384
L_mod2ruadaLN_cond__gqa_block_cached__mixer_gmlp__prompt_kernel:
    buffer_store_dwordx2 v[72:73], v125, s[24:27], s33 offen sc1
    s_mov_b32 s40, s8
    s_mov_b32 s41, s9
    s_mov_b32 s42, 3670016
    s_mov_b32 s43, 0x20000
    s_mul_i32 s35, s28, 4160
    s_lshl_b32 s34, s28, 12
    s_lshl_b32 s39, s29, 10
    v_lshrrev_b32 v1, 3, v0
    v_min_u32 v1, 13, v1
    v_lshlrev_b32 v1, 13, v1
    v_and_b32 v2, 7, v0
    v_lshl_add_u32 v1, v2, 7, v1
    s_mul_i32 s53, s30, 114688
    s_add_u32 s53, s53, s39
    buffer_load_dword v255, v1, s[40:43], s53 offen
    s_getpc_b64 s[56:57]
L_pf_adaLN_cond__gqa_block_cached__mixer_gmlp__prompt_kernel:
    s_lshr_b32 s58, s2, 3
    s_mul_i32 s58, s58, 2816
    v_min_u32 v1, 21, v0
    v_lshlrev_b32 v1, 7, v1
    v_add_u32 v1, s58, v1
    v_min_u32 v1, L_endadaLN_cond__gqa_block_cached__mixer_gmlp__prompt_kernel-L_pf_adaLN_cond__gqa_block_cached__mixer_gmlp__prompt_kernel-4, v1
    global_load_dword v254, v1, s[56:57]
    s_add_u32 m0, s35, 0
    s_add_u32 s38, s39, 0
    buffer_load_dwordx4 v4, s[40:43], s38 offen offset:0 lds
    buffer_load_dwordx4 v5, s[40:43], s38 offen offset:1024 lds
    buffer_load_dwordx4 v6, s[40:43], s38 offen offset:2048 lds
    buffer_load_dwordx4 v7, s[40:43], s38 offen offset:3072 lds
    s_add_u32 m0, s35, 16640
    s_add_u32 s38, s39, 1835520
    buffer_load_dwordx4 v4, s[40:43], s38 offen offset:0 lds
    buffer_load_dwordx4 v5, s[40:43], s38 offen offset:1024 lds
    buffer_load_dwordx4 v6, s[40:43], s38 offen offset:2048 lds
    buffer_load_dwordx4 v7, s[40:43], s38 offen offset:3072 lds
    s_waitcnt vmcnt(11)
    s_barrier
    ds_read_b128 v[16:19], v120 offset:0
    ds_read_b128 v[20:23], v120 offset:16640
    ds_read_b128 v[24:27], v120 offset:64
    ds_read_b128 v[28:31], v120 offset:16704
    ds_read_b128 v[32:35], v120 offset:128
    ds_read_b128 v[36:39], v120 offset:16768
    ds_read_b128 v[40:43], v120 offset:192
    ds_read_b128 v[44:47], v120 offset:16832
    ds_read_b128 v[48:51], v120 offset:256
    ds_read_b128 v[52:55], v120 offset:16896
    ds_read_b128 v[56:59], v120 offset:320
    ds_read_b128 v[60:63], v120 offset:16960
    ds_read_b128 v[64:67], v120 offset:384
    ds_read_b128 v[68:71], v120 offset:17024
    s_waitcnt lgkmcnt(13)
    v_lshlrev_b32 v128, 16, v16
    v_and_b32 v129, 0xffff0000, v16
    v_pk_mul_f32 v[116:117], v[128:129], v[128:129]
    v_lshlrev_b32 v130, 16, v17
    v_and_b32 v131, 0xffff0000, v17
    v_pk_add_f32 v[112:113], v[128:129], v[130:131]
    v_pk_fma_f32 v[116:117], v[130:131], v[130:131], v[116:117]
    v_lshlrev_b32 v132, 16, v18
    v_and_b32 v133, 0xffff0000, v18
    v_pk_add_f32 v[112:113], v[112:113], v[132:133]
    v_pk_fma_f32 v[116:117], v[132:133], v[132:133], v[116:117]
    v_lshlrev_b32 v134, 16, v19
    v_and_b32 v135, 0xffff0000, v19
    v_pk_add_f32 v[112:113], v[112:113], v[134:135]
    v_pk_fma_f32 v[116:117], v[134:135], v[134:135], v[116:117]
    s_waitcnt lgkmcnt(12)
    v_lshlrev_b32 v136, 16, v20
    v_and_b32 v137, 0xffff0000, v20
    v_pk_mul_f32 v[118:119], v[136:137], v[136:137]
    v_lshlrev_b32 v138, 16, v21
    v_and_b32 v139, 0xffff0000, v21
    v_pk_add_f32 v[114:115], v[136:137], v[138:139]
    v_pk_fma_f32 v[118:119], v[138:139], v[138:139], v[118:119]
    v_lshlrev_b32 v140, 16, v22
    v_and_b32 v141, 0xffff0000, v22
    v_pk_add_f32 v[114:115], v[114:115], v[140:141]
    v_pk_fma_f32 v[118:119], v[140:141], v[140:141], v[118:119]
    v_lshlrev_b32 v142, 16, v23
    v_and_b32 v143, 0xffff0000, v23
    v_pk_add_f32 v[114:115], v[114:115], v[142:143]
    v_pk_fma_f32 v[118:119], v[142:143], v[142:143], v[118:119]
    s_waitcnt lgkmcnt(11)
    v_lshlrev_b32 v144, 16, v24
    v_and_b32 v145, 0xffff0000, v24
    v_pk_add_f32 v[112:113], v[112:113], v[144:145]
    v_pk_fma_f32 v[116:117], v[144:145], v[144:145], v[116:117]
    v_lshlrev_b32 v146, 16, v25
    v_and_b32 v147, 0xffff0000, v25
    v_pk_add_f32 v[112:113], v[112:113], v[146:147]
    v_pk_fma_f32 v[116:117], v[146:147], v[146:147], v[116:117]
    v_lshlrev_b32 v148, 16, v26
    v_and_b32 v149, 0xffff0000, v26
    v_pk_add_f32 v[112:113], v[112:113], v[148:149]
    v_pk_fma_f32 v[116:117], v[148:149], v[148:149], v[116:117]
    v_lshlrev_b32 v150, 16, v27
    v_and_b32 v151, 0xffff0000, v27
    v_pk_add_f32 v[112:113], v[112:113], v[150:151]
    v_pk_fma_f32 v[116:117], v[150:151], v[150:151], v[116:117]
    s_waitcnt lgkmcnt(10)
    v_lshlrev_b32 v152, 16, v28
    v_and_b32 v153, 0xffff0000, v28
    v_pk_add_f32 v[114:115], v[114:115], v[152:153]
    v_pk_fma_f32 v[118:119], v[152:153], v[152:153], v[118:119]
    v_lshlrev_b32 v154, 16, v29
    v_and_b32 v155, 0xffff0000, v29
    v_pk_add_f32 v[114:115], v[114:115], v[154:155]
    v_pk_fma_f32 v[118:119], v[154:155], v[154:155], v[118:119]
    v_lshlrev_b32 v156, 16, v30
    v_and_b32 v157, 0xffff0000, v30
    v_pk_add_f32 v[114:115], v[114:115], v[156:157]
    v_pk_fma_f32 v[118:119], v[156:157], v[156:157], v[118:119]
    v_lshlrev_b32 v158, 16, v31
    v_and_b32 v159, 0xffff0000, v31
    v_pk_add_f32 v[114:115], v[114:115], v[158:159]
    v_pk_fma_f32 v[118:119], v[158:159], v[158:159], v[118:119]
    s_waitcnt lgkmcnt(9)
    v_lshlrev_b32 v160, 16, v32
    v_and_b32 v161, 0xffff0000, v32
    v_pk_add_f32 v[112:113], v[112:113], v[160:161]
    v_pk_fma_f32 v[116:117], v[160:161], v[160:161], v[116:117]
    v_lshlrev_b32 v162, 16, v33
    v_and_b32 v163, 0xffff0000, v33
    v_pk_add_f32 v[112:113], v[112:113], v[162:163]
    v_pk_fma_f32 v[116:117], v[162:163], v[162:163], v[116:117]
    v_lshlrev_b32 v164, 16, v34
    v_and_b32 v165, 0xffff0000, v34
    v_pk_add_f32 v[112:113], v[112:113], v[164:165]
    v_pk_fma_f32 v[116:117], v[164:165], v[164:165], v[116:117]
    v_lshlrev_b32 v166, 16, v35
    v_and_b32 v167, 0xffff0000, v35
    v_pk_add_f32 v[112:113], v[112:113], v[166:167]
    v_pk_fma_f32 v[116:117], v[166:167], v[166:167], v[116:117]
    s_waitcnt lgkmcnt(8)
    v_lshlrev_b32 v168, 16, v36
    v_and_b32 v169, 0xffff0000, v36
    v_pk_add_f32 v[114:115], v[114:115], v[168:169]
    v_pk_fma_f32 v[118:119], v[168:169], v[168:169], v[118:119]
    v_lshlrev_b32 v170, 16, v37
    v_and_b32 v171, 0xffff0000, v37
    v_pk_add_f32 v[114:115], v[114:115], v[170:171]
    v_pk_fma_f32 v[118:119], v[170:171], v[170:171], v[118:119]
    v_lshlrev_b32 v172, 16, v38
    v_and_b32 v173, 0xffff0000, v38
    v_pk_add_f32 v[114:115], v[114:115], v[172:173]
    v_pk_fma_f32 v[118:119], v[172:173], v[172:173], v[118:119]
    v_lshlrev_b32 v174, 16, v39
    v_and_b32 v175, 0xffff0000, v39
    v_pk_add_f32 v[114:115], v[114:115], v[174:175]
    v_pk_fma_f32 v[118:119], v[174:175], v[174:175], v[118:119]
    s_waitcnt lgkmcnt(7)
    v_lshlrev_b32 v176, 16, v40
    v_and_b32 v177, 0xffff0000, v40
    v_pk_add_f32 v[112:113], v[112:113], v[176:177]
    v_pk_fma_f32 v[116:117], v[176:177], v[176:177], v[116:117]
    v_lshlrev_b32 v178, 16, v41
    v_and_b32 v179, 0xffff0000, v41
    v_pk_add_f32 v[112:113], v[112:113], v[178:179]
    v_pk_fma_f32 v[116:117], v[178:179], v[178:179], v[116:117]
    v_lshlrev_b32 v180, 16, v42
    v_and_b32 v181, 0xffff0000, v42
    v_pk_add_f32 v[112:113], v[112:113], v[180:181]
    v_pk_fma_f32 v[116:117], v[180:181], v[180:181], v[116:117]
    v_lshlrev_b32 v182, 16, v43
    v_and_b32 v183, 0xffff0000, v43
    v_pk_add_f32 v[112:113], v[112:113], v[182:183]
    v_pk_fma_f32 v[116:117], v[182:183], v[182:183], v[116:117]
    s_waitcnt lgkmcnt(6)
    v_lshlrev_b32 v184, 16, v44
    v_and_b32 v185, 0xffff0000, v44
    v_pk_add_f32 v[114:115], v[114:115], v[184:185]
    v_pk_fma_f32 v[118:119], v[184:185], v[184:185], v[118:119]
    v_lshlrev_b32 v186, 16, v45
    v_and_b32 v187, 0xffff0000, v45
    v_pk_add_f32 v[114:115], v[114:115], v[186:187]
    v_pk_fma_f32 v[118:119], v[186:187], v[186:187], v[118:119]
    v_lshlrev_b32 v188, 16, v46
    v_and_b32 v189, 0xffff0000, v46
    v_pk_add_f32 v[114:115], v[114:115], v[188:189]
    v_pk_fma_f32 v[118:119], v[188:189], v[188:189], v[118:119]
    v_lshlrev_b32 v190, 16, v47
    v_and_b32 v191, 0xffff0000, v47
    v_pk_add_f32 v[114:115], v[114:115], v[190:191]
    v_pk_fma_f32 v[118:119], v[190:191], v[190:191], v[118:119]
    s_waitcnt lgkmcnt(5)
    v_lshlrev_b32 v192, 16, v48
    v_and_b32 v193, 0xffff0000, v48
    v_pk_add_f32 v[112:113], v[112:113], v[192:193]
    v_pk_fma_f32 v[116:117], v[192:193], v[192:193], v[116:117]
    v_lshlrev_b32 v194, 16, v49
    v_and_b32 v195, 0xffff0000, v49
    v_pk_add_f32 v[112:113], v[112:113], v[194:195]
    v_pk_fma_f32 v[116:117], v[194:195], v[194:195], v[116:117]
    v_lshlrev_b32 v196, 16, v50
    v_and_b32 v197, 0xffff0000, v50
    v_pk_add_f32 v[112:113], v[112:113], v[196:197]
    v_pk_fma_f32 v[116:117], v[196:197], v[196:197], v[116:117]
    v_lshlrev_b32 v198, 16, v51
    v_and_b32 v199, 0xffff0000, v51
    v_pk_add_f32 v[112:113], v[112:113], v[198:199]
    v_pk_fma_f32 v[116:117], v[198:199], v[198:199], v[116:117]
    s_waitcnt lgkmcnt(4)
    v_lshlrev_b32 v200, 16, v52
    v_and_b32 v201, 0xffff0000, v52
    v_pk_add_f32 v[114:115], v[114:115], v[200:201]
    v_pk_fma_f32 v[118:119], v[200:201], v[200:201], v[118:119]
    v_lshlrev_b32 v202, 16, v53
    v_and_b32 v203, 0xffff0000, v53
    v_pk_add_f32 v[114:115], v[114:115], v[202:203]
    v_pk_fma_f32 v[118:119], v[202:203], v[202:203], v[118:119]
    v_lshlrev_b32 v204, 16, v54
    v_and_b32 v205, 0xffff0000, v54
    v_pk_add_f32 v[114:115], v[114:115], v[204:205]
    v_pk_fma_f32 v[118:119], v[204:205], v[204:205], v[118:119]
    v_lshlrev_b32 v206, 16, v55
    v_and_b32 v207, 0xffff0000, v55
    v_pk_add_f32 v[114:115], v[114:115], v[206:207]
    v_pk_fma_f32 v[118:119], v[206:207], v[206:207], v[118:119]
    s_waitcnt lgkmcnt(3)
    v_lshlrev_b32 v208, 16, v56
    v_and_b32 v209, 0xffff0000, v56
    v_pk_add_f32 v[112:113], v[112:113], v[208:209]
    v_pk_fma_f32 v[116:117], v[208:209], v[208:209], v[116:117]
    v_lshlrev_b32 v210, 16, v57
    v_and_b32 v211, 0xffff0000, v57
    v_pk_add_f32 v[112:113], v[112:113], v[210:211]
    v_pk_fma_f32 v[116:117], v[210:211], v[210:211], v[116:117]
    v_lshlrev_b32 v212, 16, v58
    v_and_b32 v213, 0xffff0000, v58
    v_pk_add_f32 v[112:113], v[112:113], v[212:213]
    v_pk_fma_f32 v[116:117], v[212:213], v[212:213], v[116:117]
    v_lshlrev_b32 v214, 16, v59
    v_and_b32 v215, 0xffff0000, v59
    v_pk_add_f32 v[112:113], v[112:113], v[214:215]
    v_pk_fma_f32 v[116:117], v[214:215], v[214:215], v[116:117]
    s_waitcnt lgkmcnt(2)
    v_lshlrev_b32 v216, 16, v60
    v_and_b32 v217, 0xffff0000, v60
    v_pk_add_f32 v[114:115], v[114:115], v[216:217]
    v_pk_fma_f32 v[118:119], v[216:217], v[216:217], v[118:119]
    v_lshlrev_b32 v218, 16, v61
    v_and_b32 v219, 0xffff0000, v61
    v_pk_add_f32 v[114:115], v[114:115], v[218:219]
    v_pk_fma_f32 v[118:119], v[218:219], v[218:219], v[118:119]
    v_lshlrev_b32 v220, 16, v62
    v_and_b32 v221, 0xffff0000, v62
    v_pk_add_f32 v[114:115], v[114:115], v[220:221]
    v_pk_fma_f32 v[118:119], v[220:221], v[220:221], v[118:119]
    v_lshlrev_b32 v222, 16, v63
    v_and_b32 v223, 0xffff0000, v63
    v_pk_add_f32 v[114:115], v[114:115], v[222:223]
    v_pk_fma_f32 v[118:119], v[222:223], v[222:223], v[118:119]
    s_waitcnt lgkmcnt(1)
    v_lshlrev_b32 v224, 16, v64
    v_and_b32 v225, 0xffff0000, v64
    v_pk_add_f32 v[112:113], v[112:113], v[224:225]
    v_pk_fma_f32 v[116:117], v[224:225], v[224:225], v[116:117]
    v_lshlrev_b32 v226, 16, v65
    v_and_b32 v227, 0xffff0000, v65
    v_pk_add_f32 v[112:113], v[112:113], v[226:227]
    v_pk_fma_f32 v[116:117], v[226:227], v[226:227], v[116:117]
    v_lshlrev_b32 v228, 16, v66
    v_and_b32 v229, 0xffff0000, v66
    v_pk_add_f32 v[112:113], v[112:113], v[228:229]
    v_pk_fma_f32 v[116:117], v[228:229], v[228:229], v[116:117]
    v_lshlrev_b32 v230, 16, v67
    v_and_b32 v231, 0xffff0000, v67
    v_pk_add_f32 v[112:113], v[112:113], v[230:231]
    v_pk_fma_f32 v[116:117], v[230:231], v[230:231], v[116:117]
    s_waitcnt lgkmcnt(0)
    v_lshlrev_b32 v232, 16, v68
    v_and_b32 v233, 0xffff0000, v68
    v_pk_add_f32 v[114:115], v[114:115], v[232:233]
    v_pk_fma_f32 v[118:119], v[232:233], v[232:233], v[118:119]
    v_lshlrev_b32 v234, 16, v69
    v_and_b32 v235, 0xffff0000, v69
    v_pk_add_f32 v[114:115], v[114:115], v[234:235]
    v_pk_fma_f32 v[118:119], v[234:235], v[234:235], v[118:119]
    v_lshlrev_b32 v236, 16, v70
    v_and_b32 v237, 0xffff0000, v70
    v_pk_add_f32 v[114:115], v[114:115], v[236:237]
    v_pk_fma_f32 v[118:119], v[236:237], v[236:237], v[118:119]
    v_lshlrev_b32 v238, 16, v71
    v_and_b32 v239, 0xffff0000, v71
    v_pk_add_f32 v[114:115], v[114:115], v[238:239]
    v_pk_fma_f32 v[118:119], v[238:239], v[238:239], v[118:119]
    v_add_f32 v112, v112, v113
    v_add_f32 v113, v114, v115
    v_add_f32 v114, v116, v117
    v_add_f32 v115, v118, v119
    v_mov_b32 v121, v112
    s_nop 1
    v_permlane32_swap_b32 v112, v121
    v_add_f32 v112, v112, v121
    v_mov_b32 v121, v112
    s_nop 1
    v_permlane16_swap_b32 v112, v121
    v_add_f32 v112, v112, v121
    v_mov_b32 v122, v113
    s_nop 1
    v_permlane32_swap_b32 v113, v122
    v_add_f32 v113, v113, v122
    v_mov_b32 v122, v113
    s_nop 1
    v_permlane16_swap_b32 v113, v122
    v_add_f32 v113, v113, v122
    v_mov_b32 v123, v114
    s_nop 1
    v_permlane32_swap_b32 v114, v123
    v_add_f32 v114, v114, v123
    v_mov_b32 v123, v114
    s_nop 1
    v_permlane16_swap_b32 v114, v123
    v_add_f32 v114, v114, v123
    v_mov_b32 v124, v115
    s_nop 1
    v_permlane32_swap_b32 v115, v124
    v_add_f32 v115, v115, v124
    v_mov_b32 v124, v115
    s_nop 1
    v_permlane16_swap_b32 v115, v124
    v_add_f32 v115, v115, v124
    ds_write_b128 v13, v[112:115]
    s_waitcnt lgkmcnt(0)
    s_barrier
    ds_read_b128 v[116:119], v14
    s_add_u32 m0, s35, 33280
    s_add_u32 s38, s39, 262144
    buffer_load_dwordx4 v4, s[40:43], s38 offen offset:0 lds
    buffer_load_dwordx4 v5, s[40:43], s38 offen offset:1024 lds
    buffer_load_dwordx4 v6, s[40:43], s38 offen offset:2048 lds
    buffer_load_dwordx4 v7, s[40:43], s38 offen offset:3072 lds
    s_add_u32 m0, s35, 49920
    s_add_u32 s38, s39, 2097664
    buffer_load_dwordx4 v4, s[40:43], s38 offen offset:0 lds
    buffer_load_dwordx4 v5, s[40:43], s38 offen offset:1024 lds
    buffer_load_dwordx4 v6, s[40:43], s38 offen offset:2048 lds
    buffer_load_dwordx4 v7, s[40:43], s38 offen offset:3072 lds
    s_waitcnt lgkmcnt(0)
    v_add_f32 v112, v112, v116
    v_add_f32 v114, v114, v118
    v_mul_f32 v120, 991054117, v112
    v_mul_f32 v122, 991054117, v114
    v_fma_f32 v122, -v120, v120, v122
    v_max_f32 v122, 0, v122
    v_add_f32 v122, 925353388, v122
    v_rsq_f32 v122, v122
    s_nop 0
    v_mul_f32 v120, -v120, v122
    v_add_f32 v113, v113, v117
    v_add_f32 v115, v115, v119
    v_mul_f32 v124, 991054117, v113
    v_mul_f32 v126, 991054117, v115
    v_fma_f32 v126, -v124, v124, v126
    v_max_f32 v126, 0, v126
    v_add_f32 v126, 925353388, v126
    v_rsq_f32 v126, v126
    s_nop 0
    v_mul_f32 v124, -v124, v126
    v_pk_fma_f32 v[128:129], v[128:129], v[122:123], v[120:121] op_sel_hi:[1,0,0]
    v_pk_fma_f32 v[130:131], v[130:131], v[122:123], v[120:121] op_sel_hi:[1,0,0]
    v_pk_fma_f32 v[132:133], v[132:133], v[122:123], v[120:121] op_sel_hi:[1,0,0]
    v_pk_fma_f32 v[134:135], v[134:135], v[122:123], v[120:121] op_sel_hi:[1,0,0]
    v_pk_fma_f32 v[136:137], v[136:137], v[126:127], v[124:125] op_sel_hi:[1,0,0]
    v_pk_fma_f32 v[138:139], v[138:139], v[126:127], v[124:125] op_sel_hi:[1,0,0]
    v_pk_fma_f32 v[140:141], v[140:141], v[126:127], v[124:125] op_sel_hi:[1,0,0]
    v_pk_fma_f32 v[142:143], v[142:143], v[126:127], v[124:125] op_sel_hi:[1,0,0]
    v_pk_fma_f32 v[144:145], v[144:145], v[122:123], v[120:121] op_sel_hi:[1,0,0]
    v_pk_fma_f32 v[146:147], v[146:147], v[122:123], v[120:121] op_sel_hi:[1,0,0]
    v_pk_fma_f32 v[148:149], v[148:149], v[122:123], v[120:121] op_sel_hi:[1,0,0]
    v_pk_fma_f32 v[150:151], v[150:151], v[122:123], v[120:121] op_sel_hi:[1,0,0]
    v_pk_fma_f32 v[152:153], v[152:153], v[126:127], v[124:125] op_sel_hi:[1,0,0]
    v_pk_fma_f32 v[154:155], v[154:155], v[126:127], v[124:125] op_sel_hi:[1,0,0]
    v_pk_fma_f32 v[156:157], v[156:157], v[126:127], v[124:125] op_sel_hi:[1,0,0]
    v_pk_fma_f32 v[158:159], v[158:159], v[126:127], v[124:125] op_sel_hi:[1,0,0]
    v_pk_fma_f32 v[160:161], v[160:161], v[122:123], v[120:121] op_sel_hi:[1,0,0]
    v_pk_fma_f32 v[162:163], v[162:163], v[122:123], v[120:121] op_sel_hi:[1,0,0]
    v_pk_fma_f32 v[164:165], v[164:165], v[122:123], v[120:121] op_sel_hi:[1,0,0]
    v_pk_fma_f32 v[166:167], v[166:167], v[122:123], v[120:121] op_sel_hi:[1,0,0]
    v_pk_fma_f32 v[168:169], v[168:169], v[126:127], v[124:125] op_sel_hi:[1,0,0]
    v_pk_fma_f32 v[170:171], v[170:171], v[126:127], v[124:125] op_sel_hi:[1,0,0]
    v_pk_fma_f32 v[172:173], v[172:173], v[126:127], v[124:125] op_sel_hi:[1,0,0]
    v_pk_fma_f32 v[174:175], v[174:175], v[126:127], v[124:125] op_sel_hi:[1,0,0]
    v_pk_fma_f32 v[176:177], v[176:177], v[122:123], v[120:121] op_sel_hi:[1,0,0]
    v_pk_fma_f32 v[178:179], v[178:179], v[122:123], v[120:121] op_sel_hi:[1,0,0]
    v_pk_fma_f32 v[180:181], v[180:181], v[122:123], v[120:121] op_sel_hi:[1,0,0]
    v_pk_fma_f32 v[182:183], v[182:183], v[122:123], v[120:121] op_sel_hi:[1,0,0]
    v_pk_fma_f32 v[184:185], v[184:185], v[126:127], v[124:125] op_sel_hi:[1,0,0]
    v_pk_fma_f32 v[186:187], v[186:187], v[126:127], v[124:125] op_sel_hi:[1,0,0]
    v_pk_fma_f32 v[188:189], v[188:189], v[126:127], v[124:125] op_sel_hi:[1,0,0]
    v_pk_fma_f32 v[190:191], v[190:191], v[126:127], v[124:125] op_sel_hi:[1,0,0]
    v_pk_fma_f32 v[192:193], v[192:193], v[122:123], v[120:121] op_sel_hi:[1,0,0]
    v_pk_fma_f32 v[194:195], v[194:195], v[122:123], v[120:121] op_sel_hi:[1,0,0]
    v_pk_fma_f32 v[196:197], v[196:197], v[122:123], v[120:121] op_sel_hi:[1,0,0]
    v_pk_fma_f32 v[198:199], v[198:199], v[122:123], v[120:121] op_sel_hi:[1,0,0]
    v_pk_fma_f32 v[200:201], v[200:201], v[126:127], v[124:125] op_sel_hi:[1,0,0]
    v_pk_fma_f32 v[202:203], v[202:203], v[126:127], v[124:125] op_sel_hi:[1,0,0]
    v_pk_fma_f32 v[204:205], v[204:205], v[126:127], v[124:125] op_sel_hi:[1,0,0]
    v_pk_fma_f32 v[206:207], v[206:207], v[126:127], v[124:125] op_sel_hi:[1,0,0]
    v_pk_fma_f32 v[208:209], v[208:209], v[122:123], v[120:121] op_sel_hi:[1,0,0]
    v_pk_fma_f32 v[210:211], v[210:211], v[122:123], v[120:121] op_sel_hi:[1,0,0]
    v_pk_fma_f32 v[212:213], v[212:213], v[122:123], v[120:121] op_sel_hi:[1,0,0]
    v_pk_fma_f32 v[214:215], v[214:215], v[122:123], v[120:121] op_sel_hi:[1,0,0]
    v_pk_fma_f32 v[216:217], v[216:217], v[126:127], v[124:125] op_sel_hi:[1,0,0]
    v_pk_fma_f32 v[218:219], v[218:219], v[126:127], v[124:125] op_sel_hi:[1,0,0]
    v_pk_fma_f32 v[220:221], v[220:221], v[126:127], v[124:125] op_sel_hi:[1,0,0]
    v_pk_fma_f32 v[222:223], v[222:223], v[126:127], v[124:125] op_sel_hi:[1,0,0]
    v_pk_fma_f32 v[224:225], v[224:225], v[122:123], v[120:121] op_sel_hi:[1,0,0]
    v_pk_fma_f32 v[226:227], v[226:227], v[122:123], v[120:121] op_sel_hi:[1,0,0]
    v_pk_fma_f32 v[228:229], v[228:229], v[122:123], v[120:121] op_sel_hi:[1,0,0]
    v_pk_fma_f32 v[230:231], v[230:231], v[122:123], v[120:121] op_sel_hi:[1,0,0]
    v_pk_fma_f32 v[232:233], v[232:233], v[126:127], v[124:125] op_sel_hi:[1,0,0]
    v_pk_fma_f32 v[234:235], v[234:235], v[126:127], v[124:125] op_sel_hi:[1,0,0]
    v_pk_fma_f32 v[236:237], v[236:237], v[126:127], v[124:125] op_sel_hi:[1,0,0]
    v_pk_fma_f32 v[238:239], v[238:239], v[126:127], v[124:125] op_sel_hi:[1,0,0]
    s_add_u32 m0, s35, 66560
    s_add_u32 s38, s39, 524288
    buffer_load_dwordx4 v4, s[40:43], s38 offen offset:0 lds
    buffer_load_dwordx4 v5, s[40:43], s38 offen offset:1024 lds
    buffer_load_dwordx4 v6, s[40:43], s38 offen offset:2048 lds
    buffer_load_dwordx4 v7, s[40:43], s38 offen offset:3072 lds
    s_add_u32 m0, s35, 83200
    s_add_u32 s38, s39, 2359808
    buffer_load_dwordx4 v4, s[40:43], s38 offen offset:0 lds
    buffer_load_dwordx4 v5, s[40:43], s38 offen offset:1024 lds
    buffer_load_dwordx4 v6, s[40:43], s38 offen offset:2048 lds
    buffer_load_dwordx4 v7, s[40:43], s38 offen offset:3072 lds
    s_add_u32 m0, s35, 99840
    s_add_u32 s38, s39, 786432
    buffer_load_dwordx4 v4, s[40:43], s38 offen offset:0 lds
    buffer_load_dwordx4 v5, s[40:43], s38 offen offset:1024 lds
    buffer_load_dwordx4 v6, s[40:43], s38 offen offset:2048 lds
    buffer_load_dwordx4 v7, s[40:43], s38 offen offset:3072 lds
    s_add_u32 m0, s35, 116480
    s_add_u32 s38, s39, 2621952
    buffer_load_dwordx4 v4, s[40:43], s38 offen offset:0 lds
    buffer_load_dwordx4 v5, s[40:43], s38 offen offset:1024 lds
    buffer_load_dwordx4 v6, s[40:43], s38 offen offset:2048 lds
    buffer_load_dwordx4 v7, s[40:43], s38 offen offset:3072 lds
    s_mov_b32 s44, s10
    s_mov_b32 s45, s11
    s_mov_b32 s46, 3670016
    s_mov_b32 s47, 0x20000
    s_lshl_b32 s14, s29, 20
    s_add_u32 s16, s4, s14
    s_addc_u32 s17, s5, 0
    s_mov_b32 s18, 0x100000
    s_mov_b32 s19, 0x20000
    s_add_u32 s20, s6, s14
    s_addc_u32 s21, s7, 0
    s_mov_b32 s22, 0x100000
    s_mov_b32 s23, 0x20000
    s_mov_b32 s32, 0
    s_mov_b32 s33, 0
    s_mov_b32 s37, 1602224128
    s_lshl_b32 s15, s28, 3
    s_movk_i32 s31, 0x493
    s_and_b32 s12, s28, 1
    s_mul_i32 s13, s28, 7
    s_add_u32 s52, s13, s12
    s_add_u32 s52, s52, 0
    s_add_u32 s53, s13, s12
    s_add_u32 s53, s53, 1
    s_add_u32 s54, s13, s12
    s_add_u32 s54, s54, 2
    s_add_u32 s55, s13, s12
    s_add_u32 s55, s55, 3
    s_add_u32 s56, s13, s12
    s_add_u32 s56, s56, 4
    s_add_u32 s57, s13, s12
    s_add_u32 s57, s57, 5
    s_mul_i32 s58, s12, 6
    s_sub_u32 s58, s13, s58
    s_add_u32 s58, s58, 6
    v_min_u32 v1, 880, v12
    s_mul_i32 s3, s28, 1792
    s_add_u32 s3, s3, 16384
    s_add_u32 s50, s100, 1
    s_add_u32 s51, s101, 1
    s_and_b32 s51, s51, 0xffff
    s_mul_i32 s36, s28, 896
    s_add_u32 s36, s36, 149760
    v_lshrrev_b32 v2, 1, v1
    v_add_u32 v2, s36, v2
    s_mov_b32 s59, 0x100000
L_mpadaLN_cond__gqa_block_cached__mixer_gmlp__prompt_kernel:
    buffer_load_dwordx4 v[120:123], v1, s[24:27], s3 offen sc1
    buffer_load_dwordx4 v[124:127], v1, s[24:27], s3 offen offset:896 sc1
    s_waitcnt vmcnt(0)
    v_xor_b32 v112, s51, v120
    v_xor_b32 v113, s51, v122
    v_xor_b32 v114, s51, v124
    v_xor_b32 v115, s51, v126
    v_or3_b32 v116, v112, v113, v114
    v_or_b32 v116, v116, v115
    v_and_b32 v116, 0xffff, v116
    v_xor_b32 v117, s50, v121
    v_xor_b32 v118, s50, v123
    v_or3_b32 v116, v116, v117, v118
    v_xor_b32 v117, s50, v125
    v_xor_b32 v118, s50, v127
    v_or3_b32 v116, v116, v117, v118
    v_cmp_ne_u32 vcc, 0, v116
    s_cbranch_vccz L_mqadaLN_cond__gqa_block_cached__mixer_gmlp__prompt_kernel
    s_sleep 2
    s_sub_u32 s59, s59, 1
    s_cmp_lg_u32 s59, 0
    s_cbranch_scc1 L_mpadaLN_cond__gqa_block_cached__mixer_gmlp__prompt_kernel
L_mqadaLN_cond__gqa_block_cached__mixer_gmlp__prompt_kernel:
    v_mul_f32 v112, 1035512379, v112
    v_mul_f32 v113, 1035512379, v113
    v_mul_f32 v114, 1035512379, v114
    v_mul_f32 v115, 1035512379, v115
    ds_write_b64 v2, v[112:113]
    ds_write_b64 v2, v[114:115] offset:448
    s_waitcnt lgkmcnt(0)
    s_barrier
    ds_read_b128 v[72:75], v3 offset:1792
    ds_read_b128 v[76:79], v3 offset:1808
    ds_read_b128 v[80:83], v3 offset:0
    ds_read_b128 v[84:87], v3 offset:16
    ds_read_b128 v[88:91], v3 offset:1920
    ds_read_b128 v[92:95], v3 offset:1936
    ds_read_b128 v[96:99], v3 offset:128
    ds_read_b128 v[100:103], v3 offset:144
    ds_read_b128 v[104:107], v3 offset:2048
    ds_read_b128 v[108:111], v3 offset:2064
    ds_read_b128 v[112:115], v3 offset:256
    ds_read_b128 v[116:119], v3 offset:272
    s_waitcnt lgkmcnt(9)
    v_pk_fma_f32 v[128:129], v[128:129], v[72:73], v[80:81]
    v_cvt_pk_bf16_f32 v16, v128, v129
    v_pk_fma_f32 v[130:131], v[130:131], v[74:75], v[82:83]
    v_cvt_pk_bf16_f32 v17, v130, v131
    s_waitcnt lgkmcnt(8)
    v_pk_fma_f32 v[132:133], v[132:133], v[76:77], v[84:85]
    v_cvt_pk_bf16_f32 v18, v132, v133
    v_pk_fma_f32 v[134:135], v[134:135], v[78:79], v[86:87]
    v_cvt_pk_bf16_f32 v19, v134, v135
    v_pk_fma_f32 v[136:137], v[136:137], v[72:73], v[80:81]
    v_cvt_pk_bf16_f32 v20, v136, v137
    v_pk_fma_f32 v[138:139], v[138:139], v[74:75], v[82:83]
    v_cvt_pk_bf16_f32 v21, v138, v139
    v_pk_fma_f32 v[140:141], v[140:141], v[76:77], v[84:85]
    v_cvt_pk_bf16_f32 v22, v140, v141
    v_pk_fma_f32 v[142:143], v[142:143], v[78:79], v[86:87]
    v_cvt_pk_bf16_f32 v23, v142, v143
    ds_read_b128 v[72:75], v3 offset:2176
    ds_read_b128 v[76:79], v3 offset:2192
    ds_read_b128 v[80:83], v3 offset:384
    ds_read_b128 v[84:87], v3 offset:400
    s_waitcnt lgkmcnt(9)
    v_pk_fma_f32 v[144:145], v[144:145], v[88:89], v[96:97]
    v_cvt_pk_bf16_f32 v24, v144, v145
    v_pk_fma_f32 v[146:147], v[146:147], v[90:91], v[98:99]
    v_cvt_pk_bf16_f32 v25, v146, v147
    s_waitcnt lgkmcnt(8)
    v_pk_fma_f32 v[148:149], v[148:149], v[92:93], v[100:101]
    v_cvt_pk_bf16_f32 v26, v148, v149
    v_pk_fma_f32 v[150:151], v[150:151], v[94:95], v[102:103]
    v_cvt_pk_bf16_f32 v27, v150, v151
    v_pk_fma_f32 v[152:153], v[152:153], v[88:89], v[96:97]
    v_cvt_pk_bf16_f32 v28, v152, v153
    v_pk_fma_f32 v[154:155], v[154:155], v[90:91], v[98:99]
    v_cvt_pk_bf16_f32 v29, v154, v155
    v_pk_fma_f32 v[156:157], v[156:157], v[92:93], v[100:101]
    v_cvt_pk_bf16_f32 v30, v156, v157
    v_pk_fma_f32 v[158:159], v[158:159], v[94:95], v[102:103]
    v_cvt_pk_bf16_f32 v31, v158, v159
    ds_read_b128 v[88:91], v3 offset:2304
    ds_read_b128 v[92:95], v3 offset:2320
    ds_read_b128 v[96:99], v3 offset:512
    ds_read_b128 v[100:103], v3 offset:528
    s_waitcnt lgkmcnt(9)
    v_pk_fma_f32 v[160:161], v[160:161], v[104:105], v[112:113]
    v_cvt_pk_bf16_f32 v32, v160, v161
    v_pk_fma_f32 v[162:163], v[162:163], v[106:107], v[114:115]
    v_cvt_pk_bf16_f32 v33, v162, v163
    s_waitcnt lgkmcnt(8)
    v_pk_fma_f32 v[164:165], v[164:165], v[108:109], v[116:117]
    v_cvt_pk_bf16_f32 v34, v164, v165
    v_pk_fma_f32 v[166:167], v[166:167], v[110:111], v[118:119]
    v_cvt_pk_bf16_f32 v35, v166, v167
    v_pk_fma_f32 v[168:169], v[168:169], v[104:105], v[112:113]
    v_cvt_pk_bf16_f32 v36, v168, v169
    v_pk_fma_f32 v[170:171], v[170:171], v[106:107], v[114:115]
    v_cvt_pk_bf16_f32 v37, v170, v171
    v_pk_fma_f32 v[172:173], v[172:173], v[108:109], v[116:117]
    v_cvt_pk_bf16_f32 v38, v172, v173
    v_pk_fma_f32 v[174:175], v[174:175], v[110:111], v[118:119]
    v_cvt_pk_bf16_f32 v39, v174, v175
    ds_read_b128 v[104:107], v3 offset:2432
    ds_read_b128 v[108:111], v3 offset:2448
    ds_read_b128 v[112:115], v3 offset:640
    ds_read_b128 v[116:119], v3 offset:656
    s_waitcnt lgkmcnt(9)
    v_pk_fma_f32 v[176:177], v[176:177], v[72:73], v[80:81]
    v_cvt_pk_bf16_f32 v40, v176, v177
    v_pk_fma_f32 v[178:179], v[178:179], v[74:75], v[82:83]
    v_cvt_pk_bf16_f32 v41, v178, v179
    s_waitcnt lgkmcnt(8)
    v_pk_fma_f32 v[180:181], v[180:181], v[76:77], v[84:85]
    v_cvt_pk_bf16_f32 v42, v180, v181
    v_pk_fma_f32 v[182:183], v[182:183], v[78:79], v[86:87]
    v_cvt_pk_bf16_f32 v43, v182, v183
    v_pk_fma_f32 v[184:185], v[184:185], v[72:73], v[80:81]
    v_cvt_pk_bf16_f32 v44, v184, v185
    v_pk_fma_f32 v[186:187], v[186:187], v[74:75], v[82:83]
    v_cvt_pk_bf16_f32 v45, v186, v187
    v_pk_fma_f32 v[188:189], v[188:189], v[76:77], v[84:85]
    v_cvt_pk_bf16_f32 v46, v188, v189
    v_pk_fma_f32 v[190:191], v[190:191], v[78:79], v[86:87]
    v_cvt_pk_bf16_f32 v47, v190, v191
    ds_read_b128 v[72:75], v3 offset:2560
    ds_read_b128 v[76:79], v3 offset:2576
    ds_read_b128 v[80:83], v3 offset:768
    ds_read_b128 v[84:87], v3 offset:784
    s_waitcnt lgkmcnt(9)
    v_pk_fma_f32 v[192:193], v[192:193], v[88:89], v[96:97]
    v_cvt_pk_bf16_f32 v48, v192, v193
    v_pk_fma_f32 v[194:195], v[194:195], v[90:91], v[98:99]
    v_cvt_pk_bf16_f32 v49, v194, v195
    s_waitcnt lgkmcnt(8)
    v_pk_fma_f32 v[196:197], v[196:197], v[92:93], v[100:101]
    v_cvt_pk_bf16_f32 v50, v196, v197
    v_pk_fma_f32 v[198:199], v[198:199], v[94:95], v[102:103]
    v_cvt_pk_bf16_f32 v51, v198, v199
    v_pk_fma_f32 v[200:201], v[200:201], v[88:89], v[96:97]
    v_cvt_pk_bf16_f32 v52, v200, v201
    v_pk_fma_f32 v[202:203], v[202:203], v[90:91], v[98:99]
    v_cvt_pk_bf16_f32 v53, v202, v203
    v_pk_fma_f32 v[204:205], v[204:205], v[92:93], v[100:101]
    v_cvt_pk_bf16_f32 v54, v204, v205
    v_pk_fma_f32 v[206:207], v[206:207], v[94:95], v[102:103]
    v_cvt_pk_bf16_f32 v55, v206, v207
    s_waitcnt lgkmcnt(5)
    v_pk_fma_f32 v[208:209], v[208:209], v[104:105], v[112:113]
    v_cvt_pk_bf16_f32 v56, v208, v209
    v_pk_fma_f32 v[210:211], v[210:211], v[106:107], v[114:115]
    v_cvt_pk_bf16_f32 v57, v210, v211
    s_waitcnt lgkmcnt(4)
    v_pk_fma_f32 v[212:213], v[212:213], v[108:109], v[116:117]
    v_cvt_pk_bf16_f32 v58, v212, v213
    v_pk_fma_f32 v[214:215], v[214:215], v[110:111], v[118:119]
    v_cvt_pk_bf16_f32 v59, v214, v215
    v_pk_fma_f32 v[216:217], v[216:217], v[104:105], v[112:113]
    v_cvt_pk_bf16_f32 v60, v216, v217
    v_pk_fma_f32 v[218:219], v[218:219], v[106:107], v[114:115]
    v_cvt_pk_bf16_f32 v61, v218, v219
    v_pk_fma_f32 v[220:221], v[220:221], v[108:109], v[116:117]
    v_cvt_pk_bf16_f32 v62, v220, v221
    v_pk_fma_f32 v[222:223], v[222:223], v[110:111], v[118:119]
    v_cvt_pk_bf16_f32 v63, v222, v223
    s_waitcnt lgkmcnt(1)
    v_pk_fma_f32 v[224:225], v[224:225], v[72:73], v[80:81]
    v_cvt_pk_bf16_f32 v64, v224, v225
    v_pk_fma_f32 v[226:227], v[226:227], v[74:75], v[82:83]
    v_cvt_pk_bf16_f32 v65, v226, v227
    s_waitcnt lgkmcnt(0)
    v_pk_fma_f32 v[228:229], v[228:229], v[76:77], v[84:85]
    v_cvt_pk_bf16_f32 v66, v228, v229
    v_pk_fma_f32 v[230:231], v[230:231], v[78:79], v[86:87]
    v_cvt_pk_bf16_f32 v67, v230, v231
    v_pk_fma_f32 v[232:233], v[232:233], v[72:73], v[80:81]
    v_cvt_pk_bf16_f32 v68, v232, v233
    v_pk_fma_f32 v[234:235], v[234:235], v[74:75], v[82:83]
    v_cvt_pk_bf16_f32 v69, v234, v235
    v_pk_fma_f32 v[236:237], v[236:237], v[76:77], v[84:85]
    v_cvt_pk_bf16_f32 v70, v236, v237
    v_pk_fma_f32 v[238:239], v[238:239], v[78:79], v[86:87]
    v_cvt_pk_bf16_f32 v71, v238, v239
    ds_read_b64_tr_b16 a[64:65], v8 offset:0
    ds_read_b64_tr_b16 a[66:67], v8 offset:2048
    ds_read_b64_tr_b16 a[68:69], v9 offset:0
    ds_read_b64_tr_b16 a[70:71], v9 offset:2048
    ds_read_b64_tr_b16 a[72:73], v8 offset:64
    ds_read_b64_tr_b16 a[74:75], v8 offset:2112
    ds_read_b64_tr_b16 a[76:77], v9 offset:64
    ds_read_b64_tr_b16 a[78:79], v9 offset:2112
    ds_read_b64_tr_b16 a[80:81], v8 offset:128
    ds_read_b64_tr_b16 a[82:83], v8 offset:2176
    ds_read_b64_tr_b16 a[84:85], v9 offset:128
    ds_read_b64_tr_b16 a[86:87], v9 offset:2176
    ds_read_b64_tr_b16 a[88:89], v8 offset:192
    ds_read_b64_tr_b16 a[90:91], v8 offset:2240
    ds_read_b64_tr_b16 a[92:93], v9 offset:192
    ds_read_b64_tr_b16 a[94:95], v9 offset:2240
    ds_read_b64_tr_b16 a[96:97], v8 offset:256
    ds_read_b64_tr_b16 a[98:99], v8 offset:2304
    s_waitcnt lgkmcnt(15)
    v_mfma_f32_16x16x32_bf16 v[128:131], a[64:67], v[16:19], 0
    ds_read_b64_tr_b16 a[100:101], v9 offset:256
    v_mfma_f32_16x16x32_bf16 v[132:135], a[64:67], v[20:23], 0
    ds_read_b64_tr_b16 a[102:103], v9 offset:2304
    s_waitcnt lgkmcnt(15)
    v_mfma_f32_16x16x32_bf16 v[136:139], a[68:71], v[16:19], 0
    ds_read_b64_tr_b16 a[104:105], v8 offset:320
    v_mfma_f32_16x16x32_bf16 v[140:143], a[68:71], v[20:23], 0
    s_waitcnt lgkmcnt(13)
    ds_read_b64_tr_b16 a[106:107], v8 offset:2368
    v_mfma_f32_16x16x32_bf16 v[144:147], a[72:75], v[16:19], 0
    ds_read_b64_tr_b16 a[108:109], v9 offset:320
    v_mfma_f32_16x16x32_bf16 v[148:151], a[72:75], v[20:23], 0
    ds_read_b64_tr_b16 a[110:111], v9 offset:2368
    v_mfma_f32_16x16x32_bf16 v[152:155], a[76:79], v[16:19], 0
    ds_read_b64_tr_b16 a[112:113], v8 offset:384
    v_mfma_f32_16x16x32_bf16 v[156:159], a[76:79], v[20:23], 0
    s_waitcnt lgkmcnt(13)
    ds_read_b64_tr_b16 a[114:115], v8 offset:2432
    v_mfma_f32_16x16x32_bf16 v[160:163], a[80:83], v[16:19], 0
    ds_read_b64_tr_b16 a[116:117], v9 offset:384
    v_mfma_f32_16x16x32_bf16 v[164:167], a[80:83], v[20:23], 0
    ds_read_b64_tr_b16 a[118:119], v9 offset:2432
    v_mfma_f32_16x16x32_bf16 v[168:171], a[84:87], v[16:19], 0
    ds_read_b64_tr_b16 a[120:121], v8 offset:448
    v_mfma_f32_16x16x32_bf16 v[172:175], a[84:87], v[20:23], 0
    s_waitcnt lgkmcnt(13)
    ds_read_b64_tr_b16 a[122:123], v8 offset:2496
    v_mfma_f32_16x16x32_bf16 v[176:179], a[88:91], v[16:19], 0
    ds_read_b64_tr_b16 a[124:125], v9 offset:448
    v_mfma_f32_16x16x32_bf16 v[180:183], a[88:91], v[20:23], 0
    s_barrier
    v_mfma_f32_16x16x32_bf16 v[184:187], a[92:95], v[16:19], 0
    ds_write_b128 v13, v[16:19] offset:0
    v_mfma_f32_16x16x32_bf16 v[188:191], a[92:95], v[20:23], 0
    s_waitcnt lgkmcnt(12)
    ds_read_b64_tr_b16 a[126:127], v9 offset:2496
    ds_read_b64_tr_b16 a[64:65], v8 offset:33280
    v_mfma_f32_16x16x32_bf16 v[192:195], a[96:99], v[16:19], 0
    ds_read_b64_tr_b16 a[66:67], v8 offset:35328
    ds_read_b64_tr_b16 a[68:69], v9 offset:33280
    v_mfma_f32_16x16x32_bf16 v[196:199], a[96:99], v[20:23], 0
    ds_read_b64_tr_b16 a[70:71], v9 offset:35328
    v_mfma_f32_16x16x32_bf16 v[200:203], a[100:103], v[16:19], 0
    ds_read_b64_tr_b16 a[72:73], v8 offset:33344
    v_mfma_f32_16x16x32_bf16 v[204:207], a[100:103], v[20:23], 0
    s_waitcnt lgkmcnt(14)
    ds_read_b64_tr_b16 a[74:75], v8 offset:35392
    v_mfma_f32_16x16x32_bf16 v[208:211], a[104:107], v[16:19], 0
    ds_write_b128 v13, v[20:23] offset:1024
    v_mfma_f32_16x16x32_bf16 v[212:215], a[104:107], v[20:23], 0
    ds_read_b64_tr_b16 a[76:77], v9 offset:33344
    ds_read_b64_tr_b16 a[78:79], v9 offset:35392
    v_mfma_f32_16x16x32_bf16 v[216:219], a[108:111], v[16:19], 0
    ds_read_b64_tr_b16 a[80:81], v8 offset:33408
    v_mfma_f32_16x16x32_bf16 v[220:223], a[108:111], v[20:23], 0
    s_waitcnt lgkmcnt(15)
    ds_read_b64_tr_b16 a[82:83], v8 offset:35456
    v_mfma_f32_16x16x32_bf16 v[224:227], a[112:115], v[16:19], 0
    ds_read_b64_tr_b16 a[84:85], v9 offset:33408
    v_mfma_f32_16x16x32_bf16 v[228:231], a[112:115], v[20:23], 0
    ds_read_b64_tr_b16 a[86:87], v9 offset:35456
    v_mfma_f32_16x16x32_bf16 v[232:235], a[116:119], v[16:19], 0
    ds_read_b64_tr_b16 a[88:89], v8 offset:33472
    v_mfma_f32_16x16x32_bf16 v[236:239], a[116:119], v[20:23], 0
    s_waitcnt lgkmcnt(14)
    ds_write_b128 v13, v[24:27] offset:2048
    v_mfma_f32_16x16x32_bf16 v[240:243], a[120:123], v[16:19], 0
    ds_read_b64_tr_b16 a[90:91], v8 offset:35520
    ds_read_b64_tr_b16 a[92:93], v9 offset:33472
    v_mfma_f32_16x16x32_bf16 v[244:247], a[120:123], v[20:23], 0
    ds_read_b64_tr_b16 a[94:95], v9 offset:35520
    v_mfma_f32_16x16x32_bf16 v[248:251], a[124:127], v[16:19], 0
    ds_read_b64_tr_b16 a[96:97], v8 offset:33536
    v_mfma_f32_16x16x32_bf16 v[252:255], a[124:127], v[20:23], 0
    s_waitcnt lgkmcnt(15)
    ds_read_b64_tr_b16 a[98:99], v8 offset:35584
    v_mfma_f32_16x16x32_bf16 v[128:131], a[64:67], v[24:27], v[128:131]
    ds_read_b64_tr_b16 a[100:101], v9 offset:33536
    v_mfma_f32_16x16x32_bf16 v[132:135], a[64:67], v[28:31], v[132:135]
    ds_read_b64_tr_b16 a[102:103], v9 offset:35584
    v_mfma_f32_16x16x32_bf16 v[136:139], a[68:71], v[24:27], v[136:139]
    ds_write_b128 v13, v[28:31] offset:3072
    v_mfma_f32_16x16x32_bf16 v[140:143], a[68:71], v[28:31], v[140:143]
    s_waitcnt lgkmcnt(14)
    ds_read_b64_tr_b16 a[104:105], v8 offset:33600
    ds_read_b64_tr_b16 a[106:107], v8 offset:35648
    v_mfma_f32_16x16x32_bf16 v[144:147], a[72:75], v[24:27], v[144:147]
    ds_read_b64_tr_b16 a[108:109], v9 offset:33600
    v_mfma_f32_16x16x32_bf16 v[148:151], a[72:75], v[28:31], v[148:151]
    ds_read_b64_tr_b16 a[110:111], v9 offset:35648
    v_mfma_f32_16x16x32_bf16 v[152:155], a[76:79], v[24:27], v[152:155]
    ds_read_b64_tr_b16 a[112:113], v8 offset:33664
    v_mfma_f32_16x16x32_bf16 v[156:159], a[76:79], v[28:31], v[156:159]
    s_waitcnt lgkmcnt(15)
    ds_read_b64_tr_b16 a[114:115], v8 offset:35712
    v_mfma_f32_16x16x32_bf16 v[160:163], a[80:83], v[24:27], v[160:163]
    ds_read_b64_tr_b16 a[116:117], v9 offset:33664
    v_mfma_f32_16x16x32_bf16 v[164:167], a[80:83], v[28:31], v[164:167]
    ds_read_b64_tr_b16 a[118:119], v9 offset:35712
    v_mfma_f32_16x16x32_bf16 v[168:171], a[84:87], v[24:27], v[168:171]
    ds_read_b64_tr_b16 a[120:121], v8 offset:33728
    v_mfma_f32_16x16x32_bf16 v[172:175], a[84:87], v[28:31], v[172:175]
    s_waitcnt lgkmcnt(14)
    ds_read_b64_tr_b16 a[122:123], v8 offset:35776
    v_mfma_f32_16x16x32_bf16 v[176:179], a[88:91], v[24:27], v[176:179]
    s_waitcnt lgkmcnt(11)
    ds_read_b64_tr_b16 a[124:125], v9 offset:33728
    v_mfma_f32_16x16x32_bf16 v[180:183], a[88:91], v[28:31], v[180:183]
    s_waitcnt lgkmcnt(11)
    s_barrier
    v_mfma_f32_16x16x32_bf16 v[184:187], a[92:95], v[24:27], v[184:187]
    s_add_u32 m0, s35, 0
    ds_read_b64_tr_b16 a[126:127], v9 offset:35776
    ds_read_b64_tr_b16 a[64:65], v10 offset:0
    v_mfma_f32_16x16x32_bf16 v[188:191], a[92:95], v[28:31], v[188:191]
    s_add_u32 s38, s39, 1048576
    ds_read_b128 a[128:131], v14 offset:0
    ds_read_b64_tr_b16 a[66:67], v10 offset:2048
    v_mfma_f32_16x16x32_bf16 v[192:195], a[96:99], v[24:27], v[192:195]
    buffer_load_dwordx4 v4, s[40:43], s38 offen offset:0 lds
    v_mfma_f32_16x16x32_bf16 v[196:199], a[96:99], v[28:31], v[196:199]
    ds_read_b64_tr_b16 a[68:69], v11 offset:0
    ds_read_b64_tr_b16 a[70:71], v11 offset:2048
    v_mfma_f32_16x16x32_bf16 v[200:203], a[100:103], v[24:27], v[200:203]
    s_waitcnt lgkmcnt(13)
    ds_read_b64_tr_b16 a[72:73], v10 offset:64
    v_mfma_f32_16x16x32_bf16 v[204:207], a[100:103], v[28:31], v[204:207]
    buffer_load_dwordx4 v5, s[40:43], s38 offen offset:1024 lds
    v_mfma_f32_16x16x32_bf16 v[208:211], a[104:107], v[24:27], v[208:211]
    ds_read_b64_tr_b16 a[74:75], v10 offset:2112
    ds_read_b64_tr_b16 a[76:77], v11 offset:64
    v_mfma_f32_16x16x32_bf16 v[212:215], a[104:107], v[28:31], v[212:215]
    ds_read_b128 a[132:135], v14 offset:1024
    ds_read_b64_tr_b16 a[78:79], v11 offset:2112
    v_mfma_f32_16x16x32_bf16 v[216:219], a[108:111], v[24:27], v[216:219]
    buffer_load_dwordx4 v6, s[40:43], s38 offen offset:2048 lds
    v_mfma_f32_16x16x32_bf16 v[220:223], a[108:111], v[28:31], v[220:223]
    s_waitcnt lgkmcnt(14)
    ds_read_b64_tr_b16 a[80:81], v10 offset:128
    ds_read_b64_tr_b16 a[82:83], v10 offset:2176
    v_mfma_f32_16x16x32_bf16 v[224:227], a[112:115], v[24:27], v[224:227]
    s_waitcnt lgkmcnt(12)
    ds_read_b64_tr_b16 a[84:85], v11 offset:128
    v_mfma_f32_16x16x32_bf16 v[228:231], a[112:115], v[28:31], v[228:231]
    buffer_load_dwordx4 v7, s[40:43], s38 offen offset:3072 lds
    v_mfma_f32_16x16x32_bf16 v[232:235], a[116:119], v[24:27], v[232:235]
    s_add_u32 m0, s35, 16640
    ds_read_b64_tr_b16 a[86:87], v11 offset:2176
    ds_read_b64_tr_b16 a[88:89], v10 offset:192
    v_mfma_f32_16x16x32_bf16 v[236:239], a[116:119], v[28:31], v[236:239]
    s_add_u32 s38, s39, 2884096
    ds_read_b64_tr_b16 a[90:91], v10 offset:2240
    ds_read_b128 a[136:139], v14 offset:2048
    v_mfma_f32_16x16x32_bf16 v[240:243], a[120:123], v[24:27], v[240:243]
    buffer_load_dwordx4 v4, s[40:43], s38 offen offset:0 lds
    v_mfma_f32_16x16x32_bf16 v[244:247], a[120:123], v[28:31], v[244:247]
    ds_read_b64_tr_b16 a[92:93], v11 offset:192
    ds_read_b64_tr_b16 a[94:95], v11 offset:2240
    v_mfma_f32_16x16x32_bf16 v[248:251], a[124:127], v[24:27], v[248:251]
    s_waitcnt lgkmcnt(14)
    ds_read_b64_tr_b16 a[96:97], v10 offset:256
    v_mfma_f32_16x16x32_bf16 v[252:255], a[124:127], v[28:31], v[252:255]
    buffer_load_dwordx4 v5, s[40:43], s38 offen offset:1024 lds
    v_mfma_f32_16x16x32_bf16 v[128:131], a[64:67], v[32:35], v[128:131]
    ds_read_b64_tr_b16 a[98:99], v10 offset:2304
    ds_read_b64_tr_b16 a[100:101], v11 offset:256
    v_mfma_f32_16x16x32_bf16 v[132:135], a[64:67], v[36:39], v[132:135]
    ds_read_b64_tr_b16 a[102:103], v11 offset:2304
    v_mfma_f32_16x16x32_bf16 v[136:139], a[68:71], v[32:35], v[136:139]
    buffer_load_dwordx4 v6, s[40:43], s38 offen offset:2048 lds
    v_mfma_f32_16x16x32_bf16 v[140:143], a[68:71], v[36:39], v[140:143]
    s_waitcnt lgkmcnt(13)
    ds_read_b64_tr_b16 a[104:105], v10 offset:320
    ds_read_b128 a[140:143], v14 offset:3072
    v_mfma_f32_16x16x32_bf16 v[144:147], a[72:75], v[32:35], v[144:147]
    ds_read_b64_tr_b16 a[106:107], v10 offset:2368
    ds_read_b64_tr_b16 a[108:109], v11 offset:320
    v_mfma_f32_16x16x32_bf16 v[148:151], a[72:75], v[36:39], v[148:151]
    buffer_load_dwordx4 v7, s[40:43], s38 offen offset:3072 lds
    v_mfma_f32_16x16x32_bf16 v[152:155], a[76:79], v[32:35], v[152:155]
    ds_read_b64_tr_b16 a[110:111], v11 offset:2368
    ds_read_b64_tr_b16 a[112:113], v10 offset:384
    v_mfma_f32_16x16x32_bf16 v[156:159], a[76:79], v[36:39], v[156:159]
    s_waitcnt lgkmcnt(15)
    ds_read_b64_tr_b16 a[114:115], v10 offset:2432
    v_mfma_f32_16x16x32_bf16 v[160:163], a[80:83], v[32:35], v[160:163]
    ds_read_b64_tr_b16 a[116:117], v11 offset:384
    v_mfma_f32_16x16x32_bf16 v[164:167], a[80:83], v[36:39], v[164:167]
    ds_read_b64_tr_b16 a[118:119], v11 offset:2432
    v_mfma_f32_16x16x32_bf16 v[168:171], a[84:87], v[32:35], v[168:171]
    ds_read_b64_tr_b16 a[120:121], v10 offset:448
    v_mfma_f32_16x16x32_bf16 v[172:175], a[84:87], v[36:39], v[172:175]
    s_waitcnt lgkmcnt(14)
    ds_read_b64_tr_b16 a[122:123], v10 offset:2496
    v_mfma_f32_16x16x32_bf16 v[176:179], a[88:91], v[32:35], v[176:179]
    s_waitcnt lgkmcnt(11)
    ds_read_b64_tr_b16 a[124:125], v11 offset:448
    v_mfma_f32_16x16x32_bf16 v[180:183], a[88:91], v[36:39], v[180:183]
    s_waitcnt lgkmcnt(10)
    s_barrier
    v_mfma_f32_16x16x32_bf16 v[184:187], a[92:95], v[32:35], v[184:187]
    s_add_u32 m0, s35, 33280
    ds_write_b128 v13, v[32:35] offset:0
    v_mfma_f32_16x16x32_bf16 v[188:191], a[92:95], v[36:39], v[188:191]
    s_add_u32 s38, s39, 1310720
    ds_read_b64_tr_b16 a[126:127], v11 offset:2496
    ds_read_b64_tr_b16 a[64:65], v10 offset:33280
    v_mfma_f32_16x16x32_bf16 v[192:195], a[96:99], v[32:35], v[192:195]
    buffer_load_dwordx4 v4, s[40:43], s38 offen offset:0 lds
    v_mfma_f32_16x16x32_bf16 v[196:199], a[96:99], v[36:39], v[196:199]
    ds_read_b64_tr_b16 a[66:67], v10 offset:35328
    ds_read_b64_tr_b16 a[68:69], v11 offset:33280
    v_mfma_f32_16x16x32_bf16 v[200:203], a[100:103], v[32:35], v[200:203]
    s_waitcnt lgkmcnt(12)
    ds_read_b64_tr_b16 a[70:71], v11 offset:35328
    ds_read_b64_tr_b16 a[72:73], v10 offset:33344
    v_mfma_f32_16x16x32_bf16 v[204:207], a[100:103], v[36:39], v[204:207]
    buffer_load_dwordx4 v5, s[40:43], s38 offen offset:1024 lds
    v_mfma_f32_16x16x32_bf16 v[208:211], a[104:107], v[32:35], v[208:211]
    ds_write_b128 v13, v[36:39] offset:1024
    v_mfma_f32_16x16x32_bf16 v[212:215], a[104:107], v[36:39], v[212:215]
    ds_read_b64_tr_b16 a[74:75], v10 offset:35392
    ds_read_b64_tr_b16 a[76:77], v11 offset:33344
    v_mfma_f32_16x16x32_bf16 v[216:219], a[108:111], v[32:35], v[216:219]
    buffer_load_dwordx4 v6, s[40:43], s38 offen offset:2048 lds
    v_mfma_f32_16x16x32_bf16 v[220:223], a[108:111], v[36:39], v[220:223]
    s_waitcnt lgkmcnt(13)
    ds_read_b64_tr_b16 a[78:79], v11 offset:35392
    ds_read_b64_tr_b16 a[80:81], v10 offset:33408
    v_mfma_f32_16x16x32_bf16 v[224:227], a[112:115], v[32:35], v[224:227]
    s_waitcnt lgkmcnt(10)
    ds_read_b64_tr_b16 a[82:83], v10 offset:35456
    ds_read_b64_tr_b16 a[84:85], v11 offset:33408
    v_mfma_f32_16x16x32_bf16 v[228:231], a[112:115], v[36:39], v[228:231]
    buffer_load_dwordx4 v7, s[40:43], s38 offen offset:3072 lds
    v_mfma_f32_16x16x32_bf16 v[232:235], a[116:119], v[32:35], v[232:235]
    s_add_u32 m0, s35, 49920
    ds_read_b64_tr_b16 a[86:87], v11 offset:35456
    ds_read_b64_tr_b16 a[88:89], v10 offset:33472
    v_mfma_f32_16x16x32_bf16 v[236:239], a[116:119], v[36:39], v[236:239]
    s_add_u32 s38, s39, 3146240
    ds_write_b128 v13, v[40:43] offset:2048
    v_mfma_f32_16x16x32_bf16 v[240:243], a[120:123], v[32:35], v[240:243]
    buffer_load_dwordx4 v4, s[40:43], s38 offen offset:0 lds
    v_mfma_f32_16x16x32_bf16 v[244:247], a[120:123], v[36:39], v[244:247]
    ds_read_b64_tr_b16 a[90:91], v10 offset:35520
    ds_read_b64_tr_b16 a[92:93], v11 offset:33472
    v_mfma_f32_16x16x32_bf16 v[248:251], a[124:127], v[32:35], v[248:251]
    s_waitcnt lgkmcnt(13)
    ds_read_b64_tr_b16 a[94:95], v11 offset:35520
    ds_read_b64_tr_b16 a[96:97], v10 offset:33536
    v_mfma_f32_16x16x32_bf16 v[252:255], a[124:127], v[36:39], v[252:255]
    buffer_load_dwordx4 v5, s[40:43], s38 offen offset:1024 lds
    v_mfma_f32_16x16x32_bf16 v[128:131], a[64:67], v[40:43], v[128:131]
    ds_read_b64_tr_b16 a[98:99], v10 offset:35584
    ds_read_b64_tr_b16 a[100:101], v11 offset:33536
    v_mfma_f32_16x16x32_bf16 v[132:135], a[64:67], v[44:47], v[132:135]
    ds_read_b64_tr_b16 a[102:103], v11 offset:35584
    v_mfma_f32_16x16x32_bf16 v[136:139], a[68:71], v[40:43], v[136:139]
    buffer_load_dwordx4 v6, s[40:43], s38 offen offset:2048 lds
    v_mfma_f32_16x16x32_bf16 v[140:143], a[68:71], v[44:47], v[140:143]
    s_waitcnt lgkmcnt(13)
    ds_write_b128 v13, v[44:47] offset:3072
    v_mfma_f32_16x16x32_bf16 v[144:147], a[72:75], v[40:43], v[144:147]
    ds_read_b64_tr_b16 a[104:105], v10 offset:33600
    ds_read_b64_tr_b16 a[106:107], v10 offset:35648
    v_mfma_f32_16x16x32_bf16 v[148:151], a[72:75], v[44:47], v[148:151]
    buffer_load_dwordx4 v7, s[40:43], s38 offen offset:3072 lds
    v_mfma_f32_16x16x32_bf16 v[152:155], a[76:79], v[40:43], v[152:155]
    ds_read_b64_tr_b16 a[108:109], v11 offset:33600
    ds_read_b64_tr_b16 a[110:111], v11 offset:35648
    v_mfma_f32_16x16x32_bf16 v[156:159], a[76:79], v[44:47], v[156:159]
    s_waitcnt lgkmcnt(14)
    ds_read_b64_tr_b16 a[112:113], v10 offset:33664
    ds_read_b64_tr_b16 a[114:115], v10 offset:35712
    v_mfma_f32_16x16x32_bf16 v[160:163], a[80:83], v[40:43], v[160:163]
    ds_read_b64_tr_b16 a[116:117], v11 offset:33664
    v_mfma_f32_16x16x32_bf16 v[164:167], a[80:83], v[44:47], v[164:167]
    ds_read_b64_tr_b16 a[118:119], v11 offset:35712
    v_mfma_f32_16x16x32_bf16 v[168:171], a[84:87], v[40:43], v[168:171]
    ds_read_b64_tr_b16 a[120:121], v10 offset:33728
    v_mfma_f32_16x16x32_bf16 v[172:175], a[84:87], v[44:47], v[172:175]
    s_waitcnt lgkmcnt(14)
    ds_read_b64_tr_b16 a[122:123], v10 offset:35776
    v_mfma_f32_16x16x32_bf16 v[176:179], a[88:91], v[40:43], v[176:179]
    s_waitcnt lgkmcnt(11)
    ds_read_b64_tr_b16 a[124:125], v11 offset:33728
    v_mfma_f32_16x16x32_bf16 v[180:183], a[88:91], v[44:47], v[180:183]
    s_waitcnt vmcnt(8) lgkmcnt(11)
    s_barrier
    v_mfma_f32_16x16x32_bf16 v[184:187], a[92:95], v[40:43], v[184:187]
    s_add_u32 m0, s35, 66560
    ds_read_b64_tr_b16 a[126:127], v11 offset:35776
    ds_read_b64_tr_b16 a[64:65], v8 offset:0
    v_mfma_f32_16x16x32_bf16 v[188:191], a[92:95], v[44:47], v[188:191]
    s_add_u32 s38, s39, 1572864
    ds_read_b128 a[144:147], v14 offset:0
    ds_read_b64_tr_b16 a[66:67], v8 offset:2048
    v_mfma_f32_16x16x32_bf16 v[192:195], a[96:99], v[40:43], v[192:195]
    buffer_load_dwordx4 v4, s[40:43], s38 offen offset:0 lds
    v_mfma_f32_16x16x32_bf16 v[196:199], a[96:99], v[44:47], v[196:199]
    ds_read_b64_tr_b16 a[68:69], v9 offset:0
    ds_read_b64_tr_b16 a[70:71], v9 offset:2048
    v_mfma_f32_16x16x32_bf16 v[200:203], a[100:103], v[40:43], v[200:203]
    s_waitcnt lgkmcnt(13)
    ds_read_b64_tr_b16 a[72:73], v8 offset:64
    v_mfma_f32_16x16x32_bf16 v[204:207], a[100:103], v[44:47], v[204:207]
    buffer_load_dwordx4 v5, s[40:43], s38 offen offset:1024 lds
    v_mfma_f32_16x16x32_bf16 v[208:211], a[104:107], v[40:43], v[208:211]
    ds_read_b64_tr_b16 a[74:75], v8 offset:2112
    ds_read_b64_tr_b16 a[76:77], v9 offset:64
    v_mfma_f32_16x16x32_bf16 v[212:215], a[104:107], v[44:47], v[212:215]
    ds_read_b128 a[148:151], v14 offset:1024
    ds_read_b64_tr_b16 a[78:79], v9 offset:2112
    v_mfma_f32_16x16x32_bf16 v[216:219], a[108:111], v[40:43], v[216:219]
    buffer_load_dwordx4 v6, s[40:43], s38 offen offset:2048 lds
    v_mfma_f32_16x16x32_bf16 v[220:223], a[108:111], v[44:47], v[220:223]
    s_waitcnt lgkmcnt(14)
    ds_read_b64_tr_b16 a[80:81], v8 offset:128
    ds_read_b64_tr_b16 a[82:83], v8 offset:2176
    v_mfma_f32_16x16x32_bf16 v[224:227], a[112:115], v[40:43], v[224:227]
    s_waitcnt lgkmcnt(12)
    ds_read_b64_tr_b16 a[84:85], v9 offset:128
    v_mfma_f32_16x16x32_bf16 v[228:231], a[112:115], v[44:47], v[228:231]
    buffer_load_dwordx4 v7, s[40:43], s38 offen offset:3072 lds
    v_mfma_f32_16x16x32_bf16 v[232:235], a[116:119], v[40:43], v[232:235]
    s_add_u32 m0, s35, 83200
    ds_read_b64_tr_b16 a[86:87], v9 offset:2176
    ds_read_b64_tr_b16 a[88:89], v8 offset:192
    v_mfma_f32_16x16x32_bf16 v[236:239], a[116:119], v[44:47], v[236:239]
    s_add_u32 s38, s39, 3408384
    ds_read_b64_tr_b16 a[90:91], v8 offset:2240
    ds_read_b128 a[152:155], v14 offset:2048
    v_mfma_f32_16x16x32_bf16 v[240:243], a[120:123], v[40:43], v[240:243]
    buffer_load_dwordx4 v4, s[40:43], s38 offen offset:0 lds
    v_mfma_f32_16x16x32_bf16 v[244:247], a[120:123], v[44:47], v[244:247]
    ds_read_b64_tr_b16 a[92:93], v9 offset:192
    ds_read_b64_tr_b16 a[94:95], v9 offset:2240
    v_mfma_f32_16x16x32_bf16 v[248:251], a[124:127], v[40:43], v[248:251]
    s_waitcnt lgkmcnt(14)
    ds_read_b64_tr_b16 a[96:97], v8 offset:256
    v_mfma_f32_16x16x32_bf16 v[252:255], a[124:127], v[44:47], v[252:255]
    buffer_load_dwordx4 v5, s[40:43], s38 offen offset:1024 lds
    v_mfma_f32_16x16x32_bf16 v[128:131], a[64:67], v[48:51], v[128:131]
    ds_read_b64_tr_b16 a[98:99], v8 offset:2304
    ds_read_b64_tr_b16 a[100:101], v9 offset:256
    v_mfma_f32_16x16x32_bf16 v[132:135], a[64:67], v[52:55], v[132:135]
    ds_read_b64_tr_b16 a[102:103], v9 offset:2304
    v_mfma_f32_16x16x32_bf16 v[136:139], a[68:71], v[48:51], v[136:139]
    buffer_load_dwordx4 v6, s[40:43], s38 offen offset:2048 lds
    v_mfma_f32_16x16x32_bf16 v[140:143], a[68:71], v[52:55], v[140:143]
    s_waitcnt lgkmcnt(13)
    ds_read_b64_tr_b16 a[104:105], v8 offset:320
    ds_read_b128 a[156:159], v14 offset:3072
    v_mfma_f32_16x16x32_bf16 v[144:147], a[72:75], v[48:51], v[144:147]
    ds_read_b64_tr_b16 a[106:107], v8 offset:2368
    ds_read_b64_tr_b16 a[108:109], v9 offset:320
    v_mfma_f32_16x16x32_bf16 v[148:151], a[72:75], v[52:55], v[148:151]
    buffer_load_dwordx4 v7, s[40:43], s38 offen offset:3072 lds
    v_mfma_f32_16x16x32_bf16 v[152:155], a[76:79], v[48:51], v[152:155]
    ds_read_b64_tr_b16 a[110:111], v9 offset:2368
    ds_read_b64_tr_b16 a[112:113], v8 offset:384
    v_mfma_f32_16x16x32_bf16 v[156:159], a[76:79], v[52:55], v[156:159]
    s_waitcnt lgkmcnt(15)
    ds_read_b64_tr_b16 a[114:115], v8 offset:2432
    v_mfma_f32_16x16x32_bf16 v[160:163], a[80:83], v[48:51], v[160:163]
    ds_read_b64_tr_b16 a[116:117], v9 offset:384
    v_mfma_f32_16x16x32_bf16 v[164:167], a[80:83], v[52:55], v[164:167]
    ds_read_b64_tr_b16 a[118:119], v9 offset:2432
    v_mfma_f32_16x16x32_bf16 v[168:171], a[84:87], v[48:51], v[168:171]
    ds_read_b64_tr_b16 a[120:121], v8 offset:448
    v_mfma_f32_16x16x32_bf16 v[172:175], a[84:87], v[52:55], v[172:175]
    s_waitcnt lgkmcnt(14)
    ds_read_b64_tr_b16 a[122:123], v8 offset:2496
    v_mfma_f32_16x16x32_bf16 v[176:179], a[88:91], v[48:51], v[176:179]
    s_waitcnt lgkmcnt(11)
    ds_read_b64_tr_b16 a[124:125], v9 offset:448
    v_mfma_f32_16x16x32_bf16 v[180:183], a[88:91], v[52:55], v[180:183]
    s_waitcnt vmcnt(8) lgkmcnt(10)
    s_barrier
    v_mfma_f32_16x16x32_bf16 v[184:187], a[92:95], v[48:51], v[184:187]
    s_add_u32 m0, s35, 99840
    ds_write_b128 v13, v[48:51] offset:0
    v_mfma_f32_16x16x32_bf16 v[188:191], a[92:95], v[52:55], v[188:191]
    s_add_u32 s38, s39, 1835008
    ds_read_b64_tr_b16 a[126:127], v9 offset:2496
    ds_read_b64_tr_b16 a[64:65], v8 offset:33280
    v_mfma_f32_16x16x32_bf16 v[192:195], a[96:99], v[48:51], v[192:195]
    buffer_load_dwordx4 v4, s[40:43], s38 offen offset:0 lds
    v_mfma_f32_16x16x32_bf16 v[196:199], a[96:99], v[52:55], v[196:199]
    ds_read_b64_tr_b16 a[66:67], v8 offset:35328
    ds_read_b64_tr_b16 a[68:69], v9 offset:33280
    v_mfma_f32_16x16x32_bf16 v[200:203], a[100:103], v[48:51], v[200:203]
    s_waitcnt lgkmcnt(12)
    ds_read_b64_tr_b16 a[70:71], v9 offset:35328
    ds_read_b64_tr_b16 a[72:73], v8 offset:33344
    v_mfma_f32_16x16x32_bf16 v[204:207], a[100:103], v[52:55], v[204:207]
    buffer_load_dwordx4 v5, s[40:43], s38 offen offset:1024 lds
    v_mfma_f32_16x16x32_bf16 v[208:211], a[104:107], v[48:51], v[208:211]
    ds_write_b128 v13, v[52:55] offset:1024
    v_mfma_f32_16x16x32_bf16 v[212:215], a[104:107], v[52:55], v[212:215]
    ds_read_b64_tr_b16 a[74:75], v8 offset:35392
    ds_read_b64_tr_b16 a[76:77], v9 offset:33344
    v_mfma_f32_16x16x32_bf16 v[216:219], a[108:111], v[48:51], v[216:219]
    buffer_load_dwordx4 v6, s[40:43], s38 offen offset:2048 lds
    v_mfma_f32_16x16x32_bf16 v[220:223], a[108:111], v[52:55], v[220:223]
    s_waitcnt lgkmcnt(13)
    ds_read_b64_tr_b16 a[78:79], v9 offset:35392
    ds_read_b64_tr_b16 a[80:81], v8 offset:33408
    v_mfma_f32_16x16x32_bf16 v[224:227], a[112:115], v[48:51], v[224:227]
    s_waitcnt lgkmcnt(10)
    ds_read_b64_tr_b16 a[82:83], v8 offset:35456
    ds_read_b64_tr_b16 a[84:85], v9 offset:33408
    v_mfma_f32_16x16x32_bf16 v[228:231], a[112:115], v[52:55], v[228:231]
    buffer_load_dwordx4 v7, s[40:43], s38 offen offset:3072 lds
    v_mfma_f32_16x16x32_bf16 v[232:235], a[116:119], v[48:51], v[232:235]
    s_add_u32 m0, s35, 116480
    ds_read_b64_tr_b16 a[86:87], v9 offset:35456
    ds_read_b64_tr_b16 a[88:89], v8 offset:33472
    v_mfma_f32_16x16x32_bf16 v[236:239], a[116:119], v[52:55], v[236:239]
    s_add_u32 s38, s39, 512
    ds_write_b128 v13, v[56:59] offset:2048
    v_mfma_f32_16x16x32_bf16 v[240:243], a[120:123], v[48:51], v[240:243]
    buffer_load_dwordx4 v4, s[40:43], s38 offen offset:0 lds
    v_mfma_f32_16x16x32_bf16 v[244:247], a[120:123], v[52:55], v[244:247]
    ds_read_b64_tr_b16 a[90:91], v8 offset:35520
    ds_read_b64_tr_b16 a[92:93], v9 offset:33472
    v_mfma_f32_16x16x32_bf16 v[248:251], a[124:127], v[48:51], v[248:251]
    s_waitcnt lgkmcnt(13)
    ds_read_b64_tr_b16 a[94:95], v9 offset:35520
    ds_read_b64_tr_b16 a[96:97], v8 offset:33536
    v_mfma_f32_16x16x32_bf16 v[252:255], a[124:127], v[52:55], v[252:255]
    buffer_load_dwordx4 v5, s[40:43], s38 offen offset:1024 lds
    v_mfma_f32_16x16x32_bf16 v[128:131], a[64:67], v[56:59], v[128:131]
    ds_read_b64_tr_b16 a[98:99], v8 offset:35584
    ds_read_b64_tr_b16 a[100:101], v9 offset:33536
    v_mfma_f32_16x16x32_bf16 v[132:135], a[64:67], v[60:63], v[132:135]
    ds_read_b64_tr_b16 a[102:103], v9 offset:35584
    v_mfma_f32_16x16x32_bf16 v[136:139], a[68:71], v[56:59], v[136:139]
    buffer_load_dwordx4 v6, s[40:43], s38 offen offset:2048 lds
    v_mfma_f32_16x16x32_bf16 v[140:143], a[68:71], v[60:63], v[140:143]
    s_waitcnt lgkmcnt(13)
    ds_write_b128 v13, v[60:63] offset:3072
    v_mfma_f32_16x16x32_bf16 v[144:147], a[72:75], v[56:59], v[144:147]
    ds_read_b64_tr_b16 a[104:105], v8 offset:33600
    ds_read_b64_tr_b16 a[106:107], v8 offset:35648
    v_mfma_f32_16x16x32_bf16 v[148:151], a[72:75], v[60:63], v[148:151]
    buffer_load_dwordx4 v7, s[40:43], s38 offen offset:3072 lds
    v_mfma_f32_16x16x32_bf16 v[152:155], a[76:79], v[56:59], v[152:155]
    ds_read_b64_tr_b16 a[108:109], v9 offset:33600
    ds_read_b64_tr_b16 a[110:111], v9 offset:35648
    v_mfma_f32_16x16x32_bf16 v[156:159], a[76:79], v[60:63], v[156:159]
    s_waitcnt lgkmcnt(14)
    ds_read_b64_tr_b16 a[112:113], v8 offset:33664
    ds_read_b64_tr_b16 a[114:115], v8 offset:35712
    v_mfma_f32_16x16x32_bf16 v[160:163], a[80:83], v[56:59], v[160:163]
    ds_read_b64_tr_b16 a[116:117], v9 offset:33664
    v_mfma_f32_16x16x32_bf16 v[164:167], a[80:83], v[60:63], v[164:167]
    ds_read_b64_tr_b16 a[118:119], v9 offset:35712
    v_mfma_f32_16x16x32_bf16 v[168:171], a[84:87], v[56:59], v[168:171]
    ds_read_b64_tr_b16 a[120:121], v8 offset:33728
    v_mfma_f32_16x16x32_bf16 v[172:175], a[84:87], v[60:63], v[172:175]
    s_waitcnt lgkmcnt(14)
    ds_read_b64_tr_b16 a[122:123], v8 offset:35776
    v_mfma_f32_16x16x32_bf16 v[176:179], a[88:91], v[56:59], v[176:179]
    s_waitcnt lgkmcnt(11)
    ds_read_b64_tr_b16 a[124:125], v9 offset:33728
    v_mfma_f32_16x16x32_bf16 v[180:183], a[88:91], v[60:63], v[180:183]
    s_waitcnt vmcnt(8) lgkmcnt(11)
    s_barrier
    v_mfma_f32_16x16x32_bf16 v[184:187], a[92:95], v[56:59], v[184:187]
    s_add_u32 m0, s35, 0
    ds_read_b64_tr_b16 a[126:127], v9 offset:35776
    ds_read_b64_tr_b16 a[64:65], v10 offset:0
    v_mfma_f32_16x16x32_bf16 v[188:191], a[92:95], v[60:63], v[188:191]
    s_add_u32 s38, s39, 2097152
    ds_read_b128 a[160:163], v14 offset:0
    ds_read_b64_tr_b16 a[66:67], v10 offset:2048
    v_mfma_f32_16x16x32_bf16 v[192:195], a[96:99], v[56:59], v[192:195]
    buffer_load_dwordx4 v4, s[40:43], s38 offen offset:0 lds
    v_mfma_f32_16x16x32_bf16 v[196:199], a[96:99], v[60:63], v[196:199]
    ds_read_b64_tr_b16 a[68:69], v11 offset:0
    ds_read_b64_tr_b16 a[70:71], v11 offset:2048
    v_mfma_f32_16x16x32_bf16 v[200:203], a[100:103], v[56:59], v[200:203]
    s_waitcnt lgkmcnt(13)
    ds_read_b64_tr_b16 a[72:73], v10 offset:64
    v_mfma_f32_16x16x32_bf16 v[204:207], a[100:103], v[60:63], v[204:207]
    buffer_load_dwordx4 v5, s[40:43], s38 offen offset:1024 lds
    v_mfma_f32_16x16x32_bf16 v[208:211], a[104:107], v[56:59], v[208:211]
    ds_read_b64_tr_b16 a[74:75], v10 offset:2112
    ds_read_b64_tr_b16 a[76:77], v11 offset:64
    v_mfma_f32_16x16x32_bf16 v[212:215], a[104:107], v[60:63], v[212:215]
    ds_read_b128 a[164:167], v14 offset:1024
    ds_read_b64_tr_b16 a[78:79], v11 offset:2112
    v_mfma_f32_16x16x32_bf16 v[216:219], a[108:111], v[56:59], v[216:219]
    buffer_load_dwordx4 v6, s[40:43], s38 offen offset:2048 lds
    v_mfma_f32_16x16x32_bf16 v[220:223], a[108:111], v[60:63], v[220:223]
    s_waitcnt lgkmcnt(14)
    ds_read_b64_tr_b16 a[80:81], v10 offset:128
    ds_read_b64_tr_b16 a[82:83], v10 offset:2176
    v_mfma_f32_16x16x32_bf16 v[224:227], a[112:115], v[56:59], v[224:227]
    s_waitcnt lgkmcnt(12)
    ds_read_b64_tr_b16 a[84:85], v11 offset:128
    v_mfma_f32_16x16x32_bf16 v[228:231], a[112:115], v[60:63], v[228:231]
    buffer_load_dwordx4 v7, s[40:43], s38 offen offset:3072 lds
    v_mfma_f32_16x16x32_bf16 v[232:235], a[116:119], v[56:59], v[232:235]
    s_add_u32 m0, s35, 16640
    ds_read_b64_tr_b16 a[86:87], v11 offset:2176
    ds_read_b64_tr_b16 a[88:89], v10 offset:192
    v_mfma_f32_16x16x32_bf16 v[236:239], a[116:119], v[60:63], v[236:239]
    s_add_u32 s38, s39, 262656
    ds_read_b64_tr_b16 a[90:91], v10 offset:2240
    ds_read_b128 a[168:171], v14 offset:2048
    v_mfma_f32_16x16x32_bf16 v[240:243], a[120:123], v[56:59], v[240:243]
    buffer_load_dwordx4 v4, s[40:43], s38 offen offset:0 lds
    v_mfma_f32_16x16x32_bf16 v[244:247], a[120:123], v[60:63], v[244:247]
    ds_read_b64_tr_b16 a[92:93], v11 offset:192
    ds_read_b64_tr_b16 a[94:95], v11 offset:2240
    v_mfma_f32_16x16x32_bf16 v[248:251], a[124:127], v[56:59], v[248:251]
    s_waitcnt lgkmcnt(14)
    ds_read_b64_tr_b16 a[96:97], v10 offset:256
    v_mfma_f32_16x16x32_bf16 v[252:255], a[124:127], v[60:63], v[252:255]
    buffer_load_dwordx4 v5, s[40:43], s38 offen offset:1024 lds
    v_mfma_f32_16x16x32_bf16 v[128:131], a[64:67], v[64:67], v[128:131]
    ds_read_b64_tr_b16 a[98:99], v10 offset:2304
    ds_read_b64_tr_b16 a[100:101], v11 offset:256
    v_mfma_f32_16x16x32_bf16 v[132:135], a[64:67], v[68:71], v[132:135]
    ds_read_b64_tr_b16 a[102:103], v11 offset:2304
    v_mfma_f32_16x16x32_bf16 v[136:139], a[68:71], v[64:67], v[136:139]
    buffer_load_dwordx4 v6, s[40:43], s38 offen offset:2048 lds
    v_mfma_f32_16x16x32_bf16 v[140:143], a[68:71], v[68:71], v[140:143]
    s_waitcnt lgkmcnt(13)
    ds_read_b64_tr_b16 a[104:105], v10 offset:320
    ds_read_b128 a[172:175], v14 offset:3072
    v_mfma_f32_16x16x32_bf16 v[144:147], a[72:75], v[64:67], v[144:147]
    ds_read_b64_tr_b16 a[106:107], v10 offset:2368
    ds_read_b64_tr_b16 a[108:109], v11 offset:320
    v_mfma_f32_16x16x32_bf16 v[148:151], a[72:75], v[68:71], v[148:151]
    buffer_load_dwordx4 v7, s[40:43], s38 offen offset:3072 lds
    v_mfma_f32_16x16x32_bf16 v[152:155], a[76:79], v[64:67], v[152:155]
    ds_read_b64_tr_b16 a[110:111], v11 offset:2368
    ds_read_b64_tr_b16 a[112:113], v10 offset:384
    v_mfma_f32_16x16x32_bf16 v[156:159], a[76:79], v[68:71], v[156:159]
    s_waitcnt lgkmcnt(15)
    ds_read_b64_tr_b16 a[114:115], v10 offset:2432
    v_mfma_f32_16x16x32_bf16 v[160:163], a[80:83], v[64:67], v[160:163]
    ds_read_b64_tr_b16 a[116:117], v11 offset:384
    v_mfma_f32_16x16x32_bf16 v[164:167], a[80:83], v[68:71], v[164:167]
    ds_read_b64_tr_b16 a[118:119], v11 offset:2432
    v_mfma_f32_16x16x32_bf16 v[168:171], a[84:87], v[64:67], v[168:171]
    ds_read_b64_tr_b16 a[120:121], v10 offset:448
    v_mfma_f32_16x16x32_bf16 v[172:175], a[84:87], v[68:71], v[172:175]
    s_waitcnt lgkmcnt(14)
    ds_read_b64_tr_b16 a[122:123], v10 offset:2496
    v_mfma_f32_16x16x32_bf16 v[176:179], a[88:91], v[64:67], v[176:179]
    s_waitcnt lgkmcnt(11)
    ds_read_b64_tr_b16 a[124:125], v11 offset:448
    v_mfma_f32_16x16x32_bf16 v[180:183], a[88:91], v[68:71], v[180:183]
    s_waitcnt vmcnt(8) lgkmcnt(10)
    s_barrier
    v_mfma_f32_16x16x32_bf16 v[184:187], a[92:95], v[64:67], v[184:187]
    s_add_u32 m0, s35, 33280
    ds_write_b128 v13, v[64:67] offset:0
    v_mfma_f32_16x16x32_bf16 v[188:191], a[92:95], v[68:71], v[188:191]
    s_add_u32 s38, s39, 2359296
    ds_read_b64_tr_b16 a[126:127], v11 offset:2496
    ds_read_b64_tr_b16 a[64:65], v10 offset:33280
    v_mfma_f32_16x16x32_bf16 v[192:195], a[96:99], v[64:67], v[192:195]
    buffer_load_dwordx4 v4, s[40:43], s38 offen offset:0 lds
    v_mfma_f32_16x16x32_bf16 v[196:199], a[96:99], v[68:71], v[196:199]
    ds_read_b64_tr_b16 a[66:67], v10 offset:35328
    ds_read_b64_tr_b16 a[68:69], v11 offset:33280
    v_mfma_f32_16x16x32_bf16 v[200:203], a[100:103], v[64:67], v[200:203]
    s_waitcnt lgkmcnt(12)
    ds_read_b64_tr_b16 a[70:71], v11 offset:35328
    ds_read_b64_tr_b16 a[72:73], v10 offset:33344
    v_mfma_f32_16x16x32_bf16 v[204:207], a[100:103], v[68:71], v[204:207]
    buffer_load_dwordx4 v5, s[40:43], s38 offen offset:1024 lds
    v_mfma_f32_16x16x32_bf16 v[208:211], a[104:107], v[64:67], v[208:211]
    ds_read_b64_tr_b16 a[74:75], v10 offset:35392
    ds_read_b64_tr_b16 a[76:77], v11 offset:33344
    v_mfma_f32_16x16x32_bf16 v[212:215], a[104:107], v[68:71], v[212:215]
    ds_read_b64_tr_b16 a[78:79], v11 offset:35392
    v_mfma_f32_16x16x32_bf16 v[216:219], a[108:111], v[64:67], v[216:219]
    buffer_load_dwordx4 v6, s[40:43], s38 offen offset:2048 lds
    v_mfma_f32_16x16x32_bf16 v[220:223], a[108:111], v[68:71], v[220:223]
    s_waitcnt lgkmcnt(13)
    ds_read_b64_tr_b16 a[80:81], v10 offset:33408
    ds_read_b64_tr_b16 a[82:83], v10 offset:35456
    v_mfma_f32_16x16x32_bf16 v[224:227], a[112:115], v[64:67], v[224:227]
    s_waitcnt lgkmcnt(10)
    ds_read_b64_tr_b16 a[84:85], v11 offset:33408
    v_mfma_f32_16x16x32_bf16 v[228:231], a[112:115], v[68:71], v[228:231]
    buffer_load_dwordx4 v7, s[40:43], s38 offen offset:3072 lds
    v_mfma_f32_16x16x32_bf16 v[232:235], a[116:119], v[64:67], v[232:235]
    s_add_u32 m0, s35, 49920
    ds_read_b64_tr_b16 a[86:87], v11 offset:35456
    ds_read_b64_tr_b16 a[88:89], v10 offset:33472
    v_mfma_f32_16x16x32_bf16 v[236:239], a[116:119], v[68:71], v[236:239]
    s_add_u32 s38, s39, 524800
    ds_write_b128 v13, v[68:71] offset:1024
    v_mfma_f32_16x16x32_bf16 v[240:243], a[120:123], v[64:67], v[240:243]
    buffer_load_dwordx4 v4, s[40:43], s38 offen offset:0 lds
    v_mfma_f32_16x16x32_bf16 v[244:247], a[120:123], v[68:71], v[244:247]
    ds_read_b64_tr_b16 a[90:91], v10 offset:35520
    ds_read_b64_tr_b16 a[92:93], v11 offset:33472
    v_mfma_f32_16x16x32_bf16 v[248:251], a[124:127], v[64:67], v[248:251]
    s_waitcnt lgkmcnt(12)
    ds_read_b64_tr_b16 a[94:95], v11 offset:35520
    ds_read_b64_tr_b16 a[96:97], v10 offset:33536
    v_mfma_f32_16x16x32_bf16 v[252:255], a[124:127], v[68:71], v[252:255]
    buffer_load_dwordx4 v5, s[40:43], s38 offen offset:1024 lds
    v_mfma_f32_16x16x32_bf16 v[128:131], a[64:67], a[128:131], v[128:131]
    ds_read_b64_tr_b16 a[98:99], v10 offset:35584
    ds_read_b64_tr_b16 a[100:101], v11 offset:33536
    v_mfma_f32_16x16x32_bf16 v[132:135], a[64:67], a[132:135], v[132:135]
    ds_read_b64_tr_b16 a[102:103], v11 offset:35584
    v_mfma_f32_16x16x32_bf16 v[136:139], a[68:71], a[128:131], v[136:139]
    buffer_load_dwordx4 v6, s[40:43], s38 offen offset:2048 lds
    v_mfma_f32_16x16x32_bf16 v[140:143], a[68:71], a[132:135], v[140:143]
    s_waitcnt lgkmcnt(13)
    ds_read_b64_tr_b16 a[104:105], v10 offset:33600
    ds_read_b64_tr_b16 a[106:107], v10 offset:35648
    v_mfma_f32_16x16x32_bf16 v[144:147], a[72:75], a[128:131], v[144:147]
    ds_read_b64_tr_b16 a[108:109], v11 offset:33600
    v_mfma_f32_16x16x32_bf16 v[148:151], a[72:75], a[132:135], v[148:151]
    buffer_load_dwordx4 v7, s[40:43], s38 offen offset:3072 lds
    v_mfma_f32_16x16x32_bf16 v[152:155], a[76:79], a[128:131], v[152:155]
    ds_read_b64_tr_b16 a[110:111], v11 offset:35648
    ds_read_b64_tr_b16 a[112:113], v10 offset:33664
    v_mfma_f32_16x16x32_bf16 v[156:159], a[76:79], a[132:135], v[156:159]
    s_waitcnt lgkmcnt(14)
    ds_read_b64_tr_b16 a[114:115], v10 offset:35712
    v_mfma_f32_16x16x32_bf16 v[160:163], a[80:83], a[128:131], v[160:163]
    ds_read_b64_tr_b16 a[116:117], v11 offset:33664
    v_mfma_f32_16x16x32_bf16 v[164:167], a[80:83], a[132:135], v[164:167]
    ds_read_b64_tr_b16 a[118:119], v11 offset:35712
    v_mfma_f32_16x16x32_bf16 v[168:171], a[84:87], a[128:131], v[168:171]
    ds_read_b64_tr_b16 a[120:121], v10 offset:33728
    v_mfma_f32_16x16x32_bf16 v[172:175], a[84:87], a[132:135], v[172:175]
    s_waitcnt lgkmcnt(13)
    ds_read_b64_tr_b16 a[122:123], v10 offset:35776
    v_mfma_f32_16x16x32_bf16 v[176:179], a[88:91], a[128:131], v[176:179]
    s_waitcnt lgkmcnt(10)
    ds_read_b64_tr_b16 a[124:125], v11 offset:33728
    v_mfma_f32_16x16x32_bf16 v[180:183], a[88:91], a[132:135], v[180:183]
    s_waitcnt vmcnt(8)
    s_barrier
    v_mfma_f32_16x16x32_bf16 v[184:187], a[92:95], a[128:131], v[184:187]
    s_add_u32 m0, s35, 66560
    ds_read_b64_tr_b16 a[126:127], v11 offset:35776
    ds_read_b64_tr_b16 a[64:65], v8 offset:0
    v_mfma_f32_16x16x32_bf16 v[188:191], a[92:95], a[132:135], v[188:191]
    s_add_u32 s38, s39, 2621440
    ds_read_b128 a[176:179], v14 offset:0
    ds_read_b64_tr_b16 a[66:67], v8 offset:2048
    v_mfma_f32_16x16x32_bf16 v[192:195], a[96:99], a[128:131], v[192:195]
    buffer_load_dwordx4 v4, s[40:43], s38 offen offset:0 lds
    v_mfma_f32_16x16x32_bf16 v[196:199], a[96:99], a[132:135], v[196:199]
    ds_read_b64_tr_b16 a[68:69], v9 offset:0
    ds_read_b64_tr_b16 a[70:71], v9 offset:2048
    v_mfma_f32_16x16x32_bf16 v[200:203], a[100:103], a[128:131], v[200:203]
    s_waitcnt lgkmcnt(13)
    ds_read_b64_tr_b16 a[72:73], v8 offset:64
    v_mfma_f32_16x16x32_bf16 v[204:207], a[100:103], a[132:135], v[204:207]
    buffer_load_dwordx4 v5, s[40:43], s38 offen offset:1024 lds
    v_mfma_f32_16x16x32_bf16 v[208:211], a[104:107], a[128:131], v[208:211]
    ds_read_b64_tr_b16 a[74:75], v8 offset:2112
    ds_read_b64_tr_b16 a[76:77], v9 offset:64
    v_mfma_f32_16x16x32_bf16 v[212:215], a[104:107], a[132:135], v[212:215]
    ds_read_b64_tr_b16 a[78:79], v9 offset:2112
    v_mfma_f32_16x16x32_bf16 v[216:219], a[108:111], a[128:131], v[216:219]
    buffer_load_dwordx4 v6, s[40:43], s38 offen offset:2048 lds
    v_mfma_f32_16x16x32_bf16 v[220:223], a[108:111], a[132:135], v[220:223]
    s_waitcnt lgkmcnt(13)
    ds_read_b64_tr_b16 a[80:81], v8 offset:128
    ds_read_b64_tr_b16 a[82:83], v8 offset:2176
    v_mfma_f32_16x16x32_bf16 v[224:227], a[112:115], a[128:131], v[224:227]
    s_waitcnt lgkmcnt(11)
    ds_read_b64_tr_b16 a[84:85], v9 offset:128
    v_mfma_f32_16x16x32_bf16 v[228:231], a[112:115], a[132:135], v[228:231]
    buffer_load_dwordx4 v7, s[40:43], s38 offen offset:3072 lds
    v_mfma_f32_16x16x32_bf16 v[232:235], a[116:119], a[128:131], v[232:235]
    s_add_u32 m0, s35, 83200
    ds_read_b64_tr_b16 a[86:87], v9 offset:2176
    ds_read_b64_tr_b16 a[88:89], v8 offset:192
    v_mfma_f32_16x16x32_bf16 v[236:239], a[116:119], a[132:135], v[236:239]
    s_add_u32 s38, s39, 786944
    ds_read_b64_tr_b16 a[90:91], v8 offset:2240
    ds_read_b128 a[180:183], v14 offset:1024
    v_mfma_f32_16x16x32_bf16 v[240:243], a[120:123], a[128:131], v[240:243]
    buffer_load_dwordx4 v4, s[40:43], s38 offen offset:0 lds
    v_mfma_f32_16x16x32_bf16 v[244:247], a[120:123], a[132:135], v[244:247]
    ds_read_b64_tr_b16 a[92:93], v9 offset:192
    ds_read_b64_tr_b16 a[94:95], v9 offset:2240
    v_mfma_f32_16x16x32_bf16 v[248:251], a[124:127], a[128:131], v[248:251]
    s_waitcnt lgkmcnt(13)
    ds_read_b64_tr_b16 a[96:97], v8 offset:256
    v_mfma_f32_16x16x32_bf16 v[252:255], a[124:127], a[132:135], v[252:255]
    buffer_load_dwordx4 v5, s[40:43], s38 offen offset:1024 lds
    v_mfma_f32_16x16x32_bf16 v[128:131], a[64:67], a[136:139], v[128:131]
    ds_read_b64_tr_b16 a[98:99], v8 offset:2304
    ds_read_b64_tr_b16 a[100:101], v9 offset:256
    v_mfma_f32_16x16x32_bf16 v[132:135], a[64:67], a[140:143], v[132:135]
    ds_read_b64_tr_b16 a[102:103], v9 offset:2304
    v_bfe_u32 v1, v0, 5, 1
    v_mfma_f32_16x16x32_bf16 v[136:139], a[68:71], a[136:139], v[136:139]
    buffer_load_dwordx4 v6, s[40:43], s38 offen offset:2048 lds
    v_mfma_f32_16x16x32_bf16 v[140:143], a[68:71], a[140:143], v[140:143]
    s_waitcnt lgkmcnt(13)
    ds_read_b64_tr_b16 a[104:105], v8 offset:320
    ds_read_b64_tr_b16 a[106:107], v8 offset:2368
    v_mfma_f32_16x16x32_bf16 v[144:147], a[72:75], a[136:139], v[144:147]
    ds_read_b64_tr_b16 a[108:109], v9 offset:320
    v_and_b32 v2, 31, v0
    v_mfma_f32_16x16x32_bf16 v[148:151], a[72:75], a[140:143], v[148:151]
    buffer_load_dwordx4 v7, s[40:43], s38 offen offset:3072 lds
    v_mfma_f32_16x16x32_bf16 v[152:155], a[76:79], a[136:139], v[152:155]
    ds_read_b64_tr_b16 a[110:111], v9 offset:2368
    ds_read_b64_tr_b16 a[112:113], v8 offset:384
    v_mfma_f32_16x16x32_bf16 v[156:159], a[76:79], a[140:143], v[156:159]
    s_waitcnt lgkmcnt(14)
    ds_read_b64_tr_b16 a[114:115], v8 offset:2432
    v_add_u32 v16, s15, v1
    v_mfma_f32_16x16x32_bf16 v[160:163], a[80:83], a[136:139], v[160:163]
    ds_read_b64_tr_b16 a[116:117], v9 offset:384
    v_lshlrev_b32 v17, 9, v16
    v_mfma_f32_16x16x32_bf16 v[164:167], a[80:83], a[140:143], v[164:167]
    ds_read_b64_tr_b16 a[118:119], v9 offset:2432
    v_mfma_f32_16x16x32_bf16 v[168:171], a[84:87], a[136:139], v[168:171]
    ds_read_b64_tr_b16 a[120:121], v8 offset:448
    v_and_b32 v16, 15, v16
    v_mfma_f32_16x16x32_bf16 v[172:175], a[84:87], a[140:143], v[172:175]
    s_waitcnt lgkmcnt(13)
    ds_read_b64_tr_b16 a[122:123], v8 offset:2496
    v_xor_b32 v16, v16, v2
    v_mfma_f32_16x16x32_bf16 v[176:179], a[88:91], a[136:139], v[176:179]
    s_waitcnt lgkmcnt(10)
    ds_read_b64_tr_b16 a[124:125], v9 offset:448
    v_lshl_add_u32 v32, v16, 4, v17
    v_mfma_f32_16x16x32_bf16 v[180:183], a[88:91], a[140:143], v[180:183]
    s_waitcnt vmcnt(8)
    s_barrier
    v_mfma_f32_16x16x32_bf16 v[184:187], a[92:95], a[136:139], v[184:187]
    s_add_u32 m0, s35, 99840
    ds_read_b64_tr_b16 a[126:127], v9 offset:2496
    ds_read_b64_tr_b16 a[64:65], v8 offset:33280
    v_mfma_f32_16x16x32_bf16 v[188:191], a[92:95], a[140:143], v[188:191]
    s_add_u32 s38, s39, 2883584
    ds_read_b64_tr_b16 a[66:67], v8 offset:35328
    v_xor_b32 v33, 32, v32
    v_mfma_f32_16x16x32_bf16 v[192:195], a[96:99], a[136:139], v[192:195]
    buffer_load_dwordx4 v4, s[40:43], s38 offen offset:0 lds
    v_mfma_f32_16x16x32_bf16 v[196:199], a[96:99], a[140:143], v[196:199]
    ds_read_b64_tr_b16 a[68:69], v9 offset:33280
    ds_read_b64_tr_b16 a[70:71], v9 offset:35328
    v_mfma_f32_16x16x32_bf16 v[200:203], a[100:103], a[136:139], v[200:203]
    s_waitcnt lgkmcnt(12)
    ds_read_b64_tr_b16 a[72:73], v8 offset:33344
    v_mfma_f32_16x16x32_bf16 v[204:207], a[100:103], a[140:143], v[204:207]
    buffer_load_dwordx4 v5, s[40:43], s38 offen offset:1024 lds
    v_mfma_f32_16x16x32_bf16 v[208:211], a[104:107], a[136:139], v[208:211]
    ds_read_b64_tr_b16 a[74:75], v8 offset:35392
    ds_read_b64_tr_b16 a[76:77], v9 offset:33344
    v_mfma_f32_16x16x32_bf16 v[212:215], a[104:107], a[140:143], v[212:215]
    ds_read_b64_tr_b16 a[78:79], v9 offset:35392
    v_xor_b32 v34, 64, v32
    v_mfma_f32_16x16x32_bf16 v[216:219], a[108:111], a[136:139], v[216:219]
    buffer_load_dwordx4 v6, s[40:43], s38 offen offset:2048 lds
    v_mfma_f32_16x16x32_bf16 v[220:223], a[108:111], a[140:143], v[220:223]
    s_waitcnt lgkmcnt(12)
    ds_read_b64_tr_b16 a[80:81], v8 offset:33408
    ds_read_b64_tr_b16 a[82:83], v8 offset:35456
    v_mfma_f32_16x16x32_bf16 v[224:227], a[112:115], a[136:139], v[224:227]
    s_waitcnt lgkmcnt(10)
    ds_read_b64_tr_b16 a[84:85], v9 offset:33408
    v_xor_b32 v35, 96, v32
    v_mfma_f32_16x16x32_bf16 v[228:231], a[112:115], a[140:143], v[228:231]
    buffer_load_dwordx4 v7, s[40:43], s38 offen offset:3072 lds
    v_mfma_f32_16x16x32_bf16 v[232:235], a[116:119], a[136:139], v[232:235]
    s_add_u32 m0, s35, 116480
    ds_read_b64_tr_b16 a[86:87], v9 offset:35456
    ds_read_b64_tr_b16 a[88:89], v8 offset:33472
    v_mfma_f32_16x16x32_bf16 v[236:239], a[116:119], a[140:143], v[236:239]
    s_add_u32 s38, s39, 1049088
    ds_read_b64_tr_b16 a[90:91], v8 offset:35520
    v_lshlrev_b32 v16, 2, v1
    v_mfma_f32_16x16x32_bf16 v[240:243], a[120:123], a[136:139], v[240:243]
    buffer_load_dwordx4 v4, s[40:43], s38 offen offset:0 lds
    v_mfma_f32_16x16x32_bf16 v[244:247], a[120:123], a[140:143], v[244:247]
    ds_read_b64_tr_b16 a[92:93], v9 offset:33472
    ds_read_b64_tr_b16 a[94:95], v9 offset:35520
    v_mfma_f32_16x16x32_bf16 v[248:251], a[124:127], a[136:139], v[248:251]
    s_waitcnt lgkmcnt(12)
    ds_read_b64_tr_b16 a[96:97], v8 offset:33536
    v_mfma_f32_16x16x32_bf16 v[252:255], a[124:127], a[140:143], v[252:255]
    buffer_load_dwordx4 v5, s[40:43], s38 offen offset:1024 lds
    v_mfma_f32_16x16x32_bf16 v[128:131], a[64:67], a[144:147], v[128:131]
    ds_read_b64_tr_b16 a[98:99], v8 offset:35584
    ds_read_b64_tr_b16 a[100:101], v9 offset:33536
    v_mfma_f32_16x16x32_bf16 v[132:135], a[64:67], a[148:151], v[132:135]
    ds_read_b64_tr_b16 a[102:103], v9 offset:35584
    v_add_u32 v16, s28, v16
    v_mfma_f32_16x16x32_bf16 v[136:139], a[68:71], a[144:147], v[136:139]
    buffer_load_dwordx4 v6, s[40:43], s38 offen offset:2048 lds
    v_mfma_f32_16x16x32_bf16 v[140:143], a[68:71], a[148:151], v[140:143]
    s_waitcnt lgkmcnt(12)
    ds_read_b64_tr_b16 a[104:105], v8 offset:33600
    ds_read_b64_tr_b16 a[106:107], v8 offset:35648
    v_mfma_f32_16x16x32_bf16 v[144:147], a[72:75], a[144:147], v[144:147]
    ds_read_b64_tr_b16 a[108:109], v9 offset:33600
    v_lshlrev_b32 v16, 9, v16
    v_mfma_f32_16x16x32_bf16 v[148:151], a[72:75], a[148:151], v[148:151]
    buffer_load_dwordx4 v7, s[40:43], s38 offen offset:3072 lds
    v_mfma_f32_16x16x32_bf16 v[152:155], a[76:79], a[144:147], v[152:155]
    ds_read_b64_tr_b16 a[110:111], v9 offset:35648
    ds_read_b64_tr_b16 a[112:113], v8 offset:33664
    v_mfma_f32_16x16x32_bf16 v[156:159], a[76:79], a[148:151], v[156:159]
    s_waitcnt lgkmcnt(13)
    ds_read_b64_tr_b16 a[114:115], v8 offset:35712
    v_lshlrev_b32 v17, 1, v1
    v_mfma_f32_16x16x32_bf16 v[160:163], a[80:83], a[144:147], v[160:163]
    ds_read_b64_tr_b16 a[116:117], v9 offset:33664
    v_xor_b32 v17, v17, v2
    v_mfma_f32_16x16x32_bf16 v[164:167], a[80:83], a[148:151], v[164:167]
    ds_read_b64_tr_b16 a[118:119], v9 offset:35712
    v_mfma_f32_16x16x32_bf16 v[168:171], a[84:87], a[144:147], v[168:171]
    ds_read_b64_tr_b16 a[120:121], v8 offset:33728
    v_lshl_add_u32 v36, v17, 4, v16
    v_mfma_f32_16x16x32_bf16 v[172:175], a[84:87], a[148:151], v[172:175]
    s_waitcnt lgkmcnt(13)
    ds_read_b64_tr_b16 a[122:123], v8 offset:35776
    v_add_u32 v37, 3072, v36
    v_mfma_f32_16x16x32_bf16 v[176:179], a[88:91], a[144:147], v[176:179]
    s_waitcnt lgkmcnt(10)
    ds_read_b64_tr_b16 a[124:125], v9 offset:33728
    v_add_u32 v38, 6144, v36
    v_mfma_f32_16x16x32_bf16 v[180:183], a[88:91], a[148:151], v[180:183]
    s_waitcnt vmcnt(8)
    s_barrier
    v_mfma_f32_16x16x32_bf16 v[184:187], a[92:95], a[144:147], v[184:187]
    s_add_u32 m0, s35, 0
    ds_read_b64_tr_b16 a[126:127], v9 offset:35776
    ds_read_b64_tr_b16 a[64:65], v10 offset:0
    v_mfma_f32_16x16x32_bf16 v[188:191], a[92:95], a[148:151], v[188:191]
    s_add_u32 s38, s39, 3145728
    ds_read_b64_tr_b16 a[66:67], v10 offset:2048
    v_add_u32 v39, 9216, v36
    v_mfma_f32_16x16x32_bf16 v[192:195], a[96:99], a[144:147], v[192:195]
    buffer_load_dwordx4 v4, s[40:43], s38 offen offset:0 lds
    v_mfma_f32_16x16x32_bf16 v[196:199], a[96:99], a[148:151], v[196:199]
    ds_read_b64_tr_b16 a[68:69], v11 offset:0
    ds_read_b64_tr_b16 a[70:71], v11 offset:2048
    v_mfma_f32_16x16x32_bf16 v[200:203], a[100:103], a[144:147], v[200:203]
    s_waitcnt lgkmcnt(12)
    ds_read_b64_tr_b16 a[72:73], v10 offset:64
    v_mfma_f32_16x16x32_bf16 v[204:207], a[100:103], a[148:151], v[204:207]
    buffer_load_dwordx4 v5, s[40:43], s38 offen offset:1024 lds
    v_mfma_f32_16x16x32_bf16 v[208:211], a[104:107], a[144:147], v[208:211]
    ds_read_b64_tr_b16 a[74:75], v10 offset:2112
    ds_read_b64_tr_b16 a[76:77], v11 offset:64
    v_mfma_f32_16x16x32_bf16 v[212:215], a[104:107], a[148:151], v[212:215]
    ds_read_b64_tr_b16 a[78:79], v11 offset:2112
    v_and_b32 v16, 15, v0
    v_mfma_f32_16x16x32_bf16 v[216:219], a[108:111], a[144:147], v[216:219]
    buffer_load_dwordx4 v6, s[40:43], s38 offen offset:2048 lds
    v_mfma_f32_16x16x32_bf16 v[220:223], a[108:111], a[148:151], v[220:223]
    s_waitcnt lgkmcnt(12)
    ds_read_b64_tr_b16 a[80:81], v10 offset:128
    ds_read_b64_tr_b16 a[82:83], v10 offset:2176
    v_mfma_f32_16x16x32_bf16 v[224:227], a[112:115], a[144:147], v[224:227]
    s_waitcnt lgkmcnt(10)
    ds_read_b64_tr_b16 a[84:85], v11 offset:128
    v_bfe_u32 v17, v0, 4, 2
    v_mfma_f32_16x16x32_bf16 v[228:231], a[112:115], a[148:151], v[228:231]
    buffer_load_dwordx4 v7, s[40:43], s38 offen offset:3072 lds
    v_mfma_f32_16x16x32_bf16 v[232:235], a[116:119], a[144:147], v[232:235]
    s_add_u32 m0, s35, 16640
    ds_read_b64_tr_b16 a[86:87], v11 offset:2176
    ds_read_b64_tr_b16 a[88:89], v10 offset:192
    v_mfma_f32_16x16x32_bf16 v[236:239], a[116:119], a[148:151], v[236:239]
    s_add_u32 s38, s39, 1311232
    ds_read_b64_tr_b16 a[90:91], v10 offset:2240
    v_xor_b32 v17, v17, v16
    v_mfma_f32_16x16x32_bf16 v[240:243], a[120:123], a[144:147], v[240:243]
    buffer_load_dwordx4 v4, s[40:43], s38 offen offset:0 lds
    v_mfma_f32_16x16x32_bf16 v[244:247], a[120:123], a[148:151], v[244:247]
    ds_read_b64_tr_b16 a[92:93], v11 offset:192
    ds_read_b64_tr_b16 a[94:95], v11 offset:2240
    v_mfma_f32_16x16x32_bf16 v[248:251], a[124:127], a[144:147], v[248:251]
    s_waitcnt lgkmcnt(12)
    ds_read_b64_tr_b16 a[96:97], v10 offset:256
    v_mfma_f32_16x16x32_bf16 v[252:255], a[124:127], a[148:151], v[252:255]
    buffer_load_dwordx4 v5, s[40:43], s38 offen offset:1024 lds
    v_mfma_f32_16x16x32_bf16 v[128:131], a[64:67], a[152:155], v[128:131]
    ds_read_b64_tr_b16 a[98:99], v10 offset:2304
    ds_read_b64_tr_b16 a[100:101], v11 offset:256
    v_mfma_f32_16x16x32_bf16 v[132:135], a[64:67], a[156:159], v[132:135]
    ds_read_b64_tr_b16 a[102:103], v11 offset:2304
    v_lshlrev_b32 v16, 9, v16
    v_mfma_f32_16x16x32_bf16 v[136:139], a[68:71], a[152:155], v[136:139]
    buffer_load_dwordx4 v6, s[40:43], s38 offen offset:2048 lds
    v_mfma_f32_16x16x32_bf16 v[140:143], a[68:71], a[156:159], v[140:143]
    s_waitcnt lgkmcnt(12)
    ds_read_b64_tr_b16 a[104:105], v10 offset:320
    ds_read_b64_tr_b16 a[106:107], v10 offset:2368
    v_mfma_f32_16x16x32_bf16 v[144:147], a[72:75], a[152:155], v[144:147]
    ds_read_b64_tr_b16 a[108:109], v11 offset:320
    v_add_u32 v16, 66560, v16
    v_mfma_f32_16x16x32_bf16 v[148:151], a[72:75], a[156:159], v[148:151]
    buffer_load_dwordx4 v7, s[40:43], s38 offen offset:3072 lds
    v_mfma_f32_16x16x32_bf16 v[152:155], a[76:79], a[152:155], v[152:155]
    ds_read_b64_tr_b16 a[110:111], v11 offset:2368
    ds_read_b64_tr_b16 a[112:113], v10 offset:384
    v_mfma_f32_16x16x32_bf16 v[156:159], a[76:79], a[156:159], v[156:159]
    s_waitcnt lgkmcnt(13)
    ds_read_b64_tr_b16 a[114:115], v10 offset:2432
    v_lshl_add_u32 v40, v17, 4, v16
    v_mfma_f32_16x16x32_bf16 v[160:163], a[80:83], a[152:155], v[160:163]
    ds_read_b64_tr_b16 a[116:117], v11 offset:384
    v_xor_b32 v41, 64, v40
    v_mfma_f32_16x16x32_bf16 v[164:167], a[80:83], a[156:159], v[164:167]
    ds_read_b64_tr_b16 a[118:119], v11 offset:2432
    v_mfma_f32_16x16x32_bf16 v[168:171], a[84:87], a[152:155], v[168:171]
    ds_read_b64_tr_b16 a[120:121], v10 offset:448
    v_xor_b32 v42, 0x80, v40
    v_mfma_f32_16x16x32_bf16 v[172:175], a[84:87], a[156:159], v[172:175]
    s_waitcnt lgkmcnt(13)
    ds_read_b64_tr_b16 a[122:123], v10 offset:2496
    v_xor_b32 v43, 0xc0, v40
    v_mfma_f32_16x16x32_bf16 v[176:179], a[88:91], a[152:155], v[176:179]
    s_waitcnt lgkmcnt(10)
    ds_read_b64_tr_b16 a[124:125], v11 offset:448
    v_mov_b32 v48, v15
    v_mfma_f32_16x16x32_bf16 v[180:183], a[88:91], a[156:159], v[180:183]
    s_waitcnt vmcnt(8)
    s_barrier
    v_mfma_f32_16x16x32_bf16 v[184:187], a[92:95], a[152:155], v[184:187]
    s_add_u32 m0, s35, 33280
    ds_read_b64_tr_b16 a[126:127], v11 offset:2496
    ds_read_b64_tr_b16 a[64:65], v10 offset:33280
    v_mfma_f32_16x16x32_bf16 v[188:191], a[92:95], a[156:159], v[188:191]
    s_add_u32 s38, s39, 3407872
    ds_read_b64_tr_b16 a[66:67], v10 offset:35328
    v_xor_b32 v49, 32, v15
    v_mfma_f32_16x16x32_bf16 v[192:195], a[96:99], a[152:155], v[192:195]
    buffer_load_dwordx4 v4, s[40:43], s38 offen offset:0 lds
    v_mfma_f32_16x16x32_bf16 v[196:199], a[96:99], a[156:159], v[196:199]
    ds_read_b64_tr_b16 a[68:69], v11 offset:33280
    ds_read_b64_tr_b16 a[70:71], v11 offset:35328
    v_mfma_f32_16x16x32_bf16 v[200:203], a[100:103], a[152:155], v[200:203]
    s_waitcnt lgkmcnt(12)
    ds_read_b64_tr_b16 a[72:73], v10 offset:33344
    v_mfma_f32_16x16x32_bf16 v[204:207], a[100:103], a[156:159], v[204:207]
    buffer_load_dwordx4 v5, s[40:43], s38 offen offset:1024 lds
    v_mfma_f32_16x16x32_bf16 v[208:211], a[104:107], a[152:155], v[208:211]
    ds_read_b64_tr_b16 a[74:75], v10 offset:35392
    ds_read_b64_tr_b16 a[76:77], v11 offset:33344
    v_mfma_f32_16x16x32_bf16 v[212:215], a[104:107], a[156:159], v[212:215]
    ds_read_b64_tr_b16 a[78:79], v11 offset:35392
    v_mov_b32 v50, 0
    v_mfma_f32_16x16x32_bf16 v[216:219], a[108:111], a[152:155], v[216:219]
    buffer_load_dwordx4 v6, s[40:43], s38 offen offset:2048 lds
    v_mfma_f32_16x16x32_bf16 v[220:223], a[108:111], a[156:159], v[220:223]
    s_waitcnt lgkmcnt(12)
    ds_read_b64_tr_b16 a[80:81], v10 offset:33408
    ds_read_b64_tr_b16 a[82:83], v10 offset:35456
    v_mfma_f32_16x16x32_bf16 v[224:227], a[112:115], a[152:155], v[224:227]
    s_waitcnt lgkmcnt(10)
    ds_read_b64_tr_b16 a[84:85], v11 offset:33408
    v_mov_b32 v51, 0
    v_mfma_f32_16x16x32_bf16 v[228:231], a[112:115], a[156:159], v[228:231]
    buffer_load_dwordx4 v7, s[40:43], s38 offen offset:3072 lds
    v_mfma_f32_16x16x32_bf16 v[232:235], a[116:119], a[152:155], v[232:235]
    s_add_u32 m0, s35, 49920
    ds_read_b64_tr_b16 a[86:87], v11 offset:35456
    ds_read_b64_tr_b16 a[88:89], v10 offset:33472
    v_mfma_f32_16x16x32_bf16 v[236:239], a[116:119], a[156:159], v[236:239]
    s_add_u32 s38, s39, 1573376
    ds_read_b64_tr_b16 a[90:91], v10 offset:35520
    v_and_b32 v1, 63, v0
    v_mfma_f32_16x16x32_bf16 v[240:243], a[120:123], a[152:155], v[240:243]
    buffer_load_dwordx4 v4, s[40:43], s38 offen offset:0 lds
    v_mfma_f32_16x16x32_bf16 v[244:247], a[120:123], a[156:159], v[244:247]
    ds_read_b64_tr_b16 a[92:93], v11 offset:33472
    ds_read_b64_tr_b16 a[94:95], v11 offset:35520
    v_mfma_f32_16x16x32_bf16 v[248:251], a[124:127], a[152:155], v[248:251]
    s_waitcnt lgkmcnt(12)
    ds_read_b64_tr_b16 a[96:97], v10 offset:33536
    v_mfma_f32_16x16x32_bf16 v[252:255], a[124:127], a[156:159], v[252:255]
    buffer_load_dwordx4 v5, s[40:43], s38 offen offset:1024 lds
    v_mfma_f32_16x16x32_bf16 v[128:131], a[64:67], a[160:163], v[128:131]
    ds_read_b64_tr_b16 a[98:99], v10 offset:35584
    ds_read_b64_tr_b16 a[100:101], v11 offset:33536
    v_add_u32 v16, 0, v1
    v_mfma_f32_16x16x32_bf16 v[132:135], a[64:67], a[164:167], v[132:135]
    ds_read_b64_tr_b16 a[102:103], v11 offset:35584
    v_mul_u32_u24 v16, s31, v16
    v_mfma_f32_16x16x32_bf16 v[136:139], a[68:71], a[160:163], v[136:139]
    buffer_load_dwordx4 v6, s[40:43], s38 offen offset:2048 lds
    v_mfma_f32_16x16x32_bf16 v[140:143], a[68:71], a[164:167], v[140:143]
    s_waitcnt lgkmcnt(12)
    ds_read_b64_tr_b16 a[104:105], v10 offset:33600
    ds_read_b64_tr_b16 a[106:107], v10 offset:35648
    v_mfma_f32_16x16x32_bf16 v[144:147], a[72:75], a[160:163], v[144:147]
    ds_read_b64_tr_b16 a[108:109], v11 offset:33600
    v_bfe_u32 v16, v16, 17, 2
    v_mfma_f32_16x16x32_bf16 v[148:151], a[72:75], a[164:167], v[148:151]
    buffer_load_dwordx4 v7, s[40:43], s38 offen offset:3072 lds
    v_mfma_f32_16x16x32_bf16 v[152:155], a[76:79], a[160:163], v[152:155]
    ds_read_b64_tr_b16 a[110:111], v11 offset:35648
    ds_read_b64_tr_b16 a[112:113], v10 offset:33664
    v_mfma_f32_16x16x32_bf16 v[156:159], a[76:79], a[164:167], v[156:159]
    s_waitcnt lgkmcnt(13)
    ds_read_b64_tr_b16 a[114:115], v10 offset:35712
    v_lshlrev_b32 v16, 5, v16
    v_xor_b32 v44, v16, v12
    v_mfma_f32_16x16x32_bf16 v[160:163], a[80:83], a[160:163], v[160:163]
    ds_read_b64_tr_b16 a[116:117], v11 offset:33664
    v_add_u32 v16, 64, v1
    v_mfma_f32_16x16x32_bf16 v[164:167], a[80:83], a[164:167], v[164:167]
    ds_read_b64_tr_b16 a[118:119], v11 offset:35712
    v_mul_u32_u24 v16, s31, v16
    v_bfe_u32 v16, v16, 17, 2
    v_mfma_f32_16x16x32_bf16 v[168:171], a[84:87], a[160:163], v[168:171]
    ds_read_b64_tr_b16 a[120:121], v10 offset:33728
    v_lshlrev_b32 v16, 5, v16
    v_mfma_f32_16x16x32_bf16 v[172:175], a[84:87], a[164:167], v[172:175]
    s_waitcnt lgkmcnt(13)
    ds_read_b64_tr_b16 a[122:123], v10 offset:35776
    v_xor_b32 v45, v16, v12
    v_mfma_f32_16x16x32_bf16 v[176:179], a[88:91], a[160:163], v[176:179]
    ds_read_b64_tr_b16 a[124:125], v11 offset:33728
    v_add_u32 v16, 128, v1
    v_mfma_f32_16x16x32_bf16 v[180:183], a[88:91], a[164:167], v[180:183]
    s_waitcnt vmcnt(8)
    s_barrier
    v_mfma_f32_16x16x32_bf16 v[184:187], a[92:95], a[160:163], v[184:187]
    s_waitcnt lgkmcnt(11)
    ds_read_b64_tr_b16 a[126:127], v11 offset:35776
    ds_read_b64_tr_b16 a[64:65], v8 offset:0
    v_mfma_f32_16x16x32_bf16 v[188:191], a[92:95], a[164:167], v[188:191]
    s_add_u32 m0, s34, 66560
    ds_read_b64_tr_b16 a[66:67], v8 offset:2048
    v_mul_u32_u24 v16, s31, v16
    v_bfe_u32 v16, v16, 17, 2
    v_mfma_f32_16x16x32_bf16 v[192:195], a[96:99], a[160:163], v[192:195]
    buffer_load_dwordx4 v32, s[16:19], s32 offen offset:0 nt lds
    v_mfma_f32_16x16x32_bf16 v[196:199], a[96:99], a[164:167], v[196:199]
    ds_read_b64_tr_b16 a[68:69], v9 offset:0
    ds_read_b64_tr_b16 a[70:71], v9 offset:2048
    v_mfma_f32_16x16x32_bf16 v[200:203], a[100:103], a[160:163], v[200:203]
    s_waitcnt lgkmcnt(12)
    ds_read_b64_tr_b16 a[72:73], v8 offset:64
    v_lshlrev_b32 v16, 5, v16
    v_xor_b32 v46, v16, v12
    v_mfma_f32_16x16x32_bf16 v[204:207], a[100:103], a[164:167], v[204:207]
    buffer_load_dwordx4 v33, s[16:19], s32 offen offset:1024 nt lds
    v_mfma_f32_16x16x32_bf16 v[208:211], a[104:107], a[160:163], v[208:211]
    ds_read_b64_tr_b16 a[74:75], v8 offset:2112
    ds_read_b64_tr_b16 a[76:77], v9 offset:64
    v_mfma_f32_16x16x32_bf16 v[212:215], a[104:107], a[164:167], v[212:215]
    ds_read_b64_tr_b16 a[78:79], v9 offset:2112
    v_add_u32 v16, 192, v1
    v_mfma_f32_16x16x32_bf16 v[216:219], a[108:111], a[160:163], v[216:219]
    buffer_load_dwordx4 v34, s[16:19], s32 offen offset:2048 nt lds
    v_mfma_f32_16x16x32_bf16 v[220:223], a[108:111], a[164:167], v[220:223]
    s_waitcnt lgkmcnt(12)
    ds_read_b64_tr_b16 a[80:81], v8 offset:128
    ds_read_b64_tr_b16 a[82:83], v8 offset:2176
    v_mfma_f32_16x16x32_bf16 v[224:227], a[112:115], a[160:163], v[224:227]
    s_waitcnt lgkmcnt(10)
    ds_read_b64_tr_b16 a[84:85], v9 offset:128
    v_mul_u32_u24 v16, s31, v16
    v_mfma_f32_16x16x32_bf16 v[228:231], a[112:115], a[164:167], v[228:231]
    buffer_load_dwordx4 v35, s[16:19], s32 offen offset:3072 nt lds
    v_mfma_f32_16x16x32_bf16 v[232:235], a[116:119], a[160:163], v[232:235]
    s_add_u32 s32, s32, 16384
    ds_read_b64_tr_b16 a[86:87], v9 offset:2176
    ds_read_b64_tr_b16 a[88:89], v8 offset:192
    v_mfma_f32_16x16x32_bf16 v[236:239], a[116:119], a[164:167], v[236:239]
    s_add_u32 m0, s34, 83200
    ds_read_b64_tr_b16 a[90:91], v8 offset:2240
    v_bfe_u32 v16, v16, 17, 2
    v_mfma_f32_16x16x32_bf16 v[240:243], a[120:123], a[160:163], v[240:243]
    buffer_load_dwordx4 v32, s[16:19], s32 offen offset:0 nt lds
    v_mfma_f32_16x16x32_bf16 v[244:247], a[120:123], a[164:167], v[244:247]
    ds_read_b64_tr_b16 a[92:93], v9 offset:192
    ds_read_b64_tr_b16 a[94:95], v9 offset:2240
    v_lshlrev_b32 v16, 5, v16
    v_mfma_f32_16x16x32_bf16 v[248:251], a[124:127], a[160:163], v[248:251]
    s_waitcnt lgkmcnt(12)
    ds_read_b64_tr_b16 a[96:97], v8 offset:256
    v_xor_b32 v47, v16, v12
    v_mfma_f32_16x16x32_bf16 v[252:255], a[124:127], a[164:167], v[252:255]
    buffer_load_dwordx4 v33, s[16:19], s32 offen offset:1024 nt lds
    v_mfma_f32_16x16x32_bf16 v[128:131], a[64:67], a[168:171], v[128:131]
    ds_read_b64_tr_b16 a[98:99], v8 offset:2304
    ds_read_b64_tr_b16 a[100:101], v9 offset:256
    v_add_u32 v16, 256, v1
    v_mfma_f32_16x16x32_bf16 v[132:135], a[64:67], a[172:175], v[132:135]
    ds_read_b64_tr_b16 a[102:103], v9 offset:2304
    v_mul_u32_u24 v16, s31, v16
    v_mfma_f32_16x16x32_bf16 v[136:139], a[68:71], a[168:171], v[136:139]
    buffer_load_dwordx4 v34, s[16:19], s32 offen offset:2048 nt lds
    v_mfma_f32_16x16x32_bf16 v[140:143], a[68:71], a[172:175], v[140:143]
    s_waitcnt lgkmcnt(12)
    ds_read_b64_tr_b16 a[104:105], v8 offset:320
    ds_read_b64_tr_b16 a[106:107], v8 offset:2368
    v_mfma_f32_16x16x32_bf16 v[144:147], a[72:75], a[168:171], v[144:147]
    ds_read_b64_tr_b16 a[108:109], v9 offset:320
    v_bfe_u32 v16, v16, 17, 2
    v_mfma_f32_16x16x32_bf16 v[148:151], a[72:75], a[172:175], v[148:151]
    buffer_load_dwordx4 v35, s[16:19], s32 offen offset:3072 nt lds
    v_mfma_f32_16x16x32_bf16 v[152:155], a[76:79], a[168:171], v[152:155]
    s_add_u32 s32, s32, 16384
    ds_read_b64_tr_b16 a[110:111], v9 offset:2368
    ds_read_b64_tr_b16 a[112:113], v8 offset:384
    v_mfma_f32_16x16x32_bf16 v[156:159], a[76:79], a[172:175], v[156:159]
    s_waitcnt lgkmcnt(13)
    ds_read_b64_tr_b16 a[114:115], v8 offset:2432
    v_lshlrev_b32 v16, 5, v16
    v_mfma_f32_16x16x32_bf16 v[160:163], a[80:83], a[168:171], v[160:163]
    ds_read_b64_tr_b16 a[116:117], v9 offset:384
    v_xor_b32 v28, v16, v12
    v_mfma_f32_16x16x32_bf16 v[164:167], a[80:83], a[172:175], v[164:167]
    ds_read_b64_tr_b16 a[118:119], v9 offset:2432
    v_add_u32 v16, 320, v1
    v_mul_u32_u24 v16, s31, v16
    v_mfma_f32_16x16x32_bf16 v[168:171], a[84:87], a[168:171], v[168:171]
    ds_read_b64_tr_b16 a[120:121], v8 offset:448
    v_bfe_u32 v16, v16, 17, 2
    v_mfma_f32_16x16x32_bf16 v[172:175], a[84:87], a[172:175], v[172:175]
    s_waitcnt lgkmcnt(13)
    ds_read_b64_tr_b16 a[122:123], v8 offset:2496
    v_lshlrev_b32 v16, 5, v16
    v_mfma_f32_16x16x32_bf16 v[176:179], a[88:91], a[168:171], v[176:179]
    ds_read_b64_tr_b16 a[124:125], v9 offset:448
    v_xor_b32 v29, v16, v12
    v_mfma_f32_16x16x32_bf16 v[180:183], a[88:91], a[172:175], v[180:183]
    s_waitcnt vmcnt(8)
    s_barrier
    v_mfma_f32_16x16x32_bf16 v[184:187], a[92:95], a[168:171], v[184:187]
    s_waitcnt lgkmcnt(11)
    ds_read_b64_tr_b16 a[126:127], v9 offset:2496
    ds_read_b64_tr_b16 a[64:65], v8 offset:33280
    v_mfma_f32_16x16x32_bf16 v[188:191], a[92:95], a[172:175], v[188:191]
    s_add_u32 m0, s34, 99840
    ds_read_b64_tr_b16 a[66:67], v8 offset:35328
    v_add_u32 v16, 384, v1
    v_mfma_f32_16x16x32_bf16 v[192:195], a[96:99], a[168:171], v[192:195]
    buffer_load_dwordx4 v32, s[16:19], s32 offen offset:0 nt lds
    v_mfma_f32_16x16x32_bf16 v[196:199], a[96:99], a[172:175], v[196:199]
    ds_read_b64_tr_b16 a[68:69], v9 offset:33280
    ds_read_b64_tr_b16 a[70:71], v9 offset:35328
    v_mfma_f32_16x16x32_bf16 v[200:203], a[100:103], a[168:171], v[200:203]
    s_waitcnt lgkmcnt(12)
    ds_read_b64_tr_b16 a[72:73], v8 offset:33344
    v_mul_u32_u24 v16, s31, v16
    v_bfe_u32 v16, v16, 17, 2
    v_mfma_f32_16x16x32_bf16 v[204:207], a[100:103], a[172:175], v[204:207]
    buffer_load_dwordx4 v33, s[16:19], s32 offen offset:1024 nt lds
    v_mfma_f32_16x16x32_bf16 v[208:211], a[104:107], a[168:171], v[208:211]
    ds_read_b64_tr_b16 a[74:75], v8 offset:35392
    ds_read_b64_tr_b16 a[76:77], v9 offset:33344
    v_mfma_f32_16x16x32_bf16 v[212:215], a[104:107], a[172:175], v[212:215]
    ds_read_b64_tr_b16 a[78:79], v9 offset:35392
    v_lshlrev_b32 v16, 5, v16
    v_mfma_f32_16x16x32_bf16 v[216:219], a[108:111], a[168:171], v[216:219]
    buffer_load_dwordx4 v34, s[16:19], s32 offen offset:2048 nt lds
    v_mfma_f32_16x16x32_bf16 v[220:223], a[108:111], a[172:175], v[220:223]
    s_waitcnt lgkmcnt(12)
    ds_read_b64_tr_b16 a[80:81], v8 offset:33408
    ds_read_b64_tr_b16 a[82:83], v8 offset:35456
    v_mfma_f32_16x16x32_bf16 v[224:227], a[112:115], a[168:171], v[224:227]
    ds_read_b64_tr_b16 a[84:85], v9 offset:33408
    v_xor_b32 v95, v16, v12
    v_mfma_f32_16x16x32_bf16 v[228:231], a[112:115], a[172:175], v[228:231]
    buffer_load_dwordx4 v35, s[16:19], s32 offen offset:3072 nt lds
    v_mfma_f32_16x16x32_bf16 v[232:235], a[116:119], a[168:171], v[232:235]
    s_add_u32 s32, s32, 16384
    ds_read_b64_tr_b16 a[86:87], v9 offset:35456
    ds_read_b64_tr_b16 a[88:89], v8 offset:33472
    v_mfma_f32_16x16x32_bf16 v[236:239], a[116:119], a[172:175], v[236:239]
    s_waitcnt lgkmcnt(13)
    ds_read_b64_tr_b16 a[90:91], v8 offset:35520
    v_lshrrev_b32 v16, 2, v1
    v_mfma_f32_16x16x32_bf16 v[240:243], a[120:123], a[168:171], v[240:243]
    ds_read_b64_tr_b16 a[92:93], v9 offset:33472
    v_mul_u32_u24 v16, 896, v16
    v_mfma_f32_16x16x32_bf16 v[244:247], a[120:123], a[172:175], v[244:247]
    ds_read_b64_tr_b16 a[94:95], v9 offset:35520
    v_and_b32 v17, 3, v0
    v_mfma_f32_16x16x32_bf16 v[248:251], a[124:127], a[168:171], v[248:251]
    ds_read_b64_tr_b16 a[96:97], v8 offset:33536
    v_lshl_add_u32 v16, v17, 3, v16
    v_mfma_f32_16x16x32_bf16 v[252:255], a[124:127], a[172:175], v[252:255]
    s_waitcnt lgkmcnt(13)
    ds_read_b64_tr_b16 a[98:99], v8 offset:35584
    v_bfe_u32 v17, v0, 3, 2
    v_mfma_f32_16x16x32_bf16 v[128:131], a[64:67], a[176:179], v[128:131]
    ds_read_b64_tr_b16 a[100:101], v9 offset:33536
    v_xor_b32 v18, s52, v17
    v_mfma_f32_16x16x32_bf16 v[132:135], a[64:67], a[180:183], v[132:135]
    ds_read_b64_tr_b16 a[102:103], v9 offset:35584
    v_lshl_add_u32 v88, v18, 5, v16
    v_mfma_f32_16x16x32_bf16 v[136:139], a[68:71], a[176:179], v[136:139]
    ds_read_b64_tr_b16 a[104:105], v8 offset:33600
    v_mfma_f32_16x16x32_bf16 v[140:143], a[68:71], a[180:183], v[140:143]
    s_waitcnt lgkmcnt(13)
    ds_read_b64_tr_b16 a[106:107], v8 offset:35648
    v_add_u32 v21, 66560, v88
    v_mfma_f32_16x16x32_bf16 v[144:147], a[72:75], a[176:179], v[144:147]
    ds_read_b64_tr_b16 a[108:109], v9 offset:33600
    v_mfma_f32_16x16x32_bf16 v[148:151], a[72:75], a[180:183], v[148:151]
    ds_read_b64_tr_b16 a[110:111], v9 offset:35648
    v_xor_b32 v18, s53, v17
    v_mfma_f32_16x16x32_bf16 v[152:155], a[76:79], a[176:179], v[152:155]
    ds_read_b64_tr_b16 a[112:113], v8 offset:33664
    v_mfma_f32_16x16x32_bf16 v[156:159], a[76:79], a[180:183], v[156:159]
    s_waitcnt lgkmcnt(13)
    ds_read_b64_tr_b16 a[114:115], v8 offset:35712
    v_lshl_add_u32 v89, v18, 5, v16
    v_mfma_f32_16x16x32_bf16 v[160:163], a[80:83], a[176:179], v[160:163]
    ds_read_b64_tr_b16 a[116:117], v9 offset:33664
    v_mfma_f32_16x16x32_bf16 v[164:167], a[80:83], a[180:183], v[164:167]
    ds_read_b64_tr_b16 a[118:119], v9 offset:35712
    v_add_u32 v22, 66560, v89
    v_mfma_f32_16x16x32_bf16 v[168:171], a[84:87], a[176:179], v[168:171]
    ds_read_b64_tr_b16 a[120:121], v8 offset:33728
    v_xor_b32 v18, s54, v17
    v_mfma_f32_16x16x32_bf16 v[172:175], a[84:87], a[180:183], v[172:175]
    s_waitcnt lgkmcnt(13)
    ds_read_b64_tr_b16 a[122:123], v8 offset:35776
    v_mfma_f32_16x16x32_bf16 v[176:179], a[88:91], a[176:179], v[176:179]
    ds_read_b64_tr_b16 a[124:125], v9 offset:33728
    v_lshl_add_u32 v90, v18, 5, v16
    v_mfma_f32_16x16x32_bf16 v[180:183], a[88:91], a[180:183], v[180:183]
    s_waitcnt vmcnt(8)
    s_barrier
    v_mfma_f32_16x16x32_bf16 v[184:187], a[92:95], a[176:179], v[184:187]
    s_waitcnt lgkmcnt(11)
    ds_read_b64_tr_b16 a[126:127], v9 offset:35776
    v_mfma_f32_16x16x32_bf16 v[188:191], a[92:95], a[180:183], v[188:191]
    s_add_u32 m0, s35, 0
    v_add_u32 v23, 66560, v90
    v_mfma_f32_16x16x32_bf16 v[192:195], a[96:99], a[176:179], v[192:195]
    buffer_load_dwordx4 v36, s[20:23], s33 offen offset:0 nt lds
    v_mfma_f32_16x16x32_bf16 v[196:199], a[96:99], a[180:183], v[196:199]
    v_xor_b32 v18, s55, v17
    v_mfma_f32_16x16x32_bf16 v[200:203], a[100:103], a[176:179], v[200:203]
    s_waitcnt lgkmcnt(8)
    v_lshl_add_u32 v91, v18, 5, v16
    v_add_u32 v24, 66560, v91
    v_mfma_f32_16x16x32_bf16 v[204:207], a[100:103], a[180:183], v[204:207]
    buffer_load_dwordx4 v37, s[20:23], s33 offen offset:1024 nt lds
    v_mfma_f32_16x16x32_bf16 v[208:211], a[104:107], a[176:179], v[208:211]
    v_xor_b32 v18, s56, v17
    v_mfma_f32_16x16x32_bf16 v[212:215], a[104:107], a[180:183], v[212:215]
    v_lshl_add_u32 v92, v18, 5, v16
    v_mfma_f32_16x16x32_bf16 v[216:219], a[108:111], a[176:179], v[216:219]
    buffer_load_dwordx4 v38, s[20:23], s33 offen offset:2048 nt lds
    v_mfma_f32_16x16x32_bf16 v[220:223], a[108:111], a[180:183], v[220:223]
    s_waitcnt lgkmcnt(4)
    v_add_u32 v25, 66560, v92
    v_mfma_f32_16x16x32_bf16 v[224:227], a[112:115], a[176:179], v[224:227]
    s_waitcnt lgkmcnt(0)
    v_xor_b32 v18, s57, v17
    v_mfma_f32_16x16x32_bf16 v[228:231], a[112:115], a[180:183], v[228:231]
    buffer_load_dwordx4 v39, s[20:23], s33 offen offset:3072 nt lds
    v_mfma_f32_16x16x32_bf16 v[232:235], a[116:119], a[176:179], v[232:235]
    s_add_u32 s33, s33, 16384
    v_lshl_add_u32 v93, v18, 5, v16
    v_mfma_f32_16x16x32_bf16 v[236:239], a[116:119], a[180:183], v[236:239]
    s_add_u32 m0, s35, 16640
    v_add_u32 v26, 66560, v93
    v_mfma_f32_16x16x32_bf16 v[240:243], a[120:123], a[176:179], v[240:243]
    buffer_load_dwordx4 v36, s[20:23], s33 offen offset:0 nt lds
    v_mfma_f32_16x16x32_bf16 v[244:247], a[120:123], a[180:183], v[244:247]
    v_xor_b32 v18, s58, v17
    v_mfma_f32_16x16x32_bf16 v[248:251], a[124:127], a[176:179], v[248:251]
    v_lshl_add_u32 v94, v18, 5, v16
    v_mfma_f32_16x16x32_bf16 v[252:255], a[124:127], a[180:183], v[252:255]
    v_add_u32 v27, 66560, v94
    s_load_dwordx4 s[4:7], s[0:1], 48
    s_load_dwordx2 s[8:9], s[0:1], 72
    s_load_dwordx2 s[10:11], s[0:1], 0
    s_load_dwordx2 s[54:55], s[0:1], 80
    s_load_dwordx2 s[56:57], s[0:1], 88
    s_waitcnt lgkmcnt(0)
    s_mov_b32 s40, s4
    s_mov_b32 s41, s5
    s_mov_b32 s42, 1605632
    s_mov_b32 s43, 0x20000
    ds_read_b128 a[64:67], v40 offset:0
    ds_read_b128 a[68:71], v40 offset:8192
    ds_read_b128 a[72:75], v41 offset:0
    ds_read_b128 a[76:79], v41 offset:8192
    ds_read_b128 a[80:83], v42 offset:0
    ds_read_b128 a[84:87], v42 offset:8192
    ds_read_b128 a[88:91], v43 offset:0
    ds_read_b128 a[92:95], v43 offset:8192
    ds_read_b128 a[96:99], v40 offset:256
    s_mul_i32 s53, s29, 458752
    s_mul_i32 s59, s28, 7168
    s_add_u32 s39, s53, s59
    s_sub_u32 s13, s2, 40
    s_lshl_b32 s13, s13, 12
    s_add_u32 s13, s13, 114688
    v_lshlrev_b32 v1, 4, v0
    v_mov_b32 v4, 0
    v_mov_b32 v5, 0
    v_mov_b32 v6, 0
    v_mov_b32 v7, 0
    s_sub_u32 s12, s2, 40
    s_cmp_ge_u32 s12, 36
    s_cselect_b32 s13, 0x40000000, s13
    s_cselect_b32 s31, 0, 1
    s_cmp_eq_u32 s28, 0
    s_cselect_b32 s31, s31, 0
    buffer_store_dwordx4 v[4:7], v1, s[24:27], s13 offen sc1
    v_cvt_pk_bf16_f32 v128, v128, v129
    v_cvt_pk_bf16_f32 v129, v130, v131
    v_cvt_pk_bf16_f32 v136, v136, v137
    v_cvt_pk_bf16_f32 v137, v138, v139
    v_cvt_pk_bf16_f32 v132, v132, v133
    v_cvt_pk_bf16_f32 v133, v134, v135
    v_cvt_pk_bf16_f32 v140, v140, v141
    v_cvt_pk_bf16_f32 v141, v142, v143
    v_permlane32_swap_b32 v128, v136
    v_permlane32_swap_b32 v129, v137
    v_permlane32_swap_b32 v132, v140
    v_permlane32_swap_b32 v133, v141
    v_permlane16_swap_b32 v128, v136
    v_permlane16_swap_b32 v129, v137
    v_permlane16_swap_b32 v132, v140
    v_permlane16_swap_b32 v133, v141
    v_accvgpr_write_b32 a0, v128
    v_accvgpr_write_b32 a1, v129
    v_accvgpr_write_b32 a2, v136
    v_accvgpr_write_b32 a3, v137
    v_accvgpr_write_b32 a4, v132
    v_accvgpr_write_b32 a5, v133
    v_accvgpr_write_b32 a6, v140
    v_accvgpr_write_b32 a7, v141
    v_cvt_pk_bf16_f32 v144, v144, v145
    v_cvt_pk_bf16_f32 v145, v146, v147
    v_cvt_pk_bf16_f32 v152, v152, v153
    v_cvt_pk_bf16_f32 v153, v154, v155
    v_cvt_pk_bf16_f32 v148, v148, v149
    v_cvt_pk_bf16_f32 v149, v150, v151
    v_cvt_pk_bf16_f32 v156, v156, v157
    v_cvt_pk_bf16_f32 v157, v158, v159
    v_permlane32_swap_b32 v144, v152
    v_permlane32_swap_b32 v145, v153
    v_permlane32_swap_b32 v148, v156
    v_permlane32_swap_b32 v149, v157
    v_permlane16_swap_b32 v144, v152
    v_permlane16_swap_b32 v145, v153
    v_permlane16_swap_b32 v148, v156
    v_permlane16_swap_b32 v149, v157
    v_accvgpr_write_b32 a8, v144
    v_accvgpr_write_b32 a9, v145
    v_accvgpr_write_b32 a10, v152
    v_accvgpr_write_b32 a11, v153
    v_accvgpr_write_b32 a12, v148
    v_accvgpr_write_b32 a13, v149
    v_accvgpr_write_b32 a14, v156
    v_accvgpr_write_b32 a15, v157
    v_cvt_pk_bf16_f32 v160, v160, v161
    v_cvt_pk_bf16_f32 v161, v162, v163
    v_cvt_pk_bf16_f32 v168, v168, v169
    v_cvt_pk_bf16_f32 v169, v170, v171
    v_cvt_pk_bf16_f32 v164, v164, v165
    v_cvt_pk_bf16_f32 v165, v166, v167
    v_cvt_pk_bf16_f32 v172, v172, v173
    v_cvt_pk_bf16_f32 v173, v174, v175
    v_permlane32_swap_b32 v160, v168
    v_permlane32_swap_b32 v161, v169
    v_permlane32_swap_b32 v164, v172
    v_permlane32_swap_b32 v165, v173
    v_permlane16_swap_b32 v160, v168
    v_permlane16_swap_b32 v161, v169
    v_permlane16_swap_b32 v164, v172
    v_permlane16_swap_b32 v165, v173
    v_accvgpr_write_b32 a16, v160
    v_accvgpr_write_b32 a17, v161
    v_accvgpr_write_b32 a18, v168
    v_accvgpr_write_b32 a19, v169
    v_accvgpr_write_b32 a20, v164
    v_accvgpr_write_b32 a21, v165
    v_accvgpr_write_b32 a22, v172
    v_accvgpr_write_b32 a23, v173
    v_cvt_pk_bf16_f32 v176, v176, v177
    v_cvt_pk_bf16_f32 v177, v178, v179
    v_cvt_pk_bf16_f32 v184, v184, v185
    v_cvt_pk_bf16_f32 v185, v186, v187
    v_cvt_pk_bf16_f32 v180, v180, v181
    v_cvt_pk_bf16_f32 v181, v182, v183
    v_cvt_pk_bf16_f32 v188, v188, v189
    v_cvt_pk_bf16_f32 v189, v190, v191
    v_permlane32_swap_b32 v176, v184
    v_permlane32_swap_b32 v177, v185
    v_permlane32_swap_b32 v180, v188
    v_permlane32_swap_b32 v181, v189
    v_permlane16_swap_b32 v176, v184
    v_permlane16_swap_b32 v177, v185
    v_permlane16_swap_b32 v180, v188
    v_permlane16_swap_b32 v181, v189
    v_accvgpr_write_b32 a24, v176
    v_accvgpr_write_b32 a25, v177
    v_accvgpr_write_b32 a26, v184
    v_accvgpr_write_b32 a27, v185
    v_accvgpr_write_b32 a28, v180
    v_accvgpr_write_b32 a29, v181
    v_accvgpr_write_b32 a30, v188
    v_accvgpr_write_b32 a31, v189
    v_cvt_pk_bf16_f32 v192, v192, v193
    v_cvt_pk_bf16_f32 v193, v194, v195
    v_cvt_pk_bf16_f32 v200, v200, v201
    v_cvt_pk_bf16_f32 v201, v202, v203
    v_cvt_pk_bf16_f32 v196, v196, v197
    v_cvt_pk_bf16_f32 v197, v198, v199
    v_cvt_pk_bf16_f32 v204, v204, v205
    v_cvt_pk_bf16_f32 v205, v206, v207
    v_permlane32_swap_b32 v192, v200
    v_permlane32_swap_b32 v193, v201
    v_permlane32_swap_b32 v196, v204
    v_permlane32_swap_b32 v197, v205
    v_permlane16_swap_b32 v192, v200
    v_permlane16_swap_b32 v193, v201
    v_permlane16_swap_b32 v196, v204
    v_permlane16_swap_b32 v197, v205
    v_accvgpr_write_b32 a32, v192
    v_accvgpr_write_b32 a33, v193
    v_accvgpr_write_b32 a34, v200
    v_accvgpr_write_b32 a35, v201
    v_accvgpr_write_b32 a36, v196
    v_accvgpr_write_b32 a37, v197
    v_accvgpr_write_b32 a38, v204
    v_accvgpr_write_b32 a39, v205
    v_cvt_pk_bf16_f32 v208, v208, v209
    v_cvt_pk_bf16_f32 v209, v210, v211
    v_cvt_pk_bf16_f32 v216, v216, v217
    v_cvt_pk_bf16_f32 v217, v218, v219
    v_cvt_pk_bf16_f32 v212, v212, v213
    v_cvt_pk_bf16_f32 v213, v214, v215
    v_cvt_pk_bf16_f32 v220, v220, v221
    v_cvt_pk_bf16_f32 v221, v222, v223
    v_permlane32_swap_b32 v208, v216
    v_permlane32_swap_b32 v209, v217
    v_permlane32_swap_b32 v212, v220
    v_permlane32_swap_b32 v213, v221
    v_permlane16_swap_b32 v208, v216
    v_permlane16_swap_b32 v209, v217
    v_permlane16_swap_b32 v212, v220
    v_permlane16_swap_b32 v213, v221
    v_accvgpr_write_b32 a40, v208
    v_accvgpr_write_b32 a41, v209
    v_accvgpr_write_b32 a42, v216
    v_accvgpr_write_b32 a43, v217
    v_accvgpr_write_b32 a44, v212
    v_accvgpr_write_b32 a45, v213
    v_accvgpr_write_b32 a46, v220
    v_accvgpr_write_b32 a47, v221
    v_cvt_pk_bf16_f32 v224, v224, v225
    v_cvt_pk_bf16_f32 v225, v226, v227
    v_cvt_pk_bf16_f32 v232, v232, v233
    v_cvt_pk_bf16_f32 v233, v234, v235
    v_cvt_pk_bf16_f32 v228, v228, v229
    v_cvt_pk_bf16_f32 v229, v230, v231
    v_cvt_pk_bf16_f32 v236, v236, v237
    v_cvt_pk_bf16_f32 v237, v238, v239
    v_permlane32_swap_b32 v224, v232
    v_permlane32_swap_b32 v225, v233
    v_permlane32_swap_b32 v228, v236
    v_permlane32_swap_b32 v229, v237
    v_permlane16_swap_b32 v224, v232
    v_permlane16_swap_b32 v225, v233
    v_permlane16_swap_b32 v228, v236
    v_permlane16_swap_b32 v229, v237
    v_accvgpr_write_b32 a48, v224
    v_accvgpr_write_b32 a49, v225
    v_accvgpr_write_b32 a50, v232
    v_accvgpr_write_b32 a51, v233
    v_accvgpr_write_b32 a52, v228
    v_accvgpr_write_b32 a53, v229
    v_accvgpr_write_b32 a54, v236
    v_accvgpr_write_b32 a55, v237
    v_cvt_pk_bf16_f32 v240, v240, v241
    v_cvt_pk_bf16_f32 v241, v242, v243
    v_cvt_pk_bf16_f32 v248, v248, v249
    v_cvt_pk_bf16_f32 v249, v250, v251
    v_cvt_pk_bf16_f32 v244, v244, v245
    v_cvt_pk_bf16_f32 v245, v246, v247
    v_cvt_pk_bf16_f32 v252, v252, v253
    v_cvt_pk_bf16_f32 v253, v254, v255
    v_permlane32_swap_b32 v240, v248
    v_permlane32_swap_b32 v241, v249
    v_permlane32_swap_b32 v244, v252
    v_permlane32_swap_b32 v245, v253
    v_permlane16_swap_b32 v240, v248
    v_permlane16_swap_b32 v241, v249
    v_permlane16_swap_b32 v244, v252
    v_permlane16_swap_b32 v245, v253
    v_accvgpr_write_b32 a56, v240
    v_accvgpr_write_b32 a57, v241
    v_accvgpr_write_b32 a58, v248
    v_accvgpr_write_b32 a59, v249
    v_accvgpr_write_b32 a60, v244
    v_accvgpr_write_b32 a61, v245
    v_accvgpr_write_b32 a62, v252
    v_accvgpr_write_b32 a63, v253
    s_waitcnt lgkmcnt(8)
    v_mfma_f32_16x16x32_bf16 v[96:99], a[64:67], a[0:3], 0
    v_mfma_f32_16x16x32_bf16 v[100:103], a[64:67], a[4:7], 0
    buffer_load_dwordx4 v37, s[20:23], s33 offen offset:1024 nt lds
    s_waitcnt lgkmcnt(7)
    v_mfma_f32_16x16x32_bf16 v[108:111], a[68:71], a[4:7], 0
    ds_read_b128 a[100:103], v40 offset:8448
    v_mfma_f32_16x16x32_bf16 v[104:107], a[68:71], a[0:3], 0
    s_waitcnt lgkmcnt(6)
    ds_read_b128 a[104:107], v41 offset:256
    ds_read_b128 a[108:111], v41 offset:8448
    v_mfma_f32_16x16x32_bf16 v[96:99], a[72:75], a[8:11], v[96:99]
    v_mfma_f32_16x16x32_bf16 v[100:103], a[72:75], a[12:15], v[100:103]
    ds_read_b128 a[112:115], v42 offset:256
    v_mfma_f32_16x16x32_bf16 v[108:111], a[76:79], a[12:15], v[108:111]
    ds_read_b128 a[116:119], v42 offset:8448
    v_mfma_f32_16x16x32_bf16 v[104:107], a[76:79], a[8:11], v[104:107]
    s_waitcnt lgkmcnt(8)
    v_mfma_f32_16x16x32_bf16 v[96:99], a[80:83], a[16:19], v[96:99]
    ds_read_b128 a[120:123], v43 offset:256
    v_mfma_f32_16x16x32_bf16 v[100:103], a[80:83], a[20:23], v[100:103]
    buffer_load_dwordx4 v38, s[20:23], s33 offen offset:2048 nt lds
    v_mfma_f32_16x16x32_bf16 v[108:111], a[84:87], a[20:23], v[108:111]
    ds_read_b128 a[124:127], v43 offset:8448
    v_mfma_f32_16x16x32_bf16 v[104:107], a[84:87], a[16:19], v[104:107]
    s_waitcnt lgkmcnt(8)
    v_mfma_f32_16x16x32_bf16 v[96:99], a[88:91], a[24:27], v[96:99]
    v_mfma_f32_16x16x32_bf16 v[100:103], a[88:91], a[28:31], v[100:103]
    v_mfma_f32_16x16x32_bf16 v[108:111], a[92:95], a[28:31], v[108:111]
    v_mfma_f32_16x16x32_bf16 v[104:107], a[92:95], a[24:27], v[104:107]
    s_waitcnt lgkmcnt(6)
    v_mfma_f32_16x16x32_bf16 v[96:99], a[96:99], a[32:35], v[96:99]
    v_mfma_f32_16x16x32_bf16 v[100:103], a[96:99], a[36:39], v[100:103]
    buffer_load_dwordx4 v39, s[20:23], s33 offen offset:3072 nt lds
    v_mfma_f32_16x16x32_bf16 v[108:111], a[100:103], a[36:39], v[108:111]
    s_add_u32 s33, s33, 16384
    v_mfma_f32_16x16x32_bf16 v[104:107], a[100:103], a[32:35], v[104:107]
    s_waitcnt lgkmcnt(4)
    v_mfma_f32_16x16x32_bf16 v[96:99], a[104:107], a[40:43], v[96:99]
    v_mfma_f32_16x16x32_bf16 v[100:103], a[104:107], a[44:47], v[100:103]
    v_mfma_f32_16x16x32_bf16 v[108:111], a[108:111], a[44:47], v[108:111]
    v_mfma_f32_16x16x32_bf16 v[104:107], a[108:111], a[40:43], v[104:107]
    s_waitcnt lgkmcnt(2)
    v_mfma_f32_16x16x32_bf16 v[96:99], a[112:115], a[48:51], v[96:99]
    s_add_u32 m0, s34, 116480
    v_mfma_f32_16x16x32_bf16 v[100:103], a[112:115], a[52:55], v[100:103]
    buffer_load_dwordx4 v32, s[16:19], s32 offen offset:0 nt lds
    v_mfma_f32_16x16x32_bf16 v[108:111], a[116:119], a[52:55], v[108:111]
    v_mfma_f32_16x16x32_bf16 v[104:107], a[116:119], a[48:51], v[104:107]
    s_waitcnt lgkmcnt(0)
    v_mfma_f32_16x16x32_bf16 v[96:99], a[120:123], a[56:59], v[96:99]
    v_mfma_f32_16x16x32_bf16 v[100:103], a[120:123], a[60:63], v[100:103]
    v_mfma_f32_16x16x32_bf16 v[108:111], a[124:127], a[60:63], v[108:111]
    v_mfma_f32_16x16x32_bf16 v[104:107], a[124:127], a[56:59], v[104:107]
    s_nop 4
    v_max3_f32 v54, v96, v97, v98
    s_nop 1
    v_max3_f32 v54, v54, v99, v104
    v_max3_f32 v54, v54, v105, v106
    v_max_f32 v54, v54, v107
    v_mov_b32 v31, v54
    s_nop 1
    v_permlane32_swap_b32 v54, v31
    v_max_f32 v54, v54, v31
    v_mov_b32 v31, v54
    s_nop 1
    v_permlane16_swap_b32 v54, v31
    v_max_f32 v54, v54, v31
    v_max3_f32 v55, v100, v101, v102
    v_max3_f32 v55, v55, v103, v108
    v_max3_f32 v55, v55, v109, v110
    v_max_f32 v55, v55, v111
    v_mov_b32 v31, v55
    s_nop 1
    v_permlane32_swap_b32 v55, v31
    v_max_f32 v55, v55, v31
    v_mov_b32 v31, v55
    s_nop 1
    v_permlane16_swap_b32 v55, v31
    v_max_f32 v55, v55, v31
    v_sub_f32 v80, 0, v54
    v_sub_f32 v81, 0, v54
    v_sub_f32 v82, 0, v54
    v_sub_f32 v83, 0, v54
    v_sub_f32 v84, 0, v55
    v_sub_f32 v85, 0, v55
    v_sub_f32 v86, 0, v55
    v_sub_f32 v87, 0, v55
    v_sub_f32 v96, v96, v54
    v_sub_f32 v97, v97, v54
    v_sub_f32 v98, v98, v54
    v_sub_f32 v99, v99, v54
    v_sub_f32 v100, v100, v55
    v_sub_f32 v101, v101, v55
    v_sub_f32 v102, v102, v55
    v_sub_f32 v103, v103, v55
    v_sub_f32 v104, v104, v54
    v_sub_f32 v105, v105, v54
    v_sub_f32 v106, v106, v54
    v_sub_f32 v107, v107, v54
    v_sub_f32 v108, v108, v55
    v_sub_f32 v109, v109, v55
    v_sub_f32 v110, v110, v55
    v_sub_f32 v111, v111, v55
    buffer_load_dwordx4 v33, s[16:19], s32 offen offset:1024 nt lds
    v_exp_f32 v56, v96
    v_exp_f32 v57, v97
    buffer_load_dwordx4 v34, s[16:19], s32 offen offset:2048 nt lds
    v_add_f32 v52, v56, v57
    v_exp_f32 v58, v98
    v_cvt_pk_bf16_f32 v64, v56, v57
    v_add_f32 v52, v52, v58
    v_exp_f32 v59, v99
    buffer_load_dwordx4 v35, s[16:19], s32 offen offset:3072 nt lds
    s_add_u32 s32, s32, 16384
    v_exp_f32 v60, v100
    v_add_f32 v52, v52, v59
    s_waitcnt vmcnt(9)
    s_barrier
    ds_read_b128 a[64:67], v40 offset:16640
    v_cvt_pk_bf16_f32 v65, v58, v59
    v_exp_f32 v61, v101
    ds_read_b128 a[68:71], v40 offset:24832
    v_add_f32 v53, v60, v61
    s_add_u32 m0, s35, 33280
    ds_read_b128 a[72:75], v41 offset:16640
    ds_read_b128 a[76:79], v41 offset:24832
    buffer_load_dwordx4 v36, s[20:23], s33 offen offset:0 nt lds
    v_exp_f32 v62, v102
    ds_read_b128 a[80:83], v42 offset:16640
    v_cvt_pk_bf16_f32 v68, v60, v61
    ds_read_b128 a[84:87], v42 offset:24832
    v_add_f32 v53, v53, v62
    v_exp_f32 v63, v103
    ds_read_b128 a[88:91], v43 offset:16640
    v_add_f32 v53, v53, v63
    s_waitcnt lgkmcnt(5)
    ds_read_b128 a[92:95], v43 offset:24832
    ds_read_b128 a[96:99], v40 offset:16896
    s_mov_b64 s[12:13], s[54:55]
    s_waitcnt vmcnt(8)
    v_min_u32 v1, 111, v0
    v_lshlrev_b32 v1, 7, v1
    s_mul_i32 s54, s30, 14336
    s_add_u32 s53, s53, s54
    buffer_load_dword v2, v1, s[44:47], s53 offen
    v_and_b32 v1, 63, v0
    s_lshl_b32 s14, s29, 5
    s_add_u32 s14, s14, s30
    s_lshl_b32 s14, s14, 15
    s_min_u32 s14, s14, 8352768
    s_mul_i32 s15, s28, 640
    s_add_u32 s14, s14, s15
    v_cmp_gt_u32 vcc, 5, v1
    s_nop 1
    v_cndmask_b32 v3, 0, v1, vcc
    v_lshl_add_u32 v3, v3, 7, s14
    v_mov_b32 v16, s6
    v_mov_b32 v17, s7
    v_mov_b32 v18, 2560
    v_mov_b32 v19, 0
    s_mul_i32 s14, s30, 50176
    s_mul_i32 s15, s48, 1792
    s_add_u32 s14, s14, s15
    s_and_b32 s15, s29, 1
    s_mul_i32 s15, s15, 896
    s_add_u32 s14, s14, s15
    s_and_b32 s15, s28, 1
    s_mul_i32 s15, s15, 384
    s_add_u32 s14, s14, s15
    s_mov_b64 exec, 0xf00
    v_and_b32 v3, 3, v1
    v_lshl_add_u32 v3, v3, 7, s14
    v_mov_b32 v16, s4
    v_mov_b32 v17, s5
    v_mov_b32 v18, 3584
    s_mov_b64 exec, -1
    s_mul_i32 s14, s2, 3200
    s_min_u32 s14, s14, 799232
    s_and_b32 s15, s28, 1
    s_lshl_b32 s15, s15, 7
    s_add_u32 s14, s14, s15
    v_writelane_b32 v3, s14, 6
    v_writelane_b32 v16, s8, 6
    v_writelane_b32 v17, s9, 6
    s_movk_i32 s14, 0x100
    v_writelane_b32 v18, s14, 6
    s_min_u32 s14, s2, 223
    s_lshl_b32 s14, s14, 1
    s_add_u32 s14, s14, s48
    s_mul_i32 s14, s14, 5376
    s_and_b32 s15, s28, 1
    s_add_u32 s15, s15, 1
    s_mul_i32 s15, s15, 1792
    s_add_u32 s14, s14, s15
    v_writelane_b32 v3, s14, 7
    v_writelane_b32 v16, s56, 7
    v_writelane_b32 v17, s57, 7
    s_movk_i32 s14, 0x80
    v_writelane_b32 v18, s14, 7
    v_add_co_u32 v16, vcc, v16, v3
    s_nop 1
    v_addc_co_u32 v17, vcc, 0, v17, vcc
    v_mfma_f32_16x16x32_bf16 v[112:115], a[64:67], a[0:3], v[80:83]
    v_exp_f32 v56, v104
    v_mfma_f32_16x16x32_bf16 v[116:119], a[64:67], a[4:7], v[84:87]
    buffer_load_dwordx4 v37, s[20:23], s33 offen offset:1024 nt lds
    v_mfma_f32_16x16x32_bf16 v[124:127], a[68:71], a[4:7], v[84:87]
    ds_read_b128 a[100:103], v40 offset:25088
    v_cvt_pk_bf16_f32 v69, v62, v63
    v_mfma_f32_16x16x32_bf16 v[120:123], a[68:71], a[0:3], v[80:83]
    s_waitcnt lgkmcnt(6)
    ds_read_b128 a[104:107], v41 offset:16896
    ds_read_b128 a[108:111], v41 offset:25088
    v_mfma_f32_16x16x32_bf16 v[112:115], a[72:75], a[8:11], v[112:115]
    v_exp_f32 v57, v105
    v_mfma_f32_16x16x32_bf16 v[116:119], a[72:75], a[12:15], v[116:119]
    ds_read_b128 a[112:115], v42 offset:16896
    v_add_f32 v52, v52, v56
    v_mfma_f32_16x16x32_bf16 v[124:127], a[76:79], a[12:15], v[124:127]
    ds_read_b128 a[116:119], v42 offset:25088
    v_add_f32 v52, v52, v57
    v_mfma_f32_16x16x32_bf16 v[120:123], a[76:79], a[8:11], v[120:123]
    s_waitcnt lgkmcnt(8)
    v_exp_f32 v58, v106
    v_mfma_f32_16x16x32_bf16 v[112:115], a[80:83], a[16:19], v[112:115]
    ds_read_b128 a[120:123], v43 offset:16896
    v_cvt_pk_bf16_f32 v66, v56, v57
    v_mfma_f32_16x16x32_bf16 v[116:119], a[80:83], a[20:23], v[116:119]
    buffer_load_dwordx4 v38, s[20:23], s33 offen offset:2048 nt lds
    v_mfma_f32_16x16x32_bf16 v[124:127], a[84:87], a[20:23], v[124:127]
    ds_read_b128 a[124:127], v43 offset:25088
    ds_read_b64_tr_b16 a[64:65], v48 offset:0
    v_mfma_f32_16x16x32_bf16 v[120:123], a[84:87], a[16:19], v[120:123]
    s_waitcnt lgkmcnt(9)
    v_exp_f32 v59, v107
    v_mfma_f32_16x16x32_bf16 v[112:115], a[88:91], a[24:27], v[112:115]
    ds_read_b64_tr_b16 a[66:67], v48 offset:2048
    v_add_f32 v52, v52, v58
    v_mfma_f32_16x16x32_bf16 v[116:119], a[88:91], a[28:31], v[116:119]
    ds_read_b64_tr_b16 a[68:69], v49 offset:0
    ds_read_b64_tr_b16 a[70:71], v49 offset:2048
    v_mfma_f32_16x16x32_bf16 v[124:127], a[92:95], a[28:31], v[124:127]
    v_exp_f32 v60, v108
    v_mfma_f32_16x16x32_bf16 v[120:123], a[92:95], a[24:27], v[120:123]
    s_waitcnt lgkmcnt(10)
    ds_read_b64_tr_b16 a[72:73], v48 offset:64
    v_add_f32 v52, v52, v59
    v_mfma_f32_16x16x32_bf16 v[112:115], a[96:99], a[32:35], v[112:115]
    ds_read_b64_tr_b16 a[74:75], v48 offset:2112
    v_cvt_pk_bf16_f32 v67, v58, v59
    v_mfma_f32_16x16x32_bf16 v[116:119], a[96:99], a[36:39], v[116:119]
    buffer_load_dwordx4 v39, s[20:23], s33 offen offset:3072 nt lds
    v_mfma_f32_16x16x32_bf16 v[124:127], a[100:103], a[36:39], v[124:127]
    s_add_u32 s33, s33, 16384
    v_exp_f32 v61, v109
    v_mfma_f32_16x16x32_bf16 v[120:123], a[100:103], a[32:35], v[120:123]
    s_waitcnt lgkmcnt(10)
    ds_read_b64_tr_b16 a[76:77], v49 offset:64
    v_add_f32 v53, v53, v60
    v_mfma_f32_16x16x32_bf16 v[112:115], a[104:107], a[40:43], v[112:115]
    ds_read_b64_tr_b16 a[78:79], v49 offset:2112
    ds_read_b64_tr_b16 a[80:81], v48 offset:128
    v_mfma_f32_16x16x32_bf16 v[116:119], a[104:107], a[44:47], v[116:119]
    v_exp_f32 v62, v110
    v_mfma_f32_16x16x32_bf16 v[124:127], a[108:111], a[44:47], v[124:127]
    ds_read_b64_tr_b16 a[82:83], v48 offset:2176
    v_add_f32 v53, v53, v61
    v_mfma_f32_16x16x32_bf16 v[120:123], a[108:111], a[40:43], v[120:123]
    s_waitcnt lgkmcnt(12)
    ds_read_b64_tr_b16 a[84:85], v49 offset:128
    v_cvt_pk_bf16_f32 v70, v60, v61
    v_mfma_f32_16x16x32_bf16 v[112:115], a[112:115], a[48:51], v[112:115]
    s_add_u32 m0, s34, 66560
    v_exp_f32 v63, v111
    v_mfma_f32_16x16x32_bf16 v[116:119], a[112:115], a[52:55], v[116:119]
    buffer_load_dwordx4 v32, s[16:19], s32 offen offset:0 nt lds
    v_mfma_f32_16x16x32_bf16 v[124:127], a[116:119], a[52:55], v[124:127]
    ds_read_b64_tr_b16 a[86:87], v49 offset:2176
    v_add_f32 v53, v53, v62
    v_mfma_f32_16x16x32_bf16 v[120:123], a[116:119], a[48:51], v[120:123]
    s_waitcnt lgkmcnt(12)
    ds_read_b64_tr_b16 a[88:89], v48 offset:192
    v_add_f32 v53, v53, v63
    v_mfma_f32_16x16x32_bf16 v[112:115], a[120:123], a[56:59], v[112:115]
    ds_read_b64_tr_b16 a[90:91], v48 offset:2240
    v_add_f32 v30, v52, v53
    v_mfma_f32_16x16x32_bf16 v[116:119], a[120:123], a[60:63], v[116:119]
    ds_read_b64_tr_b16 a[92:93], v49 offset:192
    v_cmp_lt_f32 vcc, s37, v30
    v_mfma_f32_16x16x32_bf16 v[124:127], a[124:127], a[60:63], v[124:127]
    s_waitcnt lgkmcnt(11)
    ds_read_b64_tr_b16 a[94:95], v49 offset:2240
    v_cvt_pk_bf16_f32 v71, v62, v63
    v_mfma_f32_16x16x32_bf16 v[120:123], a[124:127], a[56:59], v[120:123]
    s_cbranch_vccnz L_fb1
L_ret1:
    v_mfma_f32_16x16x32_bf16 v[128:131], a[64:67], v[64:67], 0
    ds_read_b64_tr_b16 a[96:97], v48 offset:256
    v_add_f32 v50, v50, v52
    v_mfma_f32_16x16x32_bf16 v[132:135], a[64:67], v[68:71], 0
    buffer_load_dwordx4 v33, s[16:19], s32 offen offset:1024 nt lds
    v_mfma_f32_16x16x32_bf16 v[136:139], a[68:71], v[64:67], 0
    ds_read_b64_tr_b16 a[98:99], v48 offset:2304
    v_add_f32 v51, v51, v53
    v_mfma_f32_16x16x32_bf16 v[140:143], a[68:71], v[68:71], 0
    s_waitcnt lgkmcnt(10)
    ds_read_b64_tr_b16 a[100:101], v49 offset:256
    ds_read_b64_tr_b16 a[102:103], v49 offset:2304
    v_mfma_f32_16x16x32_bf16 v[144:147], a[72:75], v[64:67], 0
    v_exp_f32 v56, v112
    v_mfma_f32_16x16x32_bf16 v[148:151], a[72:75], v[68:71], 0
    ds_read_b64_tr_b16 a[104:105], v48 offset:320
    v_mfma_f32_16x16x32_bf16 v[152:155], a[76:79], v[64:67], 0
    ds_read_b64_tr_b16 a[106:107], v48 offset:2368
    v_mfma_f32_16x16x32_bf16 v[156:159], a[76:79], v[68:71], 0
    s_waitcnt lgkmcnt(10)
    ds_read_b64_tr_b16 a[108:109], v49 offset:320
    ds_read_b64_tr_b16 a[110:111], v49 offset:2368
    v_mfma_f32_16x16x32_bf16 v[160:163], a[80:83], v[64:67], 0
    v_exp_f32 v57, v113
    v_mfma_f32_16x16x32_bf16 v[164:167], a[80:83], v[68:71], 0
    buffer_load_dwordx4 v34, s[16:19], s32 offen offset:2048 nt lds
    v_mfma_f32_16x16x32_bf16 v[168:171], a[84:87], v[64:67], 0
    ds_read_b64_tr_b16 a[112:113], v48 offset:384
    v_add_f32 v52, v56, v57
    v_mfma_f32_16x16x32_bf16 v[172:175], a[84:87], v[68:71], 0
    s_waitcnt lgkmcnt(9)
    v_exp_f32 v58, v114
    v_mfma_f32_16x16x32_bf16 v[176:179], a[88:91], v[64:67], 0
    ds_read_b64_tr_b16 a[114:115], v48 offset:2432
    v_cvt_pk_bf16_f32 v72, v56, v57
    v_mfma_f32_16x16x32_bf16 v[180:183], a[88:91], v[68:71], 0
    ds_read_b64_tr_b16 a[116:117], v49 offset:384
    v_add_f32 v52, v52, v58
    v_mfma_f32_16x16x32_bf16 v[184:187], a[92:95], v[64:67], 0
    ds_read_b64_tr_b16 a[118:119], v49 offset:2432
    ds_read_b64_tr_b16 a[120:121], v48 offset:448
    v_mfma_f32_16x16x32_bf16 v[188:191], a[92:95], v[68:71], 0
    s_waitcnt lgkmcnt(9)
    v_exp_f32 v59, v115
    v_mfma_f32_16x16x32_bf16 v[192:195], a[96:99], v[64:67], 0
    ds_read_b64_tr_b16 a[122:123], v48 offset:2496
    ds_read_b64_tr_b16 a[124:125], v49 offset:448
    v_mfma_f32_16x16x32_bf16 v[196:199], a[96:99], v[68:71], 0
    buffer_load_dwordx4 v35, s[16:19], s32 offen offset:3072 nt lds
    v_mfma_f32_16x16x32_bf16 v[200:203], a[100:103], v[64:67], 0
    s_add_u32 s32, s32, 16384
    v_exp_f32 v60, v116
    v_mfma_f32_16x16x32_bf16 v[204:207], a[100:103], v[68:71], 0
    s_waitcnt lgkmcnt(7)
    ds_read_b64_tr_b16 a[126:127], v49 offset:2496
    v_add_f32 v52, v52, v59
    v_mfma_f32_16x16x32_bf16 v[208:211], a[104:107], v[64:67], 0
    s_waitcnt vmcnt(13)
    s_barrier
    v_mfma_f32_16x16x32_bf16 v[212:215], a[104:107], v[68:71], 0
    ds_read_b128 a[64:67], v40 offset:33280
    v_cvt_pk_bf16_f32 v73, v58, v59
    v_mfma_f32_16x16x32_bf16 v[216:219], a[108:111], v[64:67], 0
    v_exp_f32 v61, v117
    v_mfma_f32_16x16x32_bf16 v[220:223], a[108:111], v[68:71], 0
    s_waitcnt lgkmcnt(5)
    ds_read_b128 a[68:71], v40 offset:41472
    v_add_f32 v53, v60, v61
    v_mfma_f32_16x16x32_bf16 v[224:227], a[112:115], v[64:67], 0
    s_add_u32 m0, s35, 49920
    ds_read_b128 a[72:75], v41 offset:33280
    ds_read_b128 a[76:79], v41 offset:41472
    v_mfma_f32_16x16x32_bf16 v[228:231], a[112:115], v[68:71], 0
    buffer_load_dwordx4 v36, s[20:23], s33 offen offset:0 nt lds
    v_mfma_f32_16x16x32_bf16 v[232:235], a[116:119], v[64:67], 0
    v_exp_f32 v62, v118
    v_mfma_f32_16x16x32_bf16 v[236:239], a[116:119], v[68:71], 0
    s_waitcnt lgkmcnt(4)
    ds_read_b128 a[80:83], v42 offset:33280
    v_cvt_pk_bf16_f32 v76, v60, v61
    v_mfma_f32_16x16x32_bf16 v[240:243], a[120:123], v[64:67], 0
    s_mov_b32 s36, 14
    ds_read_b128 a[84:87], v42 offset:41472
    v_add_f32 v53, v53, v62
    v_mfma_f32_16x16x32_bf16 v[244:247], a[120:123], v[68:71], 0
    v_exp_f32 v63, v119
    v_mfma_f32_16x16x32_bf16 v[248:251], a[124:127], v[64:67], 0
    ds_read_b128 a[88:91], v43 offset:33280
    v_add_f32 v53, v53, v63
    v_mfma_f32_16x16x32_bf16 v[252:255], a[124:127], v[68:71], 0
    s_waitcnt lgkmcnt(5)
    ds_read_b128 a[92:95], v43 offset:41472
    ds_read_b128 a[96:99], v40 offset:33536
    s_cmp_eq_u32 s31, 0
    s_cbranch_scc1 L_naadaLN_cond__gqa_block_cached__mixer_gmlp__prompt_kernel
    v_mov_b32 v1, 1
    v_mov_b32 v3, 0
    s_mov_b64 exec, 1
    buffer_atomic_add v1, v3, s[92:95], 0 offen offset:4 sc1
    s_mov_b64 exec, -1
L_naadaLN_cond__gqa_block_cached__mixer_gmlp__prompt_kernel:
    s_mov_b32 s52, s56
    s_mov_b32 s53, s57
    s_mov_b32 s54, 2408448
    s_mov_b32 s55, 0x20000
    v_and_b32 v1, 3, v0
    v_lshrrev_b32 v4, 2, v0
    v_mul_u32_u24 v5, 14, v4
    v_and_b32 v5, -4, v5
    v_mul_u32_u24 v4, 37632, v4
    v_lshl_add_u32 v4, v1, 4, v4
    v_mov_b32 v10, 1
    v_mov_b32 v11, 0x40000000
    v_cmp_ne_u32 vcc, 0, v0
    s_nop 1
    v_cndmask_b32 v11, 0, v11, vcc
    v_lshlrev_b32 v6, 2, v0
    v_add_u32 v6, 149760, v6
    v_mov_b32 v7, 149760
L_loopadaLN_cond__gqa_block_cached__mixer_gmlp__prompt_kernel:
    v_mfma_f32_16x16x32_bf16 v[96:99], a[64:67], a[0:3], v[80:83]
    v_exp_f32 v56, v120
    v_mfma_f32_16x16x32_bf16 v[100:103], a[64:67], a[4:7], v[84:87]
    buffer_load_dwordx4 v37, s[20:23], s33 offen offset:1024 nt lds
    v_mfma_f32_16x16x32_bf16 v[108:111], a[68:71], a[4:7], v[84:87]
    ds_read_b128 a[100:103], v40 offset:41728
    v_cvt_pk_bf16_f32 v77, v62, v63
    v_mfma_f32_16x16x32_bf16 v[104:107], a[68:71], a[0:3], v[80:83]
    s_waitcnt lgkmcnt(6)
    ds_read_b128 a[104:107], v41 offset:33536
    ds_read_b128 a[108:111], v41 offset:41728
    v_mfma_f32_16x16x32_bf16 v[96:99], a[72:75], a[8:11], v[96:99]
    v_exp_f32 v57, v121
    v_mfma_f32_16x16x32_bf16 v[100:103], a[72:75], a[12:15], v[100:103]
    ds_read_b128 a[112:115], v42 offset:33536
    v_add_f32 v52, v52, v56
    v_mfma_f32_16x16x32_bf16 v[108:111], a[76:79], a[12:15], v[108:111]
    ds_read_b128 a[116:119], v42 offset:41728
    v_add_f32 v52, v52, v57
    v_mfma_f32_16x16x32_bf16 v[104:107], a[76:79], a[8:11], v[104:107]
    s_waitcnt lgkmcnt(8)
    v_exp_f32 v58, v122
    v_mfma_f32_16x16x32_bf16 v[96:99], a[80:83], a[16:19], v[96:99]
    ds_read_b128 a[120:123], v43 offset:33536
    v_cvt_pk_bf16_f32 v74, v56, v57
    v_mfma_f32_16x16x32_bf16 v[100:103], a[80:83], a[20:23], v[100:103]
    buffer_load_dwordx4 v38, s[20:23], s33 offen offset:2048 nt lds
    v_mfma_f32_16x16x32_bf16 v[108:111], a[84:87], a[20:23], v[108:111]
    ds_read_b128 a[124:127], v43 offset:41728
    ds_read_b64_tr_b16 a[64:65], v48 offset:16640
    v_mfma_f32_16x16x32_bf16 v[104:107], a[84:87], a[16:19], v[104:107]
    s_waitcnt lgkmcnt(9)
    v_exp_f32 v59, v123
    v_mfma_f32_16x16x32_bf16 v[96:99], a[88:91], a[24:27], v[96:99]
    ds_read_b64_tr_b16 a[66:67], v48 offset:18688
    v_add_f32 v52, v52, v58
    v_mfma_f32_16x16x32_bf16 v[100:103], a[88:91], a[28:31], v[100:103]
    ds_read_b64_tr_b16 a[68:69], v49 offset:16640
    ds_read_b64_tr_b16 a[70:71], v49 offset:18688
    v_mfma_f32_16x16x32_bf16 v[108:111], a[92:95], a[28:31], v[108:111]
    v_exp_f32 v60, v124
    v_mfma_f32_16x16x32_bf16 v[104:107], a[92:95], a[24:27], v[104:107]
    s_waitcnt lgkmcnt(10)
    ds_read_b64_tr_b16 a[72:73], v48 offset:16704
    v_add_f32 v52, v52, v59
    v_mfma_f32_16x16x32_bf16 v[96:99], a[96:99], a[32:35], v[96:99]
    ds_read_b64_tr_b16 a[74:75], v48 offset:18752
    v_cvt_pk_bf16_f32 v75, v58, v59
    v_mfma_f32_16x16x32_bf16 v[100:103], a[96:99], a[36:39], v[100:103]
    buffer_load_dwordx4 v39, s[20:23], s33 offen offset:3072 nt lds
    v_mfma_f32_16x16x32_bf16 v[108:111], a[100:103], a[36:39], v[108:111]
    s_add_u32 s33, s33, 16384
    v_exp_f32 v61, v125
    v_mfma_f32_16x16x32_bf16 v[104:107], a[100:103], a[32:35], v[104:107]
    s_waitcnt lgkmcnt(10)
    ds_read_b64_tr_b16 a[76:77], v49 offset:16704
    v_add_f32 v53, v53, v60
    v_mfma_f32_16x16x32_bf16 v[96:99], a[104:107], a[40:43], v[96:99]
    ds_read_b64_tr_b16 a[78:79], v49 offset:18752
    ds_read_b64_tr_b16 a[80:81], v48 offset:16768
    v_mfma_f32_16x16x32_bf16 v[100:103], a[104:107], a[44:47], v[100:103]
    v_exp_f32 v62, v126
    v_mfma_f32_16x16x32_bf16 v[108:111], a[108:111], a[44:47], v[108:111]
    ds_read_b64_tr_b16 a[82:83], v48 offset:18816
    v_add_f32 v53, v53, v61
    v_mfma_f32_16x16x32_bf16 v[104:107], a[108:111], a[40:43], v[104:107]
    s_waitcnt lgkmcnt(12)
    ds_read_b64_tr_b16 a[84:85], v49 offset:16768
    v_cvt_pk_bf16_f32 v78, v60, v61
    v_mfma_f32_16x16x32_bf16 v[96:99], a[112:115], a[48:51], v[96:99]
    s_add_u32 m0, s34, 83200
    v_exp_f32 v63, v127
    v_mfma_f32_16x16x32_bf16 v[100:103], a[112:115], a[52:55], v[100:103]
    buffer_load_dwordx4 v32, s[16:19], s32 offen offset:0 nt lds
    v_mfma_f32_16x16x32_bf16 v[108:111], a[116:119], a[52:55], v[108:111]
    ds_read_b64_tr_b16 a[86:87], v49 offset:18816
    v_add_f32 v53, v53, v62
    v_mfma_f32_16x16x32_bf16 v[104:107], a[116:119], a[48:51], v[104:107]
    s_waitcnt lgkmcnt(12)
    ds_read_b64_tr_b16 a[88:89], v48 offset:16832
    v_add_f32 v53, v53, v63
    v_mfma_f32_16x16x32_bf16 v[96:99], a[120:123], a[56:59], v[96:99]
    ds_read_b64_tr_b16 a[90:91], v48 offset:18880
    v_add_f32 v30, v52, v53
    v_mfma_f32_16x16x32_bf16 v[100:103], a[120:123], a[60:63], v[100:103]
    ds_read_b64_tr_b16 a[92:93], v49 offset:16832
    v_cmp_lt_f32 vcc, s37, v30
    v_mfma_f32_16x16x32_bf16 v[108:111], a[124:127], a[60:63], v[108:111]
    s_waitcnt lgkmcnt(11)
    ds_read_b64_tr_b16 a[94:95], v49 offset:18880
    v_cvt_pk_bf16_f32 v79, v62, v63
    v_mfma_f32_16x16x32_bf16 v[104:107], a[124:127], a[56:59], v[104:107]
    s_cbranch_vccnz L_fb2
L_ret2:
    v_mfma_f32_16x16x32_bf16 v[128:131], a[64:67], v[72:75], v[128:131]
    ds_read_b64_tr_b16 a[96:97], v48 offset:16896
    v_add_f32 v50, v50, v52
    v_mfma_f32_16x16x32_bf16 v[132:135], a[64:67], v[76:79], v[132:135]
    buffer_load_dwordx4 v33, s[16:19], s32 offen offset:1024 nt lds
    v_mfma_f32_16x16x32_bf16 v[136:139], a[68:71], v[72:75], v[136:139]
    ds_read_b64_tr_b16 a[98:99], v48 offset:18944
    v_add_f32 v51, v51, v53
    v_mfma_f32_16x16x32_bf16 v[140:143], a[68:71], v[76:79], v[140:143]
    s_waitcnt lgkmcnt(10)
    ds_read_b64_tr_b16 a[100:101], v49 offset:16896
    ds_read_b64_tr_b16 a[102:103], v49 offset:18944
    v_mfma_f32_16x16x32_bf16 v[144:147], a[72:75], v[72:75], v[144:147]
    v_exp_f32 v56, v96
    v_mfma_f32_16x16x32_bf16 v[148:151], a[72:75], v[76:79], v[148:151]
    ds_read_b64_tr_b16 a[104:105], v48 offset:16960
    v_mfma_f32_16x16x32_bf16 v[152:155], a[76:79], v[72:75], v[152:155]
    ds_read_b64_tr_b16 a[106:107], v48 offset:19008
    v_mfma_f32_16x16x32_bf16 v[156:159], a[76:79], v[76:79], v[156:159]
    s_waitcnt lgkmcnt(10)
    ds_read_b64_tr_b16 a[108:109], v49 offset:16960
    ds_read_b64_tr_b16 a[110:111], v49 offset:19008
    v_mfma_f32_16x16x32_bf16 v[160:163], a[80:83], v[72:75], v[160:163]
    v_exp_f32 v57, v97
    v_mfma_f32_16x16x32_bf16 v[164:167], a[80:83], v[76:79], v[164:167]
    buffer_load_dwordx4 v34, s[16:19], s32 offen offset:2048 nt lds
    v_mfma_f32_16x16x32_bf16 v[168:171], a[84:87], v[72:75], v[168:171]
    ds_read_b64_tr_b16 a[112:113], v48 offset:17024
    v_add_f32 v52, v56, v57
    v_mfma_f32_16x16x32_bf16 v[172:175], a[84:87], v[76:79], v[172:175]
    s_waitcnt lgkmcnt(9)
    v_exp_f32 v58, v98
    v_mfma_f32_16x16x32_bf16 v[176:179], a[88:91], v[72:75], v[176:179]
    ds_read_b64_tr_b16 a[114:115], v48 offset:19072
    v_cvt_pk_bf16_f32 v64, v56, v57
    v_mfma_f32_16x16x32_bf16 v[180:183], a[88:91], v[76:79], v[180:183]
    ds_read_b64_tr_b16 a[116:117], v49 offset:17024
    v_add_f32 v52, v52, v58
    v_mfma_f32_16x16x32_bf16 v[184:187], a[92:95], v[72:75], v[184:187]
    ds_read_b64_tr_b16 a[118:119], v49 offset:19072
    ds_read_b64_tr_b16 a[120:121], v48 offset:17088
    v_mfma_f32_16x16x32_bf16 v[188:191], a[92:95], v[76:79], v[188:191]
    s_waitcnt lgkmcnt(9)
    v_exp_f32 v59, v99
    v_mfma_f32_16x16x32_bf16 v[192:195], a[96:99], v[72:75], v[192:195]
    ds_read_b64_tr_b16 a[122:123], v48 offset:19136
    ds_read_b64_tr_b16 a[124:125], v49 offset:17088
    v_mfma_f32_16x16x32_bf16 v[196:199], a[96:99], v[76:79], v[196:199]
    buffer_load_dwordx4 v35, s[16:19], s32 offen offset:3072 nt lds
    v_mfma_f32_16x16x32_bf16 v[200:203], a[100:103], v[72:75], v[200:203]
    s_add_u32 s32, s32, 16384
    v_exp_f32 v60, v100
    v_mfma_f32_16x16x32_bf16 v[204:207], a[100:103], v[76:79], v[204:207]
    s_waitcnt lgkmcnt(7)
    ds_read_b64_tr_b16 a[126:127], v49 offset:19136
    v_add_f32 v52, v52, v59
    v_mfma_f32_16x16x32_bf16 v[208:211], a[104:107], v[72:75], v[208:211]
    s_waitcnt vmcnt(12)
    s_barrier
    global_load_dword v20, v[16:17], off
    v_mfma_f32_16x16x32_bf16 v[212:215], a[104:107], v[76:79], v[212:215]
    ds_read_b128 a[64:67], v40 offset:49920
    v_cvt_pk_bf16_f32 v65, v58, v59
    v_mfma_f32_16x16x32_bf16 v[216:219], a[108:111], v[72:75], v[216:219]
    v_exp_f32 v61, v101
    v_mfma_f32_16x16x32_bf16 v[220:223], a[108:111], v[76:79], v[220:223]
    s_waitcnt lgkmcnt(5)
    ds_read_b128 a[68:71], v40 offset:58112
    v_add_f32 v53, v60, v61
    v_mfma_f32_16x16x32_bf16 v[224:227], a[112:115], v[72:75], v[224:227]
    s_add_u32 m0, s35, 0
    ds_read_b128 a[72:75], v41 offset:49920
    ds_read_b128 a[76:79], v41 offset:58112
    v_mfma_f32_16x16x32_bf16 v[228:231], a[112:115], v[76:79], v[228:231]
    buffer_load_dwordx4 v36, s[20:23], s33 offen offset:0 nt lds
    v_mfma_f32_16x16x32_bf16 v[232:235], a[116:119], v[72:75], v[232:235]
    v_exp_f32 v62, v102
    v_mfma_f32_16x16x32_bf16 v[236:239], a[116:119], v[76:79], v[236:239]
    s_waitcnt lgkmcnt(4)
    ds_read_b128 a[80:83], v42 offset:49920
    v_cvt_pk_bf16_f32 v68, v60, v61
    v_mfma_f32_16x16x32_bf16 v[240:243], a[120:123], v[72:75], v[240:243]
    ds_read_b128 a[84:87], v42 offset:58112
    v_add_f32 v53, v53, v62
    v_mfma_f32_16x16x32_bf16 v[244:247], a[120:123], v[76:79], v[244:247]
    v_exp_f32 v63, v103
    v_mfma_f32_16x16x32_bf16 v[248:251], a[124:127], v[72:75], v[248:251]
    ds_read_b128 a[88:91], v43 offset:49920
    v_add_f32 v53, v53, v63
    v_mfma_f32_16x16x32_bf16 v[252:255], a[124:127], v[76:79], v[252:255]
    s_waitcnt lgkmcnt(5)
    ds_read_b128 a[92:95], v43 offset:58112
    ds_read_b128 a[96:99], v40 offset:50176
    v_mfma_f32_16x16x32_bf16 v[112:115], a[64:67], a[0:3], v[80:83]
    v_exp_f32 v56, v104
    v_mfma_f32_16x16x32_bf16 v[116:119], a[64:67], a[4:7], v[84:87]
    buffer_load_dwordx4 v37, s[20:23], s33 offen offset:1024 nt lds
    v_mfma_f32_16x16x32_bf16 v[124:127], a[68:71], a[4:7], v[84:87]
    ds_read_b128 a[100:103], v40 offset:58368
    v_cvt_pk_bf16_f32 v69, v62, v63
    v_mfma_f32_16x16x32_bf16 v[120:123], a[68:71], a[0:3], v[80:83]
    s_waitcnt lgkmcnt(6)
    ds_read_b128 a[104:107], v41 offset:50176
    ds_read_b128 a[108:111], v41 offset:58368
    v_mfma_f32_16x16x32_bf16 v[112:115], a[72:75], a[8:11], v[112:115]
    v_exp_f32 v57, v105
    v_mfma_f32_16x16x32_bf16 v[116:119], a[72:75], a[12:15], v[116:119]
    ds_read_b128 a[112:115], v42 offset:50176
    v_add_f32 v52, v52, v56
    v_mfma_f32_16x16x32_bf16 v[124:127], a[76:79], a[12:15], v[124:127]
    ds_read_b128 a[116:119], v42 offset:58368
    v_add_f32 v52, v52, v57
    v_mfma_f32_16x16x32_bf16 v[120:123], a[76:79], a[8:11], v[120:123]
    s_waitcnt lgkmcnt(8)
    v_exp_f32 v58, v106
    v_mfma_f32_16x16x32_bf16 v[112:115], a[80:83], a[16:19], v[112:115]
    ds_read_b128 a[120:123], v43 offset:50176
    v_cvt_pk_bf16_f32 v66, v56, v57
    v_mfma_f32_16x16x32_bf16 v[116:119], a[80:83], a[20:23], v[116:119]
    buffer_load_dwordx4 v38, s[20:23], s33 offen offset:2048 nt lds
    v_mfma_f32_16x16x32_bf16 v[124:127], a[84:87], a[20:23], v[124:127]
    ds_read_b128 a[124:127], v43 offset:58368
    ds_read_b64_tr_b16 a[64:65], v48 offset:33280
    v_mfma_f32_16x16x32_bf16 v[120:123], a[84:87], a[16:19], v[120:123]
    s_waitcnt lgkmcnt(9)
    v_exp_f32 v59, v107
    v_mfma_f32_16x16x32_bf16 v[112:115], a[88:91], a[24:27], v[112:115]
    ds_read_b64_tr_b16 a[66:67], v48 offset:35328
    v_add_f32 v52, v52, v58
    v_mfma_f32_16x16x32_bf16 v[116:119], a[88:91], a[28:31], v[116:119]
    ds_read_b64_tr_b16 a[68:69], v49 offset:33280
    ds_read_b64_tr_b16 a[70:71], v49 offset:35328
    v_mfma_f32_16x16x32_bf16 v[124:127], a[92:95], a[28:31], v[124:127]
    v_exp_f32 v60, v108
    v_mfma_f32_16x16x32_bf16 v[120:123], a[92:95], a[24:27], v[120:123]
    s_waitcnt lgkmcnt(10)
    ds_read_b64_tr_b16 a[72:73], v48 offset:33344
    v_add_f32 v52, v52, v59
    v_mfma_f32_16x16x32_bf16 v[112:115], a[96:99], a[32:35], v[112:115]
    ds_read_b64_tr_b16 a[74:75], v48 offset:35392
    v_cvt_pk_bf16_f32 v67, v58, v59
    v_mfma_f32_16x16x32_bf16 v[116:119], a[96:99], a[36:39], v[116:119]
    buffer_load_dwordx4 v39, s[20:23], s33 offen offset:3072 nt lds
    v_mfma_f32_16x16x32_bf16 v[124:127], a[100:103], a[36:39], v[124:127]
    s_add_u32 s33, s33, 16384
    v_exp_f32 v61, v109
    v_mfma_f32_16x16x32_bf16 v[120:123], a[100:103], a[32:35], v[120:123]
    s_waitcnt lgkmcnt(10)
    ds_read_b64_tr_b16 a[76:77], v49 offset:33344
    v_add_f32 v53, v53, v60
    v_mfma_f32_16x16x32_bf16 v[112:115], a[104:107], a[40:43], v[112:115]
    ds_read_b64_tr_b16 a[78:79], v49 offset:35392
    ds_read_b64_tr_b16 a[80:81], v48 offset:33408
    v_mfma_f32_16x16x32_bf16 v[116:119], a[104:107], a[44:47], v[116:119]
    v_exp_f32 v62, v110
    v_mfma_f32_16x16x32_bf16 v[124:127], a[108:111], a[44:47], v[124:127]
    ds_read_b64_tr_b16 a[82:83], v48 offset:35456
    v_add_f32 v53, v53, v61
    v_mfma_f32_16x16x32_bf16 v[120:123], a[108:111], a[40:43], v[120:123]
    s_waitcnt lgkmcnt(12)
    ds_read_b64_tr_b16 a[84:85], v49 offset:33408
    v_cvt_pk_bf16_f32 v70, v60, v61
    v_mfma_f32_16x16x32_bf16 v[112:115], a[112:115], a[48:51], v[112:115]
    s_add_u32 m0, s34, 99840
    v_exp_f32 v63, v111
    v_mfma_f32_16x16x32_bf16 v[116:119], a[112:115], a[52:55], v[116:119]
    buffer_load_dwordx4 v32, s[16:19], s32 offen offset:0 nt lds
    v_mfma_f32_16x16x32_bf16 v[124:127], a[116:119], a[52:55], v[124:127]
    ds_read_b64_tr_b16 a[86:87], v49 offset:35456
    v_add_f32 v53, v53, v62
    v_mfma_f32_16x16x32_bf16 v[120:123], a[116:119], a[48:51], v[120:123]
    s_waitcnt lgkmcnt(12)
    ds_read_b64_tr_b16 a[88:89], v48 offset:33472
    v_add_f32 v53, v53, v63
    v_mfma_f32_16x16x32_bf16 v[112:115], a[120:123], a[56:59], v[112:115]
    ds_read_b64_tr_b16 a[90:91], v48 offset:35520
    v_add_f32 v30, v52, v53
    v_mfma_f32_16x16x32_bf16 v[116:119], a[120:123], a[60:63], v[116:119]
    ds_read_b64_tr_b16 a[92:93], v49 offset:33472
    v_cmp_lt_f32 vcc, s37, v30
    v_mfma_f32_16x16x32_bf16 v[124:127], a[124:127], a[60:63], v[124:127]
    s_waitcnt lgkmcnt(11)
    ds_read_b64_tr_b16 a[94:95], v49 offset:35520
    v_cvt_pk_bf16_f32 v71, v62, v63
    v_mfma_f32_16x16x32_bf16 v[120:123], a[124:127], a[56:59], v[120:123]
    s_cbranch_vccnz L_fb3
L_ret3:
    v_mfma_f32_16x16x32_bf16 v[128:131], a[64:67], v[64:67], v[128:131]
    ds_read_b64_tr_b16 a[96:97], v48 offset:33536
    v_add_f32 v50, v50, v52
    v_mfma_f32_16x16x32_bf16 v[132:135], a[64:67], v[68:71], v[132:135]
    buffer_load_dwordx4 v33, s[16:19], s32 offen offset:1024 nt lds
    v_mfma_f32_16x16x32_bf16 v[136:139], a[68:71], v[64:67], v[136:139]
    ds_read_b64_tr_b16 a[98:99], v48 offset:35584
    v_add_f32 v51, v51, v53
    v_mfma_f32_16x16x32_bf16 v[140:143], a[68:71], v[68:71], v[140:143]
    s_waitcnt lgkmcnt(10)
    ds_read_b64_tr_b16 a[100:101], v49 offset:33536
    ds_read_b64_tr_b16 a[102:103], v49 offset:35584
    v_mfma_f32_16x16x32_bf16 v[144:147], a[72:75], v[64:67], v[144:147]
    v_exp_f32 v56, v112
    v_mfma_f32_16x16x32_bf16 v[148:151], a[72:75], v[68:71], v[148:151]
    ds_read_b64_tr_b16 a[104:105], v48 offset:33600
    v_mfma_f32_16x16x32_bf16 v[152:155], a[76:79], v[64:67], v[152:155]
    ds_read_b64_tr_b16 a[106:107], v48 offset:35648
    v_mfma_f32_16x16x32_bf16 v[156:159], a[76:79], v[68:71], v[156:159]
    s_waitcnt lgkmcnt(10)
    ds_read_b64_tr_b16 a[108:109], v49 offset:33600
    ds_read_b64_tr_b16 a[110:111], v49 offset:35648
    v_mfma_f32_16x16x32_bf16 v[160:163], a[80:83], v[64:67], v[160:163]
    v_exp_f32 v57, v113
    v_mfma_f32_16x16x32_bf16 v[164:167], a[80:83], v[68:71], v[164:167]
    buffer_load_dwordx4 v34, s[16:19], s32 offen offset:2048 nt lds
    v_mfma_f32_16x16x32_bf16 v[168:171], a[84:87], v[64:67], v[168:171]
    ds_read_b64_tr_b16 a[112:113], v48 offset:33664
    v_add_f32 v52, v56, v57
    v_mfma_f32_16x16x32_bf16 v[172:175], a[84:87], v[68:71], v[172:175]
    s_waitcnt lgkmcnt(9)
    v_exp_f32 v58, v114
    v_mfma_f32_16x16x32_bf16 v[176:179], a[88:91], v[64:67], v[176:179]
    ds_read_b64_tr_b16 a[114:115], v48 offset:35712
    v_cvt_pk_bf16_f32 v72, v56, v57
    v_mfma_f32_16x16x32_bf16 v[180:183], a[88:91], v[68:71], v[180:183]
    ds_read_b64_tr_b16 a[116:117], v49 offset:33664
    v_add_f32 v52, v52, v58
    v_mfma_f32_16x16x32_bf16 v[184:187], a[92:95], v[64:67], v[184:187]
    ds_read_b64_tr_b16 a[118:119], v49 offset:35712
    ds_read_b64_tr_b16 a[120:121], v48 offset:33728
    v_mfma_f32_16x16x32_bf16 v[188:191], a[92:95], v[68:71], v[188:191]
    s_waitcnt lgkmcnt(9)
    v_exp_f32 v59, v115
    v_mfma_f32_16x16x32_bf16 v[192:195], a[96:99], v[64:67], v[192:195]
    ds_read_b64_tr_b16 a[122:123], v48 offset:35776
    ds_read_b64_tr_b16 a[124:125], v49 offset:33728
    v_mfma_f32_16x16x32_bf16 v[196:199], a[96:99], v[68:71], v[196:199]
    buffer_load_dwordx4 v35, s[16:19], s32 offen offset:3072 nt lds
    v_mfma_f32_16x16x32_bf16 v[200:203], a[100:103], v[64:67], v[200:203]
    s_add_u32 s32, s32, 16384
    v_exp_f32 v60, v116
    v_mfma_f32_16x16x32_bf16 v[204:207], a[100:103], v[68:71], v[204:207]
    s_waitcnt lgkmcnt(7)
    ds_read_b64_tr_b16 a[126:127], v49 offset:35776
    v_add_f32 v52, v52, v59
    v_mfma_f32_16x16x32_bf16 v[208:211], a[104:107], v[64:67], v[208:211]
    s_waitcnt vmcnt(13)
    s_barrier
    v_mfma_f32_16x16x32_bf16 v[212:215], a[104:107], v[68:71], v[212:215]
    ds_read_b128 a[64:67], v40 offset:0
    v_cvt_pk_bf16_f32 v73, v58, v59
    v_mfma_f32_16x16x32_bf16 v[216:219], a[108:111], v[64:67], v[216:219]
    v_exp_f32 v61, v117
    v_mfma_f32_16x16x32_bf16 v[220:223], a[108:111], v[68:71], v[220:223]
    s_waitcnt lgkmcnt(5)
    ds_read_b128 a[68:71], v40 offset:8192
    v_add_f32 v53, v60, v61
    v_mfma_f32_16x16x32_bf16 v[224:227], a[112:115], v[64:67], v[224:227]
    s_add_u32 m0, s35, 16640
    ds_read_b128 a[72:75], v41 offset:0
    ds_read_b128 a[76:79], v41 offset:8192
    v_mfma_f32_16x16x32_bf16 v[228:231], a[112:115], v[68:71], v[228:231]
    buffer_load_dwordx4 v36, s[20:23], s33 offen offset:0 nt lds
    v_mfma_f32_16x16x32_bf16 v[232:235], a[116:119], v[64:67], v[232:235]
    v_exp_f32 v62, v118
    v_mfma_f32_16x16x32_bf16 v[236:239], a[116:119], v[68:71], v[236:239]
    s_waitcnt lgkmcnt(4)
    ds_read_b128 a[80:83], v42 offset:0
    v_cvt_pk_bf16_f32 v76, v60, v61
    v_mfma_f32_16x16x32_bf16 v[240:243], a[120:123], v[64:67], v[240:243]
    s_sub_u32 s36, s36, 1
    ds_read_b128 a[84:87], v42 offset:8192
    v_add_f32 v53, v53, v62
    v_mfma_f32_16x16x32_bf16 v[244:247], a[120:123], v[68:71], v[244:247]
    v_exp_f32 v63, v119
    v_mfma_f32_16x16x32_bf16 v[248:251], a[124:127], v[64:67], v[248:251]
    ds_read_b128 a[88:91], v43 offset:0
    v_add_f32 v53, v53, v63
    v_mfma_f32_16x16x32_bf16 v[252:255], a[124:127], v[68:71], v[252:255]
    s_waitcnt lgkmcnt(5)
    ds_read_b128 a[92:95], v43 offset:8192
    ds_read_b128 a[96:99], v40 offset:256
    v_mfma_f32_16x16x32_bf16 v[96:99], a[64:67], a[0:3], v[80:83]
    v_exp_f32 v56, v120
    v_mfma_f32_16x16x32_bf16 v[100:103], a[64:67], a[4:7], v[84:87]
    buffer_load_dwordx4 v37, s[20:23], s33 offen offset:1024 nt lds
    v_mfma_f32_16x16x32_bf16 v[108:111], a[68:71], a[4:7], v[84:87]
    ds_read_b128 a[100:103], v40 offset:8448
    v_cvt_pk_bf16_f32 v77, v62, v63
    v_mfma_f32_16x16x32_bf16 v[104:107], a[68:71], a[0:3], v[80:83]
    s_waitcnt lgkmcnt(6)
    ds_read_b128 a[104:107], v41 offset:256
    ds_read_b128 a[108:111], v41 offset:8448
    v_mfma_f32_16x16x32_bf16 v[96:99], a[72:75], a[8:11], v[96:99]
    v_exp_f32 v57, v121
    v_mfma_f32_16x16x32_bf16 v[100:103], a[72:75], a[12:15], v[100:103]
    ds_read_b128 a[112:115], v42 offset:256
    v_add_f32 v52, v52, v56
    v_mfma_f32_16x16x32_bf16 v[108:111], a[76:79], a[12:15], v[108:111]
    ds_read_b128 a[116:119], v42 offset:8448
    v_add_f32 v52, v52, v57
    v_mfma_f32_16x16x32_bf16 v[104:107], a[76:79], a[8:11], v[104:107]
    s_waitcnt lgkmcnt(8)
    v_exp_f32 v58, v122
    v_mfma_f32_16x16x32_bf16 v[96:99], a[80:83], a[16:19], v[96:99]
    ds_read_b128 a[120:123], v43 offset:256
    v_cvt_pk_bf16_f32 v74, v56, v57
    v_mfma_f32_16x16x32_bf16 v[100:103], a[80:83], a[20:23], v[100:103]
    buffer_load_dwordx4 v38, s[20:23], s33 offen offset:2048 nt lds
    v_mfma_f32_16x16x32_bf16 v[108:111], a[84:87], a[20:23], v[108:111]
    ds_read_b128 a[124:127], v43 offset:8448
    ds_read_b64_tr_b16 a[64:65], v48 offset:49920
    v_mfma_f32_16x16x32_bf16 v[104:107], a[84:87], a[16:19], v[104:107]
    s_waitcnt lgkmcnt(9)
    v_exp_f32 v59, v123
    v_mfma_f32_16x16x32_bf16 v[96:99], a[88:91], a[24:27], v[96:99]
    ds_read_b64_tr_b16 a[66:67], v48 offset:51968
    v_add_f32 v52, v52, v58
    v_mfma_f32_16x16x32_bf16 v[100:103], a[88:91], a[28:31], v[100:103]
    ds_read_b64_tr_b16 a[68:69], v49 offset:49920
    ds_read_b64_tr_b16 a[70:71], v49 offset:51968
    v_mfma_f32_16x16x32_bf16 v[108:111], a[92:95], a[28:31], v[108:111]
    v_exp_f32 v60, v124
    v_mfma_f32_16x16x32_bf16 v[104:107], a[92:95], a[24:27], v[104:107]
    s_waitcnt lgkmcnt(10)
    ds_read_b64_tr_b16 a[72:73], v48 offset:49984
    v_add_f32 v52, v52, v59
    v_mfma_f32_16x16x32_bf16 v[96:99], a[96:99], a[32:35], v[96:99]
    ds_read_b64_tr_b16 a[74:75], v48 offset:52032
    v_cvt_pk_bf16_f32 v75, v58, v59
    v_mfma_f32_16x16x32_bf16 v[100:103], a[96:99], a[36:39], v[100:103]
    buffer_load_dwordx4 v39, s[20:23], s33 offen offset:3072 nt lds
    v_mfma_f32_16x16x32_bf16 v[108:111], a[100:103], a[36:39], v[108:111]
    s_add_u32 s33, s33, 16384
    v_exp_f32 v61, v125
    v_mfma_f32_16x16x32_bf16 v[104:107], a[100:103], a[32:35], v[104:107]
    s_waitcnt lgkmcnt(10)
    ds_read_b64_tr_b16 a[76:77], v49 offset:49984
    v_add_f32 v53, v53, v60
    v_mfma_f32_16x16x32_bf16 v[96:99], a[104:107], a[40:43], v[96:99]
    ds_read_b64_tr_b16 a[78:79], v49 offset:52032
    ds_read_b64_tr_b16 a[80:81], v48 offset:50048
    v_mfma_f32_16x16x32_bf16 v[100:103], a[104:107], a[44:47], v[100:103]
    v_exp_f32 v62, v126
    v_mfma_f32_16x16x32_bf16 v[108:111], a[108:111], a[44:47], v[108:111]
    ds_read_b64_tr_b16 a[82:83], v48 offset:52096
    v_add_f32 v53, v53, v61
    v_mfma_f32_16x16x32_bf16 v[104:107], a[108:111], a[40:43], v[104:107]
    s_waitcnt lgkmcnt(12)
    ds_read_b64_tr_b16 a[84:85], v49 offset:50048
    v_cvt_pk_bf16_f32 v78, v60, v61
    v_mfma_f32_16x16x32_bf16 v[96:99], a[112:115], a[48:51], v[96:99]
    s_add_u32 m0, s34, 116480
    v_exp_f32 v63, v127
    v_mfma_f32_16x16x32_bf16 v[100:103], a[112:115], a[52:55], v[100:103]
    buffer_load_dwordx4 v32, s[16:19], s32 offen offset:0 nt lds
    v_mfma_f32_16x16x32_bf16 v[108:111], a[116:119], a[52:55], v[108:111]
    ds_read_b64_tr_b16 a[86:87], v49 offset:52096
    v_add_f32 v53, v53, v62
    v_mfma_f32_16x16x32_bf16 v[104:107], a[116:119], a[48:51], v[104:107]
    s_waitcnt lgkmcnt(12)
    ds_read_b64_tr_b16 a[88:89], v48 offset:50112
    v_add_f32 v53, v53, v63
    v_mfma_f32_16x16x32_bf16 v[96:99], a[120:123], a[56:59], v[96:99]
    ds_read_b64_tr_b16 a[90:91], v48 offset:52160
    v_add_f32 v30, v52, v53
    v_mfma_f32_16x16x32_bf16 v[100:103], a[120:123], a[60:63], v[100:103]
    ds_read_b64_tr_b16 a[92:93], v49 offset:50112
    v_cmp_lt_f32 vcc, s37, v30
    v_mfma_f32_16x16x32_bf16 v[108:111], a[124:127], a[60:63], v[108:111]
    s_waitcnt lgkmcnt(11)
    ds_read_b64_tr_b16 a[94:95], v49 offset:52160
    v_cvt_pk_bf16_f32 v79, v62, v63
    v_mfma_f32_16x16x32_bf16 v[104:107], a[124:127], a[56:59], v[104:107]
    s_cbranch_vccnz L_fb4
L_ret4:
    v_lshl_add_u64 v[16:17], v[16:17], 0, v[18:19]
    v_mfma_f32_16x16x32_bf16 v[128:131], a[64:67], v[72:75], v[128:131]
    ds_read_b64_tr_b16 a[96:97], v48 offset:50176
    v_add_f32 v50, v50, v52
    v_mfma_f32_16x16x32_bf16 v[132:135], a[64:67], v[76:79], v[132:135]
    buffer_load_dwordx4 v33, s[16:19], s32 offen offset:1024 nt lds
    v_mfma_f32_16x16x32_bf16 v[136:139], a[68:71], v[72:75], v[136:139]
    ds_read_b64_tr_b16 a[98:99], v48 offset:52224
    v_add_f32 v51, v51, v53
    v_mfma_f32_16x16x32_bf16 v[140:143], a[68:71], v[76:79], v[140:143]
    s_waitcnt lgkmcnt(10)
    ds_read_b64_tr_b16 a[100:101], v49 offset:50176
    ds_read_b64_tr_b16 a[102:103], v49 offset:52224
    v_mfma_f32_16x16x32_bf16 v[144:147], a[72:75], v[72:75], v[144:147]
    v_exp_f32 v56, v96
    v_mfma_f32_16x16x32_bf16 v[148:151], a[72:75], v[76:79], v[148:151]
    ds_read_b64_tr_b16 a[104:105], v48 offset:50240
    v_mfma_f32_16x16x32_bf16 v[152:155], a[76:79], v[72:75], v[152:155]
    ds_read_b64_tr_b16 a[106:107], v48 offset:52288
    v_mfma_f32_16x16x32_bf16 v[156:159], a[76:79], v[76:79], v[156:159]
    s_waitcnt lgkmcnt(10)
    ds_read_b64_tr_b16 a[108:109], v49 offset:50240
    ds_read_b64_tr_b16 a[110:111], v49 offset:52288
    v_mfma_f32_16x16x32_bf16 v[160:163], a[80:83], v[72:75], v[160:163]
    v_exp_f32 v57, v97
    v_mfma_f32_16x16x32_bf16 v[164:167], a[80:83], v[76:79], v[164:167]
    buffer_load_dwordx4 v34, s[16:19], s32 offen offset:2048 nt lds
    v_mfma_f32_16x16x32_bf16 v[168:171], a[84:87], v[72:75], v[168:171]
    ds_read_b64_tr_b16 a[112:113], v48 offset:50304
    v_add_f32 v52, v56, v57
    v_mfma_f32_16x16x32_bf16 v[172:175], a[84:87], v[76:79], v[172:175]
    s_waitcnt lgkmcnt(9)
    v_exp_f32 v58, v98
    v_mfma_f32_16x16x32_bf16 v[176:179], a[88:91], v[72:75], v[176:179]
    ds_read_b64_tr_b16 a[114:115], v48 offset:52352
    v_cvt_pk_bf16_f32 v64, v56, v57
    v_mfma_f32_16x16x32_bf16 v[180:183], a[88:91], v[76:79], v[180:183]
    ds_read_b64_tr_b16 a[116:117], v49 offset:50304
    v_add_f32 v52, v52, v58
    v_mfma_f32_16x16x32_bf16 v[184:187], a[92:95], v[72:75], v[184:187]
    ds_read_b64_tr_b16 a[118:119], v49 offset:52352
    ds_read_b64_tr_b16 a[120:121], v48 offset:50368
    v_mfma_f32_16x16x32_bf16 v[188:191], a[92:95], v[76:79], v[188:191]
    s_waitcnt lgkmcnt(9)
    v_exp_f32 v59, v99
    v_mfma_f32_16x16x32_bf16 v[192:195], a[96:99], v[72:75], v[192:195]
    ds_read_b64_tr_b16 a[122:123], v48 offset:52416
    ds_read_b64_tr_b16 a[124:125], v49 offset:50368
    v_mfma_f32_16x16x32_bf16 v[196:199], a[96:99], v[76:79], v[196:199]
    buffer_load_dwordx4 v35, s[16:19], s32 offen offset:3072 nt lds
    v_mfma_f32_16x16x32_bf16 v[200:203], a[100:103], v[72:75], v[200:203]
    s_add_u32 s32, s32, 16384
    v_exp_f32 v60, v100
    v_mfma_f32_16x16x32_bf16 v[204:207], a[100:103], v[76:79], v[204:207]
    s_waitcnt lgkmcnt(7)
    ds_read_b64_tr_b16 a[126:127], v49 offset:52416
    v_add_f32 v52, v52, v59
    v_mfma_f32_16x16x32_bf16 v[208:211], a[104:107], v[72:75], v[208:211]
    s_waitcnt vmcnt(12)
    s_barrier
    v_mfma_f32_16x16x32_bf16 v[212:215], a[104:107], v[76:79], v[212:215]
    ds_read_b128 a[64:67], v40 offset:16640
    v_cvt_pk_bf16_f32 v65, v58, v59
    v_mfma_f32_16x16x32_bf16 v[216:219], a[108:111], v[72:75], v[216:219]
    v_exp_f32 v61, v101
    v_mfma_f32_16x16x32_bf16 v[220:223], a[108:111], v[76:79], v[220:223]
    s_waitcnt lgkmcnt(5)
    ds_read_b128 a[68:71], v40 offset:24832
    v_add_f32 v53, v60, v61
    v_mfma_f32_16x16x32_bf16 v[224:227], a[112:115], v[72:75], v[224:227]
    s_add_u32 m0, s35, 33280
    ds_read_b128 a[72:75], v41 offset:16640
    ds_read_b128 a[76:79], v41 offset:24832
    v_mfma_f32_16x16x32_bf16 v[228:231], a[112:115], v[76:79], v[228:231]
    buffer_load_dwordx4 v36, s[20:23], s33 offen offset:0 nt lds
    v_mfma_f32_16x16x32_bf16 v[232:235], a[116:119], v[72:75], v[232:235]
    v_exp_f32 v62, v102
    v_mfma_f32_16x16x32_bf16 v[236:239], a[116:119], v[76:79], v[236:239]
    s_waitcnt lgkmcnt(4)
    ds_read_b128 a[80:83], v42 offset:16640
    v_cvt_pk_bf16_f32 v68, v60, v61
    v_mfma_f32_16x16x32_bf16 v[240:243], a[120:123], v[72:75], v[240:243]
    ds_read_b128 a[84:87], v42 offset:24832
    v_add_f32 v53, v53, v62
    v_mfma_f32_16x16x32_bf16 v[244:247], a[120:123], v[76:79], v[244:247]
    v_exp_f32 v63, v103
    v_mfma_f32_16x16x32_bf16 v[248:251], a[124:127], v[72:75], v[248:251]
    ds_read_b128 a[88:91], v43 offset:16640
    v_add_f32 v53, v53, v63
    v_mfma_f32_16x16x32_bf16 v[252:255], a[124:127], v[76:79], v[252:255]
    s_waitcnt lgkmcnt(5)
    ds_read_b128 a[92:95], v43 offset:24832
    ds_read_b128 a[96:99], v40 offset:16896
    v_mfma_f32_16x16x32_bf16 v[112:115], a[64:67], a[0:3], v[80:83]
    v_exp_f32 v56, v104
    v_mfma_f32_16x16x32_bf16 v[116:119], a[64:67], a[4:7], v[84:87]
    buffer_load_dwordx4 v37, s[20:23], s33 offen offset:1024 nt lds
    v_mfma_f32_16x16x32_bf16 v[124:127], a[68:71], a[4:7], v[84:87]
    ds_read_b128 a[100:103], v40 offset:25088
    v_cvt_pk_bf16_f32 v69, v62, v63
    v_mfma_f32_16x16x32_bf16 v[120:123], a[68:71], a[0:3], v[80:83]
    s_waitcnt lgkmcnt(6)
    ds_read_b128 a[104:107], v41 offset:16896
    ds_read_b128 a[108:111], v41 offset:25088
    v_mfma_f32_16x16x32_bf16 v[112:115], a[72:75], a[8:11], v[112:115]
    v_exp_f32 v57, v105
    v_mfma_f32_16x16x32_bf16 v[116:119], a[72:75], a[12:15], v[116:119]
    ds_read_b128 a[112:115], v42 offset:16896
    v_add_f32 v52, v52, v56
    v_mfma_f32_16x16x32_bf16 v[124:127], a[76:79], a[12:15], v[124:127]
    ds_read_b128 a[116:119], v42 offset:25088
    v_add_f32 v52, v52, v57
    v_mfma_f32_16x16x32_bf16 v[120:123], a[76:79], a[8:11], v[120:123]
    s_waitcnt lgkmcnt(8)
    v_exp_f32 v58, v106
    v_mfma_f32_16x16x32_bf16 v[112:115], a[80:83], a[16:19], v[112:115]
    ds_read_b128 a[120:123], v43 offset:16896
    v_cvt_pk_bf16_f32 v66, v56, v57
    v_mfma_f32_16x16x32_bf16 v[116:119], a[80:83], a[20:23], v[116:119]
    buffer_load_dwordx4 v38, s[20:23], s33 offen offset:2048 nt lds
    v_mfma_f32_16x16x32_bf16 v[124:127], a[84:87], a[20:23], v[124:127]
    ds_read_b128 a[124:127], v43 offset:25088
    ds_read_b64_tr_b16 a[64:65], v48 offset:0
    v_mfma_f32_16x16x32_bf16 v[120:123], a[84:87], a[16:19], v[120:123]
    s_waitcnt lgkmcnt(9)
    v_exp_f32 v59, v107
    v_mfma_f32_16x16x32_bf16 v[112:115], a[88:91], a[24:27], v[112:115]
    ds_read_b64_tr_b16 a[66:67], v48 offset:2048
    v_add_f32 v52, v52, v58
    v_mfma_f32_16x16x32_bf16 v[116:119], a[88:91], a[28:31], v[116:119]
    ds_read_b64_tr_b16 a[68:69], v49 offset:0
    ds_read_b64_tr_b16 a[70:71], v49 offset:2048
    v_mfma_f32_16x16x32_bf16 v[124:127], a[92:95], a[28:31], v[124:127]
    v_exp_f32 v60, v108
    v_mfma_f32_16x16x32_bf16 v[120:123], a[92:95], a[24:27], v[120:123]
    s_waitcnt lgkmcnt(10)
    ds_read_b64_tr_b16 a[72:73], v48 offset:64
    v_add_f32 v52, v52, v59
    v_mfma_f32_16x16x32_bf16 v[112:115], a[96:99], a[32:35], v[112:115]
    ds_read_b64_tr_b16 a[74:75], v48 offset:2112
    v_cvt_pk_bf16_f32 v67, v58, v59
    v_mfma_f32_16x16x32_bf16 v[116:119], a[96:99], a[36:39], v[116:119]
    buffer_load_dwordx4 v39, s[20:23], s33 offen offset:3072 nt lds
    v_mfma_f32_16x16x32_bf16 v[124:127], a[100:103], a[36:39], v[124:127]
    s_add_u32 s33, s33, 16384
    v_exp_f32 v61, v109
    v_mfma_f32_16x16x32_bf16 v[120:123], a[100:103], a[32:35], v[120:123]
    s_waitcnt lgkmcnt(10)
    ds_read_b64_tr_b16 a[76:77], v49 offset:64
    v_add_f32 v53, v53, v60
    v_mfma_f32_16x16x32_bf16 v[112:115], a[104:107], a[40:43], v[112:115]
    ds_read_b64_tr_b16 a[78:79], v49 offset:2112
    ds_read_b64_tr_b16 a[80:81], v48 offset:128
    v_mfma_f32_16x16x32_bf16 v[116:119], a[104:107], a[44:47], v[116:119]
    v_exp_f32 v62, v110
    v_mfma_f32_16x16x32_bf16 v[124:127], a[108:111], a[44:47], v[124:127]
    ds_read_b64_tr_b16 a[82:83], v48 offset:2176
    v_add_f32 v53, v53, v61
    v_mfma_f32_16x16x32_bf16 v[120:123], a[108:111], a[40:43], v[120:123]
    s_waitcnt lgkmcnt(12)
    ds_read_b64_tr_b16 a[84:85], v49 offset:128
    v_cvt_pk_bf16_f32 v70, v60, v61
    v_mfma_f32_16x16x32_bf16 v[112:115], a[112:115], a[48:51], v[112:115]
    s_add_u32 m0, s34, 66560
    v_exp_f32 v63, v111
    v_mfma_f32_16x16x32_bf16 v[116:119], a[112:115], a[52:55], v[116:119]
    buffer_load_dwordx4 v32, s[16:19], s32 offen offset:0 nt lds
    v_mfma_f32_16x16x32_bf16 v[124:127], a[116:119], a[52:55], v[124:127]
    ds_read_b64_tr_b16 a[86:87], v49 offset:2176
    v_add_f32 v53, v53, v62
    v_mfma_f32_16x16x32_bf16 v[120:123], a[116:119], a[48:51], v[120:123]
    s_waitcnt lgkmcnt(12)
    ds_read_b64_tr_b16 a[88:89], v48 offset:192
    v_add_f32 v53, v53, v63
    v_mfma_f32_16x16x32_bf16 v[112:115], a[120:123], a[56:59], v[112:115]
    ds_read_b64_tr_b16 a[90:91], v48 offset:2240
    v_add_f32 v30, v52, v53
    v_mfma_f32_16x16x32_bf16 v[116:119], a[120:123], a[60:63], v[116:119]
    ds_read_b64_tr_b16 a[92:93], v49 offset:192
    v_cmp_lt_f32 vcc, s37, v30
    v_mfma_f32_16x16x32_bf16 v[124:127], a[124:127], a[60:63], v[124:127]
    s_waitcnt lgkmcnt(11)
    ds_read_b64_tr_b16 a[94:95], v49 offset:2240
    v_cvt_pk_bf16_f32 v71, v62, v63
    v_mfma_f32_16x16x32_bf16 v[120:123], a[124:127], a[56:59], v[120:123]
    s_cbranch_vccnz L_fb5
L_ret5:
    v_mfma_f32_16x16x32_bf16 v[128:131], a[64:67], v[64:67], v[128:131]
    ds_read_b64_tr_b16 a[96:97], v48 offset:256
    v_add_f32 v50, v50, v52
    v_mfma_f32_16x16x32_bf16 v[132:135], a[64:67], v[68:71], v[132:135]
    buffer_load_dwordx4 v33, s[16:19], s32 offen offset:1024 nt lds
    v_mfma_f32_16x16x32_bf16 v[136:139], a[68:71], v[64:67], v[136:139]
    ds_read_b64_tr_b16 a[98:99], v48 offset:2304
    v_add_f32 v51, v51, v53
    v_mfma_f32_16x16x32_bf16 v[140:143], a[68:71], v[68:71], v[140:143]
    s_waitcnt lgkmcnt(10)
    ds_read_b64_tr_b16 a[100:101], v49 offset:256
    ds_read_b64_tr_b16 a[102:103], v49 offset:2304
    v_mfma_f32_16x16x32_bf16 v[144:147], a[72:75], v[64:67], v[144:147]
    v_exp_f32 v56, v112
    v_mfma_f32_16x16x32_bf16 v[148:151], a[72:75], v[68:71], v[148:151]
    ds_read_b64_tr_b16 a[104:105], v48 offset:320
    v_mfma_f32_16x16x32_bf16 v[152:155], a[76:79], v[64:67], v[152:155]
    ds_read_b64_tr_b16 a[106:107], v48 offset:2368
    v_mfma_f32_16x16x32_bf16 v[156:159], a[76:79], v[68:71], v[156:159]
    s_waitcnt lgkmcnt(10)
    ds_read_b64_tr_b16 a[108:109], v49 offset:320
    ds_read_b64_tr_b16 a[110:111], v49 offset:2368
    v_mfma_f32_16x16x32_bf16 v[160:163], a[80:83], v[64:67], v[160:163]
    v_exp_f32 v57, v113
    v_mfma_f32_16x16x32_bf16 v[164:167], a[80:83], v[68:71], v[164:167]
    buffer_load_dwordx4 v34, s[16:19], s32 offen offset:2048 nt lds
    v_mfma_f32_16x16x32_bf16 v[168:171], a[84:87], v[64:67], v[168:171]
    ds_read_b64_tr_b16 a[112:113], v48 offset:384
    v_add_f32 v52, v56, v57
    v_mfma_f32_16x16x32_bf16 v[172:175], a[84:87], v[68:71], v[172:175]
    s_waitcnt lgkmcnt(9)
    v_exp_f32 v58, v114
    v_mfma_f32_16x16x32_bf16 v[176:179], a[88:91], v[64:67], v[176:179]
    ds_read_b64_tr_b16 a[114:115], v48 offset:2432
    v_cvt_pk_bf16_f32 v72, v56, v57
    v_mfma_f32_16x16x32_bf16 v[180:183], a[88:91], v[68:71], v[180:183]
    ds_read_b64_tr_b16 a[116:117], v49 offset:384
    v_add_f32 v52, v52, v58
    v_mfma_f32_16x16x32_bf16 v[184:187], a[92:95], v[64:67], v[184:187]
    ds_read_b64_tr_b16 a[118:119], v49 offset:2432
    ds_read_b64_tr_b16 a[120:121], v48 offset:448
    v_mfma_f32_16x16x32_bf16 v[188:191], a[92:95], v[68:71], v[188:191]
    s_waitcnt lgkmcnt(9)
    v_exp_f32 v59, v115
    v_mfma_f32_16x16x32_bf16 v[192:195], a[96:99], v[64:67], v[192:195]
    ds_read_b64_tr_b16 a[122:123], v48 offset:2496
    ds_read_b64_tr_b16 a[124:125], v49 offset:448
    v_mfma_f32_16x16x32_bf16 v[196:199], a[96:99], v[68:71], v[196:199]
    buffer_load_dwordx4 v35, s[16:19], s32 offen offset:3072 nt lds
    v_mfma_f32_16x16x32_bf16 v[200:203], a[100:103], v[64:67], v[200:203]
    s_add_u32 s32, s32, 16384
    v_exp_f32 v60, v116
    v_mfma_f32_16x16x32_bf16 v[204:207], a[100:103], v[68:71], v[204:207]
    s_waitcnt lgkmcnt(7)
    ds_read_b64_tr_b16 a[126:127], v49 offset:2496
    v_add_f32 v52, v52, v59
    v_mfma_f32_16x16x32_bf16 v[208:211], a[104:107], v[64:67], v[208:211]
    s_waitcnt vmcnt(12)
    s_barrier
    v_mfma_f32_16x16x32_bf16 v[212:215], a[104:107], v[68:71], v[212:215]
    ds_read_b128 a[64:67], v40 offset:33280
    v_cvt_pk_bf16_f32 v73, v58, v59
    v_mfma_f32_16x16x32_bf16 v[216:219], a[108:111], v[64:67], v[216:219]
    v_exp_f32 v61, v117
    v_mfma_f32_16x16x32_bf16 v[220:223], a[108:111], v[68:71], v[220:223]
    s_waitcnt lgkmcnt(5)
    ds_read_b128 a[68:71], v40 offset:41472
    v_add_f32 v53, v60, v61
    v_mfma_f32_16x16x32_bf16 v[224:227], a[112:115], v[64:67], v[224:227]
    s_add_u32 m0, s35, 49920
    ds_read_b128 a[72:75], v41 offset:33280
    ds_read_b128 a[76:79], v41 offset:41472
    v_mfma_f32_16x16x32_bf16 v[228:231], a[112:115], v[68:71], v[228:231]
    buffer_load_dwordx4 v36, s[20:23], s33 offen offset:0 nt lds
    v_mfma_f32_16x16x32_bf16 v[232:235], a[116:119], v[64:67], v[232:235]
    v_exp_f32 v62, v118
    v_mfma_f32_16x16x32_bf16 v[236:239], a[116:119], v[68:71], v[236:239]
    s_waitcnt lgkmcnt(4)
    ds_read_b128 a[80:83], v42 offset:33280
    v_cvt_pk_bf16_f32 v76, v60, v61
    v_mfma_f32_16x16x32_bf16 v[240:243], a[120:123], v[64:67], v[240:243]
    ds_read_b128 a[84:87], v42 offset:41472
    v_add_f32 v53, v53, v62
    v_mfma_f32_16x16x32_bf16 v[244:247], a[120:123], v[68:71], v[244:247]
    v_exp_f32 v63, v119
    v_mfma_f32_16x16x32_bf16 v[248:251], a[124:127], v[64:67], v[248:251]
    ds_read_b128 a[88:91], v43 offset:33280
    v_add_f32 v53, v53, v63
    v_mfma_f32_16x16x32_bf16 v[252:255], a[124:127], v[68:71], v[252:255]
    s_waitcnt lgkmcnt(5)
    ds_read_b128 a[92:95], v43 offset:41472
    ds_read_b128 a[96:99], v40 offset:33536
    s_cmp_lg_u32 s36, 0
    s_cbranch_scc1 L_loopadaLN_cond__gqa_block_cached__mixer_gmlp__prompt_kernel
    v_mov_b32 v8, 4
    buffer_load_dword v9, v8, s[92:95], 0 offen sc1
    s_movk_i32 s31, 0x124a
    s_and_b32 s57, s30, 1
    s_lshl_b32 s57, s57, 1
    v_and_b32 v1, 63, v0
    v_mfma_f32_16x16x32_bf16 v[96:99], a[64:67], a[0:3], v[80:83]
    v_exp_f32 v56, v120
    v_mfma_f32_16x16x32_bf16 v[100:103], a[64:67], a[4:7], v[84:87]
    buffer_load_dwordx4 v37, s[20:23], s33 offen offset:1024 nt lds
    v_mfma_f32_16x16x32_bf16 v[108:111], a[68:71], a[4:7], v[84:87]
    ds_read_b128 a[100:103], v40 offset:41728
    v_cvt_pk_bf16_f32 v77, v62, v63
    v_mfma_f32_16x16x32_bf16 v[104:107], a[68:71], a[0:3], v[80:83]
    s_waitcnt lgkmcnt(6)
    ds_read_b128 a[104:107], v41 offset:33536
    ds_read_b128 a[108:111], v41 offset:41728
    v_mfma_f32_16x16x32_bf16 v[96:99], a[72:75], a[8:11], v[96:99]
    v_exp_f32 v57, v121
    v_mfma_f32_16x16x32_bf16 v[100:103], a[72:75], a[12:15], v[100:103]
    ds_read_b128 a[112:115], v42 offset:33536
    v_add_f32 v52, v52, v56
    v_mfma_f32_16x16x32_bf16 v[108:111], a[76:79], a[12:15], v[108:111]
    ds_read_b128 a[116:119], v42 offset:41728
    v_add_f32 v52, v52, v57
    v_mfma_f32_16x16x32_bf16 v[104:107], a[76:79], a[8:11], v[104:107]
    s_waitcnt lgkmcnt(8)
    v_exp_f32 v58, v122
    v_mfma_f32_16x16x32_bf16 v[96:99], a[80:83], a[16:19], v[96:99]
    ds_read_b128 a[120:123], v43 offset:33536
    v_cvt_pk_bf16_f32 v74, v56, v57
    v_mfma_f32_16x16x32_bf16 v[100:103], a[80:83], a[20:23], v[100:103]
    buffer_load_dwordx4 v38, s[20:23], s33 offen offset:2048 nt lds
    v_mfma_f32_16x16x32_bf16 v[108:111], a[84:87], a[20:23], v[108:111]
    ds_read_b128 a[124:127], v43 offset:41728
    ds_read_b64_tr_b16 a[64:65], v48 offset:16640
    v_mfma_f32_16x16x32_bf16 v[104:107], a[84:87], a[16:19], v[104:107]
    s_waitcnt lgkmcnt(9)
    v_exp_f32 v59, v123
    v_mfma_f32_16x16x32_bf16 v[96:99], a[88:91], a[24:27], v[96:99]
    ds_read_b64_tr_b16 a[66:67], v48 offset:18688
    v_add_f32 v52, v52, v58
    v_mfma_f32_16x16x32_bf16 v[100:103], a[88:91], a[28:31], v[100:103]
    ds_read_b64_tr_b16 a[68:69], v49 offset:16640
    ds_read_b64_tr_b16 a[70:71], v49 offset:18688
    v_mfma_f32_16x16x32_bf16 v[108:111], a[92:95], a[28:31], v[108:111]
    v_exp_f32 v60, v124
    v_mfma_f32_16x16x32_bf16 v[104:107], a[92:95], a[24:27], v[104:107]
    s_waitcnt lgkmcnt(10)
    ds_read_b64_tr_b16 a[72:73], v48 offset:16704
    v_add_f32 v52, v52, v59
    v_mfma_f32_16x16x32_bf16 v[96:99], a[96:99], a[32:35], v[96:99]
    ds_read_b64_tr_b16 a[74:75], v48 offset:18752
    v_cvt_pk_bf16_f32 v75, v58, v59
    v_mfma_f32_16x16x32_bf16 v[100:103], a[96:99], a[36:39], v[100:103]
    buffer_load_dwordx4 v39, s[20:23], s33 offen offset:3072 nt lds
    v_mfma_f32_16x16x32_bf16 v[108:111], a[100:103], a[36:39], v[108:111]
    s_add_u32 s33, s33, 16384
    v_exp_f32 v61, v125
    v_mfma_f32_16x16x32_bf16 v[104:107], a[100:103], a[32:35], v[104:107]
    s_waitcnt lgkmcnt(10)
    ds_read_b64_tr_b16 a[76:77], v49 offset:16704
    v_add_f32 v53, v53, v60
    v_mfma_f32_16x16x32_bf16 v[96:99], a[104:107], a[40:43], v[96:99]
    ds_read_b64_tr_b16 a[78:79], v49 offset:18752
    ds_read_b64_tr_b16 a[80:81], v48 offset:16768
    v_mfma_f32_16x16x32_bf16 v[100:103], a[104:107], a[44:47], v[100:103]
    v_exp_f32 v62, v126
    v_mfma_f32_16x16x32_bf16 v[108:111], a[108:111], a[44:47], v[108:111]
    ds_read_b64_tr_b16 a[82:83], v48 offset:18816
    v_add_f32 v53, v53, v61
    v_mfma_f32_16x16x32_bf16 v[104:107], a[108:111], a[40:43], v[104:107]
    s_waitcnt lgkmcnt(12)
    ds_read_b64_tr_b16 a[84:85], v49 offset:16768
    v_cvt_pk_bf16_f32 v78, v60, v61
    v_mfma_f32_16x16x32_bf16 v[96:99], a[112:115], a[48:51], v[96:99]
    s_add_u32 m0, s34, 83200
    v_exp_f32 v63, v127
    v_mfma_f32_16x16x32_bf16 v[100:103], a[112:115], a[52:55], v[100:103]
    buffer_load_dwordx4 v32, s[16:19], s32 offen offset:0 nt lds
    v_mfma_f32_16x16x32_bf16 v[108:111], a[116:119], a[52:55], v[108:111]
    ds_read_b64_tr_b16 a[86:87], v49 offset:18816
    v_add_f32 v53, v53, v62
    v_mfma_f32_16x16x32_bf16 v[104:107], a[116:119], a[48:51], v[104:107]
    s_waitcnt lgkmcnt(12)
    ds_read_b64_tr_b16 a[88:89], v48 offset:16832
    v_add_f32 v53, v53, v63
    v_mfma_f32_16x16x32_bf16 v[96:99], a[120:123], a[56:59], v[96:99]
    ds_read_b64_tr_b16 a[90:91], v48 offset:18880
    v_add_f32 v30, v52, v53
    v_mfma_f32_16x16x32_bf16 v[100:103], a[120:123], a[60:63], v[100:103]
    ds_read_b64_tr_b16 a[92:93], v49 offset:16832
    v_cmp_lt_f32 vcc, s37, v30
    v_mfma_f32_16x16x32_bf16 v[108:111], a[124:127], a[60:63], v[108:111]
    s_waitcnt lgkmcnt(11)
    ds_read_b64_tr_b16 a[94:95], v49 offset:18880
    v_cvt_pk_bf16_f32 v79, v62, v63
    v_mfma_f32_16x16x32_bf16 v[104:107], a[124:127], a[56:59], v[104:107]
    s_cbranch_vccnz L_fb6
L_ret6:
    v_mfma_f32_16x16x32_bf16 v[128:131], a[64:67], v[72:75], v[128:131]
    ds_read_b64_tr_b16 a[96:97], v48 offset:16896
    v_add_f32 v50, v50, v52
    v_mfma_f32_16x16x32_bf16 v[132:135], a[64:67], v[76:79], v[132:135]
    buffer_load_dwordx4 v33, s[16:19], s32 offen offset:1024 nt lds
    v_mfma_f32_16x16x32_bf16 v[136:139], a[68:71], v[72:75], v[136:139]
    ds_read_b64_tr_b16 a[98:99], v48 offset:18944
    v_add_f32 v51, v51, v53
    v_mfma_f32_16x16x32_bf16 v[140:143], a[68:71], v[76:79], v[140:143]
    s_waitcnt lgkmcnt(10)
    ds_read_b64_tr_b16 a[100:101], v49 offset:16896
    ds_read_b64_tr_b16 a[102:103], v49 offset:18944
    v_mfma_f32_16x16x32_bf16 v[144:147], a[72:75], v[72:75], v[144:147]
    v_exp_f32 v56, v96
    v_mfma_f32_16x16x32_bf16 v[148:151], a[72:75], v[76:79], v[148:151]
    ds_read_b64_tr_b16 a[104:105], v48 offset:16960
    v_mfma_f32_16x16x32_bf16 v[152:155], a[76:79], v[72:75], v[152:155]
    ds_read_b64_tr_b16 a[106:107], v48 offset:19008
    v_mfma_f32_16x16x32_bf16 v[156:159], a[76:79], v[76:79], v[156:159]
    s_waitcnt lgkmcnt(10)
    ds_read_b64_tr_b16 a[108:109], v49 offset:16960
    ds_read_b64_tr_b16 a[110:111], v49 offset:19008
    v_mfma_f32_16x16x32_bf16 v[160:163], a[80:83], v[72:75], v[160:163]
    v_exp_f32 v57, v97
    v_mfma_f32_16x16x32_bf16 v[164:167], a[80:83], v[76:79], v[164:167]
    buffer_load_dwordx4 v34, s[16:19], s32 offen offset:2048 nt lds
    v_mfma_f32_16x16x32_bf16 v[168:171], a[84:87], v[72:75], v[168:171]
    ds_read_b64_tr_b16 a[112:113], v48 offset:17024
    v_add_f32 v52, v56, v57
    v_mfma_f32_16x16x32_bf16 v[172:175], a[84:87], v[76:79], v[172:175]
    s_waitcnt lgkmcnt(9)
    v_exp_f32 v58, v98
    v_mfma_f32_16x16x32_bf16 v[176:179], a[88:91], v[72:75], v[176:179]
    ds_read_b64_tr_b16 a[114:115], v48 offset:19072
    v_cvt_pk_bf16_f32 v64, v56, v57
    v_mfma_f32_16x16x32_bf16 v[180:183], a[88:91], v[76:79], v[180:183]
    ds_read_b64_tr_b16 a[116:117], v49 offset:17024
    v_add_f32 v52, v52, v58
    v_mfma_f32_16x16x32_bf16 v[184:187], a[92:95], v[72:75], v[184:187]
    ds_read_b64_tr_b16 a[118:119], v49 offset:19072
    ds_read_b64_tr_b16 a[120:121], v48 offset:17088
    v_mfma_f32_16x16x32_bf16 v[188:191], a[92:95], v[76:79], v[188:191]
    s_waitcnt lgkmcnt(9)
    v_exp_f32 v59, v99
    v_mfma_f32_16x16x32_bf16 v[192:195], a[96:99], v[72:75], v[192:195]
    ds_read_b64_tr_b16 a[122:123], v48 offset:19136
    ds_read_b64_tr_b16 a[124:125], v49 offset:17088
    v_mfma_f32_16x16x32_bf16 v[196:199], a[96:99], v[76:79], v[196:199]
    buffer_load_dwordx4 v35, s[16:19], s32 offen offset:3072 nt lds
    v_mfma_f32_16x16x32_bf16 v[200:203], a[100:103], v[72:75], v[200:203]
    s_add_u32 s32, s32, 16384
    v_exp_f32 v60, v100
    v_mfma_f32_16x16x32_bf16 v[204:207], a[100:103], v[76:79], v[204:207]
    s_waitcnt lgkmcnt(7)
    ds_read_b64_tr_b16 a[126:127], v49 offset:19136
    v_add_f32 v52, v52, v59
    v_mfma_f32_16x16x32_bf16 v[208:211], a[104:107], v[72:75], v[208:211]
    s_waitcnt vmcnt(13)
    s_barrier
    v_mfma_f32_16x16x32_bf16 v[212:215], a[104:107], v[76:79], v[212:215]
    ds_read_b128 a[64:67], v40 offset:49920
    v_cvt_pk_bf16_f32 v65, v58, v59
    v_mfma_f32_16x16x32_bf16 v[216:219], a[108:111], v[72:75], v[216:219]
    v_exp_f32 v61, v101
    v_mfma_f32_16x16x32_bf16 v[220:223], a[108:111], v[76:79], v[220:223]
    s_waitcnt lgkmcnt(5)
    ds_read_b128 a[68:71], v40 offset:58112
    v_add_f32 v53, v60, v61
    v_mfma_f32_16x16x32_bf16 v[224:227], a[112:115], v[72:75], v[224:227]
    s_add_u32 m0, s35, 0
    ds_read_b128 a[72:75], v41 offset:49920
    ds_read_b128 a[76:79], v41 offset:58112
    v_mfma_f32_16x16x32_bf16 v[228:231], a[112:115], v[76:79], v[228:231]
    buffer_load_dwordx4 v36, s[20:23], s33 offen offset:0 nt lds
    v_mfma_f32_16x16x32_bf16 v[232:235], a[116:119], v[72:75], v[232:235]
    v_exp_f32 v62, v102
    v_mfma_f32_16x16x32_bf16 v[236:239], a[116:119], v[76:79], v[236:239]
    s_waitcnt lgkmcnt(4)
    ds_read_b128 a[80:83], v42 offset:49920
    v_cvt_pk_bf16_f32 v68, v60, v61
    v_mfma_f32_16x16x32_bf16 v[240:243], a[120:123], v[72:75], v[240:243]
    ds_read_b128 a[84:87], v42 offset:58112
    v_add_f32 v53, v53, v62
    v_mfma_f32_16x16x32_bf16 v[244:247], a[120:123], v[76:79], v[244:247]
    v_exp_f32 v63, v103
    v_mfma_f32_16x16x32_bf16 v[248:251], a[124:127], v[72:75], v[248:251]
    ds_read_b128 a[88:91], v43 offset:49920
    v_add_f32 v53, v53, v63
    v_mfma_f32_16x16x32_bf16 v[252:255], a[124:127], v[76:79], v[252:255]
    s_waitcnt lgkmcnt(5)
    ds_read_b128 a[92:95], v43 offset:58112
    ds_read_b128 a[96:99], v40 offset:50176
    v_mfma_f32_16x16x32_bf16 v[112:115], a[64:67], a[0:3], v[80:83]
    v_exp_f32 v56, v104
    v_mfma_f32_16x16x32_bf16 v[116:119], a[64:67], a[4:7], v[84:87]
    buffer_load_dwordx4 v37, s[20:23], s33 offen offset:1024 nt lds
    v_mfma_f32_16x16x32_bf16 v[124:127], a[68:71], a[4:7], v[84:87]
    ds_read_b128 a[100:103], v40 offset:58368
    v_cvt_pk_bf16_f32 v69, v62, v63
    v_mfma_f32_16x16x32_bf16 v[120:123], a[68:71], a[0:3], v[80:83]
    s_waitcnt lgkmcnt(6)
    ds_read_b128 a[104:107], v41 offset:50176
    ds_read_b128 a[108:111], v41 offset:58368
    v_mfma_f32_16x16x32_bf16 v[112:115], a[72:75], a[8:11], v[112:115]
    v_exp_f32 v57, v105
    v_mfma_f32_16x16x32_bf16 v[116:119], a[72:75], a[12:15], v[116:119]
    ds_read_b128 a[112:115], v42 offset:50176
    v_add_f32 v52, v52, v56
    v_mfma_f32_16x16x32_bf16 v[124:127], a[76:79], a[12:15], v[124:127]
    ds_read_b128 a[116:119], v42 offset:58368
    v_add_f32 v52, v52, v57
    v_mfma_f32_16x16x32_bf16 v[120:123], a[76:79], a[8:11], v[120:123]
    s_waitcnt lgkmcnt(8)
    v_exp_f32 v58, v106
    v_mfma_f32_16x16x32_bf16 v[112:115], a[80:83], a[16:19], v[112:115]
    ds_read_b128 a[120:123], v43 offset:50176
    v_cvt_pk_bf16_f32 v66, v56, v57
    v_mfma_f32_16x16x32_bf16 v[116:119], a[80:83], a[20:23], v[116:119]
    buffer_load_dwordx4 v38, s[20:23], s33 offen offset:2048 nt lds
    v_mfma_f32_16x16x32_bf16 v[124:127], a[84:87], a[20:23], v[124:127]
    ds_read_b128 a[124:127], v43 offset:58368
    ds_read_b64_tr_b16 a[64:65], v48 offset:33280
    v_mfma_f32_16x16x32_bf16 v[120:123], a[84:87], a[16:19], v[120:123]
    s_waitcnt lgkmcnt(9)
    v_exp_f32 v59, v107
    v_mfma_f32_16x16x32_bf16 v[112:115], a[88:91], a[24:27], v[112:115]
    ds_read_b64_tr_b16 a[66:67], v48 offset:35328
    v_add_f32 v52, v52, v58
    v_mfma_f32_16x16x32_bf16 v[116:119], a[88:91], a[28:31], v[116:119]
    ds_read_b64_tr_b16 a[68:69], v49 offset:33280
    ds_read_b64_tr_b16 a[70:71], v49 offset:35328
    v_mfma_f32_16x16x32_bf16 v[124:127], a[92:95], a[28:31], v[124:127]
    v_exp_f32 v60, v108
    v_mfma_f32_16x16x32_bf16 v[120:123], a[92:95], a[24:27], v[120:123]
    s_waitcnt lgkmcnt(10)
    ds_read_b64_tr_b16 a[72:73], v48 offset:33344
    v_add_f32 v52, v52, v59
    v_mfma_f32_16x16x32_bf16 v[112:115], a[96:99], a[32:35], v[112:115]
    ds_read_b64_tr_b16 a[74:75], v48 offset:35392
    v_cvt_pk_bf16_f32 v67, v58, v59
    v_mfma_f32_16x16x32_bf16 v[116:119], a[96:99], a[36:39], v[116:119]
    buffer_load_dwordx4 v39, s[20:23], s33 offen offset:3072 nt lds
    v_mfma_f32_16x16x32_bf16 v[124:127], a[100:103], a[36:39], v[124:127]
    s_add_u32 s33, s33, 16384
    v_exp_f32 v61, v109
    v_mfma_f32_16x16x32_bf16 v[120:123], a[100:103], a[32:35], v[120:123]
    s_waitcnt lgkmcnt(10)
    ds_read_b64_tr_b16 a[76:77], v49 offset:33344
    v_add_f32 v53, v53, v60
    v_mfma_f32_16x16x32_bf16 v[112:115], a[104:107], a[40:43], v[112:115]
    ds_read_b64_tr_b16 a[78:79], v49 offset:35392
    ds_read_b64_tr_b16 a[80:81], v48 offset:33408
    v_mfma_f32_16x16x32_bf16 v[116:119], a[104:107], a[44:47], v[116:119]
    v_exp_f32 v62, v110
    v_mfma_f32_16x16x32_bf16 v[124:127], a[108:111], a[44:47], v[124:127]
    ds_read_b64_tr_b16 a[82:83], v48 offset:35456
    v_add_f32 v53, v53, v61
    v_mfma_f32_16x16x32_bf16 v[120:123], a[108:111], a[40:43], v[120:123]
    s_waitcnt lgkmcnt(12)
    ds_read_b64_tr_b16 a[84:85], v49 offset:33408
    v_cvt_pk_bf16_f32 v70, v60, v61
    v_mfma_f32_16x16x32_bf16 v[112:115], a[112:115], a[48:51], v[112:115]
    s_add_u32 m0, s34, 99840
    v_exp_f32 v63, v111
    v_mfma_f32_16x16x32_bf16 v[116:119], a[112:115], a[52:55], v[116:119]
    buffer_load_dwordx4 v32, s[16:19], s32 offen offset:0 nt lds
    v_mfma_f32_16x16x32_bf16 v[124:127], a[116:119], a[52:55], v[124:127]
    ds_read_b64_tr_b16 a[86:87], v49 offset:35456
    v_add_f32 v53, v53, v62
    v_mfma_f32_16x16x32_bf16 v[120:123], a[116:119], a[48:51], v[120:123]
    s_waitcnt lgkmcnt(12)
    ds_read_b64_tr_b16 a[88:89], v48 offset:33472
    v_add_f32 v53, v53, v63
    v_mfma_f32_16x16x32_bf16 v[112:115], a[120:123], a[56:59], v[112:115]
    ds_read_b64_tr_b16 a[90:91], v48 offset:35520
    v_add_f32 v30, v52, v53
    v_mfma_f32_16x16x32_bf16 v[116:119], a[120:123], a[60:63], v[116:119]
    ds_read_b64_tr_b16 a[92:93], v49 offset:33472
    v_cmp_lt_f32 vcc, s37, v30
    v_mfma_f32_16x16x32_bf16 v[124:127], a[124:127], a[60:63], v[124:127]
    s_waitcnt lgkmcnt(11)
    ds_read_b64_tr_b16 a[94:95], v49 offset:35520
    v_cvt_pk_bf16_f32 v71, v62, v63
    v_mfma_f32_16x16x32_bf16 v[120:123], a[124:127], a[56:59], v[120:123]
    s_cbranch_vccnz L_fb7
L_ret7:
    v_mfma_f32_16x16x32_bf16 v[128:131], a[64:67], v[64:67], v[128:131]
    ds_read_b64_tr_b16 a[96:97], v48 offset:33536
    v_add_f32 v50, v50, v52
    v_mfma_f32_16x16x32_bf16 v[132:135], a[64:67], v[68:71], v[132:135]
    buffer_load_dwordx4 v33, s[16:19], s32 offen offset:1024 nt lds
    v_mfma_f32_16x16x32_bf16 v[136:139], a[68:71], v[64:67], v[136:139]
    ds_read_b64_tr_b16 a[98:99], v48 offset:35584
    v_add_f32 v51, v51, v53
    v_mfma_f32_16x16x32_bf16 v[140:143], a[68:71], v[68:71], v[140:143]
    s_waitcnt lgkmcnt(10)
    ds_read_b64_tr_b16 a[100:101], v49 offset:33536
    ds_read_b64_tr_b16 a[102:103], v49 offset:35584
    v_mfma_f32_16x16x32_bf16 v[144:147], a[72:75], v[64:67], v[144:147]
    v_exp_f32 v56, v112
    v_mfma_f32_16x16x32_bf16 v[148:151], a[72:75], v[68:71], v[148:151]
    ds_read_b64_tr_b16 a[104:105], v48 offset:33600
    v_mfma_f32_16x16x32_bf16 v[152:155], a[76:79], v[64:67], v[152:155]
    ds_read_b64_tr_b16 a[106:107], v48 offset:35648
    v_mfma_f32_16x16x32_bf16 v[156:159], a[76:79], v[68:71], v[156:159]
    s_waitcnt lgkmcnt(10)
    ds_read_b64_tr_b16 a[108:109], v49 offset:33600
    ds_read_b64_tr_b16 a[110:111], v49 offset:35648
    v_mfma_f32_16x16x32_bf16 v[160:163], a[80:83], v[64:67], v[160:163]
    v_exp_f32 v57, v113
    v_mfma_f32_16x16x32_bf16 v[164:167], a[80:83], v[68:71], v[164:167]
    buffer_load_dwordx4 v34, s[16:19], s32 offen offset:2048 nt lds
    v_mfma_f32_16x16x32_bf16 v[168:171], a[84:87], v[64:67], v[168:171]
    ds_read_b64_tr_b16 a[112:113], v48 offset:33664
    v_add_f32 v52, v56, v57
    v_mfma_f32_16x16x32_bf16 v[172:175], a[84:87], v[68:71], v[172:175]
    s_waitcnt lgkmcnt(9)
    v_exp_f32 v58, v114
    v_mfma_f32_16x16x32_bf16 v[176:179], a[88:91], v[64:67], v[176:179]
    ds_read_b64_tr_b16 a[114:115], v48 offset:35712
    v_cvt_pk_bf16_f32 v72, v56, v57
    v_mfma_f32_16x16x32_bf16 v[180:183], a[88:91], v[68:71], v[180:183]
    ds_read_b64_tr_b16 a[116:117], v49 offset:33664
    v_add_f32 v52, v52, v58
    v_mfma_f32_16x16x32_bf16 v[184:187], a[92:95], v[64:67], v[184:187]
    ds_read_b64_tr_b16 a[118:119], v49 offset:35712
    ds_read_b64_tr_b16 a[120:121], v48 offset:33728
    v_mfma_f32_16x16x32_bf16 v[188:191], a[92:95], v[68:71], v[188:191]
    s_waitcnt lgkmcnt(9)
    v_exp_f32 v59, v115
    v_mfma_f32_16x16x32_bf16 v[192:195], a[96:99], v[64:67], v[192:195]
    ds_read_b64_tr_b16 a[122:123], v48 offset:35776
    ds_read_b64_tr_b16 a[124:125], v49 offset:33728
    v_mfma_f32_16x16x32_bf16 v[196:199], a[96:99], v[68:71], v[196:199]
    buffer_load_dwordx4 v35, s[16:19], s32 offen offset:3072 nt lds
    v_mfma_f32_16x16x32_bf16 v[200:203], a[100:103], v[64:67], v[200:203]
    s_add_u32 s32, s32, 16384
    v_exp_f32 v60, v116
    v_mfma_f32_16x16x32_bf16 v[204:207], a[100:103], v[68:71], v[204:207]
    s_waitcnt lgkmcnt(7)
    ds_read_b64_tr_b16 a[126:127], v49 offset:35776
    v_add_f32 v52, v52, v59
    v_mfma_f32_16x16x32_bf16 v[208:211], a[104:107], v[64:67], v[208:211]
    s_waitcnt vmcnt(12)
    s_barrier
    v_mfma_f32_16x16x32_bf16 v[212:215], a[104:107], v[68:71], v[212:215]
    ds_read_b128 a[64:67], v40 offset:0
    v_cvt_pk_bf16_f32 v73, v58, v59
    v_mfma_f32_16x16x32_bf16 v[216:219], a[108:111], v[64:67], v[216:219]
    v_exp_f32 v61, v117
    v_mfma_f32_16x16x32_bf16 v[220:223], a[108:111], v[68:71], v[220:223]
    s_waitcnt lgkmcnt(5)
    ds_read_b128 a[68:71], v40 offset:8192
    v_add_f32 v53, v60, v61
    v_mfma_f32_16x16x32_bf16 v[224:227], a[112:115], v[64:67], v[224:227]
    s_add_u32 m0, s35, 16640
    ds_read_b128 a[72:75], v41 offset:0
    ds_read_b128 a[76:79], v41 offset:8192
    v_mfma_f32_16x16x32_bf16 v[228:231], a[112:115], v[68:71], v[228:231]
    buffer_load_dwordx4 v36, s[20:23], s33 offen offset:0 nt lds
    v_mfma_f32_16x16x32_bf16 v[232:235], a[116:119], v[64:67], v[232:235]
    v_exp_f32 v62, v118
    v_mfma_f32_16x16x32_bf16 v[236:239], a[116:119], v[68:71], v[236:239]
    s_waitcnt lgkmcnt(4)
    ds_read_b128 a[80:83], v42 offset:0
    v_cvt_pk_bf16_f32 v76, v60, v61
    v_mfma_f32_16x16x32_bf16 v[240:243], a[120:123], v[64:67], v[240:243]
    ds_read_b128 a[84:87], v42 offset:8192
    v_add_f32 v53, v53, v62
    v_mfma_f32_16x16x32_bf16 v[244:247], a[120:123], v[68:71], v[244:247]
    v_exp_f32 v63, v119
    v_mfma_f32_16x16x32_bf16 v[248:251], a[124:127], v[64:67], v[248:251]
    ds_read_b128 a[88:91], v43 offset:0
    v_add_f32 v53, v53, v63
    v_mfma_f32_16x16x32_bf16 v[252:255], a[124:127], v[68:71], v[252:255]
    s_waitcnt lgkmcnt(5)
    ds_read_b128 a[92:95], v43 offset:8192
    ds_read_b128 a[96:99], v40 offset:256
    v_readfirstlane_b32 s14, v9
    s_nop 0
    s_cmp_lt_u32 s14, 36
    s_cbranch_scc1 L_mslowadaLN_cond__gqa_block_cached__mixer_gmlp__prompt_kernel
L_mokadaLN_cond__gqa_block_cached__mixer_gmlp__prompt_kernel:
    s_lshl_b32 s14, s30, 7
    s_add_u32 s14, s14, 118800
    v_mfma_f32_16x16x32_bf16 v[96:99], a[64:67], a[0:3], v[80:83]
    v_exp_f32 v56, v120
    v_mfma_f32_16x16x32_bf16 v[100:103], a[64:67], a[4:7], v[84:87]
    buffer_load_dwordx4 v37, s[20:23], s33 offen offset:1024 nt lds
    v_mfma_f32_16x16x32_bf16 v[108:111], a[68:71], a[4:7], v[84:87]
    ds_read_b128 a[100:103], v40 offset:8448
    v_cvt_pk_bf16_f32 v77, v62, v63
    buffer_atomic_add v10, v11, s[24:27], s14 offen sc0 sc1
    v_mfma_f32_16x16x32_bf16 v[104:107], a[68:71], a[0:3], v[80:83]
    s_waitcnt lgkmcnt(6)
    ds_read_b128 a[104:107], v41 offset:256
    ds_read_b128 a[108:111], v41 offset:8448
    v_mfma_f32_16x16x32_bf16 v[96:99], a[72:75], a[8:11], v[96:99]
    v_exp_f32 v57, v121
    v_mfma_f32_16x16x32_bf16 v[100:103], a[72:75], a[12:15], v[100:103]
    ds_read_b128 a[112:115], v42 offset:256
    v_add_f32 v52, v52, v56
    v_mfma_f32_16x16x32_bf16 v[108:111], a[76:79], a[12:15], v[108:111]
    ds_read_b128 a[116:119], v42 offset:8448
    v_add_f32 v52, v52, v57
    v_mfma_f32_16x16x32_bf16 v[104:107], a[76:79], a[8:11], v[104:107]
    s_waitcnt lgkmcnt(8)
    v_exp_f32 v58, v122
    v_mfma_f32_16x16x32_bf16 v[96:99], a[80:83], a[16:19], v[96:99]
    ds_read_b128 a[120:123], v43 offset:256
    v_cvt_pk_bf16_f32 v74, v56, v57
    v_mfma_f32_16x16x32_bf16 v[100:103], a[80:83], a[20:23], v[100:103]
    buffer_load_dwordx4 v38, s[20:23], s33 offen offset:2048 nt lds
    v_mfma_f32_16x16x32_bf16 v[108:111], a[84:87], a[20:23], v[108:111]
    ds_read_b128 a[124:127], v43 offset:8448
    ds_read_b64_tr_b16 a[64:65], v48 offset:49920
    v_mfma_f32_16x16x32_bf16 v[104:107], a[84:87], a[16:19], v[104:107]
    s_waitcnt lgkmcnt(9)
    v_exp_f32 v59, v123
    v_mfma_f32_16x16x32_bf16 v[96:99], a[88:91], a[24:27], v[96:99]
    ds_read_b64_tr_b16 a[66:67], v48 offset:51968
    v_add_f32 v52, v52, v58
    v_mfma_f32_16x16x32_bf16 v[100:103], a[88:91], a[28:31], v[100:103]
    ds_read_b64_tr_b16 a[68:69], v49 offset:49920
    ds_read_b64_tr_b16 a[70:71], v49 offset:51968
    v_mfma_f32_16x16x32_bf16 v[108:111], a[92:95], a[28:31], v[108:111]
    v_exp_f32 v60, v124
    v_mfma_f32_16x16x32_bf16 v[104:107], a[92:95], a[24:27], v[104:107]
    s_waitcnt lgkmcnt(10)
    ds_read_b64_tr_b16 a[72:73], v48 offset:49984
    v_add_f32 v52, v52, v59
    v_mfma_f32_16x16x32_bf16 v[96:99], a[96:99], a[32:35], v[96:99]
    ds_read_b64_tr_b16 a[74:75], v48 offset:52032
    v_cvt_pk_bf16_f32 v75, v58, v59
    v_mfma_f32_16x16x32_bf16 v[100:103], a[96:99], a[36:39], v[100:103]
    buffer_load_dwordx4 v39, s[20:23], s33 offen offset:3072 nt lds
    v_mfma_f32_16x16x32_bf16 v[108:111], a[100:103], a[36:39], v[108:111]
    s_add_u32 s33, s33, 16384
    v_exp_f32 v61, v125
    v_mfma_f32_16x16x32_bf16 v[104:107], a[100:103], a[32:35], v[104:107]
    s_waitcnt lgkmcnt(10)
    ds_read_b64_tr_b16 a[76:77], v49 offset:49984
    v_add_f32 v53, v53, v60
    v_mfma_f32_16x16x32_bf16 v[96:99], a[104:107], a[40:43], v[96:99]
    ds_read_b64_tr_b16 a[78:79], v49 offset:52032
    ds_read_b64_tr_b16 a[80:81], v48 offset:50048
    v_mfma_f32_16x16x32_bf16 v[100:103], a[104:107], a[44:47], v[100:103]
    v_exp_f32 v62, v126
    v_mfma_f32_16x16x32_bf16 v[108:111], a[108:111], a[44:47], v[108:111]
    ds_read_b64_tr_b16 a[82:83], v48 offset:52096
    v_add_f32 v53, v53, v61
    v_mfma_f32_16x16x32_bf16 v[104:107], a[108:111], a[40:43], v[104:107]
    s_waitcnt lgkmcnt(12)
    ds_read_b64_tr_b16 a[84:85], v49 offset:50048
    v_cvt_pk_bf16_f32 v78, v60, v61
    v_mfma_f32_16x16x32_bf16 v[96:99], a[112:115], a[48:51], v[96:99]
    s_add_u32 m0, s34, 116480
    v_exp_f32 v63, v127
    v_mfma_f32_16x16x32_bf16 v[100:103], a[112:115], a[52:55], v[100:103]
    buffer_load_dwordx4 v32, s[16:19], s32 offen offset:0 nt lds
    v_mfma_f32_16x16x32_bf16 v[108:111], a[116:119], a[52:55], v[108:111]
    ds_read_b64_tr_b16 a[86:87], v49 offset:52096
    v_add_f32 v53, v53, v62
    v_mfma_f32_16x16x32_bf16 v[104:107], a[116:119], a[48:51], v[104:107]
    s_waitcnt lgkmcnt(12)
    ds_read_b64_tr_b16 a[88:89], v48 offset:50112
    v_add_f32 v53, v53, v63
    v_mfma_f32_16x16x32_bf16 v[96:99], a[120:123], a[56:59], v[96:99]
    ds_read_b64_tr_b16 a[90:91], v48 offset:52160
    v_add_f32 v30, v52, v53
    v_mfma_f32_16x16x32_bf16 v[100:103], a[120:123], a[60:63], v[100:103]
    ds_read_b64_tr_b16 a[92:93], v49 offset:50112
    v_cmp_lt_f32 vcc, s37, v30
    v_mfma_f32_16x16x32_bf16 v[108:111], a[124:127], a[60:63], v[108:111]
    s_waitcnt lgkmcnt(11)
    ds_read_b64_tr_b16 a[94:95], v49 offset:52160
    v_cvt_pk_bf16_f32 v79, v62, v63
    v_mfma_f32_16x16x32_bf16 v[104:107], a[124:127], a[56:59], v[104:107]
    s_cbranch_vccnz L_fb8
L_ret8:
    v_mfma_f32_16x16x32_bf16 v[128:131], a[64:67], v[72:75], v[128:131]
    ds_read_b64_tr_b16 a[96:97], v48 offset:50176
    v_add_f32 v50, v50, v52
    v_mfma_f32_16x16x32_bf16 v[132:135], a[64:67], v[76:79], v[132:135]
    buffer_load_dwordx4 v33, s[16:19], s32 offen offset:1024 nt lds
    v_mfma_f32_16x16x32_bf16 v[136:139], a[68:71], v[72:75], v[136:139]
    ds_read_b64_tr_b16 a[98:99], v48 offset:52224
    v_add_f32 v51, v51, v53
    v_mfma_f32_16x16x32_bf16 v[140:143], a[68:71], v[76:79], v[140:143]
    s_waitcnt lgkmcnt(10)
    ds_read_b64_tr_b16 a[100:101], v49 offset:50176
    ds_read_b64_tr_b16 a[102:103], v49 offset:52224
    v_mfma_f32_16x16x32_bf16 v[144:147], a[72:75], v[72:75], v[144:147]
    v_exp_f32 v56, v96
    v_mfma_f32_16x16x32_bf16 v[148:151], a[72:75], v[76:79], v[148:151]
    ds_read_b64_tr_b16 a[104:105], v48 offset:50240
    v_mfma_f32_16x16x32_bf16 v[152:155], a[76:79], v[72:75], v[152:155]
    ds_read_b64_tr_b16 a[106:107], v48 offset:52288
    v_mfma_f32_16x16x32_bf16 v[156:159], a[76:79], v[76:79], v[156:159]
    s_waitcnt lgkmcnt(10)
    ds_read_b64_tr_b16 a[108:109], v49 offset:50240
    ds_read_b64_tr_b16 a[110:111], v49 offset:52288
    v_mfma_f32_16x16x32_bf16 v[160:163], a[80:83], v[72:75], v[160:163]
    v_exp_f32 v57, v97
    v_mfma_f32_16x16x32_bf16 v[164:167], a[80:83], v[76:79], v[164:167]
    buffer_load_dwordx4 v34, s[16:19], s32 offen offset:2048 nt lds
    v_mfma_f32_16x16x32_bf16 v[168:171], a[84:87], v[72:75], v[168:171]
    ds_read_b64_tr_b16 a[112:113], v48 offset:50304
    v_add_f32 v52, v56, v57
    v_mfma_f32_16x16x32_bf16 v[172:175], a[84:87], v[76:79], v[172:175]
    s_waitcnt lgkmcnt(9)
    v_exp_f32 v58, v98
    v_mfma_f32_16x16x32_bf16 v[176:179], a[88:91], v[72:75], v[176:179]
    ds_read_b64_tr_b16 a[114:115], v48 offset:52352
    v_cvt_pk_bf16_f32 v64, v56, v57
    v_mfma_f32_16x16x32_bf16 v[180:183], a[88:91], v[76:79], v[180:183]
    ds_read_b64_tr_b16 a[116:117], v49 offset:50304
    v_add_f32 v52, v52, v58
    v_mfma_f32_16x16x32_bf16 v[184:187], a[92:95], v[72:75], v[184:187]
    ds_read_b64_tr_b16 a[118:119], v49 offset:52352
    ds_read_b64_tr_b16 a[120:121], v48 offset:50368
    v_mfma_f32_16x16x32_bf16 v[188:191], a[92:95], v[76:79], v[188:191]
    s_waitcnt lgkmcnt(9)
    v_exp_f32 v59, v99
    v_mfma_f32_16x16x32_bf16 v[192:195], a[96:99], v[72:75], v[192:195]
    ds_read_b64_tr_b16 a[122:123], v48 offset:52416
    ds_read_b64_tr_b16 a[124:125], v49 offset:50368
    v_mfma_f32_16x16x32_bf16 v[196:199], a[96:99], v[76:79], v[196:199]
    buffer_load_dwordx4 v35, s[16:19], s32 offen offset:3072 nt lds
    v_mfma_f32_16x16x32_bf16 v[200:203], a[100:103], v[72:75], v[200:203]
    s_add_u32 s32, s32, 16384
    v_exp_f32 v60, v100
    v_mfma_f32_16x16x32_bf16 v[204:207], a[100:103], v[76:79], v[204:207]
    s_waitcnt lgkmcnt(7)
    ds_read_b64_tr_b16 a[126:127], v49 offset:52416
    v_add_f32 v52, v52, v59
    v_mfma_f32_16x16x32_bf16 v[208:211], a[104:107], v[72:75], v[208:211]
    s_waitcnt vmcnt(13)
    s_barrier
    v_mfma_f32_16x16x32_bf16 v[212:215], a[104:107], v[76:79], v[212:215]
    ds_read_b128 a[64:67], v40 offset:16640
    v_cvt_pk_bf16_f32 v65, v58, v59
    v_mfma_f32_16x16x32_bf16 v[216:219], a[108:111], v[72:75], v[216:219]
    v_exp_f32 v61, v101
    v_mfma_f32_16x16x32_bf16 v[220:223], a[108:111], v[76:79], v[220:223]
    s_waitcnt lgkmcnt(5)
    ds_read_b128 a[68:71], v40 offset:24832
    v_add_f32 v53, v60, v61
    v_mfma_f32_16x16x32_bf16 v[224:227], a[112:115], v[72:75], v[224:227]
    s_add_u32 m0, s35, 33280
    ds_read_b128 a[72:75], v41 offset:16640
    ds_read_b128 a[76:79], v41 offset:24832
    v_mfma_f32_16x16x32_bf16 v[228:231], a[112:115], v[76:79], v[228:231]
    buffer_load_dwordx4 v36, s[20:23], s33 offen offset:0 nt lds
    v_mfma_f32_16x16x32_bf16 v[232:235], a[116:119], v[72:75], v[232:235]
    v_exp_f32 v62, v102
    v_mfma_f32_16x16x32_bf16 v[236:239], a[116:119], v[76:79], v[236:239]
    s_waitcnt lgkmcnt(4)
    ds_read_b128 a[80:83], v42 offset:16640
    v_cvt_pk_bf16_f32 v68, v60, v61
    v_mfma_f32_16x16x32_bf16 v[240:243], a[120:123], v[72:75], v[240:243]
    ds_read_b128 a[84:87], v42 offset:24832
    v_add_f32 v53, v53, v62
    v_mfma_f32_16x16x32_bf16 v[244:247], a[120:123], v[76:79], v[244:247]
    v_exp_f32 v63, v103
    v_mfma_f32_16x16x32_bf16 v[248:251], a[124:127], v[72:75], v[248:251]
    ds_read_b128 a[88:91], v43 offset:16640
    v_add_f32 v53, v53, v63
    v_mfma_f32_16x16x32_bf16 v[252:255], a[124:127], v[76:79], v[252:255]
    s_waitcnt lgkmcnt(5)
    ds_read_b128 a[92:95], v43 offset:24832
    ds_read_b128 a[96:99], v40 offset:16896
    v_mfma_f32_16x16x32_bf16 v[112:115], a[64:67], a[0:3], v[80:83]
    v_exp_f32 v56, v104
    v_mfma_f32_16x16x32_bf16 v[116:119], a[64:67], a[4:7], v[84:87]
    buffer_load_dwordx4 v37, s[20:23], s33 offen offset:1024 nt lds
    v_mfma_f32_16x16x32_bf16 v[124:127], a[68:71], a[4:7], v[84:87]
    ds_read_b128 a[100:103], v40 offset:25088
    v_cvt_pk_bf16_f32 v69, v62, v63
    v_mfma_f32_16x16x32_bf16 v[120:123], a[68:71], a[0:3], v[80:83]
    s_waitcnt lgkmcnt(6)
    ds_read_b128 a[104:107], v41 offset:16896
    ds_read_b128 a[108:111], v41 offset:25088
    v_mfma_f32_16x16x32_bf16 v[112:115], a[72:75], a[8:11], v[112:115]
    v_exp_f32 v57, v105
    v_mfma_f32_16x16x32_bf16 v[116:119], a[72:75], a[12:15], v[116:119]
    ds_read_b128 a[112:115], v42 offset:16896
    v_add_f32 v52, v52, v56
    v_mfma_f32_16x16x32_bf16 v[124:127], a[76:79], a[12:15], v[124:127]
    ds_read_b128 a[116:119], v42 offset:25088
    v_add_f32 v52, v52, v57
    v_mfma_f32_16x16x32_bf16 v[120:123], a[76:79], a[8:11], v[120:123]
    s_waitcnt lgkmcnt(8)
    v_exp_f32 v58, v106
    v_mfma_f32_16x16x32_bf16 v[112:115], a[80:83], a[16:19], v[112:115]
    ds_read_b128 a[120:123], v43 offset:16896
    v_cvt_pk_bf16_f32 v66, v56, v57
    v_mfma_f32_16x16x32_bf16 v[116:119], a[80:83], a[20:23], v[116:119]
    buffer_load_dwordx4 v38, s[20:23], s33 offen offset:2048 nt lds
    v_mfma_f32_16x16x32_bf16 v[124:127], a[84:87], a[20:23], v[124:127]
    ds_read_b128 a[124:127], v43 offset:25088
    ds_read_b64_tr_b16 a[64:65], v48 offset:0
    v_mfma_f32_16x16x32_bf16 v[120:123], a[84:87], a[16:19], v[120:123]
    s_waitcnt lgkmcnt(9)
    v_exp_f32 v59, v107
    v_mfma_f32_16x16x32_bf16 v[112:115], a[88:91], a[24:27], v[112:115]
    ds_read_b64_tr_b16 a[66:67], v48 offset:2048
    v_add_f32 v52, v52, v58
    v_mfma_f32_16x16x32_bf16 v[116:119], a[88:91], a[28:31], v[116:119]
    ds_read_b64_tr_b16 a[68:69], v49 offset:0
    ds_read_b64_tr_b16 a[70:71], v49 offset:2048
    v_mfma_f32_16x16x32_bf16 v[124:127], a[92:95], a[28:31], v[124:127]
    v_exp_f32 v60, v108
    v_mfma_f32_16x16x32_bf16 v[120:123], a[92:95], a[24:27], v[120:123]
    s_waitcnt lgkmcnt(10)
    ds_read_b64_tr_b16 a[72:73], v48 offset:64
    v_add_f32 v52, v52, v59
    v_mfma_f32_16x16x32_bf16 v[112:115], a[96:99], a[32:35], v[112:115]
    ds_read_b64_tr_b16 a[74:75], v48 offset:2112
    v_cvt_pk_bf16_f32 v67, v58, v59
    v_mfma_f32_16x16x32_bf16 v[116:119], a[96:99], a[36:39], v[116:119]
    buffer_load_dwordx4 v39, s[20:23], s33 offen offset:3072 nt lds
    v_mfma_f32_16x16x32_bf16 v[124:127], a[100:103], a[36:39], v[124:127]
    s_add_u32 s33, s33, 16384
    v_exp_f32 v61, v109
    v_mfma_f32_16x16x32_bf16 v[120:123], a[100:103], a[32:35], v[120:123]
    s_waitcnt lgkmcnt(10)
    ds_read_b64_tr_b16 a[76:77], v49 offset:64
    v_add_f32 v53, v53, v60
    v_mfma_f32_16x16x32_bf16 v[112:115], a[104:107], a[40:43], v[112:115]
    ds_read_b64_tr_b16 a[78:79], v49 offset:2112
    ds_read_b64_tr_b16 a[80:81], v48 offset:128
    v_mfma_f32_16x16x32_bf16 v[116:119], a[104:107], a[44:47], v[116:119]
    v_exp_f32 v62, v110
    v_mfma_f32_16x16x32_bf16 v[124:127], a[108:111], a[44:47], v[124:127]
    ds_read_b64_tr_b16 a[82:83], v48 offset:2176
    v_add_f32 v53, v53, v61
    v_mfma_f32_16x16x32_bf16 v[120:123], a[108:111], a[40:43], v[120:123]
    s_waitcnt lgkmcnt(12)
    ds_read_b64_tr_b16 a[84:85], v49 offset:128
    v_cvt_pk_bf16_f32 v70, v60, v61
    v_mfma_f32_16x16x32_bf16 v[112:115], a[112:115], a[48:51], v[112:115]
    v_exp_f32 v63, v111
    v_mfma_f32_16x16x32_bf16 v[116:119], a[112:115], a[52:55], v[116:119]
    v_mfma_f32_16x16x32_bf16 v[124:127], a[116:119], a[52:55], v[124:127]
    ds_read_b64_tr_b16 a[86:87], v49 offset:2176
    v_add_f32 v53, v53, v62
    v_mfma_f32_16x16x32_bf16 v[120:123], a[116:119], a[48:51], v[120:123]
    s_waitcnt lgkmcnt(12)
    ds_read_b64_tr_b16 a[88:89], v48 offset:192
    v_add_f32 v53, v53, v63
    v_mfma_f32_16x16x32_bf16 v[112:115], a[120:123], a[56:59], v[112:115]
    ds_read_b64_tr_b16 a[90:91], v48 offset:2240
    v_add_f32 v30, v52, v53
    v_mfma_f32_16x16x32_bf16 v[116:119], a[120:123], a[60:63], v[116:119]
    ds_read_b64_tr_b16 a[92:93], v49 offset:192
    v_cmp_lt_f32 vcc, s37, v30
    v_mfma_f32_16x16x32_bf16 v[124:127], a[124:127], a[60:63], v[124:127]
    s_waitcnt lgkmcnt(11)
    ds_read_b64_tr_b16 a[94:95], v49 offset:2240
    v_cvt_pk_bf16_f32 v71, v62, v63
    v_mfma_f32_16x16x32_bf16 v[120:123], a[124:127], a[56:59], v[120:123]
    s_cbranch_vccnz L_fb9
L_ret9:
    v_mfma_f32_16x16x32_bf16 v[128:131], a[64:67], v[64:67], v[128:131]
    ds_read_b64_tr_b16 a[96:97], v48 offset:256
    v_add_f32 v50, v50, v52
    v_mfma_f32_16x16x32_bf16 v[132:135], a[64:67], v[68:71], v[132:135]
    v_mfma_f32_16x16x32_bf16 v[136:139], a[68:71], v[64:67], v[136:139]
    ds_read_b64_tr_b16 a[98:99], v48 offset:2304
    v_add_f32 v51, v51, v53
    v_mfma_f32_16x16x32_bf16 v[140:143], a[68:71], v[68:71], v[140:143]
    s_waitcnt lgkmcnt(10)
    ds_read_b64_tr_b16 a[100:101], v49 offset:256
    ds_read_b64_tr_b16 a[102:103], v49 offset:2304
    v_mfma_f32_16x16x32_bf16 v[144:147], a[72:75], v[64:67], v[144:147]
    v_exp_f32 v56, v112
    v_mfma_f32_16x16x32_bf16 v[148:151], a[72:75], v[68:71], v[148:151]
    ds_read_b64_tr_b16 a[104:105], v48 offset:320
    v_mfma_f32_16x16x32_bf16 v[152:155], a[76:79], v[64:67], v[152:155]
    ds_read_b64_tr_b16 a[106:107], v48 offset:2368
    v_mfma_f32_16x16x32_bf16 v[156:159], a[76:79], v[68:71], v[156:159]
    s_waitcnt lgkmcnt(10)
    ds_read_b64_tr_b16 a[108:109], v49 offset:320
    ds_read_b64_tr_b16 a[110:111], v49 offset:2368
    v_mfma_f32_16x16x32_bf16 v[160:163], a[80:83], v[64:67], v[160:163]
    v_exp_f32 v57, v113
    v_mfma_f32_16x16x32_bf16 v[164:167], a[80:83], v[68:71], v[164:167]
    v_mfma_f32_16x16x32_bf16 v[168:171], a[84:87], v[64:67], v[168:171]
    ds_read_b64_tr_b16 a[112:113], v48 offset:384
    v_add_f32 v52, v56, v57
    v_mfma_f32_16x16x32_bf16 v[172:175], a[84:87], v[68:71], v[172:175]
    s_waitcnt lgkmcnt(9)
    v_exp_f32 v58, v114
    v_mfma_f32_16x16x32_bf16 v[176:179], a[88:91], v[64:67], v[176:179]
    ds_read_b64_tr_b16 a[114:115], v48 offset:2432
    v_cvt_pk_bf16_f32 v72, v56, v57
    v_mfma_f32_16x16x32_bf16 v[180:183], a[88:91], v[68:71], v[180:183]
    ds_read_b64_tr_b16 a[116:117], v49 offset:384
    v_add_f32 v52, v52, v58
    v_mfma_f32_16x16x32_bf16 v[184:187], a[92:95], v[64:67], v[184:187]
    ds_read_b64_tr_b16 a[118:119], v49 offset:2432
    ds_read_b64_tr_b16 a[120:121], v48 offset:448
    v_mfma_f32_16x16x32_bf16 v[188:191], a[92:95], v[68:71], v[188:191]
    s_waitcnt lgkmcnt(9)
    v_exp_f32 v59, v115
    v_mfma_f32_16x16x32_bf16 v[192:195], a[96:99], v[64:67], v[192:195]
    ds_read_b64_tr_b16 a[122:123], v48 offset:2496
    ds_read_b64_tr_b16 a[124:125], v49 offset:448
    v_mfma_f32_16x16x32_bf16 v[196:199], a[96:99], v[68:71], v[196:199]
    v_mfma_f32_16x16x32_bf16 v[200:203], a[100:103], v[64:67], v[200:203]
    v_exp_f32 v60, v116
    v_mfma_f32_16x16x32_bf16 v[204:207], a[100:103], v[68:71], v[204:207]
    s_waitcnt lgkmcnt(7)
    ds_read_b64_tr_b16 a[126:127], v49 offset:2496
    v_add_f32 v52, v52, v59
    v_mfma_f32_16x16x32_bf16 v[208:211], a[104:107], v[64:67], v[208:211]
    s_waitcnt vmcnt(8)
    s_barrier
    v_mfma_f32_16x16x32_bf16 v[212:215], a[104:107], v[68:71], v[212:215]
    ds_read_b128 a[64:67], v40 offset:33280
    v_cvt_pk_bf16_f32 v73, v58, v59
    v_mfma_f32_16x16x32_bf16 v[216:219], a[108:111], v[64:67], v[216:219]
    v_exp_f32 v61, v117
    v_mfma_f32_16x16x32_bf16 v[220:223], a[108:111], v[68:71], v[220:223]
    s_waitcnt lgkmcnt(5)
    ds_read_b128 a[68:71], v40 offset:41472
    v_add_f32 v53, v60, v61
    v_mfma_f32_16x16x32_bf16 v[224:227], a[112:115], v[64:67], v[224:227]
    s_add_u32 m0, s35, 49920
    ds_read_b128 a[72:75], v41 offset:33280
    ds_read_b128 a[76:79], v41 offset:41472
    v_mfma_f32_16x16x32_bf16 v[228:231], a[112:115], v[68:71], v[228:231]
    buffer_load_dwordx4 v36, s[20:23], s33 offen offset:0 nt lds
    v_mfma_f32_16x16x32_bf16 v[232:235], a[116:119], v[64:67], v[232:235]
    v_exp_f32 v62, v118
    v_mfma_f32_16x16x32_bf16 v[236:239], a[116:119], v[68:71], v[236:239]
    s_waitcnt lgkmcnt(4)
    ds_read_b128 a[80:83], v42 offset:33280
    v_cvt_pk_bf16_f32 v76, v60, v61
    v_mfma_f32_16x16x32_bf16 v[240:243], a[120:123], v[64:67], v[240:243]
    ds_read_b128 a[84:87], v42 offset:41472
    v_add_f32 v53, v53, v62
    v_mfma_f32_16x16x32_bf16 v[244:247], a[120:123], v[68:71], v[244:247]
    v_exp_f32 v63, v119
    v_mfma_f32_16x16x32_bf16 v[248:251], a[124:127], v[64:67], v[248:251]
    ds_read_b128 a[88:91], v43 offset:33280
    v_add_f32 v53, v53, v63
    v_mfma_f32_16x16x32_bf16 v[252:255], a[124:127], v[68:71], v[252:255]
    s_waitcnt lgkmcnt(5)
    ds_read_b128 a[92:95], v43 offset:41472
    ds_read_b128 a[96:99], v40 offset:33536
    v_mfma_f32_16x16x32_bf16 v[96:99], a[64:67], a[0:3], v[80:83]
    v_exp_f32 v56, v120
    v_mfma_f32_16x16x32_bf16 v[100:103], a[64:67], a[4:7], v[84:87]
    buffer_load_dwordx4 v37, s[20:23], s33 offen offset:1024 nt lds
    v_mfma_f32_16x16x32_bf16 v[108:111], a[68:71], a[4:7], v[84:87]
    ds_read_b128 a[100:103], v40 offset:41728
    v_cvt_pk_bf16_f32 v77, v62, v63
    v_mfma_f32_16x16x32_bf16 v[104:107], a[68:71], a[0:3], v[80:83]
    s_waitcnt lgkmcnt(6)
    ds_read_b128 a[104:107], v41 offset:33536
    ds_read_b128 a[108:111], v41 offset:41728
    v_mfma_f32_16x16x32_bf16 v[96:99], a[72:75], a[8:11], v[96:99]
    v_exp_f32 v57, v121
    v_mfma_f32_16x16x32_bf16 v[100:103], a[72:75], a[12:15], v[100:103]
    ds_read_b128 a[112:115], v42 offset:33536
    v_add_f32 v52, v52, v56
    v_mfma_f32_16x16x32_bf16 v[108:111], a[76:79], a[12:15], v[108:111]
    ds_read_b128 a[116:119], v42 offset:41728
    v_add_f32 v52, v52, v57
    v_mfma_f32_16x16x32_bf16 v[104:107], a[76:79], a[8:11], v[104:107]
    s_waitcnt lgkmcnt(8)
    v_exp_f32 v58, v122
    v_mfma_f32_16x16x32_bf16 v[96:99], a[80:83], a[16:19], v[96:99]
    ds_read_b128 a[120:123], v43 offset:33536
    v_cvt_pk_bf16_f32 v74, v56, v57
    v_mfma_f32_16x16x32_bf16 v[100:103], a[80:83], a[20:23], v[100:103]
    buffer_load_dwordx4 v38, s[20:23], s33 offen offset:2048 nt lds
    v_mfma_f32_16x16x32_bf16 v[108:111], a[84:87], a[20:23], v[108:111]
    ds_read_b128 a[124:127], v43 offset:41728
    ds_read_b64_tr_b16 a[64:65], v48 offset:16640
    v_mfma_f32_16x16x32_bf16 v[104:107], a[84:87], a[16:19], v[104:107]
    s_waitcnt lgkmcnt(9)
    v_exp_f32 v59, v123
    v_mfma_f32_16x16x32_bf16 v[96:99], a[88:91], a[24:27], v[96:99]
    ds_read_b64_tr_b16 a[66:67], v48 offset:18688
    v_add_f32 v52, v52, v58
    v_mfma_f32_16x16x32_bf16 v[100:103], a[88:91], a[28:31], v[100:103]
    ds_read_b64_tr_b16 a[68:69], v49 offset:16640
    ds_read_b64_tr_b16 a[70:71], v49 offset:18688
    v_mfma_f32_16x16x32_bf16 v[108:111], a[92:95], a[28:31], v[108:111]
    v_exp_f32 v60, v124
    v_mfma_f32_16x16x32_bf16 v[104:107], a[92:95], a[24:27], v[104:107]
    s_waitcnt lgkmcnt(10)
    ds_read_b64_tr_b16 a[72:73], v48 offset:16704
    v_add_f32 v52, v52, v59
    v_mfma_f32_16x16x32_bf16 v[96:99], a[96:99], a[32:35], v[96:99]
    ds_read_b64_tr_b16 a[74:75], v48 offset:18752
    v_cvt_pk_bf16_f32 v75, v58, v59
    v_mfma_f32_16x16x32_bf16 v[100:103], a[96:99], a[36:39], v[100:103]
    buffer_load_dwordx4 v39, s[20:23], s33 offen offset:3072 nt lds
    v_mfma_f32_16x16x32_bf16 v[108:111], a[100:103], a[36:39], v[108:111]
    s_add_u32 s33, s33, 16384
    v_exp_f32 v61, v125
    v_mfma_f32_16x16x32_bf16 v[104:107], a[100:103], a[32:35], v[104:107]
    s_waitcnt lgkmcnt(10)
    ds_read_b64_tr_b16 a[76:77], v49 offset:16704
    v_add_f32 v53, v53, v60
    v_mfma_f32_16x16x32_bf16 v[96:99], a[104:107], a[40:43], v[96:99]
    ds_read_b64_tr_b16 a[78:79], v49 offset:18752
    ds_read_b64_tr_b16 a[80:81], v48 offset:16768
    v_mfma_f32_16x16x32_bf16 v[100:103], a[104:107], a[44:47], v[100:103]
    v_exp_f32 v62, v126
    v_mfma_f32_16x16x32_bf16 v[108:111], a[108:111], a[44:47], v[108:111]
    s_waitcnt lgkmcnt(11)
    ds_read_b64_tr_b16 a[82:83], v48 offset:18816
    v_add_f32 v53, v53, v61
    v_mfma_f32_16x16x32_bf16 v[104:107], a[108:111], a[40:43], v[104:107]
    s_add_u32 s38, s39, 0
    ds_read_b64_tr_b16 a[84:85], v49 offset:16768
    v_cvt_pk_bf16_f32 v78, v60, v61
    v_mfma_f32_16x16x32_bf16 v[96:99], a[112:115], a[48:51], v[96:99]
    s_add_u32 m0, s59, 66560
    v_exp_f32 v63, v127
    v_mfma_f32_16x16x32_bf16 v[100:103], a[112:115], a[52:55], v[100:103]
    buffer_load_dwordx4 v44, s[44:47], s38 offen offset:0 lds
    v_mfma_f32_16x16x32_bf16 v[108:111], a[116:119], a[52:55], v[108:111]
    ds_read_b64_tr_b16 a[86:87], v49 offset:18816
    v_add_f32 v53, v53, v62
    v_mfma_f32_16x16x32_bf16 v[104:107], a[116:119], a[48:51], v[104:107]
    s_waitcnt lgkmcnt(12)
    ds_read_b64_tr_b16 a[88:89], v48 offset:16832
    v_add_f32 v53, v53, v63
    v_mfma_f32_16x16x32_bf16 v[96:99], a[120:123], a[56:59], v[96:99]
    ds_read_b64_tr_b16 a[90:91], v48 offset:18880
    v_add_f32 v30, v52, v53
    v_mfma_f32_16x16x32_bf16 v[100:103], a[120:123], a[60:63], v[100:103]
    ds_read_b64_tr_b16 a[92:93], v49 offset:16832
    v_cmp_lt_f32 vcc, s37, v30
    v_mfma_f32_16x16x32_bf16 v[108:111], a[124:127], a[60:63], v[108:111]
    s_waitcnt lgkmcnt(11)
    ds_read_b64_tr_b16 a[94:95], v49 offset:18880
    v_cvt_pk_bf16_f32 v79, v62, v63
    v_mfma_f32_16x16x32_bf16 v[104:107], a[124:127], a[56:59], v[104:107]
    s_cbranch_vccnz L_fb10
L_ret10:
    ds_write_b32 v6, v10
    v_mfma_f32_16x16x32_bf16 v[128:131], a[64:67], v[72:75], v[128:131]
    ds_read_b64_tr_b16 a[96:97], v48 offset:16896
    v_add_f32 v50, v50, v52
    v_mfma_f32_16x16x32_bf16 v[132:135], a[64:67], v[76:79], v[132:135]
    buffer_load_dwordx4 v45, s[44:47], s38 offen offset:1024 lds
    v_mfma_f32_16x16x32_bf16 v[136:139], a[68:71], v[72:75], v[136:139]
    ds_read_b64_tr_b16 a[98:99], v48 offset:18944
    v_add_f32 v51, v51, v53
    v_mfma_f32_16x16x32_bf16 v[140:143], a[68:71], v[76:79], v[140:143]
    s_waitcnt lgkmcnt(11)
    ds_read_b64_tr_b16 a[100:101], v49 offset:16896
    ds_read_b64_tr_b16 a[102:103], v49 offset:18944
    v_mfma_f32_16x16x32_bf16 v[144:147], a[72:75], v[72:75], v[144:147]
    v_exp_f32 v56, v96
    v_mfma_f32_16x16x32_bf16 v[148:151], a[72:75], v[76:79], v[148:151]
    ds_read_b64_tr_b16 a[104:105], v48 offset:16960
    v_mfma_f32_16x16x32_bf16 v[152:155], a[76:79], v[72:75], v[152:155]
    ds_read_b64_tr_b16 a[106:107], v48 offset:19008
    v_mfma_f32_16x16x32_bf16 v[156:159], a[76:79], v[76:79], v[156:159]
    s_waitcnt lgkmcnt(11)
    ds_read_b64_tr_b16 a[108:109], v49 offset:16960
    ds_read_b64_tr_b16 a[110:111], v49 offset:19008
    v_mfma_f32_16x16x32_bf16 v[160:163], a[80:83], v[72:75], v[160:163]
    v_exp_f32 v57, v97
    v_mfma_f32_16x16x32_bf16 v[164:167], a[80:83], v[76:79], v[164:167]
    buffer_load_dwordx4 v46, s[44:47], s38 offen offset:2048 lds
    v_mfma_f32_16x16x32_bf16 v[168:171], a[84:87], v[72:75], v[168:171]
    ds_read_b64_tr_b16 a[112:113], v48 offset:17024
    v_add_f32 v52, v56, v57
    v_mfma_f32_16x16x32_bf16 v[172:175], a[84:87], v[76:79], v[172:175]
    s_waitcnt lgkmcnt(10)
    v_exp_f32 v58, v98
    v_mfma_f32_16x16x32_bf16 v[176:179], a[88:91], v[72:75], v[176:179]
    ds_read_b64_tr_b16 a[114:115], v48 offset:19072
    v_cvt_pk_bf16_f32 v64, v56, v57
    v_mfma_f32_16x16x32_bf16 v[180:183], a[88:91], v[76:79], v[180:183]
    ds_read_b64_tr_b16 a[116:117], v49 offset:17024
    v_add_f32 v52, v52, v58
    v_mfma_f32_16x16x32_bf16 v[184:187], a[92:95], v[72:75], v[184:187]
    ds_read_b64_tr_b16 a[118:119], v49 offset:19072
    ds_read_b64_tr_b16 a[120:121], v48 offset:17088
    v_mfma_f32_16x16x32_bf16 v[188:191], a[92:95], v[76:79], v[188:191]
    s_waitcnt lgkmcnt(9)
    v_exp_f32 v59, v99
    v_mfma_f32_16x16x32_bf16 v[192:195], a[96:99], v[72:75], v[192:195]
    ds_read_b64_tr_b16 a[122:123], v48 offset:19136
    ds_read_b64_tr_b16 a[124:125], v49 offset:17088
    v_mfma_f32_16x16x32_bf16 v[196:199], a[96:99], v[76:79], v[196:199]
    buffer_load_dwordx4 v47, s[44:47], s38 offen offset:3072 lds
    v_mfma_f32_16x16x32_bf16 v[200:203], a[100:103], v[72:75], v[200:203]
    v_exp_f32 v60, v100
    v_mfma_f32_16x16x32_bf16 v[204:207], a[100:103], v[76:79], v[204:207]
    s_waitcnt lgkmcnt(7)
    ds_read_b64_tr_b16 a[126:127], v49 offset:19136
    v_add_f32 v52, v52, v59
    v_mfma_f32_16x16x32_bf16 v[208:211], a[104:107], v[72:75], v[208:211]
    s_waitcnt vmcnt(8)
    s_barrier
    v_mfma_f32_16x16x32_bf16 v[212:215], a[104:107], v[76:79], v[212:215]
    ds_read_b128 a[64:67], v40 offset:49920
    v_cvt_pk_bf16_f32 v65, v58, v59
    v_mfma_f32_16x16x32_bf16 v[216:219], a[108:111], v[72:75], v[216:219]
    s_waitcnt lgkmcnt(5)
    v_exp_f32 v61, v101
    v_mfma_f32_16x16x32_bf16 v[220:223], a[108:111], v[76:79], v[220:223]
    s_add_u32 s38, s39, 4096
    ds_read_b128 a[68:71], v40 offset:58112
    v_add_f32 v53, v60, v61
    v_mfma_f32_16x16x32_bf16 v[224:227], a[112:115], v[72:75], v[224:227]
    s_add_u32 m0, s59, 70656
    ds_read_b128 a[72:75], v41 offset:49920
    ds_read_b128 a[76:79], v41 offset:58112
    v_mfma_f32_16x16x32_bf16 v[228:231], a[112:115], v[76:79], v[228:231]
    buffer_load_dwordx4 v28, s[44:47], s38 offen offset:0 lds
    v_mfma_f32_16x16x32_bf16 v[232:235], a[116:119], v[72:75], v[232:235]
    v_exp_f32 v62, v102
    v_mfma_f32_16x16x32_bf16 v[236:239], a[116:119], v[76:79], v[236:239]
    s_waitcnt lgkmcnt(4)
    ds_read_b128 a[80:83], v42 offset:49920
    v_cvt_pk_bf16_f32 v68, v60, v61
    v_mfma_f32_16x16x32_bf16 v[240:243], a[120:123], v[72:75], v[240:243]
    ds_read_b128 a[84:87], v42 offset:58112
    v_add_f32 v53, v53, v62
    v_mfma_f32_16x16x32_bf16 v[244:247], a[120:123], v[76:79], v[244:247]
    v_exp_f32 v63, v103
    v_mfma_f32_16x16x32_bf16 v[248:251], a[124:127], v[72:75], v[248:251]
    ds_read_b128 a[88:91], v43 offset:49920
    v_add_f32 v53, v53, v63
    v_mfma_f32_16x16x32_bf16 v[252:255], a[124:127], v[76:79], v[252:255]
    s_waitcnt lgkmcnt(5)
    ds_read_b128 a[92:95], v43 offset:58112
    ds_read_b128 a[96:99], v40 offset:50176
    v_mfma_f32_16x16x32_bf16 v[112:115], a[64:67], a[0:3], v[80:83]
    v_exp_f32 v56, v104
    v_mfma_f32_16x16x32_bf16 v[116:119], a[64:67], a[4:7], v[84:87]
    buffer_load_dwordx4 v29, s[44:47], s38 offen offset:1024 lds
    v_mfma_f32_16x16x32_bf16 v[124:127], a[68:71], a[4:7], v[84:87]
    ds_read_b128 a[100:103], v40 offset:58368
    v_cvt_pk_bf16_f32 v69, v62, v63
    v_mfma_f32_16x16x32_bf16 v[120:123], a[68:71], a[0:3], v[80:83]
    s_waitcnt lgkmcnt(6)
    ds_read_b128 a[104:107], v41 offset:50176
    ds_read_b128 a[108:111], v41 offset:58368
    v_mfma_f32_16x16x32_bf16 v[112:115], a[72:75], a[8:11], v[112:115]
    v_exp_f32 v57, v105
    v_mfma_f32_16x16x32_bf16 v[116:119], a[72:75], a[12:15], v[116:119]
    ds_read_b128 a[112:115], v42 offset:50176
    v_add_f32 v52, v52, v56
    v_mfma_f32_16x16x32_bf16 v[124:127], a[76:79], a[12:15], v[124:127]
    ds_read_b128 a[116:119], v42 offset:58368
    v_add_f32 v52, v52, v57
    v_mfma_f32_16x16x32_bf16 v[120:123], a[76:79], a[8:11], v[120:123]
    s_waitcnt lgkmcnt(8)
    v_exp_f32 v58, v106
    v_mfma_f32_16x16x32_bf16 v[112:115], a[80:83], a[16:19], v[112:115]
    ds_read_b128 a[120:123], v43 offset:50176
    v_cvt_pk_bf16_f32 v66, v56, v57
    v_mfma_f32_16x16x32_bf16 v[116:119], a[80:83], a[20:23], v[116:119]
    buffer_load_dwordx4 v95, s[44:47], s38 offen offset:2048 lds
    v_mfma_f32_16x16x32_bf16 v[124:127], a[84:87], a[20:23], v[124:127]
    ds_read_b128 a[124:127], v43 offset:58368
    ds_read_b64_tr_b16 a[64:65], v48 offset:33280
    v_mfma_f32_16x16x32_bf16 v[120:123], a[84:87], a[16:19], v[120:123]
    s_waitcnt lgkmcnt(9)
    v_exp_f32 v59, v107
    v_mfma_f32_16x16x32_bf16 v[112:115], a[88:91], a[24:27], v[112:115]
    ds_read_b64_tr_b16 a[66:67], v48 offset:35328
    v_add_f32 v52, v52, v58
    v_mfma_f32_16x16x32_bf16 v[116:119], a[88:91], a[28:31], v[116:119]
    ds_read_b64_tr_b16 a[68:69], v49 offset:33280
    ds_read_b64_tr_b16 a[70:71], v49 offset:35328
    v_mfma_f32_16x16x32_bf16 v[124:127], a[92:95], a[28:31], v[124:127]
    v_exp_f32 v60, v108
    v_mfma_f32_16x16x32_bf16 v[120:123], a[92:95], a[24:27], v[120:123]
    s_waitcnt lgkmcnt(10)
    ds_read_b64_tr_b16 a[72:73], v48 offset:33344
    v_add_f32 v52, v52, v59
    v_mfma_f32_16x16x32_bf16 v[112:115], a[96:99], a[32:35], v[112:115]
    ds_read_b64_tr_b16 a[74:75], v48 offset:35392
    v_cvt_pk_bf16_f32 v67, v58, v59
    v_mfma_f32_16x16x32_bf16 v[116:119], a[96:99], a[36:39], v[116:119]
    v_mfma_f32_16x16x32_bf16 v[124:127], a[100:103], a[36:39], v[124:127]
    v_exp_f32 v61, v109
    v_mfma_f32_16x16x32_bf16 v[120:123], a[100:103], a[32:35], v[120:123]
    s_waitcnt lgkmcnt(10)
    ds_read_b64_tr_b16 a[76:77], v49 offset:33344
    v_add_f32 v53, v53, v60
    v_mfma_f32_16x16x32_bf16 v[112:115], a[104:107], a[40:43], v[112:115]
    ds_read_b64_tr_b16 a[78:79], v49 offset:35392
    ds_read_b64_tr_b16 a[80:81], v48 offset:33408
    v_mfma_f32_16x16x32_bf16 v[116:119], a[104:107], a[44:47], v[116:119]
    v_exp_f32 v62, v110
    v_mfma_f32_16x16x32_bf16 v[124:127], a[108:111], a[44:47], v[124:127]
    ds_read_b64_tr_b16 a[82:83], v48 offset:35456
    v_add_f32 v53, v53, v61
    v_mfma_f32_16x16x32_bf16 v[120:123], a[108:111], a[40:43], v[120:123]
    s_waitcnt lgkmcnt(12)
    ds_read_b64_tr_b16 a[84:85], v49 offset:33408
    v_cvt_pk_bf16_f32 v70, v60, v61
    v_mfma_f32_16x16x32_bf16 v[112:115], a[112:115], a[48:51], v[112:115]
    v_exp_f32 v63, v111
    v_mfma_f32_16x16x32_bf16 v[116:119], a[112:115], a[52:55], v[116:119]
    v_mfma_f32_16x16x32_bf16 v[124:127], a[116:119], a[52:55], v[124:127]
    ds_read_b64_tr_b16 a[86:87], v49 offset:35456
    v_add_f32 v53, v53, v62
    v_mfma_f32_16x16x32_bf16 v[120:123], a[116:119], a[48:51], v[120:123]
    s_waitcnt lgkmcnt(12)
    ds_read_b64_tr_b16 a[88:89], v48 offset:33472
    v_add_f32 v53, v53, v63
    v_mfma_f32_16x16x32_bf16 v[112:115], a[120:123], a[56:59], v[112:115]
    ds_read_b64_tr_b16 a[90:91], v48 offset:35520
    v_add_f32 v30, v52, v53
    v_mfma_f32_16x16x32_bf16 v[116:119], a[120:123], a[60:63], v[116:119]
    ds_read_b64_tr_b16 a[92:93], v49 offset:33472
    v_cmp_lt_f32 vcc, s37, v30
    v_mfma_f32_16x16x32_bf16 v[124:127], a[124:127], a[60:63], v[124:127]
    s_waitcnt lgkmcnt(11)
    ds_read_b64_tr_b16 a[94:95], v49 offset:35520
    v_cvt_pk_bf16_f32 v71, v62, v63
    v_mfma_f32_16x16x32_bf16 v[120:123], a[124:127], a[56:59], v[120:123]
    s_cbranch_vccnz L_fb11
L_ret11:
    ds_read_b32 v10, v7
    v_mfma_f32_16x16x32_bf16 v[128:131], a[64:67], v[64:67], v[128:131]
    ds_read_b64_tr_b16 a[96:97], v48 offset:33536
    v_add_f32 v50, v50, v52
    v_mfma_f32_16x16x32_bf16 v[132:135], a[64:67], v[68:71], v[132:135]
    v_mfma_f32_16x16x32_bf16 v[136:139], a[68:71], v[64:67], v[136:139]
    ds_read_b64_tr_b16 a[98:99], v48 offset:35584
    v_add_f32 v51, v51, v53
    v_mfma_f32_16x16x32_bf16 v[140:143], a[68:71], v[68:71], v[140:143]
    s_waitcnt lgkmcnt(11)
    ds_read_b64_tr_b16 a[100:101], v49 offset:33536
    ds_read_b64_tr_b16 a[102:103], v49 offset:35584
    v_mfma_f32_16x16x32_bf16 v[144:147], a[72:75], v[64:67], v[144:147]
    v_exp_f32 v56, v112
    v_mfma_f32_16x16x32_bf16 v[148:151], a[72:75], v[68:71], v[148:151]
    ds_read_b64_tr_b16 a[104:105], v48 offset:33600
    v_mfma_f32_16x16x32_bf16 v[152:155], a[76:79], v[64:67], v[152:155]
    ds_read_b64_tr_b16 a[106:107], v48 offset:35648
    v_mfma_f32_16x16x32_bf16 v[156:159], a[76:79], v[68:71], v[156:159]
    s_waitcnt lgkmcnt(11)
    ds_read_b64_tr_b16 a[108:109], v49 offset:33600
    ds_read_b64_tr_b16 a[110:111], v49 offset:35648
    v_mfma_f32_16x16x32_bf16 v[160:163], a[80:83], v[64:67], v[160:163]
    v_exp_f32 v57, v113
    v_mfma_f32_16x16x32_bf16 v[164:167], a[80:83], v[68:71], v[164:167]
    v_mfma_f32_16x16x32_bf16 v[168:171], a[84:87], v[64:67], v[168:171]
    ds_read_b64_tr_b16 a[112:113], v48 offset:33664
    v_add_f32 v52, v56, v57
    v_mfma_f32_16x16x32_bf16 v[172:175], a[84:87], v[68:71], v[172:175]
    s_waitcnt lgkmcnt(10)
    v_exp_f32 v58, v114
    v_mfma_f32_16x16x32_bf16 v[176:179], a[88:91], v[64:67], v[176:179]
    ds_read_b64_tr_b16 a[114:115], v48 offset:35712
    v_cvt_pk_bf16_f32 v72, v56, v57
    v_mfma_f32_16x16x32_bf16 v[180:183], a[88:91], v[68:71], v[180:183]
    ds_read_b64_tr_b16 a[116:117], v49 offset:33664
    v_add_f32 v52, v52, v58
    v_mfma_f32_16x16x32_bf16 v[184:187], a[92:95], v[64:67], v[184:187]
    ds_read_b64_tr_b16 a[118:119], v49 offset:35712
    ds_read_b64_tr_b16 a[120:121], v48 offset:33728
    v_mfma_f32_16x16x32_bf16 v[188:191], a[92:95], v[68:71], v[188:191]
    s_waitcnt lgkmcnt(9)
    v_exp_f32 v59, v115
    v_mfma_f32_16x16x32_bf16 v[192:195], a[96:99], v[64:67], v[192:195]
    ds_read_b64_tr_b16 a[122:123], v48 offset:35776
    ds_read_b64_tr_b16 a[124:125], v49 offset:33728
    v_mfma_f32_16x16x32_bf16 v[196:199], a[96:99], v[68:71], v[196:199]
    v_mfma_f32_16x16x32_bf16 v[200:203], a[100:103], v[64:67], v[200:203]
    v_exp_f32 v60, v116
    v_mfma_f32_16x16x32_bf16 v[204:207], a[100:103], v[68:71], v[204:207]
    s_waitcnt lgkmcnt(7)
    ds_read_b64_tr_b16 a[126:127], v49 offset:35776
    v_add_f32 v52, v52, v59
    v_mfma_f32_16x16x32_bf16 v[208:211], a[104:107], v[64:67], v[208:211]
    s_waitcnt vmcnt(7)
    s_barrier
    v_mfma_f32_16x16x32_bf16 v[212:215], a[104:107], v[68:71], v[212:215]
    v_cvt_pk_bf16_f32 v73, v58, v59
    v_mfma_f32_16x16x32_bf16 v[216:219], a[108:111], v[64:67], v[216:219]
    s_waitcnt lgkmcnt(4)
    v_exp_f32 v61, v117
    v_mfma_f32_16x16x32_bf16 v[220:223], a[108:111], v[68:71], v[220:223]
    s_add_u32 s38, s39, 28672
    v_add_f32 v53, v60, v61
    v_mfma_f32_16x16x32_bf16 v[224:227], a[112:115], v[64:67], v[224:227]
    s_add_u32 m0, s59, 99840
    v_mfma_f32_16x16x32_bf16 v[228:231], a[112:115], v[68:71], v[228:231]
    buffer_load_dwordx4 v44, s[44:47], s38 offen offset:0 lds
    v_mfma_f32_16x16x32_bf16 v[232:235], a[116:119], v[64:67], v[232:235]
    v_exp_f32 v62, v118
    v_mfma_f32_16x16x32_bf16 v[236:239], a[116:119], v[68:71], v[236:239]
    s_waitcnt lgkmcnt(0)
    v_cvt_pk_bf16_f32 v76, v60, v61
    v_mfma_f32_16x16x32_bf16 v[240:243], a[120:123], v[64:67], v[240:243]
    v_add_f32 v53, v53, v62
    v_mfma_f32_16x16x32_bf16 v[244:247], a[120:123], v[68:71], v[244:247]
    v_exp_f32 v63, v119
    v_mfma_f32_16x16x32_bf16 v[248:251], a[124:127], v[64:67], v[248:251]
    v_add_f32 v53, v53, v63
    v_mfma_f32_16x16x32_bf16 v[252:255], a[124:127], v[68:71], v[252:255]
    v_readfirstlane_b32 s58, v10
    s_nop 0
    s_cmp_ge_u32 s58, 2
    s_cselect_b32 s58, 64, s58
    s_lshl_b32 s14, s30, 1
    s_add_u32 s58, s58, s14
    s_lshl_b32 s14, s58, 6
    s_add_u32 s14, s14, 1792
    s_cmp_ge_u32 s58, 56
    s_cselect_b32 s14, 0x40000000, s14
    v_exp_f32 v56, v120
    v_add_u32 v103, 0, v1
    v_mul_u32_u24 v104, s31, v103
    v_lshrrev_b32 v104, 16, v104
    buffer_load_dwordx4 v45, s[44:47], s38 offen offset:1024 lds
    v_cvt_pk_bf16_f32 v77, v62, v63
    v_mul_u32_u24 v105, 14, v104
    v_sub_u32 v103, v103, v105
    buffer_load_dwordx4 a[184:187], v4, s[52:55], s14 offen
    s_add_u32 s14, s14, 5376
    v_add_u32 v103, s57, v103
    v_subrev_u32 v105, 14, v103
    v_min_u32 v103, v103, v105
    v_exp_f32 v57, v121
    v_mul_u32_u24 v104, 3584, v104
    v_lshl_add_u32 v96, v103, 4, v104
    v_add_f32 v52, v52, v56
    v_add_u32 v103, 64, v1
    v_mul_u32_u24 v104, s31, v103
    v_lshrrev_b32 v104, 16, v104
    buffer_load_dwordx4 a[188:191], v4, s[52:55], s14 offen
    s_add_u32 s14, s14, 5376
    v_add_f32 v52, v52, v57
    v_mul_u32_u24 v105, 14, v104
    v_sub_u32 v103, v103, v105
    v_exp_f32 v58, v122
    v_add_u32 v103, s57, v103
    v_subrev_u32 v105, 14, v103
    v_min_u32 v103, v103, v105
    v_cvt_pk_bf16_f32 v74, v56, v57
    v_mul_u32_u24 v104, 3584, v104
    v_lshl_add_u32 v97, v103, 4, v104
    buffer_load_dwordx4 a[192:195], v4, s[52:55], s14 offen
    s_add_u32 s14, s14, 5376
    v_subrev_u32 v97, 1024, v97
    v_add_u32 v103, 128, v1
    v_mul_u32_u24 v104, s31, v103
    buffer_load_dwordx4 v46, s[44:47], s38 offen offset:2048 lds
    ds_read_b64_tr_b16 a[64:65], v48 offset:49920
    v_lshrrev_b32 v104, 16, v104
    v_mul_u32_u24 v105, 14, v104
    v_exp_f32 v59, v123
    v_sub_u32 v103, v103, v105
    v_add_u32 v103, s57, v103
    v_subrev_u32 v105, 14, v103
    buffer_load_dwordx4 a[196:199], v4, s[52:55], s14 offen
    s_add_u32 s14, s14, 5376
    ds_read_b64_tr_b16 a[66:67], v48 offset:51968
    v_add_f32 v52, v52, v58
    v_min_u32 v103, v103, v105
    v_mul_u32_u24 v104, 3584, v104
    ds_read_b64_tr_b16 a[68:69], v49 offset:49920
    ds_read_b64_tr_b16 a[70:71], v49 offset:51968
    v_lshl_add_u32 v98, v103, 4, v104
    v_subrev_u32 v98, 2048, v98
    v_add_u32 v103, 192, v1
    v_exp_f32 v60, v124
    v_mul_u32_u24 v104, s31, v103
    v_lshrrev_b32 v104, 16, v104
    buffer_load_dwordx4 a[200:203], v4, s[52:55], s14 offen
    s_add_u32 s14, s14, 5376
    ds_read_b64_tr_b16 a[72:73], v48 offset:49984
    v_add_f32 v52, v52, v59
    v_mul_u32_u24 v105, 14, v104
    v_sub_u32 v103, v103, v105
    v_add_u32 v103, s57, v103
    ds_read_b64_tr_b16 a[74:75], v48 offset:52032
    v_cvt_pk_bf16_f32 v75, v58, v59
    v_subrev_u32 v105, 14, v103
    v_min_u32 v103, v103, v105
    v_mul_u32_u24 v104, 3584, v104
    v_lshl_add_u32 v99, v103, 4, v104
    v_subrev_u32 v99, 3072, v99
    buffer_load_dwordx4 a[204:207], v4, s[52:55], s14 offen
    s_add_u32 s14, s14, 5376
    buffer_load_dwordx4 v47, s[44:47], s38 offen offset:3072 lds
    v_exp_f32 v61, v125
    v_add_u32 v103, 256, v1
    v_mul_u32_u24 v104, s31, v103
    ds_read_b64_tr_b16 a[76:77], v49 offset:49984
    v_add_f32 v53, v53, v60
    v_lshrrev_b32 v104, 16, v104
    v_mul_u32_u24 v105, 14, v104
    v_sub_u32 v103, v103, v105
    ds_read_b64_tr_b16 a[78:79], v49 offset:52032
    ds_read_b64_tr_b16 a[80:81], v48 offset:50048
    v_add_u32 v103, s57, v103
    v_subrev_u32 v105, 14, v103
    buffer_load_dwordx4 a[208:211], v4, s[52:55], s14 offen
    s_add_u32 s14, s14, 5376
    v_exp_f32 v62, v126
    v_min_u32 v103, v103, v105
    v_mul_u32_u24 v104, 3584, v104
    v_lshl_add_u32 v100, v103, 4, v104
    ds_read_b64_tr_b16 a[82:83], v48 offset:52096
    v_add_f32 v53, v53, v61
    v_add_u32 v103, 320, v1
    v_mul_u32_u24 v104, s31, v103
    s_add_u32 s38, s39, 32768
    ds_read_b64_tr_b16 a[84:85], v49 offset:50048
    v_cvt_pk_bf16_f32 v78, v60, v61
    v_lshrrev_b32 v104, 16, v104
    v_mul_u32_u24 v105, 14, v104
    v_sub_u32 v103, v103, v105
    s_add_u32 m0, s59, 103936
    v_exp_f32 v63, v127
    v_add_u32 v103, s57, v103
    v_subrev_u32 v105, 14, v103
    global_load_dwordx4 a[212:215], v5, s[12:13]
    v_min_u32 v103, v103, v105
    v_mul_u32_u24 v104, 3584, v104
    v_lshl_add_u32 v101, v103, 4, v104
    buffer_load_dwordx4 v28, s[44:47], s38 offen offset:0 lds
    ds_read_b64_tr_b16 a[86:87], v49 offset:52096
    v_add_f32 v53, v53, v62
    v_subrev_u32 v101, 1024, v101
    v_add_u32 v103, 384, v1
    ds_read_b64_tr_b16 a[88:89], v48 offset:50112
    v_add_f32 v53, v53, v63
    v_mul_u32_u24 v104, s31, v103
    v_lshrrev_b32 v104, 16, v104
    v_mul_u32_u24 v105, 14, v104
    ds_read_b64_tr_b16 a[90:91], v48 offset:52160
    v_add_f32 v30, v52, v53
    v_sub_u32 v103, v103, v105
    v_add_u32 v103, s57, v103
    ds_read_b64_tr_b16 a[92:93], v49 offset:50112
    v_cmp_lt_f32 vcc, s37, v30
    v_subrev_u32 v105, 14, v103
    v_min_u32 v103, v103, v105
    v_mul_u32_u24 v104, 3584, v104
    s_waitcnt lgkmcnt(11)
    ds_read_b64_tr_b16 a[94:95], v49 offset:52160
    v_cvt_pk_bf16_f32 v79, v62, v63
    v_lshl_add_u32 v102, v103, 4, v104
    v_subrev_u32 v102, 2048, v102
    s_cbranch_vccnz L_fb12
L_ret12:
    v_mfma_f32_16x16x32_bf16 v[128:131], a[64:67], v[72:75], v[128:131]
    ds_read_b64_tr_b16 a[96:97], v48 offset:50176
    v_add_f32 v50, v50, v52
    v_mfma_f32_16x16x32_bf16 v[132:135], a[64:67], v[76:79], v[132:135]
    buffer_load_dwordx4 v29, s[44:47], s38 offen offset:1024 lds
    v_mfma_f32_16x16x32_bf16 v[136:139], a[68:71], v[72:75], v[136:139]
    ds_read_b64_tr_b16 a[98:99], v48 offset:52224
    v_add_f32 v51, v51, v53
    v_mfma_f32_16x16x32_bf16 v[140:143], a[68:71], v[76:79], v[140:143]
    s_waitcnt lgkmcnt(10)
    ds_read_b64_tr_b16 a[100:101], v49 offset:50176
    ds_read_b64_tr_b16 a[102:103], v49 offset:52224
    v_mfma_f32_16x16x32_bf16 v[144:147], a[72:75], v[72:75], v[144:147]
    v_mfma_f32_16x16x32_bf16 v[148:151], a[72:75], v[76:79], v[148:151]
    ds_read_b64_tr_b16 a[104:105], v48 offset:50240
    v_mfma_f32_16x16x32_bf16 v[152:155], a[76:79], v[72:75], v[152:155]
    ds_read_b64_tr_b16 a[106:107], v48 offset:52288
    v_mfma_f32_16x16x32_bf16 v[156:159], a[76:79], v[76:79], v[156:159]
    s_waitcnt lgkmcnt(10)
    ds_read_b64_tr_b16 a[108:109], v49 offset:50240
    ds_read_b64_tr_b16 a[110:111], v49 offset:52288
    v_mfma_f32_16x16x32_bf16 v[160:163], a[80:83], v[72:75], v[160:163]
    v_mfma_f32_16x16x32_bf16 v[164:167], a[80:83], v[76:79], v[164:167]
    buffer_load_dwordx4 v95, s[44:47], s38 offen offset:2048 lds
    v_mfma_f32_16x16x32_bf16 v[168:171], a[84:87], v[72:75], v[168:171]
    ds_read_b64_tr_b16 a[112:113], v48 offset:50304
    v_mfma_f32_16x16x32_bf16 v[172:175], a[84:87], v[76:79], v[172:175]
    s_waitcnt lgkmcnt(9)
    v_mfma_f32_16x16x32_bf16 v[176:179], a[88:91], v[72:75], v[176:179]
    ds_read_b64_tr_b16 a[114:115], v48 offset:52352
    v_mfma_f32_16x16x32_bf16 v[180:183], a[88:91], v[76:79], v[180:183]
    ds_read_b64_tr_b16 a[116:117], v49 offset:50304
    v_mfma_f32_16x16x32_bf16 v[184:187], a[92:95], v[72:75], v[184:187]
    ds_read_b64_tr_b16 a[118:119], v49 offset:52352
    ds_read_b64_tr_b16 a[120:121], v48 offset:50368
    v_mfma_f32_16x16x32_bf16 v[188:191], a[92:95], v[76:79], v[188:191]
    s_waitcnt lgkmcnt(9)
    v_mfma_f32_16x16x32_bf16 v[192:195], a[96:99], v[72:75], v[192:195]
    ds_read_b64_tr_b16 a[122:123], v48 offset:52416
    ds_read_b64_tr_b16 a[124:125], v49 offset:50368
    v_mfma_f32_16x16x32_bf16 v[196:199], a[96:99], v[76:79], v[196:199]
    v_mfma_f32_16x16x32_bf16 v[200:203], a[100:103], v[72:75], v[200:203]
    v_mfma_f32_16x16x32_bf16 v[204:207], a[100:103], v[76:79], v[204:207]
    s_waitcnt lgkmcnt(7)
    ds_read_b64_tr_b16 a[126:127], v49 offset:52416
    v_mfma_f32_16x16x32_bf16 v[208:211], a[104:107], v[72:75], v[208:211]
    s_waitcnt vmcnt(15)
    s_barrier
    v_mfma_f32_16x16x32_bf16 v[212:215], a[104:107], v[76:79], v[212:215]
    v_mfma_f32_16x16x32_bf16 v[216:219], a[108:111], v[72:75], v[216:219]
    v_mfma_f32_16x16x32_bf16 v[220:223], a[108:111], v[76:79], v[220:223]
    s_waitcnt lgkmcnt(4)
    v_mfma_f32_16x16x32_bf16 v[224:227], a[112:115], v[72:75], v[224:227]
    v_mfma_f32_16x16x32_bf16 v[228:231], a[112:115], v[76:79], v[228:231]
    v_mfma_f32_16x16x32_bf16 v[232:235], a[116:119], v[72:75], v[232:235]
    v_mfma_f32_16x16x32_bf16 v[236:239], a[116:119], v[76:79], v[236:239]
    s_waitcnt lgkmcnt(0)
    v_mfma_f32_16x16x32_bf16 v[240:243], a[120:123], v[72:75], v[240:243]
    v_mfma_f32_16x16x32_bf16 v[244:247], a[120:123], v[76:79], v[244:247]
    v_mfma_f32_16x16x32_bf16 v[248:251], a[124:127], v[72:75], v[248:251]
    v_mfma_f32_16x16x32_bf16 v[252:255], a[124:127], v[76:79], v[252:255]
    v_mov_b32 v31, v50
    s_nop 1
    v_permlane32_swap_b32 v50, v31
    v_add_f32 v50, v50, v31
    v_mov_b32 v31, v50
    s_nop 1
    v_permlane16_swap_b32 v50, v31
    v_add_f32 v50, v50, v31
    v_rcp_f32 v2, v50
    v_mov_b32 v31, v51
    s_nop 1
    v_permlane32_swap_b32 v51, v31
    v_add_f32 v51, v51, v31
    v_mov_b32 v31, v51
    s_nop 1
    v_permlane16_swap_b32 v51, v31
    v_add_f32 v51, v51, v31
    v_rcp_f32 v3, v51
    s_mov_b32 s57, 0x40000000
    s_waitcnt vmcnt(3)
    s_waitcnt lgkmcnt(0)
    s_cmp_ge_u32 s58, 56
    s_cbranch_scc1 L_mod2rnadaLN_cond__gqa_block_cached__mixer_gmlp__prompt_kernel
    v_accvgpr_read_b32 v48, a184
    v_accvgpr_read_b32 v49, a185
    v_accvgpr_read_b32 v50, a186
    v_accvgpr_read_b32 v51, a187
    v_accvgpr_read_b32 v52, a188
    v_accvgpr_read_b32 v53, a189
    v_accvgpr_read_b32 v54, a190
    v_accvgpr_read_b32 v55, a191
    v_accvgpr_read_b32 v56, a192
    v_accvgpr_read_b32 v57, a193
    v_accvgpr_read_b32 v58, a194
    v_accvgpr_read_b32 v59, a195
    v_accvgpr_read_b32 v60, a196
    v_accvgpr_read_b32 v61, a197
    v_accvgpr_read_b32 v62, a198
    v_accvgpr_read_b32 v63, a199
    v_accvgpr_read_b32 v64, a200
    v_accvgpr_read_b32 v65, a201
    v_accvgpr_read_b32 v66, a202
    v_accvgpr_read_b32 v67, a203
    v_accvgpr_read_b32 v68, a204
    v_accvgpr_read_b32 v69, a205
    v_accvgpr_read_b32 v70, a206
    v_accvgpr_read_b32 v71, a207
    v_accvgpr_read_b32 v72, a208
    v_accvgpr_read_b32 v73, a209
    v_accvgpr_read_b32 v74, a210
    v_accvgpr_read_b32 v75, a211
    v_accvgpr_read_b32 v76, a212
    v_accvgpr_read_b32 v77, a213
    v_accvgpr_read_b32 v78, a214
    v_accvgpr_read_b32 v79, a215
    s_mov_b32 s13, 3216550459
    v_bfe_u32 v121, v0, 2, 1
    v_lshlrev_b32 v121, 4, v121
    v_alignbit_b32 v76, v77, v76, v121
    v_alignbit_b32 v77, v78, v77, v121
    v_alignbit_b32 v78, v79, v78, v121
    v_alignbit_b32 v79, v79, v79, v121
    v_lshlrev_b32 v104, 16, v76
    v_and_b32 v105, 0xffff0000, v76
    v_lshlrev_b32 v106, 16, v77
    v_and_b32 v107, 0xffff0000, v77
    v_lshlrev_b32 v108, 16, v78
    v_and_b32 v109, 0xffff0000, v78
    v_lshlrev_b32 v110, 16, v79
    v_mul_f32 v112, s13, v104
    v_mul_f32 v113, s13, v105
    v_mul_f32 v114, s13, v106
    v_mul_f32 v115, s13, v107
    v_mul_f32 v116, s13, v108
    v_mul_f32 v117, s13, v109
    v_mul_f32 v118, s13, v110
    v_exp_f32 v112, v112
    v_exp_f32 v113, v113
    v_exp_f32 v114, v114
    v_exp_f32 v115, v115
    v_exp_f32 v116, v116
    v_exp_f32 v117, v117
    v_exp_f32 v118, v118
    v_add_f32 v112, 1.0, v112
    v_add_f32 v113, 1.0, v113
    v_add_f32 v114, 1.0, v114
    v_add_f32 v115, 1.0, v115
    v_add_f32 v116, 1.0, v116
    v_add_f32 v117, 1.0, v117
    v_add_f32 v118, 1.0, v118
    v_rcp_f32 v112, v112
    v_rcp_f32 v113, v113
    v_rcp_f32 v114, v114
    v_rcp_f32 v115, v115
    v_rcp_f32 v116, v116
    v_rcp_f32 v117, v117
    v_rcp_f32 v118, v118
    v_mul_f32 v112, v112, v104
    v_cvt_pk_bf16_f32 v112, v112, v112
    v_lshlrev_b32 v30, 16, v112
    v_mul_f32 v113, v113, v105
    v_cvt_pk_bf16_f32 v113, v113, v113
    v_lshlrev_b32 v32, 16, v113
    v_mul_f32 v114, v114, v106
    v_cvt_pk_bf16_f32 v114, v114, v114
    v_lshlrev_b32 v34, 16, v114
    v_mul_f32 v115, v115, v107
    v_cvt_pk_bf16_f32 v115, v115, v115
    v_lshlrev_b32 v36, 16, v115
    v_mul_f32 v116, v116, v108
    v_cvt_pk_bf16_f32 v116, v116, v116
    v_lshlrev_b32 v38, 16, v116
    v_mul_f32 v117, v117, v109
    v_cvt_pk_bf16_f32 v117, v117, v117
    v_lshlrev_b32 v40, 16, v117
    v_mul_f32 v118, v118, v110
    v_cvt_pk_bf16_f32 v118, v118, v118
    v_lshlrev_b32 v42, 16, v118
    v_lshlrev_b32 v104, 16, v48
    v_and_b32 v105, 0xffff0000, v48
    v_pk_mul_f32 v[80:81], v[104:105], v[30:31] op_sel_hi:[1,0]
    v_lshlrev_b32 v106, 16, v49
    v_and_b32 v107, 0xffff0000, v49
    v_pk_mul_f32 v[82:83], v[106:107], v[30:31] op_sel_hi:[1,0]
    v_lshlrev_b32 v108, 16, v50
    v_and_b32 v109, 0xffff0000, v50
    v_pk_mul_f32 v[84:85], v[108:109], v[30:31] op_sel_hi:[1,0]
    v_lshlrev_b32 v110, 16, v51
    v_and_b32 v111, 0xffff0000, v51
    v_pk_mul_f32 v[86:87], v[110:111], v[30:31] op_sel_hi:[1,0]
    v_lshlrev_b32 v104, 16, v52
    v_and_b32 v105, 0xffff0000, v52
    v_pk_fma_f32 v[80:81], v[104:105], v[32:33], v[80:81] op_sel_hi:[1,0,1]
    v_lshlrev_b32 v106, 16, v53
    v_and_b32 v107, 0xffff0000, v53
    v_pk_fma_f32 v[82:83], v[106:107], v[32:33], v[82:83] op_sel_hi:[1,0,1]
    v_lshlrev_b32 v108, 16, v54
    v_and_b32 v109, 0xffff0000, v54
    v_pk_fma_f32 v[84:85], v[108:109], v[32:33], v[84:85] op_sel_hi:[1,0,1]
    v_lshlrev_b32 v110, 16, v55
    v_and_b32 v111, 0xffff0000, v55
    v_pk_fma_f32 v[86:87], v[110:111], v[32:33], v[86:87] op_sel_hi:[1,0,1]
    v_lshlrev_b32 v104, 16, v56
    v_and_b32 v105, 0xffff0000, v56
    v_pk_fma_f32 v[80:81], v[104:105], v[34:35], v[80:81] op_sel_hi:[1,0,1]
    v_lshlrev_b32 v106, 16, v57
    v_and_b32 v107, 0xffff0000, v57
    v_pk_fma_f32 v[82:83], v[106:107], v[34:35], v[82:83] op_sel_hi:[1,0,1]
    v_lshlrev_b32 v108, 16, v58
    v_and_b32 v109, 0xffff0000, v58
    v_pk_fma_f32 v[84:85], v[108:109], v[34:35], v[84:85] op_sel_hi:[1,0,1]
    v_lshlrev_b32 v110, 16, v59
    v_and_b32 v111, 0xffff0000, v59
    v_pk_fma_f32 v[86:87], v[110:111], v[34:35], v[86:87] op_sel_hi:[1,0,1]
    v_lshlrev_b32 v104, 16, v60
    v_and_b32 v105, 0xffff0000, v60
    v_pk_fma_f32 v[80:81], v[104:105], v[36:37], v[80:81] op_sel_hi:[1,0,1]
    v_lshlrev_b32 v106, 16, v61
    v_and_b32 v107, 0xffff0000, v61
    v_pk_fma_f32 v[82:83], v[106:107], v[36:37], v[82:83] op_sel_hi:[1,0,1]
    v_lshlrev_b32 v108, 16, v62
    v_and_b32 v109, 0xffff0000, v62
    v_pk_fma_f32 v[84:85], v[108:109], v[36:37], v[84:85] op_sel_hi:[1,0,1]
    v_lshlrev_b32 v110, 16, v63
    v_and_b32 v111, 0xffff0000, v63
    v_pk_fma_f32 v[86:87], v[110:111], v[36:37], v[86:87] op_sel_hi:[1,0,1]
    v_lshlrev_b32 v104, 16, v64
    v_and_b32 v105, 0xffff0000, v64
    v_pk_fma_f32 v[80:81], v[104:105], v[38:39], v[80:81] op_sel_hi:[1,0,1]
    v_lshlrev_b32 v106, 16, v65
    v_and_b32 v107, 0xffff0000, v65
    v_pk_fma_f32 v[82:83], v[106:107], v[38:39], v[82:83] op_sel_hi:[1,0,1]
    v_lshlrev_b32 v108, 16, v66
    v_and_b32 v109, 0xffff0000, v66
    v_pk_fma_f32 v[84:85], v[108:109], v[38:39], v[84:85] op_sel_hi:[1,0,1]
    v_lshlrev_b32 v110, 16, v67
    v_and_b32 v111, 0xffff0000, v67
    v_pk_fma_f32 v[86:87], v[110:111], v[38:39], v[86:87] op_sel_hi:[1,0,1]
    v_lshlrev_b32 v104, 16, v68
    v_and_b32 v105, 0xffff0000, v68
    v_pk_fma_f32 v[80:81], v[104:105], v[40:41], v[80:81] op_sel_hi:[1,0,1]
    v_lshlrev_b32 v106, 16, v69
    v_and_b32 v107, 0xffff0000, v69
    v_pk_fma_f32 v[82:83], v[106:107], v[40:41], v[82:83] op_sel_hi:[1,0,1]
    v_lshlrev_b32 v108, 16, v70
    v_and_b32 v109, 0xffff0000, v70
    v_pk_fma_f32 v[84:85], v[108:109], v[40:41], v[84:85] op_sel_hi:[1,0,1]
    v_lshlrev_b32 v110, 16, v71
    v_and_b32 v111, 0xffff0000, v71
    v_pk_fma_f32 v[86:87], v[110:111], v[40:41], v[86:87] op_sel_hi:[1,0,1]
    v_lshlrev_b32 v104, 16, v72
    v_and_b32 v105, 0xffff0000, v72
    v_pk_fma_f32 v[80:81], v[104:105], v[42:43], v[80:81] op_sel_hi:[1,0,1]
    v_lshlrev_b32 v106, 16, v73
    v_and_b32 v107, 0xffff0000, v73
    v_pk_fma_f32 v[82:83], v[106:107], v[42:43], v[82:83] op_sel_hi:[1,0,1]
    v_lshlrev_b32 v108, 16, v74
    v_and_b32 v109, 0xffff0000, v74
    v_pk_fma_f32 v[84:85], v[108:109], v[42:43], v[84:85] op_sel_hi:[1,0,1]
    v_lshlrev_b32 v110, 16, v75
    v_and_b32 v111, 0xffff0000, v75
    v_pk_fma_f32 v[86:87], v[110:111], v[42:43], v[86:87] op_sel_hi:[1,0,1]
    v_add_f32_dpp v80, v80, v80 row_ror:4 row_mask:0xf bank_mask:0xf
    v_add_f32_dpp v81, v81, v81 row_ror:4 row_mask:0xf bank_mask:0xf
    v_add_f32_dpp v82, v82, v82 row_ror:4 row_mask:0xf bank_mask:0xf
    v_add_f32_dpp v83, v83, v83 row_ror:4 row_mask:0xf bank_mask:0xf
    v_add_f32_dpp v84, v84, v84 row_ror:4 row_mask:0xf bank_mask:0xf
    v_add_f32_dpp v85, v85, v85 row_ror:4 row_mask:0xf bank_mask:0xf
    v_add_f32_dpp v86, v86, v86 row_ror:4 row_mask:0xf bank_mask:0xf
    v_add_f32_dpp v87, v87, v87 row_ror:4 row_mask:0xf bank_mask:0xf
    v_add_f32_dpp v80, v80, v80 row_ror:8 row_mask:0xf bank_mask:0xf
    v_add_f32_dpp v81, v81, v81 row_ror:8 row_mask:0xf bank_mask:0xf
    v_add_f32_dpp v82, v82, v82 row_ror:8 row_mask:0xf bank_mask:0xf
    v_add_f32_dpp v83, v83, v83 row_ror:8 row_mask:0xf bank_mask:0xf
    v_add_f32_dpp v84, v84, v84 row_ror:8 row_mask:0xf bank_mask:0xf
    v_add_f32_dpp v85, v85, v85 row_ror:8 row_mask:0xf bank_mask:0xf
    v_add_f32_dpp v86, v86, v86 row_ror:8 row_mask:0xf bank_mask:0xf
    v_add_f32_dpp v87, v87, v87 row_ror:8 row_mask:0xf bank_mask:0xf
    v_lshrrev_b32 v121, 4, v0
    v_lshlrev_b32 v121, 7, v121
    v_and_b32 v120, 3, v0
    v_lshl_add_u32 v120, v120, 5, v121
    v_add_u32 v120, 161792, v120
    ds_write_b128 v120, v[80:83]
    ds_write_b128 v120, v[84:87] offset:16
    v_lshlrev_b32 v121, 2, v0
    v_add_u32 v121, 161792, v121
    s_waitcnt lgkmcnt(0)
    s_barrier
    s_cmp_lg_u32 s28, 0
    s_cbranch_scc1 L_mod2rnadaLN_cond__gqa_block_cached__mixer_gmlp__prompt_kernel
    ds_read_b32 v48, v121 offset:0
    ds_read_b32 v49, v121 offset:256
    ds_read_b32 v50, v121 offset:512
    ds_read_b32 v51, v121 offset:768
    ds_read_b32 v52, v121 offset:1024
    ds_read_b32 v53, v121 offset:1280
    ds_read_b32 v54, v121 offset:1536
    ds_read_b32 v55, v121 offset:1792
    s_waitcnt lgkmcnt(3)
    v_add_f32 v48, v48, v52
    s_waitcnt lgkmcnt(2)
    v_add_f32 v49, v49, v53
    s_waitcnt lgkmcnt(1)
    v_add_f32 v50, v50, v54
    s_waitcnt lgkmcnt(0)
    v_add_f32 v51, v51, v55
    v_add_f32 v48, v48, v50
    v_add_f32 v49, v49, v51
    v_add_f32 v48, v48, v49
    v_mov_b32 v49, v48
    s_nop 1
    v_permlane32_swap_b32 v48, v49
    v_add_f32 v48, v48, v49
    v_cvt_pk_bf16_f32 v48, v48, v48
    v_lshlrev_b32 v48, 16, v48
    v_add_f32 v49, 1.0, v48
    v_cvt_pk_bf16_f32 v49, v49, v49
    v_lshlrev_b32 v49, 16, v49
    s_sub_u32 s12, s58, 28
    s_cmp_lt_u32 s12, 14
    s_cselect_b64 vcc, -1, 0
    v_cndmask_b32 v48, v48, v49, vcc
    s_lshl_b32 s12, s58, 7
    v_and_b32 v120, 31, v0
    v_lshlrev_b32 v120, 2, v120
    s_mov_b32 s57, 0
    buffer_store_dword v48, v120, s[24:27], s12 offen offset:3584 sc1
L_mod2rnadaLN_cond__gqa_block_cached__mixer_gmlp__prompt_kernel:
    s_and_b32 s14, s28, 1
    s_lshl_b32 s14, s14, 11
    s_mul_i32 s15, s48, 32768
    s_add_u32 s15, s15, s14
    s_add_u32 s15, s15, 28672
    v_add_u32 v4, s15, v12
    s_mul_i32 s15, s48, 100352
    s_add_u32 s15, s15, s14
    s_add_u32 s15, s15, 28672
    v_add_u32 v5, s15, v12
    v_add_u32 v6, 28672, v12
    v_add_u32 v7, 133120, v12
    s_lshl_b32 s14, s30, 7
    s_add_u32 s14, s14, 114688
    v_mov_b32 v13, s14
    v_mov_b32 v10, 1
    v_mov_b32 v9, 12
    s_barrier
    v_pk_mul_f32 v[128:129], v[128:129], v[2:3] op_sel_hi:[1,0]
    v_pk_mul_f32 v[130:131], v[130:131], v[2:3] op_sel_hi:[1,0]
    v_pk_mul_f32 v[136:137], v[136:137], v[2:3] op_sel_hi:[1,0]
    v_pk_mul_f32 v[138:139], v[138:139], v[2:3] op_sel_hi:[1,0]
    v_cvt_pk_bf16_f32 v128, v128, v129
    v_cvt_pk_bf16_f32 v129, v130, v131
    v_cvt_pk_bf16_f32 v130, v136, v137
    v_cvt_pk_bf16_f32 v131, v138, v139
    ds_write_b128 v4, v[128:131] offset:0
    v_pk_mul_f32 v[132:133], v[132:133], v[2:3] op_sel:[0,1] op_sel_hi:[1,1]
    v_pk_mul_f32 v[134:135], v[134:135], v[2:3] op_sel:[0,1] op_sel_hi:[1,1]
    v_pk_mul_f32 v[140:141], v[140:141], v[2:3] op_sel:[0,1] op_sel_hi:[1,1]
    v_pk_mul_f32 v[142:143], v[142:143], v[2:3] op_sel:[0,1] op_sel_hi:[1,1]
    v_cvt_pk_bf16_f32 v132, v132, v133
    v_cvt_pk_bf16_f32 v133, v134, v135
    v_cvt_pk_bf16_f32 v134, v140, v141
    v_cvt_pk_bf16_f32 v135, v142, v143
    ds_write_b128 v4, v[132:135] offset:1024
    v_pk_mul_f32 v[144:145], v[144:145], v[2:3] op_sel_hi:[1,0]
    v_pk_mul_f32 v[146:147], v[146:147], v[2:3] op_sel_hi:[1,0]
    v_pk_mul_f32 v[152:153], v[152:153], v[2:3] op_sel_hi:[1,0]
    v_pk_mul_f32 v[154:155], v[154:155], v[2:3] op_sel_hi:[1,0]
    v_cvt_pk_bf16_f32 v144, v144, v145
    v_cvt_pk_bf16_f32 v145, v146, v147
    v_cvt_pk_bf16_f32 v146, v152, v153
    v_cvt_pk_bf16_f32 v147, v154, v155
    ds_write_b128 v5, v[144:147] offset:4096
    v_pk_mul_f32 v[148:149], v[148:149], v[2:3] op_sel:[0,1] op_sel_hi:[1,1]
    v_pk_mul_f32 v[150:151], v[150:151], v[2:3] op_sel:[0,1] op_sel_hi:[1,1]
    v_pk_mul_f32 v[156:157], v[156:157], v[2:3] op_sel:[0,1] op_sel_hi:[1,1]
    v_pk_mul_f32 v[158:159], v[158:159], v[2:3] op_sel:[0,1] op_sel_hi:[1,1]
    v_cvt_pk_bf16_f32 v148, v148, v149
    v_cvt_pk_bf16_f32 v149, v150, v151
    v_cvt_pk_bf16_f32 v150, v156, v157
    v_cvt_pk_bf16_f32 v151, v158, v159
    ds_write_b128 v5, v[148:151] offset:5120
    v_pk_mul_f32 v[160:161], v[160:161], v[2:3] op_sel_hi:[1,0]
    v_pk_mul_f32 v[162:163], v[162:163], v[2:3] op_sel_hi:[1,0]
    v_pk_mul_f32 v[168:169], v[168:169], v[2:3] op_sel_hi:[1,0]
    v_pk_mul_f32 v[170:171], v[170:171], v[2:3] op_sel_hi:[1,0]
    v_cvt_pk_bf16_f32 v160, v160, v161
    v_cvt_pk_bf16_f32 v161, v162, v163
    v_cvt_pk_bf16_f32 v162, v168, v169
    v_cvt_pk_bf16_f32 v163, v170, v171
    ds_write_b128 v5, v[160:163] offset:8192
    v_pk_mul_f32 v[164:165], v[164:165], v[2:3] op_sel:[0,1] op_sel_hi:[1,1]
    v_pk_mul_f32 v[166:167], v[166:167], v[2:3] op_sel:[0,1] op_sel_hi:[1,1]
    v_pk_mul_f32 v[172:173], v[172:173], v[2:3] op_sel:[0,1] op_sel_hi:[1,1]
    v_pk_mul_f32 v[174:175], v[174:175], v[2:3] op_sel:[0,1] op_sel_hi:[1,1]
    v_cvt_pk_bf16_f32 v164, v164, v165
    v_cvt_pk_bf16_f32 v165, v166, v167
    v_cvt_pk_bf16_f32 v166, v172, v173
    v_cvt_pk_bf16_f32 v167, v174, v175
    ds_write_b128 v5, v[164:167] offset:9216
    v_pk_mul_f32 v[176:177], v[176:177], v[2:3] op_sel_hi:[1,0]
    v_pk_mul_f32 v[178:179], v[178:179], v[2:3] op_sel_hi:[1,0]
    v_pk_mul_f32 v[184:185], v[184:185], v[2:3] op_sel_hi:[1,0]
    v_pk_mul_f32 v[186:187], v[186:187], v[2:3] op_sel_hi:[1,0]
    v_cvt_pk_bf16_f32 v176, v176, v177
    v_cvt_pk_bf16_f32 v177, v178, v179
    v_cvt_pk_bf16_f32 v178, v184, v185
    v_cvt_pk_bf16_f32 v179, v186, v187
    ds_write_b128 v5, v[176:179] offset:12288
    v_pk_mul_f32 v[180:181], v[180:181], v[2:3] op_sel:[0,1] op_sel_hi:[1,1]
    v_pk_mul_f32 v[182:183], v[182:183], v[2:3] op_sel:[0,1] op_sel_hi:[1,1]
    v_pk_mul_f32 v[188:189], v[188:189], v[2:3] op_sel:[0,1] op_sel_hi:[1,1]
    v_pk_mul_f32 v[190:191], v[190:191], v[2:3] op_sel:[0,1] op_sel_hi:[1,1]
    v_cvt_pk_bf16_f32 v180, v180, v181
    v_cvt_pk_bf16_f32 v181, v182, v183
    v_cvt_pk_bf16_f32 v182, v188, v189
    v_cvt_pk_bf16_f32 v183, v190, v191
    ds_write_b128 v5, v[180:183] offset:13312
    v_pk_mul_f32 v[192:193], v[192:193], v[2:3] op_sel_hi:[1,0]
    v_pk_mul_f32 v[194:195], v[194:195], v[2:3] op_sel_hi:[1,0]
    v_pk_mul_f32 v[200:201], v[200:201], v[2:3] op_sel_hi:[1,0]
    v_pk_mul_f32 v[202:203], v[202:203], v[2:3] op_sel_hi:[1,0]
    v_cvt_pk_bf16_f32 v192, v192, v193
    v_cvt_pk_bf16_f32 v193, v194, v195
    v_cvt_pk_bf16_f32 v194, v200, v201
    v_cvt_pk_bf16_f32 v195, v202, v203
    ds_write_b128 v5, v[192:195] offset:16384
    v_pk_mul_f32 v[196:197], v[196:197], v[2:3] op_sel:[0,1] op_sel_hi:[1,1]
    v_pk_mul_f32 v[198:199], v[198:199], v[2:3] op_sel:[0,1] op_sel_hi:[1,1]
    v_pk_mul_f32 v[204:205], v[204:205], v[2:3] op_sel:[0,1] op_sel_hi:[1,1]
    v_pk_mul_f32 v[206:207], v[206:207], v[2:3] op_sel:[0,1] op_sel_hi:[1,1]
    v_cvt_pk_bf16_f32 v196, v196, v197
    v_cvt_pk_bf16_f32 v197, v198, v199
    v_cvt_pk_bf16_f32 v198, v204, v205
    v_cvt_pk_bf16_f32 v199, v206, v207
    ds_write_b128 v5, v[196:199] offset:17408
    v_pk_mul_f32 v[208:209], v[208:209], v[2:3] op_sel_hi:[1,0]
    v_pk_mul_f32 v[210:211], v[210:211], v[2:3] op_sel_hi:[1,0]
    v_pk_mul_f32 v[216:217], v[216:217], v[2:3] op_sel_hi:[1,0]
    v_pk_mul_f32 v[218:219], v[218:219], v[2:3] op_sel_hi:[1,0]
    v_cvt_pk_bf16_f32 v208, v208, v209
    v_cvt_pk_bf16_f32 v209, v210, v211
    v_cvt_pk_bf16_f32 v210, v216, v217
    v_cvt_pk_bf16_f32 v211, v218, v219
    ds_write_b128 v5, v[208:211] offset:20480
    v_pk_mul_f32 v[212:213], v[212:213], v[2:3] op_sel:[0,1] op_sel_hi:[1,1]
    v_pk_mul_f32 v[214:215], v[214:215], v[2:3] op_sel:[0,1] op_sel_hi:[1,1]
    v_pk_mul_f32 v[220:221], v[220:221], v[2:3] op_sel:[0,1] op_sel_hi:[1,1]
    v_pk_mul_f32 v[222:223], v[222:223], v[2:3] op_sel:[0,1] op_sel_hi:[1,1]
    v_cvt_pk_bf16_f32 v212, v212, v213
    v_cvt_pk_bf16_f32 v213, v214, v215
    v_cvt_pk_bf16_f32 v214, v220, v221
    v_cvt_pk_bf16_f32 v215, v222, v223
    ds_write_b128 v5, v[212:215] offset:21504
    v_pk_mul_f32 v[224:225], v[224:225], v[2:3] op_sel_hi:[1,0]
    v_pk_mul_f32 v[226:227], v[226:227], v[2:3] op_sel_hi:[1,0]
    v_pk_mul_f32 v[232:233], v[232:233], v[2:3] op_sel_hi:[1,0]
    v_pk_mul_f32 v[234:235], v[234:235], v[2:3] op_sel_hi:[1,0]
    v_cvt_pk_bf16_f32 v224, v224, v225
    v_cvt_pk_bf16_f32 v225, v226, v227
    v_cvt_pk_bf16_f32 v226, v232, v233
    v_cvt_pk_bf16_f32 v227, v234, v235
    ds_write_b128 v5, v[224:227] offset:24576
    v_pk_mul_f32 v[228:229], v[228:229], v[2:3] op_sel:[0,1] op_sel_hi:[1,1]
    v_pk_mul_f32 v[230:231], v[230:231], v[2:3] op_sel:[0,1] op_sel_hi:[1,1]
    v_pk_mul_f32 v[236:237], v[236:237], v[2:3] op_sel:[0,1] op_sel_hi:[1,1]
    v_pk_mul_f32 v[238:239], v[238:239], v[2:3] op_sel:[0,1] op_sel_hi:[1,1]
    v_cvt_pk_bf16_f32 v228, v228, v229
    v_cvt_pk_bf16_f32 v229, v230, v231
    v_cvt_pk_bf16_f32 v230, v236, v237
    v_cvt_pk_bf16_f32 v231, v238, v239
    ds_write_b128 v5, v[228:231] offset:25600
    v_pk_mul_f32 v[240:241], v[240:241], v[2:3] op_sel_hi:[1,0]
    v_pk_mul_f32 v[242:243], v[242:243], v[2:3] op_sel_hi:[1,0]
    v_pk_mul_f32 v[248:249], v[248:249], v[2:3] op_sel_hi:[1,0]
    v_pk_mul_f32 v[250:251], v[250:251], v[2:3] op_sel_hi:[1,0]
    v_cvt_pk_bf16_f32 v240, v240, v241
    v_cvt_pk_bf16_f32 v241, v242, v243
    v_cvt_pk_bf16_f32 v242, v248, v249
    v_cvt_pk_bf16_f32 v243, v250, v251
    ds_write_b128 v5, v[240:243] offset:28672
    v_pk_mul_f32 v[244:245], v[244:245], v[2:3] op_sel:[0,1] op_sel_hi:[1,1]
    v_pk_mul_f32 v[246:247], v[246:247], v[2:3] op_sel:[0,1] op_sel_hi:[1,1]
    v_pk_mul_f32 v[252:253], v[252:253], v[2:3] op_sel:[0,1] op_sel_hi:[1,1]
    v_pk_mul_f32 v[254:255], v[254:255], v[2:3] op_sel:[0,1] op_sel_hi:[1,1]
    v_cvt_pk_bf16_f32 v244, v244, v245
    v_cvt_pk_bf16_f32 v245, v246, v247
    v_cvt_pk_bf16_f32 v246, v252, v253
    v_cvt_pk_bf16_f32 v247, v254, v255
    ds_write_b128 v5, v[244:247] offset:29696
    s_and_b32 s15, s29, 1
    s_lshl_b32 s15, s15, 2
    s_and_b32 s32, s30, 3
    s_add_u32 s32, s32, s15
    s_lshr_b32 s15, s29, 1
    s_lshl_b32 s15, s15, 3
    s_lshr_b32 s33, s30, 2
    s_add_u32 s33, s33, s15
    s_mul_i32 s34, s32, 224
    s_mul_i32 s36, s28, 114688
    s_add_u32 s34, s34, s36
    s_add_u32 s37, s34, 1792
    s_mul_i32 s36, s28, 7168
    ds_read_b64_tr_b16 a[64:65], v21 offset:0
    ds_read_b64_tr_b16 a[66:67], v21 offset:14336
    ds_read_b64_tr_b16 a[68:69], v22 offset:0
    ds_read_b64_tr_b16 a[70:71], v22 offset:14336
    s_waitcnt lgkmcnt(0)
    s_barrier
    ds_read_b128 a[0:3], v6 offset:0
    ds_read_b128 a[4:7], v6 offset:1024
    ds_read_b128 a[8:11], v6 offset:2048
    ds_read_b128 a[12:15], v6 offset:3072
    s_waitcnt lgkmcnt(3)
    v_mfma_f32_16x16x32_bf16 v[128:131], a[64:67], a[0:3], 0
    ds_read_b64_tr_b16 a[72:73], v23 offset:0
    s_waitcnt lgkmcnt(3)
    v_mfma_f32_16x16x32_bf16 v[132:135], a[64:67], a[4:7], 0
    s_add_u32 m0, s59, 0
    ds_read_b64_tr_b16 a[74:75], v23 offset:14336
    s_waitcnt lgkmcnt(3)
    v_mfma_f32_16x16x32_bf16 v[136:139], a[64:67], a[8:11], 0
    s_add_u32 s38, s39, 57344
    s_waitcnt lgkmcnt(2)
    v_mfma_f32_16x16x32_bf16 v[140:143], a[64:67], a[12:15], 0
    buffer_load_dwordx4 v44, s[44:47], s38 offen offset:0 lds
    v_mfma_f32_16x16x32_bf16 v[144:147], a[68:71], a[0:3], 0
    ds_read_b64_tr_b16 a[76:77], v24 offset:0
    v_mfma_f32_16x16x32_bf16 v[148:151], a[68:71], a[4:7], 0
    buffer_load_dwordx4 v45, s[44:47], s38 offen offset:1024 lds
    v_mfma_f32_16x16x32_bf16 v[152:155], a[68:71], a[8:11], 0
    s_waitcnt lgkmcnt(1)
    ds_read_b64_tr_b16 a[78:79], v24 offset:14336
    v_mfma_f32_16x16x32_bf16 v[156:159], a[68:71], a[12:15], 0
    buffer_load_dwordx4 v46, s[44:47], s38 offen offset:2048 lds
    v_mfma_f32_16x16x32_bf16 v[160:163], a[72:75], a[0:3], 0
    s_waitcnt lgkmcnt(0)
    ds_read_b64_tr_b16 a[80:81], v25 offset:0
    v_mfma_f32_16x16x32_bf16 v[164:167], a[72:75], a[4:7], 0
    buffer_load_dwordx4 v47, s[44:47], s38 offen offset:3072 lds
    v_mfma_f32_16x16x32_bf16 v[168:171], a[72:75], a[8:11], 0
    s_add_u32 m0, s59, 4096
    ds_read_b64_tr_b16 a[82:83], v25 offset:14336
    v_mfma_f32_16x16x32_bf16 v[172:175], a[72:75], a[12:15], 0
    s_add_u32 s38, s39, 61440
    v_mfma_f32_16x16x32_bf16 v[176:179], a[76:79], a[0:3], 0
    buffer_load_dwordx4 v28, s[44:47], s38 offen offset:0 lds
    v_mfma_f32_16x16x32_bf16 v[180:183], a[76:79], a[4:7], 0
    ds_read_b64_tr_b16 a[84:85], v26 offset:0
    v_mfma_f32_16x16x32_bf16 v[184:187], a[76:79], a[8:11], 0
    buffer_load_dwordx4 v29, s[44:47], s38 offen offset:1024 lds
    v_mfma_f32_16x16x32_bf16 v[188:191], a[76:79], a[12:15], 0
    s_waitcnt lgkmcnt(1)
    ds_read_b64_tr_b16 a[86:87], v26 offset:14336
    v_mfma_f32_16x16x32_bf16 v[192:195], a[80:83], a[0:3], 0
    buffer_load_dwordx4 v95, s[44:47], s38 offen offset:2048 lds
    v_mfma_f32_16x16x32_bf16 v[196:199], a[80:83], a[4:7], 0
    ds_read_b64_tr_b16 a[88:89], v27 offset:0
    v_mfma_f32_16x16x32_bf16 v[200:203], a[80:83], a[8:11], 0
    s_waitcnt lgkmcnt(1)
    ds_read_b64_tr_b16 a[90:91], v27 offset:14336
    v_mfma_f32_16x16x32_bf16 v[204:207], a[80:83], a[12:15], 0
    s_waitcnt vmcnt(7)
    s_barrier
    v_mfma_f32_16x16x32_bf16 v[208:211], a[84:87], a[0:3], 0
    ds_read_b128 a[16:19], v6 offset:4096
    ds_read_b128 a[20:23], v6 offset:5120
    v_mfma_f32_16x16x32_bf16 v[212:215], a[84:87], a[4:7], 0
    ds_read_b128 a[24:27], v6 offset:6144
    v_mfma_f32_16x16x32_bf16 v[216:219], a[84:87], a[8:11], 0
    ds_read_b64_tr_b16 a[92:93], v21 offset:33280
    ds_read_b128 a[28:31], v6 offset:7168
    v_mfma_f32_16x16x32_bf16 v[220:223], a[84:87], a[12:15], 0
    s_waitcnt lgkmcnt(5)
    ds_read_b64_tr_b16 a[94:95], v21 offset:47616
    v_mfma_f32_16x16x32_bf16 v[224:227], a[88:91], a[0:3], 0
    ds_read_b64_tr_b16 a[64:65], v22 offset:33280
    v_mfma_f32_16x16x32_bf16 v[228:231], a[88:91], a[4:7], 0
    ds_read_b64_tr_b16 a[66:67], v22 offset:47616
    v_mfma_f32_16x16x32_bf16 v[232:235], a[88:91], a[8:11], 0
    v_mfma_f32_16x16x32_bf16 v[236:239], a[88:91], a[12:15], 0
    s_waitcnt lgkmcnt(2)
    v_mfma_f32_16x16x32_bf16 v[128:131], a[92:95], a[16:19], v[128:131]
    s_barrier
    v_mfma_f32_16x16x32_bf16 v[132:135], a[92:95], a[20:23], v[132:135]
    s_add_u32 m0, s59, 66560
    ds_read_b64_tr_b16 a[68:69], v23 offset:33280
    v_mfma_f32_16x16x32_bf16 v[136:139], a[92:95], a[24:27], v[136:139]
    s_add_u32 s38, s39, 86016
    ds_read_b64_tr_b16 a[70:71], v23 offset:47616
    v_mfma_f32_16x16x32_bf16 v[140:143], a[92:95], a[28:31], v[140:143]
    buffer_load_dwordx4 v44, s[44:47], s38 offen offset:0 lds
    s_waitcnt lgkmcnt(2)
    v_mfma_f32_16x16x32_bf16 v[144:147], a[64:67], a[16:19], v[144:147]
    ds_read_b64_tr_b16 a[72:73], v24 offset:33280
    v_mfma_f32_16x16x32_bf16 v[148:151], a[64:67], a[20:23], v[148:151]
    buffer_load_dwordx4 v45, s[44:47], s38 offen offset:1024 lds
    v_mfma_f32_16x16x32_bf16 v[152:155], a[64:67], a[24:27], v[152:155]
    s_waitcnt lgkmcnt(1)
    ds_read_b64_tr_b16 a[74:75], v24 offset:47616
    v_mfma_f32_16x16x32_bf16 v[156:159], a[64:67], a[28:31], v[156:159]
    buffer_load_dwordx4 v46, s[44:47], s38 offen offset:2048 lds
    v_mfma_f32_16x16x32_bf16 v[160:163], a[68:71], a[16:19], v[160:163]
    s_waitcnt lgkmcnt(0)
    ds_read_b64_tr_b16 a[76:77], v25 offset:33280
    v_mfma_f32_16x16x32_bf16 v[164:167], a[68:71], a[20:23], v[164:167]
    buffer_load_dwordx4 v47, s[44:47], s38 offen offset:3072 lds
    v_mfma_f32_16x16x32_bf16 v[168:171], a[68:71], a[24:27], v[168:171]
    s_add_u32 m0, s59, 70656
    ds_read_b64_tr_b16 a[78:79], v25 offset:47616
    v_mfma_f32_16x16x32_bf16 v[172:175], a[68:71], a[28:31], v[172:175]
    s_add_u32 s38, s39, 90112
    v_mfma_f32_16x16x32_bf16 v[176:179], a[72:75], a[16:19], v[176:179]
    buffer_load_dwordx4 v28, s[44:47], s38 offen offset:0 lds
    v_mfma_f32_16x16x32_bf16 v[180:183], a[72:75], a[20:23], v[180:183]
    ds_read_b64_tr_b16 a[80:81], v26 offset:33280
    v_mfma_f32_16x16x32_bf16 v[184:187], a[72:75], a[24:27], v[184:187]
    buffer_load_dwordx4 v29, s[44:47], s38 offen offset:1024 lds
    v_mfma_f32_16x16x32_bf16 v[188:191], a[72:75], a[28:31], v[188:191]
    s_waitcnt lgkmcnt(1)
    ds_read_b64_tr_b16 a[82:83], v26 offset:47616
    v_mfma_f32_16x16x32_bf16 v[192:195], a[76:79], a[16:19], v[192:195]
    buffer_load_dwordx4 v95, s[44:47], s38 offen offset:2048 lds
    v_mfma_f32_16x16x32_bf16 v[196:199], a[76:79], a[20:23], v[196:199]
    ds_read_b64_tr_b16 a[84:85], v27 offset:33280
    v_mfma_f32_16x16x32_bf16 v[200:203], a[76:79], a[24:27], v[200:203]
    s_waitcnt lgkmcnt(1)
    ds_read_b64_tr_b16 a[86:87], v27 offset:47616
    v_mfma_f32_16x16x32_bf16 v[204:207], a[76:79], a[28:31], v[204:207]
    s_waitcnt vmcnt(7)
    s_barrier
    v_mfma_f32_16x16x32_bf16 v[208:211], a[80:83], a[16:19], v[208:211]
    ds_read_b128 a[0:3], v6 offset:8192
    ds_read_b128 a[4:7], v6 offset:9216
    v_mfma_f32_16x16x32_bf16 v[212:215], a[80:83], a[20:23], v[212:215]
    ds_read_b128 a[8:11], v6 offset:10240
    v_mfma_f32_16x16x32_bf16 v[216:219], a[80:83], a[24:27], v[216:219]
    ds_read_b64_tr_b16 a[88:89], v88 offset:0
    ds_read_b128 a[12:15], v6 offset:11264
    v_mfma_f32_16x16x32_bf16 v[220:223], a[80:83], a[28:31], v[220:223]
    s_waitcnt lgkmcnt(5)
    ds_read_b64_tr_b16 a[90:91], v88 offset:14336
    v_mfma_f32_16x16x32_bf16 v[224:227], a[84:87], a[16:19], v[224:227]
    ds_read_b64_tr_b16 a[92:93], v89 offset:0
    v_mfma_f32_16x16x32_bf16 v[228:231], a[84:87], a[20:23], v[228:231]
    ds_read_b64_tr_b16 a[94:95], v89 offset:14336
    v_mfma_f32_16x16x32_bf16 v[232:235], a[84:87], a[24:27], v[232:235]
    v_mfma_f32_16x16x32_bf16 v[236:239], a[84:87], a[28:31], v[236:239]
    s_waitcnt lgkmcnt(2)
    v_mfma_f32_16x16x32_bf16 v[128:131], a[88:91], a[0:3], v[128:131]
    s_barrier
    v_mfma_f32_16x16x32_bf16 v[132:135], a[88:91], a[4:7], v[132:135]
    s_add_u32 m0, s59, 99840
    ds_read_b64_tr_b16 a[64:65], v90 offset:0
    v_mfma_f32_16x16x32_bf16 v[136:139], a[88:91], a[8:11], v[136:139]
    s_add_u32 s38, s39, 114688
    ds_read_b64_tr_b16 a[66:67], v90 offset:14336
    v_mfma_f32_16x16x32_bf16 v[140:143], a[88:91], a[12:15], v[140:143]
    buffer_load_dwordx4 v44, s[44:47], s38 offen offset:0 lds
    s_waitcnt lgkmcnt(2)
    v_mfma_f32_16x16x32_bf16 v[144:147], a[92:95], a[0:3], v[144:147]
    ds_read_b64_tr_b16 a[68:69], v91 offset:0
    v_mfma_f32_16x16x32_bf16 v[148:151], a[92:95], a[4:7], v[148:151]
    buffer_load_dwordx4 v45, s[44:47], s38 offen offset:1024 lds
    v_mfma_f32_16x16x32_bf16 v[152:155], a[92:95], a[8:11], v[152:155]
    s_waitcnt lgkmcnt(1)
    ds_read_b64_tr_b16 a[70:71], v91 offset:14336
    v_mfma_f32_16x16x32_bf16 v[156:159], a[92:95], a[12:15], v[156:159]
    buffer_load_dwordx4 v46, s[44:47], s38 offen offset:2048 lds
    v_mfma_f32_16x16x32_bf16 v[160:163], a[64:67], a[0:3], v[160:163]
    s_waitcnt lgkmcnt(0)
    ds_read_b64_tr_b16 a[72:73], v92 offset:0
    v_mfma_f32_16x16x32_bf16 v[164:167], a[64:67], a[4:7], v[164:167]
    buffer_load_dwordx4 v47, s[44:47], s38 offen offset:3072 lds
    v_mfma_f32_16x16x32_bf16 v[168:171], a[64:67], a[8:11], v[168:171]
    s_add_u32 m0, s59, 103936
    ds_read_b64_tr_b16 a[74:75], v92 offset:14336
    v_mfma_f32_16x16x32_bf16 v[172:175], a[64:67], a[12:15], v[172:175]
    s_add_u32 s38, s39, 118784
    v_mfma_f32_16x16x32_bf16 v[176:179], a[68:71], a[0:3], v[176:179]
    buffer_load_dwordx4 v28, s[44:47], s38 offen offset:0 lds
    v_mfma_f32_16x16x32_bf16 v[180:183], a[68:71], a[4:7], v[180:183]
    ds_read_b64_tr_b16 a[76:77], v93 offset:0
    v_mfma_f32_16x16x32_bf16 v[184:187], a[68:71], a[8:11], v[184:187]
    buffer_load_dwordx4 v29, s[44:47], s38 offen offset:1024 lds
    v_mfma_f32_16x16x32_bf16 v[188:191], a[68:71], a[12:15], v[188:191]
    s_waitcnt lgkmcnt(1)
    ds_read_b64_tr_b16 a[78:79], v93 offset:14336
    v_mfma_f32_16x16x32_bf16 v[192:195], a[72:75], a[0:3], v[192:195]
    buffer_load_dwordx4 v95, s[44:47], s38 offen offset:2048 lds
    v_mfma_f32_16x16x32_bf16 v[196:199], a[72:75], a[4:7], v[196:199]
    ds_read_b64_tr_b16 a[80:81], v94 offset:0
    v_mfma_f32_16x16x32_bf16 v[200:203], a[72:75], a[8:11], v[200:203]
    s_waitcnt lgkmcnt(1)
    ds_read_b64_tr_b16 a[82:83], v94 offset:14336
    v_mfma_f32_16x16x32_bf16 v[204:207], a[72:75], a[12:15], v[204:207]
    s_waitcnt vmcnt(7)
    s_barrier
    v_mfma_f32_16x16x32_bf16 v[208:211], a[76:79], a[0:3], v[208:211]
    ds_read_b128 a[16:19], v6 offset:12288
    ds_read_b128 a[20:23], v6 offset:13312
    v_mfma_f32_16x16x32_bf16 v[212:215], a[76:79], a[4:7], v[212:215]
    ds_read_b128 a[24:27], v6 offset:14336
    v_mfma_f32_16x16x32_bf16 v[216:219], a[76:79], a[8:11], v[216:219]
    ds_read_b64_tr_b16 a[84:85], v21 offset:0
    ds_read_b128 a[28:31], v6 offset:15360
    v_mfma_f32_16x16x32_bf16 v[220:223], a[76:79], a[12:15], v[220:223]
    s_waitcnt lgkmcnt(5)
    ds_read_b64_tr_b16 a[86:87], v21 offset:14336
    v_mfma_f32_16x16x32_bf16 v[224:227], a[80:83], a[0:3], v[224:227]
    ds_read_b64_tr_b16 a[88:89], v22 offset:0
    v_mfma_f32_16x16x32_bf16 v[228:231], a[80:83], a[4:7], v[228:231]
    ds_read_b64_tr_b16 a[90:91], v22 offset:14336
    v_mfma_f32_16x16x32_bf16 v[232:235], a[80:83], a[8:11], v[232:235]
    v_mfma_f32_16x16x32_bf16 v[236:239], a[80:83], a[12:15], v[236:239]
    s_waitcnt lgkmcnt(2)
    v_mfma_f32_16x16x32_bf16 v[128:131], a[84:87], a[16:19], v[128:131]
    s_barrier
    v_mfma_f32_16x16x32_bf16 v[132:135], a[84:87], a[20:23], v[132:135]
    s_add_u32 m0, s59, 0
    ds_read_b64_tr_b16 a[92:93], v23 offset:0
    v_mfma_f32_16x16x32_bf16 v[136:139], a[84:87], a[24:27], v[136:139]
    s_add_u32 s38, s39, 143360
    ds_read_b64_tr_b16 a[94:95], v23 offset:14336
    v_mfma_f32_16x16x32_bf16 v[140:143], a[84:87], a[28:31], v[140:143]
    buffer_load_dwordx4 v44, s[44:47], s38 offen offset:0 lds
    s_waitcnt lgkmcnt(2)
    v_mfma_f32_16x16x32_bf16 v[144:147], a[88:91], a[16:19], v[144:147]
    ds_read_b64_tr_b16 a[64:65], v24 offset:0
    v_mfma_f32_16x16x32_bf16 v[148:151], a[88:91], a[20:23], v[148:151]
    buffer_load_dwordx4 v45, s[44:47], s38 offen offset:1024 lds
    v_mfma_f32_16x16x32_bf16 v[152:155], a[88:91], a[24:27], v[152:155]
    s_waitcnt lgkmcnt(1)
    ds_read_b64_tr_b16 a[66:67], v24 offset:14336
    v_mfma_f32_16x16x32_bf16 v[156:159], a[88:91], a[28:31], v[156:159]
    buffer_load_dwordx4 v46, s[44:47], s38 offen offset:2048 lds
    v_mfma_f32_16x16x32_bf16 v[160:163], a[92:95], a[16:19], v[160:163]
    s_waitcnt lgkmcnt(0)
    ds_read_b64_tr_b16 a[68:69], v25 offset:0
    v_mfma_f32_16x16x32_bf16 v[164:167], a[92:95], a[20:23], v[164:167]
    buffer_load_dwordx4 v47, s[44:47], s38 offen offset:3072 lds
    v_mfma_f32_16x16x32_bf16 v[168:171], a[92:95], a[24:27], v[168:171]
    s_add_u32 m0, s59, 4096
    ds_read_b64_tr_b16 a[70:71], v25 offset:14336
    v_mfma_f32_16x16x32_bf16 v[172:175], a[92:95], a[28:31], v[172:175]
    s_add_u32 s38, s39, 147456
    v_mfma_f32_16x16x32_bf16 v[176:179], a[64:67], a[16:19], v[176:179]
    buffer_load_dwordx4 v28, s[44:47], s38 offen offset:0 lds
    v_mfma_f32_16x16x32_bf16 v[180:183], a[64:67], a[20:23], v[180:183]
    ds_read_b64_tr_b16 a[72:73], v26 offset:0
    v_mfma_f32_16x16x32_bf16 v[184:187], a[64:67], a[24:27], v[184:187]
    buffer_load_dwordx4 v29, s[44:47], s38 offen offset:1024 lds
    v_mfma_f32_16x16x32_bf16 v[188:191], a[64:67], a[28:31], v[188:191]
    s_waitcnt lgkmcnt(1)
    ds_read_b64_tr_b16 a[74:75], v26 offset:14336
    v_mfma_f32_16x16x32_bf16 v[192:195], a[68:71], a[16:19], v[192:195]
    buffer_load_dwordx4 v95, s[44:47], s38 offen offset:2048 lds
    v_mfma_f32_16x16x32_bf16 v[196:199], a[68:71], a[20:23], v[196:199]
    ds_read_b64_tr_b16 a[76:77], v27 offset:0
    v_mfma_f32_16x16x32_bf16 v[200:203], a[68:71], a[24:27], v[200:203]
    s_waitcnt lgkmcnt(1)
    ds_read_b64_tr_b16 a[78:79], v27 offset:14336
    v_mfma_f32_16x16x32_bf16 v[204:207], a[68:71], a[28:31], v[204:207]
    s_waitcnt vmcnt(7)
    s_barrier
    v_mfma_f32_16x16x32_bf16 v[208:211], a[72:75], a[16:19], v[208:211]
    ds_read_b128 a[0:3], v6 offset:16384
    ds_read_b128 a[4:7], v6 offset:17408
    v_mfma_f32_16x16x32_bf16 v[212:215], a[72:75], a[20:23], v[212:215]
    ds_read_b128 a[8:11], v6 offset:18432
    v_mfma_f32_16x16x32_bf16 v[216:219], a[72:75], a[24:27], v[216:219]
    ds_read_b64_tr_b16 a[80:81], v21 offset:33280
    ds_read_b128 a[12:15], v6 offset:19456
    v_mfma_f32_16x16x32_bf16 v[220:223], a[72:75], a[28:31], v[220:223]
    s_waitcnt lgkmcnt(5)
    ds_read_b64_tr_b16 a[82:83], v21 offset:47616
    v_mfma_f32_16x16x32_bf16 v[224:227], a[76:79], a[16:19], v[224:227]
    ds_read_b64_tr_b16 a[84:85], v22 offset:33280
    v_mfma_f32_16x16x32_bf16 v[228:231], a[76:79], a[20:23], v[228:231]
    ds_read_b64_tr_b16 a[86:87], v22 offset:47616
    v_mfma_f32_16x16x32_bf16 v[232:235], a[76:79], a[24:27], v[232:235]
    v_mfma_f32_16x16x32_bf16 v[236:239], a[76:79], a[28:31], v[236:239]
    s_waitcnt lgkmcnt(2)
    v_mfma_f32_16x16x32_bf16 v[128:131], a[80:83], a[0:3], v[128:131]
    s_barrier
    v_mfma_f32_16x16x32_bf16 v[132:135], a[80:83], a[4:7], v[132:135]
    s_add_u32 m0, s59, 66560
    ds_read_b64_tr_b16 a[88:89], v23 offset:33280
    v_mfma_f32_16x16x32_bf16 v[136:139], a[80:83], a[8:11], v[136:139]
    s_add_u32 s38, s39, 172032
    ds_read_b64_tr_b16 a[90:91], v23 offset:47616
    v_mfma_f32_16x16x32_bf16 v[140:143], a[80:83], a[12:15], v[140:143]
    buffer_load_dwordx4 v44, s[44:47], s38 offen offset:0 lds
    s_waitcnt lgkmcnt(2)
    v_mfma_f32_16x16x32_bf16 v[144:147], a[84:87], a[0:3], v[144:147]
    ds_read_b64_tr_b16 a[92:93], v24 offset:33280
    v_mfma_f32_16x16x32_bf16 v[148:151], a[84:87], a[4:7], v[148:151]
    buffer_load_dwordx4 v45, s[44:47], s38 offen offset:1024 lds
    v_mfma_f32_16x16x32_bf16 v[152:155], a[84:87], a[8:11], v[152:155]
    s_waitcnt lgkmcnt(1)
    ds_read_b64_tr_b16 a[94:95], v24 offset:47616
    v_mfma_f32_16x16x32_bf16 v[156:159], a[84:87], a[12:15], v[156:159]
    buffer_load_dwordx4 v46, s[44:47], s38 offen offset:2048 lds
    v_mfma_f32_16x16x32_bf16 v[160:163], a[88:91], a[0:3], v[160:163]
    s_waitcnt lgkmcnt(0)
    ds_read_b64_tr_b16 a[64:65], v25 offset:33280
    v_mfma_f32_16x16x32_bf16 v[164:167], a[88:91], a[4:7], v[164:167]
    buffer_load_dwordx4 v47, s[44:47], s38 offen offset:3072 lds
    v_mfma_f32_16x16x32_bf16 v[168:171], a[88:91], a[8:11], v[168:171]
    s_add_u32 m0, s59, 70656
    ds_read_b64_tr_b16 a[66:67], v25 offset:47616
    v_mfma_f32_16x16x32_bf16 v[172:175], a[88:91], a[12:15], v[172:175]
    s_add_u32 s38, s39, 176128
    v_mfma_f32_16x16x32_bf16 v[176:179], a[92:95], a[0:3], v[176:179]
    buffer_load_dwordx4 v28, s[44:47], s38 offen offset:0 lds
    v_mfma_f32_16x16x32_bf16 v[180:183], a[92:95], a[4:7], v[180:183]
    ds_read_b64_tr_b16 a[68:69], v26 offset:33280
    v_mfma_f32_16x16x32_bf16 v[184:187], a[92:95], a[8:11], v[184:187]
    buffer_load_dwordx4 v29, s[44:47], s38 offen offset:1024 lds
    v_mfma_f32_16x16x32_bf16 v[188:191], a[92:95], a[12:15], v[188:191]
    s_waitcnt lgkmcnt(1)
    ds_read_b64_tr_b16 a[70:71], v26 offset:47616
    v_mfma_f32_16x16x32_bf16 v[192:195], a[64:67], a[0:3], v[192:195]
    buffer_load_dwordx4 v95, s[44:47], s38 offen offset:2048 lds
    v_mfma_f32_16x16x32_bf16 v[196:199], a[64:67], a[4:7], v[196:199]
    ds_read_b64_tr_b16 a[72:73], v27 offset:33280
    v_mfma_f32_16x16x32_bf16 v[200:203], a[64:67], a[8:11], v[200:203]
    s_waitcnt lgkmcnt(1)
    ds_read_b64_tr_b16 a[74:75], v27 offset:47616
    v_mfma_f32_16x16x32_bf16 v[204:207], a[64:67], a[12:15], v[204:207]
    s_waitcnt vmcnt(7)
    s_barrier
    v_mfma_f32_16x16x32_bf16 v[208:211], a[68:71], a[0:3], v[208:211]
    buffer_atomic_add v10, v11, s[92:95], s57 offen offset:12 sc1
    v_mfma_f32_16x16x32_bf16 v[212:215], a[68:71], a[4:7], v[212:215]
    ds_read_b128 a[16:19], v6 offset:20480
    ds_read_b128 a[20:23], v6 offset:21504
    v_mfma_f32_16x16x32_bf16 v[216:219], a[68:71], a[8:11], v[216:219]
    ds_read_b128 a[24:27], v6 offset:22528
    ds_read_b64_tr_b16 a[76:77], v88 offset:0
    v_mfma_f32_16x16x32_bf16 v[220:223], a[68:71], a[12:15], v[220:223]
    s_waitcnt lgkmcnt(4)
    ds_read_b128 a[28:31], v6 offset:23552
    ds_read_b64_tr_b16 a[78:79], v88 offset:14336
    v_mfma_f32_16x16x32_bf16 v[224:227], a[72:75], a[0:3], v[224:227]
    ds_read_b64_tr_b16 a[80:81], v89 offset:0
    v_mfma_f32_16x16x32_bf16 v[228:231], a[72:75], a[4:7], v[228:231]
    ds_read_b64_tr_b16 a[82:83], v89 offset:14336
    v_mfma_f32_16x16x32_bf16 v[232:235], a[72:75], a[8:11], v[232:235]
    v_mfma_f32_16x16x32_bf16 v[236:239], a[72:75], a[12:15], v[236:239]
    s_waitcnt lgkmcnt(2)
    v_mfma_f32_16x16x32_bf16 v[128:131], a[76:79], a[16:19], v[128:131]
    s_barrier
    v_mfma_f32_16x16x32_bf16 v[132:135], a[76:79], a[20:23], v[132:135]
    s_add_u32 m0, s59, 99840
    ds_read_b64_tr_b16 a[84:85], v90 offset:0
    v_mfma_f32_16x16x32_bf16 v[136:139], a[76:79], a[24:27], v[136:139]
    s_add_u32 s38, s39, 200704
    ds_read_b64_tr_b16 a[86:87], v90 offset:14336
    v_mfma_f32_16x16x32_bf16 v[140:143], a[76:79], a[28:31], v[140:143]
    buffer_load_dwordx4 v44, s[44:47], s38 offen offset:0 lds
    s_waitcnt lgkmcnt(2)
    v_mfma_f32_16x16x32_bf16 v[144:147], a[80:83], a[16:19], v[144:147]
    ds_read_b64_tr_b16 a[88:89], v91 offset:0
    v_mfma_f32_16x16x32_bf16 v[148:151], a[80:83], a[20:23], v[148:151]
    buffer_load_dwordx4 v45, s[44:47], s38 offen offset:1024 lds
    v_mfma_f32_16x16x32_bf16 v[152:155], a[80:83], a[24:27], v[152:155]
    s_waitcnt lgkmcnt(1)
    ds_read_b64_tr_b16 a[90:91], v91 offset:14336
    v_mfma_f32_16x16x32_bf16 v[156:159], a[80:83], a[28:31], v[156:159]
    buffer_load_dwordx4 v46, s[44:47], s38 offen offset:2048 lds
    v_mfma_f32_16x16x32_bf16 v[160:163], a[84:87], a[16:19], v[160:163]
    s_waitcnt lgkmcnt(0)
    ds_read_b64_tr_b16 a[92:93], v92 offset:0
    v_mfma_f32_16x16x32_bf16 v[164:167], a[84:87], a[20:23], v[164:167]
    buffer_load_dwordx4 v47, s[44:47], s38 offen offset:3072 lds
    v_mfma_f32_16x16x32_bf16 v[168:171], a[84:87], a[24:27], v[168:171]
    s_add_u32 m0, s59, 103936
    ds_read_b64_tr_b16 a[94:95], v92 offset:14336
    v_mfma_f32_16x16x32_bf16 v[172:175], a[84:87], a[28:31], v[172:175]
    s_add_u32 s38, s39, 204800
    v_mfma_f32_16x16x32_bf16 v[176:179], a[88:91], a[16:19], v[176:179]
    buffer_load_dwordx4 v28, s[44:47], s38 offen offset:0 lds
    v_mfma_f32_16x16x32_bf16 v[180:183], a[88:91], a[20:23], v[180:183]
    ds_read_b64_tr_b16 a[64:65], v93 offset:0
    v_mfma_f32_16x16x32_bf16 v[184:187], a[88:91], a[24:27], v[184:187]
    buffer_load_dwordx4 v29, s[44:47], s38 offen offset:1024 lds
    v_mfma_f32_16x16x32_bf16 v[188:191], a[88:91], a[28:31], v[188:191]
    s_waitcnt lgkmcnt(1)
    ds_read_b64_tr_b16 a[66:67], v93 offset:14336
    v_mfma_f32_16x16x32_bf16 v[192:195], a[92:95], a[16:19], v[192:195]
    buffer_load_dwordx4 v95, s[44:47], s38 offen offset:2048 lds
    v_mfma_f32_16x16x32_bf16 v[196:199], a[92:95], a[20:23], v[196:199]
    ds_read_b64_tr_b16 a[68:69], v94 offset:0
    v_mfma_f32_16x16x32_bf16 v[200:203], a[92:95], a[24:27], v[200:203]
    s_waitcnt lgkmcnt(1)
    ds_read_b64_tr_b16 a[70:71], v94 offset:14336
    v_mfma_f32_16x16x32_bf16 v[204:207], a[92:95], a[28:31], v[204:207]
    s_waitcnt vmcnt(8)
    s_barrier
    v_mfma_f32_16x16x32_bf16 v[208:211], a[64:67], a[16:19], v[208:211]
    ds_read_b128 a[0:3], v6 offset:24576
    ds_read_b128 a[4:7], v6 offset:25600
    v_mfma_f32_16x16x32_bf16 v[212:215], a[64:67], a[20:23], v[212:215]
    ds_read_b128 a[8:11], v6 offset:26624
    v_mfma_f32_16x16x32_bf16 v[216:219], a[64:67], a[24:27], v[216:219]
    ds_read_b64_tr_b16 a[72:73], v21 offset:0
    ds_read_b128 a[12:15], v6 offset:27648
    v_mfma_f32_16x16x32_bf16 v[220:223], a[64:67], a[28:31], v[220:223]
    s_waitcnt lgkmcnt(5)
    ds_read_b64_tr_b16 a[74:75], v21 offset:14336
    v_mfma_f32_16x16x32_bf16 v[224:227], a[68:71], a[16:19], v[224:227]
    ds_read_b64_tr_b16 a[76:77], v22 offset:0
    v_mfma_f32_16x16x32_bf16 v[228:231], a[68:71], a[20:23], v[228:231]
    ds_read_b64_tr_b16 a[78:79], v22 offset:14336
    v_mfma_f32_16x16x32_bf16 v[232:235], a[68:71], a[24:27], v[232:235]
    v_mfma_f32_16x16x32_bf16 v[236:239], a[68:71], a[28:31], v[236:239]
    s_waitcnt lgkmcnt(2)
    v_mfma_f32_16x16x32_bf16 v[128:131], a[72:75], a[0:3], v[128:131]
    s_barrier
    v_mfma_f32_16x16x32_bf16 v[132:135], a[72:75], a[4:7], v[132:135]
    s_add_u32 m0, s59, 0
    ds_read_b64_tr_b16 a[80:81], v23 offset:0
    v_mfma_f32_16x16x32_bf16 v[136:139], a[72:75], a[8:11], v[136:139]
    s_add_u32 s38, s39, 229376
    ds_read_b64_tr_b16 a[82:83], v23 offset:14336
    v_mfma_f32_16x16x32_bf16 v[140:143], a[72:75], a[12:15], v[140:143]
    buffer_load_dwordx4 v44, s[44:47], s38 offen offset:0 lds
    s_waitcnt lgkmcnt(2)
    v_mfma_f32_16x16x32_bf16 v[144:147], a[76:79], a[0:3], v[144:147]
    ds_read_b64_tr_b16 a[84:85], v24 offset:0
    v_mfma_f32_16x16x32_bf16 v[148:151], a[76:79], a[4:7], v[148:151]
    buffer_load_dwordx4 v45, s[44:47], s38 offen offset:1024 lds
    v_mfma_f32_16x16x32_bf16 v[152:155], a[76:79], a[8:11], v[152:155]
    s_waitcnt lgkmcnt(1)
    ds_read_b64_tr_b16 a[86:87], v24 offset:14336
    v_mfma_f32_16x16x32_bf16 v[156:159], a[76:79], a[12:15], v[156:159]
    buffer_load_dwordx4 v46, s[44:47], s38 offen offset:2048 lds
    v_mfma_f32_16x16x32_bf16 v[160:163], a[80:83], a[0:3], v[160:163]
    s_waitcnt lgkmcnt(0)
    ds_read_b64_tr_b16 a[88:89], v25 offset:0
    v_mfma_f32_16x16x32_bf16 v[164:167], a[80:83], a[4:7], v[164:167]
    buffer_load_dwordx4 v47, s[44:47], s38 offen offset:3072 lds
    v_mfma_f32_16x16x32_bf16 v[168:171], a[80:83], a[8:11], v[168:171]
    s_add_u32 m0, s59, 4096
    ds_read_b64_tr_b16 a[90:91], v25 offset:14336
    v_mfma_f32_16x16x32_bf16 v[172:175], a[80:83], a[12:15], v[172:175]
    s_add_u32 s38, s39, 233472
    v_mfma_f32_16x16x32_bf16 v[176:179], a[84:87], a[0:3], v[176:179]
    buffer_load_dwordx4 v28, s[44:47], s38 offen offset:0 lds
    v_mfma_f32_16x16x32_bf16 v[180:183], a[84:87], a[4:7], v[180:183]
    ds_read_b64_tr_b16 a[92:93], v26 offset:0
    v_mfma_f32_16x16x32_bf16 v[184:187], a[84:87], a[8:11], v[184:187]
    buffer_load_dwordx4 v29, s[44:47], s38 offen offset:1024 lds
    v_mfma_f32_16x16x32_bf16 v[188:191], a[84:87], a[12:15], v[188:191]
    s_waitcnt lgkmcnt(1)
    ds_read_b64_tr_b16 a[94:95], v26 offset:14336
    v_mfma_f32_16x16x32_bf16 v[192:195], a[88:91], a[0:3], v[192:195]
    buffer_load_dwordx4 v95, s[44:47], s38 offen offset:2048 lds
    v_mfma_f32_16x16x32_bf16 v[196:199], a[88:91], a[4:7], v[196:199]
    ds_read_b64_tr_b16 a[64:65], v27 offset:0
    v_mfma_f32_16x16x32_bf16 v[200:203], a[88:91], a[8:11], v[200:203]
    s_waitcnt lgkmcnt(1)
    ds_read_b64_tr_b16 a[66:67], v27 offset:14336
    v_mfma_f32_16x16x32_bf16 v[204:207], a[88:91], a[12:15], v[204:207]
    s_waitcnt vmcnt(7)
    s_barrier
    v_mfma_f32_16x16x32_bf16 v[208:211], a[92:95], a[0:3], v[208:211]
    ds_read_b128 a[16:19], v6 offset:28672
    ds_read_b128 a[20:23], v6 offset:29696
    v_mfma_f32_16x16x32_bf16 v[212:215], a[92:95], a[4:7], v[212:215]
    ds_read_b128 a[24:27], v6 offset:30720
    v_mfma_f32_16x16x32_bf16 v[216:219], a[92:95], a[8:11], v[216:219]
    ds_read_b64_tr_b16 a[68:69], v21 offset:33280
    ds_read_b128 a[28:31], v6 offset:31744
    v_mfma_f32_16x16x32_bf16 v[220:223], a[92:95], a[12:15], v[220:223]
    s_waitcnt lgkmcnt(5)
    ds_read_b64_tr_b16 a[70:71], v21 offset:47616
    v_mfma_f32_16x16x32_bf16 v[224:227], a[64:67], a[0:3], v[224:227]
    ds_read_b64_tr_b16 a[72:73], v22 offset:33280
    v_mfma_f32_16x16x32_bf16 v[228:231], a[64:67], a[4:7], v[228:231]
    ds_read_b64_tr_b16 a[74:75], v22 offset:47616
    v_mfma_f32_16x16x32_bf16 v[232:235], a[64:67], a[8:11], v[232:235]
    v_mfma_f32_16x16x32_bf16 v[236:239], a[64:67], a[12:15], v[236:239]
    s_waitcnt lgkmcnt(2)
    v_mfma_f32_16x16x32_bf16 v[128:131], a[68:71], a[16:19], v[128:131]
    s_barrier
    v_mfma_f32_16x16x32_bf16 v[132:135], a[68:71], a[20:23], v[132:135]
    s_add_u32 m0, s59, 66560
    ds_read_b64_tr_b16 a[76:77], v23 offset:33280
    v_mfma_f32_16x16x32_bf16 v[136:139], a[68:71], a[24:27], v[136:139]
    s_add_u32 s38, s39, 258048
    ds_read_b64_tr_b16 a[78:79], v23 offset:47616
    v_mfma_f32_16x16x32_bf16 v[140:143], a[68:71], a[28:31], v[140:143]
    buffer_load_dwordx4 v44, s[44:47], s38 offen offset:0 lds
    s_waitcnt lgkmcnt(2)
    v_mfma_f32_16x16x32_bf16 v[144:147], a[72:75], a[16:19], v[144:147]
    ds_read_b64_tr_b16 a[80:81], v24 offset:33280
    v_mfma_f32_16x16x32_bf16 v[148:151], a[72:75], a[20:23], v[148:151]
    buffer_load_dwordx4 v45, s[44:47], s38 offen offset:1024 lds
    v_mfma_f32_16x16x32_bf16 v[152:155], a[72:75], a[24:27], v[152:155]
    s_waitcnt lgkmcnt(1)
    ds_read_b64_tr_b16 a[82:83], v24 offset:47616
    v_mfma_f32_16x16x32_bf16 v[156:159], a[72:75], a[28:31], v[156:159]
    buffer_load_dwordx4 v46, s[44:47], s38 offen offset:2048 lds
    v_mfma_f32_16x16x32_bf16 v[160:163], a[76:79], a[16:19], v[160:163]
    s_waitcnt lgkmcnt(0)
    ds_read_b64_tr_b16 a[84:85], v25 offset:33280
    v_mfma_f32_16x16x32_bf16 v[164:167], a[76:79], a[20:23], v[164:167]
    buffer_load_dwordx4 v47, s[44:47], s38 offen offset:3072 lds
    v_mfma_f32_16x16x32_bf16 v[168:171], a[76:79], a[24:27], v[168:171]
    s_add_u32 m0, s59, 70656
    ds_read_b64_tr_b16 a[86:87], v25 offset:47616
    v_mfma_f32_16x16x32_bf16 v[172:175], a[76:79], a[28:31], v[172:175]
    s_add_u32 s38, s39, 262144
    v_mfma_f32_16x16x32_bf16 v[176:179], a[80:83], a[16:19], v[176:179]
    buffer_load_dwordx4 v28, s[44:47], s38 offen offset:0 lds
    v_mfma_f32_16x16x32_bf16 v[180:183], a[80:83], a[20:23], v[180:183]
    ds_read_b64_tr_b16 a[88:89], v26 offset:33280
    v_mfma_f32_16x16x32_bf16 v[184:187], a[80:83], a[24:27], v[184:187]
    buffer_load_dwordx4 v29, s[44:47], s38 offen offset:1024 lds
    v_mfma_f32_16x16x32_bf16 v[188:191], a[80:83], a[28:31], v[188:191]
    s_waitcnt lgkmcnt(1)
    ds_read_b64_tr_b16 a[90:91], v26 offset:47616
    v_mfma_f32_16x16x32_bf16 v[192:195], a[84:87], a[16:19], v[192:195]
    buffer_load_dwordx4 v95, s[44:47], s38 offen offset:2048 lds
    v_mfma_f32_16x16x32_bf16 v[196:199], a[84:87], a[20:23], v[196:199]
    ds_read_b64_tr_b16 a[92:93], v27 offset:33280
    v_mfma_f32_16x16x32_bf16 v[200:203], a[84:87], a[24:27], v[200:203]
    s_waitcnt lgkmcnt(1)
    ds_read_b64_tr_b16 a[94:95], v27 offset:47616
    v_mfma_f32_16x16x32_bf16 v[204:207], a[84:87], a[28:31], v[204:207]
    s_waitcnt vmcnt(7)
    s_barrier
    v_mfma_f32_16x16x32_bf16 v[208:211], a[88:91], a[16:19], v[208:211]
    ds_read_b128 a[0:3], v6 offset:32768
    ds_read_b128 a[4:7], v6 offset:33792
    v_mfma_f32_16x16x32_bf16 v[212:215], a[88:91], a[20:23], v[212:215]
    ds_read_b128 a[8:11], v6 offset:34816
    v_mfma_f32_16x16x32_bf16 v[216:219], a[88:91], a[24:27], v[216:219]
    ds_read_b64_tr_b16 a[64:65], v88 offset:0
    ds_read_b128 a[12:15], v6 offset:35840
    v_mfma_f32_16x16x32_bf16 v[220:223], a[88:91], a[28:31], v[220:223]
    s_waitcnt lgkmcnt(5)
    ds_read_b64_tr_b16 a[66:67], v88 offset:14336
    v_mfma_f32_16x16x32_bf16 v[224:227], a[92:95], a[16:19], v[224:227]
    ds_read_b64_tr_b16 a[68:69], v89 offset:0
    v_mfma_f32_16x16x32_bf16 v[228:231], a[92:95], a[20:23], v[228:231]
    ds_read_b64_tr_b16 a[70:71], v89 offset:14336
    v_mfma_f32_16x16x32_bf16 v[232:235], a[92:95], a[24:27], v[232:235]
    v_mfma_f32_16x16x32_bf16 v[236:239], a[92:95], a[28:31], v[236:239]
    s_waitcnt lgkmcnt(2)
    v_mfma_f32_16x16x32_bf16 v[128:131], a[64:67], a[0:3], v[128:131]
    s_barrier
    v_mfma_f32_16x16x32_bf16 v[132:135], a[64:67], a[4:7], v[132:135]
    s_add_u32 m0, s59, 99840
    ds_read_b64_tr_b16 a[72:73], v90 offset:0
    v_mfma_f32_16x16x32_bf16 v[136:139], a[64:67], a[8:11], v[136:139]
    s_add_u32 s38, s39, 286720
    ds_read_b64_tr_b16 a[74:75], v90 offset:14336
    v_mfma_f32_16x16x32_bf16 v[140:143], a[64:67], a[12:15], v[140:143]
    buffer_load_dwordx4 v44, s[44:47], s38 offen offset:0 lds
    s_waitcnt lgkmcnt(2)
    v_mfma_f32_16x16x32_bf16 v[144:147], a[68:71], a[0:3], v[144:147]
    ds_read_b64_tr_b16 a[76:77], v91 offset:0
    v_mfma_f32_16x16x32_bf16 v[148:151], a[68:71], a[4:7], v[148:151]
    buffer_load_dwordx4 v45, s[44:47], s38 offen offset:1024 lds
    v_mfma_f32_16x16x32_bf16 v[152:155], a[68:71], a[8:11], v[152:155]
    s_waitcnt lgkmcnt(1)
    ds_read_b64_tr_b16 a[78:79], v91 offset:14336
    v_mfma_f32_16x16x32_bf16 v[156:159], a[68:71], a[12:15], v[156:159]
    buffer_load_dwordx4 v46, s[44:47], s38 offen offset:2048 lds
    v_mfma_f32_16x16x32_bf16 v[160:163], a[72:75], a[0:3], v[160:163]
    s_waitcnt lgkmcnt(0)
    ds_read_b64_tr_b16 a[80:81], v92 offset:0
    v_mfma_f32_16x16x32_bf16 v[164:167], a[72:75], a[4:7], v[164:167]
    buffer_load_dwordx4 v47, s[44:47], s38 offen offset:3072 lds
    v_mfma_f32_16x16x32_bf16 v[168:171], a[72:75], a[8:11], v[168:171]
    s_add_u32 m0, s59, 103936
    ds_read_b64_tr_b16 a[82:83], v92 offset:14336
    v_mfma_f32_16x16x32_bf16 v[172:175], a[72:75], a[12:15], v[172:175]
    s_add_u32 s38, s39, 290816
    v_mfma_f32_16x16x32_bf16 v[176:179], a[76:79], a[0:3], v[176:179]
    buffer_load_dwordx4 v28, s[44:47], s38 offen offset:0 lds
    v_mfma_f32_16x16x32_bf16 v[180:183], a[76:79], a[4:7], v[180:183]
    ds_read_b64_tr_b16 a[84:85], v93 offset:0
    v_mfma_f32_16x16x32_bf16 v[184:187], a[76:79], a[8:11], v[184:187]
    buffer_load_dwordx4 v29, s[44:47], s38 offen offset:1024 lds
    v_mfma_f32_16x16x32_bf16 v[188:191], a[76:79], a[12:15], v[188:191]
    s_waitcnt lgkmcnt(1)
    ds_read_b64_tr_b16 a[86:87], v93 offset:14336
    v_mfma_f32_16x16x32_bf16 v[192:195], a[80:83], a[0:3], v[192:195]
    buffer_load_dwordx4 v95, s[44:47], s38 offen offset:2048 lds
    v_mfma_f32_16x16x32_bf16 v[196:199], a[80:83], a[4:7], v[196:199]
    ds_read_b64_tr_b16 a[88:89], v94 offset:0
    v_mfma_f32_16x16x32_bf16 v[200:203], a[80:83], a[8:11], v[200:203]
    s_waitcnt lgkmcnt(1)
    ds_read_b64_tr_b16 a[90:91], v94 offset:14336
    v_mfma_f32_16x16x32_bf16 v[204:207], a[80:83], a[12:15], v[204:207]
    s_waitcnt vmcnt(7)
    s_barrier
    v_mfma_f32_16x16x32_bf16 v[208:211], a[84:87], a[0:3], v[208:211]
    ds_read_b128 a[16:19], v7 offset:0
    ds_read_b128 a[20:23], v7 offset:1024
    v_mfma_f32_16x16x32_bf16 v[212:215], a[84:87], a[4:7], v[212:215]
    ds_read_b128 a[24:27], v7 offset:2048
    v_mfma_f32_16x16x32_bf16 v[216:219], a[84:87], a[8:11], v[216:219]
    ds_read_b64_tr_b16 a[92:93], v21 offset:0
    ds_read_b128 a[28:31], v7 offset:3072
    v_mfma_f32_16x16x32_bf16 v[220:223], a[84:87], a[12:15], v[220:223]
    s_waitcnt lgkmcnt(5)
    ds_read_b64_tr_b16 a[94:95], v21 offset:14336
    v_mfma_f32_16x16x32_bf16 v[224:227], a[88:91], a[0:3], v[224:227]
    ds_read_b64_tr_b16 a[64:65], v22 offset:0
    v_mfma_f32_16x16x32_bf16 v[228:231], a[88:91], a[4:7], v[228:231]
    ds_read_b64_tr_b16 a[66:67], v22 offset:14336
    v_mfma_f32_16x16x32_bf16 v[232:235], a[88:91], a[8:11], v[232:235]
    v_mfma_f32_16x16x32_bf16 v[236:239], a[88:91], a[12:15], v[236:239]
    s_waitcnt lgkmcnt(2)
    v_mfma_f32_16x16x32_bf16 v[128:131], a[92:95], a[16:19], v[128:131]
    s_barrier
    v_mfma_f32_16x16x32_bf16 v[132:135], a[92:95], a[20:23], v[132:135]
    s_add_u32 m0, s59, 0
    ds_read_b64_tr_b16 a[68:69], v23 offset:0
    v_mfma_f32_16x16x32_bf16 v[136:139], a[92:95], a[24:27], v[136:139]
    s_add_u32 s38, s39, 315392
    ds_read_b64_tr_b16 a[70:71], v23 offset:14336
    v_mfma_f32_16x16x32_bf16 v[140:143], a[92:95], a[28:31], v[140:143]
    buffer_load_dwordx4 v44, s[44:47], s38 offen offset:0 lds
    s_waitcnt lgkmcnt(2)
    v_mfma_f32_16x16x32_bf16 v[144:147], a[64:67], a[16:19], v[144:147]
    ds_read_b64_tr_b16 a[72:73], v24 offset:0
    v_mfma_f32_16x16x32_bf16 v[148:151], a[64:67], a[20:23], v[148:151]
    buffer_load_dwordx4 v45, s[44:47], s38 offen offset:1024 lds
    v_mfma_f32_16x16x32_bf16 v[152:155], a[64:67], a[24:27], v[152:155]
    s_waitcnt lgkmcnt(1)
    ds_read_b64_tr_b16 a[74:75], v24 offset:14336
    v_mfma_f32_16x16x32_bf16 v[156:159], a[64:67], a[28:31], v[156:159]
    buffer_load_dwordx4 v46, s[44:47], s38 offen offset:2048 lds
    v_mfma_f32_16x16x32_bf16 v[160:163], a[68:71], a[16:19], v[160:163]
    s_waitcnt lgkmcnt(0)
    ds_read_b64_tr_b16 a[76:77], v25 offset:0
    v_mfma_f32_16x16x32_bf16 v[164:167], a[68:71], a[20:23], v[164:167]
    buffer_load_dwordx4 v47, s[44:47], s38 offen offset:3072 lds
    v_mfma_f32_16x16x32_bf16 v[168:171], a[68:71], a[24:27], v[168:171]
    s_add_u32 m0, s59, 4096
    ds_read_b64_tr_b16 a[78:79], v25 offset:14336
    v_mfma_f32_16x16x32_bf16 v[172:175], a[68:71], a[28:31], v[172:175]
    s_add_u32 s38, s39, 319488
    v_mfma_f32_16x16x32_bf16 v[176:179], a[72:75], a[16:19], v[176:179]
    buffer_load_dwordx4 v28, s[44:47], s38 offen offset:0 lds
    v_mfma_f32_16x16x32_bf16 v[180:183], a[72:75], a[20:23], v[180:183]
    ds_read_b64_tr_b16 a[80:81], v26 offset:0
    v_mfma_f32_16x16x32_bf16 v[184:187], a[72:75], a[24:27], v[184:187]
    buffer_load_dwordx4 v29, s[44:47], s38 offen offset:1024 lds
    v_mfma_f32_16x16x32_bf16 v[188:191], a[72:75], a[28:31], v[188:191]
    s_waitcnt lgkmcnt(1)
    ds_read_b64_tr_b16 a[82:83], v26 offset:14336
    v_mfma_f32_16x16x32_bf16 v[192:195], a[76:79], a[16:19], v[192:195]
    buffer_load_dwordx4 v95, s[44:47], s38 offen offset:2048 lds
    v_mfma_f32_16x16x32_bf16 v[196:199], a[76:79], a[20:23], v[196:199]
    ds_read_b64_tr_b16 a[84:85], v27 offset:0
    v_mfma_f32_16x16x32_bf16 v[200:203], a[76:79], a[24:27], v[200:203]
    s_waitcnt lgkmcnt(1)
    ds_read_b64_tr_b16 a[86:87], v27 offset:14336
    v_mfma_f32_16x16x32_bf16 v[204:207], a[76:79], a[28:31], v[204:207]
    s_waitcnt vmcnt(7)
    s_barrier
    v_mfma_f32_16x16x32_bf16 v[208:211], a[80:83], a[16:19], v[208:211]
    ds_read_b128 a[0:3], v7 offset:4096
    ds_read_b128 a[4:7], v7 offset:5120
    v_mfma_f32_16x16x32_bf16 v[212:215], a[80:83], a[20:23], v[212:215]
    ds_read_b128 a[8:11], v7 offset:6144
    v_mfma_f32_16x16x32_bf16 v[216:219], a[80:83], a[24:27], v[216:219]
    ds_read_b64_tr_b16 a[88:89], v21 offset:33280
    ds_read_b128 a[12:15], v7 offset:7168
    v_mfma_f32_16x16x32_bf16 v[220:223], a[80:83], a[28:31], v[220:223]
    s_waitcnt lgkmcnt(5)
    ds_read_b64_tr_b16 a[90:91], v21 offset:47616
    v_mfma_f32_16x16x32_bf16 v[224:227], a[84:87], a[16:19], v[224:227]
    ds_read_b64_tr_b16 a[92:93], v22 offset:33280
    v_mfma_f32_16x16x32_bf16 v[228:231], a[84:87], a[20:23], v[228:231]
    ds_read_b64_tr_b16 a[94:95], v22 offset:47616
    v_mfma_f32_16x16x32_bf16 v[232:235], a[84:87], a[24:27], v[232:235]
    v_mfma_f32_16x16x32_bf16 v[236:239], a[84:87], a[28:31], v[236:239]
    s_waitcnt lgkmcnt(2)
    v_mfma_f32_16x16x32_bf16 v[128:131], a[88:91], a[0:3], v[128:131]
    s_barrier
    v_mfma_f32_16x16x32_bf16 v[132:135], a[88:91], a[4:7], v[132:135]
    s_add_u32 m0, s59, 66560
    ds_read_b64_tr_b16 a[64:65], v23 offset:33280
    v_mfma_f32_16x16x32_bf16 v[136:139], a[88:91], a[8:11], v[136:139]
    s_add_u32 s38, s39, 344064
    ds_read_b64_tr_b16 a[66:67], v23 offset:47616
    v_mfma_f32_16x16x32_bf16 v[140:143], a[88:91], a[12:15], v[140:143]
    buffer_load_dwordx4 v44, s[44:47], s38 offen offset:0 lds
    s_waitcnt lgkmcnt(2)
    v_mfma_f32_16x16x32_bf16 v[144:147], a[92:95], a[0:3], v[144:147]
    ds_read_b64_tr_b16 a[68:69], v24 offset:33280
    v_mfma_f32_16x16x32_bf16 v[148:151], a[92:95], a[4:7], v[148:151]
    buffer_load_dwordx4 v45, s[44:47], s38 offen offset:1024 lds
    v_mfma_f32_16x16x32_bf16 v[152:155], a[92:95], a[8:11], v[152:155]
    s_waitcnt lgkmcnt(1)
    ds_read_b64_tr_b16 a[70:71], v24 offset:47616
    v_mfma_f32_16x16x32_bf16 v[156:159], a[92:95], a[12:15], v[156:159]
    buffer_load_dwordx4 v46, s[44:47], s38 offen offset:2048 lds
    v_mfma_f32_16x16x32_bf16 v[160:163], a[64:67], a[0:3], v[160:163]
    s_waitcnt lgkmcnt(0)
    ds_read_b64_tr_b16 a[72:73], v25 offset:33280
    v_mfma_f32_16x16x32_bf16 v[164:167], a[64:67], a[4:7], v[164:167]
    buffer_load_dwordx4 v47, s[44:47], s38 offen offset:3072 lds
    v_mfma_f32_16x16x32_bf16 v[168:171], a[64:67], a[8:11], v[168:171]
    s_add_u32 m0, s59, 70656
    ds_read_b64_tr_b16 a[74:75], v25 offset:47616
    v_mfma_f32_16x16x32_bf16 v[172:175], a[64:67], a[12:15], v[172:175]
    s_add_u32 s38, s39, 348160
    v_mfma_f32_16x16x32_bf16 v[176:179], a[68:71], a[0:3], v[176:179]
    buffer_load_dwordx4 v28, s[44:47], s38 offen offset:0 lds
    v_mfma_f32_16x16x32_bf16 v[180:183], a[68:71], a[4:7], v[180:183]
    ds_read_b64_tr_b16 a[76:77], v26 offset:33280
    v_mfma_f32_16x16x32_bf16 v[184:187], a[68:71], a[8:11], v[184:187]
    buffer_load_dwordx4 v29, s[44:47], s38 offen offset:1024 lds
    v_mfma_f32_16x16x32_bf16 v[188:191], a[68:71], a[12:15], v[188:191]
    s_waitcnt lgkmcnt(1)
    ds_read_b64_tr_b16 a[78:79], v26 offset:47616
    v_mfma_f32_16x16x32_bf16 v[192:195], a[72:75], a[0:3], v[192:195]
    buffer_load_dwordx4 v95, s[44:47], s38 offen offset:2048 lds
    v_mfma_f32_16x16x32_bf16 v[196:199], a[72:75], a[4:7], v[196:199]
    ds_read_b64_tr_b16 a[80:81], v27 offset:33280
    v_mfma_f32_16x16x32_bf16 v[200:203], a[72:75], a[8:11], v[200:203]
    s_waitcnt lgkmcnt(1)
    ds_read_b64_tr_b16 a[82:83], v27 offset:47616
    v_mfma_f32_16x16x32_bf16 v[204:207], a[72:75], a[12:15], v[204:207]
    s_waitcnt vmcnt(7)
    s_barrier
    v_mfma_f32_16x16x32_bf16 v[208:211], a[76:79], a[0:3], v[208:211]
    ds_read_b128 a[16:19], v7 offset:8192
    ds_read_b128 a[20:23], v7 offset:9216
    v_mfma_f32_16x16x32_bf16 v[212:215], a[76:79], a[4:7], v[212:215]
    ds_read_b128 a[24:27], v7 offset:10240
    v_mfma_f32_16x16x32_bf16 v[216:219], a[76:79], a[8:11], v[216:219]
    ds_read_b64_tr_b16 a[84:85], v88 offset:0
    ds_read_b128 a[28:31], v7 offset:11264
    v_mfma_f32_16x16x32_bf16 v[220:223], a[76:79], a[12:15], v[220:223]
    s_waitcnt lgkmcnt(5)
    ds_read_b64_tr_b16 a[86:87], v88 offset:14336
    v_mfma_f32_16x16x32_bf16 v[224:227], a[80:83], a[0:3], v[224:227]
    ds_read_b64_tr_b16 a[88:89], v89 offset:0
    v_mfma_f32_16x16x32_bf16 v[228:231], a[80:83], a[4:7], v[228:231]
    ds_read_b64_tr_b16 a[90:91], v89 offset:14336
    v_mfma_f32_16x16x32_bf16 v[232:235], a[80:83], a[8:11], v[232:235]
    v_mfma_f32_16x16x32_bf16 v[236:239], a[80:83], a[12:15], v[236:239]
    s_waitcnt lgkmcnt(2)
    v_mfma_f32_16x16x32_bf16 v[128:131], a[84:87], a[16:19], v[128:131]
    s_barrier
    v_mfma_f32_16x16x32_bf16 v[132:135], a[84:87], a[20:23], v[132:135]
    s_add_u32 m0, s59, 99840
    ds_read_b64_tr_b16 a[92:93], v90 offset:0
    v_mfma_f32_16x16x32_bf16 v[136:139], a[84:87], a[24:27], v[136:139]
    s_add_u32 s38, s39, 372736
    ds_read_b64_tr_b16 a[94:95], v90 offset:14336
    v_mfma_f32_16x16x32_bf16 v[140:143], a[84:87], a[28:31], v[140:143]
    buffer_load_dwordx4 v44, s[44:47], s38 offen offset:0 lds
    s_waitcnt lgkmcnt(2)
    v_mfma_f32_16x16x32_bf16 v[144:147], a[88:91], a[16:19], v[144:147]
    ds_read_b64_tr_b16 a[64:65], v91 offset:0
    v_mfma_f32_16x16x32_bf16 v[148:151], a[88:91], a[20:23], v[148:151]
    buffer_load_dwordx4 v45, s[44:47], s38 offen offset:1024 lds
    v_mfma_f32_16x16x32_bf16 v[152:155], a[88:91], a[24:27], v[152:155]
    s_waitcnt lgkmcnt(1)
    ds_read_b64_tr_b16 a[66:67], v91 offset:14336
    v_mfma_f32_16x16x32_bf16 v[156:159], a[88:91], a[28:31], v[156:159]
    buffer_load_dwordx4 v46, s[44:47], s38 offen offset:2048 lds
    v_mfma_f32_16x16x32_bf16 v[160:163], a[92:95], a[16:19], v[160:163]
    s_waitcnt lgkmcnt(0)
    ds_read_b64_tr_b16 a[68:69], v92 offset:0
    v_mfma_f32_16x16x32_bf16 v[164:167], a[92:95], a[20:23], v[164:167]
    buffer_load_dwordx4 v47, s[44:47], s38 offen offset:3072 lds
    v_mfma_f32_16x16x32_bf16 v[168:171], a[92:95], a[24:27], v[168:171]
    s_add_u32 m0, s59, 103936
    ds_read_b64_tr_b16 a[70:71], v92 offset:14336
    v_mfma_f32_16x16x32_bf16 v[172:175], a[92:95], a[28:31], v[172:175]
    s_add_u32 s38, s39, 376832
    v_mfma_f32_16x16x32_bf16 v[176:179], a[64:67], a[16:19], v[176:179]
    buffer_load_dwordx4 v28, s[44:47], s38 offen offset:0 lds
    v_mfma_f32_16x16x32_bf16 v[180:183], a[64:67], a[20:23], v[180:183]
    ds_read_b64_tr_b16 a[72:73], v93 offset:0
    v_mfma_f32_16x16x32_bf16 v[184:187], a[64:67], a[24:27], v[184:187]
    buffer_load_dwordx4 v29, s[44:47], s38 offen offset:1024 lds
    v_mfma_f32_16x16x32_bf16 v[188:191], a[64:67], a[28:31], v[188:191]
    s_waitcnt lgkmcnt(1)
    ds_read_b64_tr_b16 a[74:75], v93 offset:14336
    v_mfma_f32_16x16x32_bf16 v[192:195], a[68:71], a[16:19], v[192:195]
    buffer_load_dwordx4 v95, s[44:47], s38 offen offset:2048 lds
    v_mfma_f32_16x16x32_bf16 v[196:199], a[68:71], a[20:23], v[196:199]
    ds_read_b64_tr_b16 a[76:77], v94 offset:0
    v_mfma_f32_16x16x32_bf16 v[200:203], a[68:71], a[24:27], v[200:203]
    s_waitcnt lgkmcnt(1)
    ds_read_b64_tr_b16 a[78:79], v94 offset:14336
    v_mfma_f32_16x16x32_bf16 v[204:207], a[68:71], a[28:31], v[204:207]
    s_waitcnt vmcnt(7)
    s_barrier
    v_mfma_f32_16x16x32_bf16 v[208:211], a[72:75], a[16:19], v[208:211]
    ds_read_b128 a[0:3], v7 offset:12288
    ds_read_b128 a[4:7], v7 offset:13312
    v_mfma_f32_16x16x32_bf16 v[212:215], a[72:75], a[20:23], v[212:215]
    ds_read_b128 a[8:11], v7 offset:14336
    v_mfma_f32_16x16x32_bf16 v[216:219], a[72:75], a[24:27], v[216:219]
    ds_read_b64_tr_b16 a[80:81], v21 offset:0
    ds_read_b128 a[12:15], v7 offset:15360
    v_mfma_f32_16x16x32_bf16 v[220:223], a[72:75], a[28:31], v[220:223]
    s_waitcnt lgkmcnt(5)
    ds_read_b64_tr_b16 a[82:83], v21 offset:14336
    v_mfma_f32_16x16x32_bf16 v[224:227], a[76:79], a[16:19], v[224:227]
    ds_read_b64_tr_b16 a[84:85], v22 offset:0
    v_mfma_f32_16x16x32_bf16 v[228:231], a[76:79], a[20:23], v[228:231]
    ds_read_b64_tr_b16 a[86:87], v22 offset:14336
    v_mfma_f32_16x16x32_bf16 v[232:235], a[76:79], a[24:27], v[232:235]
    v_mfma_f32_16x16x32_bf16 v[236:239], a[76:79], a[28:31], v[236:239]
    s_waitcnt lgkmcnt(2)
    v_mfma_f32_16x16x32_bf16 v[128:131], a[80:83], a[0:3], v[128:131]
    s_barrier
    v_mfma_f32_16x16x32_bf16 v[132:135], a[80:83], a[4:7], v[132:135]
    s_add_u32 m0, s59, 0
    ds_read_b64_tr_b16 a[88:89], v23 offset:0
    v_mfma_f32_16x16x32_bf16 v[136:139], a[80:83], a[8:11], v[136:139]
    s_add_u32 s38, s39, 401408
    ds_read_b64_tr_b16 a[90:91], v23 offset:14336
    v_mfma_f32_16x16x32_bf16 v[140:143], a[80:83], a[12:15], v[140:143]
    buffer_load_dwordx4 v44, s[44:47], s38 offen offset:0 lds
    s_waitcnt lgkmcnt(2)
    v_mfma_f32_16x16x32_bf16 v[144:147], a[84:87], a[0:3], v[144:147]
    ds_read_b64_tr_b16 a[92:93], v24 offset:0
    v_mfma_f32_16x16x32_bf16 v[148:151], a[84:87], a[4:7], v[148:151]
    buffer_load_dwordx4 v45, s[44:47], s38 offen offset:1024 lds
    v_mfma_f32_16x16x32_bf16 v[152:155], a[84:87], a[8:11], v[152:155]
    s_waitcnt lgkmcnt(1)
    ds_read_b64_tr_b16 a[94:95], v24 offset:14336
    v_mfma_f32_16x16x32_bf16 v[156:159], a[84:87], a[12:15], v[156:159]
    buffer_load_dwordx4 v46, s[44:47], s38 offen offset:2048 lds
    v_mfma_f32_16x16x32_bf16 v[160:163], a[88:91], a[0:3], v[160:163]
    s_waitcnt lgkmcnt(0)
    ds_read_b64_tr_b16 a[64:65], v25 offset:0
    v_mfma_f32_16x16x32_bf16 v[164:167], a[88:91], a[4:7], v[164:167]
    buffer_load_dwordx4 v47, s[44:47], s38 offen offset:3072 lds
    v_mfma_f32_16x16x32_bf16 v[168:171], a[88:91], a[8:11], v[168:171]
    s_add_u32 m0, s59, 4096
    ds_read_b64_tr_b16 a[66:67], v25 offset:14336
    v_mfma_f32_16x16x32_bf16 v[172:175], a[88:91], a[12:15], v[172:175]
    s_add_u32 s38, s39, 405504
    v_mfma_f32_16x16x32_bf16 v[176:179], a[92:95], a[0:3], v[176:179]
    buffer_load_dwordx4 v28, s[44:47], s38 offen offset:0 lds
    v_mfma_f32_16x16x32_bf16 v[180:183], a[92:95], a[4:7], v[180:183]
    ds_read_b64_tr_b16 a[68:69], v26 offset:0
    v_mfma_f32_16x16x32_bf16 v[184:187], a[92:95], a[8:11], v[184:187]
    buffer_load_dwordx4 v29, s[44:47], s38 offen offset:1024 lds
    v_mfma_f32_16x16x32_bf16 v[188:191], a[92:95], a[12:15], v[188:191]
    s_waitcnt lgkmcnt(1)
    ds_read_b64_tr_b16 a[70:71], v26 offset:14336
    v_mfma_f32_16x16x32_bf16 v[192:195], a[64:67], a[0:3], v[192:195]
    buffer_load_dwordx4 v95, s[44:47], s38 offen offset:2048 lds
    v_mfma_f32_16x16x32_bf16 v[196:199], a[64:67], a[4:7], v[196:199]
    ds_read_b64_tr_b16 a[72:73], v27 offset:0
    v_mfma_f32_16x16x32_bf16 v[200:203], a[64:67], a[8:11], v[200:203]
    s_waitcnt lgkmcnt(1)
    ds_read_b64_tr_b16 a[74:75], v27 offset:14336
    v_mfma_f32_16x16x32_bf16 v[204:207], a[64:67], a[12:15], v[204:207]
    s_waitcnt vmcnt(7)
    s_barrier
    v_mfma_f32_16x16x32_bf16 v[208:211], a[68:71], a[0:3], v[208:211]
    ds_read_b128 a[16:19], v7 offset:16384
    ds_read_b128 a[20:23], v7 offset:17408
    v_mfma_f32_16x16x32_bf16 v[212:215], a[68:71], a[4:7], v[212:215]
    ds_read_b128 a[24:27], v7 offset:18432
    v_mfma_f32_16x16x32_bf16 v[216:219], a[68:71], a[8:11], v[216:219]
    ds_read_b64_tr_b16 a[76:77], v21 offset:33280
    ds_read_b128 a[28:31], v7 offset:19456
    v_mfma_f32_16x16x32_bf16 v[220:223], a[68:71], a[12:15], v[220:223]
    s_waitcnt lgkmcnt(5)
    ds_read_b64_tr_b16 a[78:79], v21 offset:47616
    v_mfma_f32_16x16x32_bf16 v[224:227], a[72:75], a[0:3], v[224:227]
    ds_read_b64_tr_b16 a[80:81], v22 offset:33280
    v_mfma_f32_16x16x32_bf16 v[228:231], a[72:75], a[4:7], v[228:231]
    ds_read_b64_tr_b16 a[82:83], v22 offset:47616
    v_mfma_f32_16x16x32_bf16 v[232:235], a[72:75], a[8:11], v[232:235]
    v_mfma_f32_16x16x32_bf16 v[236:239], a[72:75], a[12:15], v[236:239]
    s_waitcnt lgkmcnt(2)
    v_mfma_f32_16x16x32_bf16 v[128:131], a[76:79], a[16:19], v[128:131]
    s_barrier
    v_mfma_f32_16x16x32_bf16 v[132:135], a[76:79], a[20:23], v[132:135]
    s_add_u32 m0, s59, 66560
    ds_read_b64_tr_b16 a[84:85], v23 offset:33280
    v_mfma_f32_16x16x32_bf16 v[136:139], a[76:79], a[24:27], v[136:139]
    s_add_u32 s38, s39, 430080
    ds_read_b64_tr_b16 a[86:87], v23 offset:47616
    v_mfma_f32_16x16x32_bf16 v[140:143], a[76:79], a[28:31], v[140:143]
    buffer_load_dwordx4 v44, s[44:47], s38 offen offset:0 lds
    s_waitcnt lgkmcnt(2)
    v_mfma_f32_16x16x32_bf16 v[144:147], a[80:83], a[16:19], v[144:147]
    ds_read_b64_tr_b16 a[88:89], v24 offset:33280
    v_mfma_f32_16x16x32_bf16 v[148:151], a[80:83], a[20:23], v[148:151]
    buffer_load_dwordx4 v45, s[44:47], s38 offen offset:1024 lds
    v_mfma_f32_16x16x32_bf16 v[152:155], a[80:83], a[24:27], v[152:155]
    s_waitcnt lgkmcnt(1)
    ds_read_b64_tr_b16 a[90:91], v24 offset:47616
    v_mfma_f32_16x16x32_bf16 v[156:159], a[80:83], a[28:31], v[156:159]
    buffer_load_dwordx4 v46, s[44:47], s38 offen offset:2048 lds
    v_mfma_f32_16x16x32_bf16 v[160:163], a[84:87], a[16:19], v[160:163]
    s_waitcnt lgkmcnt(0)
    ds_read_b64_tr_b16 a[92:93], v25 offset:33280
    v_mfma_f32_16x16x32_bf16 v[164:167], a[84:87], a[20:23], v[164:167]
    buffer_load_dwordx4 v47, s[44:47], s38 offen offset:3072 lds
    v_mfma_f32_16x16x32_bf16 v[168:171], a[84:87], a[24:27], v[168:171]
    s_add_u32 m0, s59, 70656
    ds_read_b64_tr_b16 a[94:95], v25 offset:47616
    v_mfma_f32_16x16x32_bf16 v[172:175], a[84:87], a[28:31], v[172:175]
    s_add_u32 s38, s39, 434176
    v_mfma_f32_16x16x32_bf16 v[176:179], a[88:91], a[16:19], v[176:179]
    buffer_load_dwordx4 v28, s[44:47], s38 offen offset:0 lds
    v_mfma_f32_16x16x32_bf16 v[180:183], a[88:91], a[20:23], v[180:183]
    ds_read_b64_tr_b16 a[64:65], v26 offset:33280
    v_mfma_f32_16x16x32_bf16 v[184:187], a[88:91], a[24:27], v[184:187]
    buffer_load_dwordx4 v29, s[44:47], s38 offen offset:1024 lds
    v_mfma_f32_16x16x32_bf16 v[188:191], a[88:91], a[28:31], v[188:191]
    s_waitcnt lgkmcnt(1)
    ds_read_b64_tr_b16 a[66:67], v26 offset:47616
    v_mfma_f32_16x16x32_bf16 v[192:195], a[92:95], a[16:19], v[192:195]
    buffer_load_dwordx4 v95, s[44:47], s38 offen offset:2048 lds
    v_mfma_f32_16x16x32_bf16 v[196:199], a[92:95], a[20:23], v[196:199]
    ds_read_b64_tr_b16 a[68:69], v27 offset:33280
    v_mfma_f32_16x16x32_bf16 v[200:203], a[92:95], a[24:27], v[200:203]
    s_waitcnt lgkmcnt(1)
    ds_read_b64_tr_b16 a[70:71], v27 offset:47616
    v_mfma_f32_16x16x32_bf16 v[204:207], a[92:95], a[28:31], v[204:207]
    s_waitcnt vmcnt(7)
    s_barrier
    v_mfma_f32_16x16x32_bf16 v[208:211], a[64:67], a[16:19], v[208:211]
    ds_read_b128 a[0:3], v7 offset:20480
    ds_read_b128 a[4:7], v7 offset:21504
    v_mfma_f32_16x16x32_bf16 v[212:215], a[64:67], a[20:23], v[212:215]
    ds_read_b128 a[8:11], v7 offset:22528
    v_mfma_f32_16x16x32_bf16 v[216:219], a[64:67], a[24:27], v[216:219]
    ds_read_b64_tr_b16 a[72:73], v88 offset:0
    ds_read_b128 a[12:15], v7 offset:23552
    v_mfma_f32_16x16x32_bf16 v[220:223], a[64:67], a[28:31], v[220:223]
    s_waitcnt lgkmcnt(5)
    ds_read_b64_tr_b16 a[74:75], v88 offset:14336
    v_mfma_f32_16x16x32_bf16 v[224:227], a[68:71], a[16:19], v[224:227]
    ds_read_b64_tr_b16 a[76:77], v89 offset:0
    v_mfma_f32_16x16x32_bf16 v[228:231], a[68:71], a[20:23], v[228:231]
    ds_read_b64_tr_b16 a[78:79], v89 offset:14336
    v_mfma_f32_16x16x32_bf16 v[232:235], a[68:71], a[24:27], v[232:235]
    v_mfma_f32_16x16x32_bf16 v[236:239], a[68:71], a[28:31], v[236:239]
    s_waitcnt lgkmcnt(2)
    v_mfma_f32_16x16x32_bf16 v[128:131], a[72:75], a[0:3], v[128:131]
    s_barrier
    v_mfma_f32_16x16x32_bf16 v[132:135], a[72:75], a[4:7], v[132:135]
    s_waitcnt lgkmcnt(0)
    ds_read_b64_tr_b16 a[80:81], v90 offset:0
    v_mfma_f32_16x16x32_bf16 v[136:139], a[72:75], a[8:11], v[136:139]
    s_add_u32 m0, s36, 33280
    ds_read_b64_tr_b16 a[82:83], v90 offset:14336
    v_mfma_f32_16x16x32_bf16 v[140:143], a[72:75], a[12:15], v[140:143]
    buffer_load_dwordx4 v96, s[40:43], s37 offen offset:0 lds
    v_mfma_f32_16x16x32_bf16 v[144:147], a[76:79], a[0:3], v[144:147]
    ds_read_b64_tr_b16 a[84:85], v91 offset:0
    v_mfma_f32_16x16x32_bf16 v[148:151], a[76:79], a[4:7], v[148:151]
    buffer_load_dwordx4 v97, s[40:43], s37 offen offset:1024 lds
    v_mfma_f32_16x16x32_bf16 v[152:155], a[76:79], a[8:11], v[152:155]
    s_waitcnt lgkmcnt(1)
    ds_read_b64_tr_b16 a[86:87], v91 offset:14336
    v_mfma_f32_16x16x32_bf16 v[156:159], a[76:79], a[12:15], v[156:159]
    buffer_load_dwordx4 v98, s[40:43], s37 offen offset:2048 lds
    v_mfma_f32_16x16x32_bf16 v[160:163], a[80:83], a[0:3], v[160:163]
    ds_read_b64_tr_b16 a[88:89], v92 offset:0
    v_mfma_f32_16x16x32_bf16 v[164:167], a[80:83], a[4:7], v[164:167]
    buffer_load_dwordx4 v99, s[40:43], s37 offen offset:3072 lds
    v_mfma_f32_16x16x32_bf16 v[168:171], a[80:83], a[8:11], v[168:171]
    s_waitcnt lgkmcnt(1)
    ds_read_b64_tr_b16 a[90:91], v92 offset:14336
    v_mfma_f32_16x16x32_bf16 v[172:175], a[80:83], a[12:15], v[172:175]
    s_add_u32 m0, s36, 37376
    v_mfma_f32_16x16x32_bf16 v[176:179], a[84:87], a[0:3], v[176:179]
    buffer_load_dwordx4 v100, s[40:43], s37 offen offset:0 lds
    v_mfma_f32_16x16x32_bf16 v[180:183], a[84:87], a[4:7], v[180:183]
    ds_read_b64_tr_b16 a[92:93], v93 offset:0
    v_mfma_f32_16x16x32_bf16 v[184:187], a[84:87], a[8:11], v[184:187]
    buffer_load_dwordx4 v101, s[40:43], s37 offen offset:1024 lds
    v_mfma_f32_16x16x32_bf16 v[188:191], a[84:87], a[12:15], v[188:191]
    s_waitcnt lgkmcnt(1)
    ds_read_b64_tr_b16 a[94:95], v93 offset:14336
    v_mfma_f32_16x16x32_bf16 v[192:195], a[88:91], a[0:3], v[192:195]
    buffer_load_dwordx4 v102, s[40:43], s37 offen offset:2048 lds
    v_mfma_f32_16x16x32_bf16 v[196:199], a[88:91], a[4:7], v[196:199]
    s_add_u32 s37, s37, 458752
    ds_read_b64_tr_b16 a[64:65], v94 offset:0
    v_mfma_f32_16x16x32_bf16 v[200:203], a[88:91], a[8:11], v[200:203]
    s_waitcnt lgkmcnt(1)
    ds_read_b64_tr_b16 a[66:67], v94 offset:14336
    v_mfma_f32_16x16x32_bf16 v[204:207], a[88:91], a[12:15], v[204:207]
    s_waitcnt vmcnt(7)
    s_barrier
    v_mfma_f32_16x16x32_bf16 v[208:211], a[92:95], a[0:3], v[208:211]
    buffer_load_dword v15, v9, s[92:95], 0 offen sc1
    v_mfma_f32_16x16x32_bf16 v[212:215], a[92:95], a[4:7], v[212:215]
    ds_read_b128 a[16:19], v7 offset:24576
    ds_read_b128 a[20:23], v7 offset:25600
    v_mfma_f32_16x16x32_bf16 v[216:219], a[92:95], a[8:11], v[216:219]
    ds_read_b128 a[24:27], v7 offset:26624
    ds_read_b64_tr_b16 a[68:69], v21 offset:0
    v_mfma_f32_16x16x32_bf16 v[220:223], a[92:95], a[12:15], v[220:223]
    s_waitcnt lgkmcnt(4)
    ds_read_b128 a[28:31], v7 offset:27648
    ds_read_b64_tr_b16 a[70:71], v21 offset:14336
    v_mfma_f32_16x16x32_bf16 v[224:227], a[64:67], a[0:3], v[224:227]
    ds_read_b64_tr_b16 a[72:73], v22 offset:0
    v_mfma_f32_16x16x32_bf16 v[228:231], a[64:67], a[4:7], v[228:231]
    ds_read_b64_tr_b16 a[74:75], v22 offset:14336
    v_mfma_f32_16x16x32_bf16 v[232:235], a[64:67], a[8:11], v[232:235]
    v_mfma_f32_16x16x32_bf16 v[236:239], a[64:67], a[12:15], v[236:239]
    s_waitcnt lgkmcnt(2)
    v_mfma_f32_16x16x32_bf16 v[128:131], a[68:71], a[16:19], v[128:131]
    ds_read_b64_tr_b16 a[76:77], v23 offset:0
    v_mfma_f32_16x16x32_bf16 v[132:135], a[68:71], a[20:23], v[132:135]
    s_waitcnt lgkmcnt(1)
    ds_read_b64_tr_b16 a[78:79], v23 offset:14336
    v_mfma_f32_16x16x32_bf16 v[136:139], a[68:71], a[24:27], v[136:139]
    s_add_u32 m0, s36, 99840
    v_mfma_f32_16x16x32_bf16 v[140:143], a[68:71], a[28:31], v[140:143]
    buffer_load_dwordx4 v96, s[40:43], s37 offen offset:0 lds
    v_mfma_f32_16x16x32_bf16 v[144:147], a[72:75], a[16:19], v[144:147]
    ds_read_b64_tr_b16 a[80:81], v24 offset:0
    v_mfma_f32_16x16x32_bf16 v[148:151], a[72:75], a[20:23], v[148:151]
    buffer_load_dwordx4 v97, s[40:43], s37 offen offset:1024 lds
    v_mfma_f32_16x16x32_bf16 v[152:155], a[72:75], a[24:27], v[152:155]
    s_waitcnt lgkmcnt(1)
    ds_read_b64_tr_b16 a[82:83], v24 offset:14336
    v_mfma_f32_16x16x32_bf16 v[156:159], a[72:75], a[28:31], v[156:159]
    buffer_load_dwordx4 v98, s[40:43], s37 offen offset:2048 lds
    v_mfma_f32_16x16x32_bf16 v[160:163], a[76:79], a[16:19], v[160:163]
    ds_read_b64_tr_b16 a[84:85], v25 offset:0
    v_mfma_f32_16x16x32_bf16 v[164:167], a[76:79], a[20:23], v[164:167]
    buffer_load_dwordx4 v99, s[40:43], s37 offen offset:3072 lds
    v_mfma_f32_16x16x32_bf16 v[168:171], a[76:79], a[24:27], v[168:171]
    s_waitcnt lgkmcnt(1)
    ds_read_b64_tr_b16 a[86:87], v25 offset:14336
    v_mfma_f32_16x16x32_bf16 v[172:175], a[76:79], a[28:31], v[172:175]
    s_add_u32 m0, s36, 103936
    v_mfma_f32_16x16x32_bf16 v[176:179], a[80:83], a[16:19], v[176:179]
    buffer_load_dwordx4 v100, s[40:43], s37 offen offset:0 lds
    v_mfma_f32_16x16x32_bf16 v[180:183], a[80:83], a[20:23], v[180:183]
    ds_read_b64_tr_b16 a[88:89], v26 offset:0
    v_mfma_f32_16x16x32_bf16 v[184:187], a[80:83], a[24:27], v[184:187]
    buffer_load_dwordx4 v101, s[40:43], s37 offen offset:1024 lds
    v_mfma_f32_16x16x32_bf16 v[188:191], a[80:83], a[28:31], v[188:191]
    s_waitcnt lgkmcnt(1)
    ds_read_b64_tr_b16 a[90:91], v26 offset:14336
    v_mfma_f32_16x16x32_bf16 v[192:195], a[84:87], a[16:19], v[192:195]
    buffer_load_dwordx4 v102, s[40:43], s37 offen offset:2048 lds
    v_mfma_f32_16x16x32_bf16 v[196:199], a[84:87], a[20:23], v[196:199]
    s_add_u32 s37, s37, 458752
    ds_read_b64_tr_b16 a[92:93], v27 offset:0
    v_mfma_f32_16x16x32_bf16 v[200:203], a[84:87], a[24:27], v[200:203]
    ds_read_b64_tr_b16 a[94:95], v27 offset:14336
    v_mfma_f32_16x16x32_bf16 v[204:207], a[84:87], a[28:31], v[204:207]
    s_waitcnt lgkmcnt(2)
    v_mfma_f32_16x16x32_bf16 v[208:211], a[88:91], a[16:19], v[208:211]
    buffer_load_dword v14, v13, s[24:27], 0 offen sc1
    v_mfma_f32_16x16x32_bf16 v[212:215], a[88:91], a[20:23], v[212:215]
    v_mfma_f32_16x16x32_bf16 v[216:219], a[88:91], a[24:27], v[216:219]
    v_mfma_f32_16x16x32_bf16 v[220:223], a[88:91], a[28:31], v[220:223]
    s_waitcnt lgkmcnt(0)
    v_mfma_f32_16x16x32_bf16 v[224:227], a[92:95], a[16:19], v[224:227]
    v_mfma_f32_16x16x32_bf16 v[228:231], a[92:95], a[20:23], v[228:231]
    v_mfma_f32_16x16x32_bf16 v[232:235], a[92:95], a[24:27], v[232:235]
    v_mfma_f32_16x16x32_bf16 v[236:239], a[92:95], a[28:31], v[236:239]
    s_lshl_b32 s14, s29, 7
    s_lshl_b32 s15, s30, 2
    s_add_u32 s14, s14, s15
    s_mul_i32 s14, s14, 14336
    s_mul_i32 s15, s28, 7
    s_add_u32 s15, s15, 1
    s_lshr_b32 s15, s15, 1
    s_lshl_b32 s15, s15, 10
    s_add_u32 s14, s14, s15
    s_add_u32 s14, s14, 4194304
    s_and_b32 s50, s28, 1
    s_mul_i32 s15, s50, 24576
    s_add_u32 s15, s15, s14
    s_add_u32 s15, s15, 3072
    s_mul_i32 s51, s48, 33280
    s_add_u32 s51, s51, 95232
    s_lshl_b32 s52, s50, 3
    s_add_u32 s52, s52, s51
    v_add_u32 v4, s52, v12
    s_lshl_b32 s52, s50, 11
    s_add_u32 s52, s52, s51
    v_add_u32 v5, s52, v12
    v_cvt_pk_bf16_f32 v224, v224, v225
    v_cvt_pk_bf16_f32 v225, v226, v227
    ds_write_b64 v4, v[224:225] offset:0
    v_cvt_pk_bf16_f32 v228, v228, v229
    v_cvt_pk_bf16_f32 v229, v230, v231
    ds_write_b64 v4, v[228:229] offset:1024
    v_cvt_pk_bf16_f32 v232, v232, v233
    v_cvt_pk_bf16_f32 v233, v234, v235
    ds_write_b64 v4, v[232:233] offset:2048
    v_cvt_pk_bf16_f32 v236, v236, v237
    v_cvt_pk_bf16_f32 v237, v238, v239
    ds_write_b64 v4, v[236:237] offset:3072
    v_cvt_pk_bf16_f32 v128, v128, v129
    v_cvt_pk_bf16_f32 v129, v130, v131
    v_cvt_pk_bf16_f32 v130, v144, v145
    v_cvt_pk_bf16_f32 v131, v146, v147
    buffer_store_dwordx4 v[128:131], v12, s[24:27], s14 offen offset:0 sc1
    v_cvt_pk_bf16_f32 v160, v160, v161
    v_cvt_pk_bf16_f32 v161, v162, v163
    v_cvt_pk_bf16_f32 v162, v176, v177
    v_cvt_pk_bf16_f32 v163, v178, v179
    buffer_store_dwordx4 v[160:163], v12, s[24:27], s14 offen offset:1024 sc1
    v_cvt_pk_bf16_f32 v192, v192, v193
    v_cvt_pk_bf16_f32 v193, v194, v195
    v_cvt_pk_bf16_f32 v194, v208, v209
    v_cvt_pk_bf16_f32 v195, v210, v211
    buffer_store_dwordx4 v[192:195], v12, s[24:27], s14 offen offset:2048 sc1
    s_add_u32 s14, s14, 14336
    s_waitcnt lgkmcnt(0)
    s_barrier
    ds_read_b128 v[240:243], v5 offset:0
    ds_read_b128 v[244:247], v5 offset:1024
    v_cvt_pk_bf16_f32 v132, v132, v133
    v_cvt_pk_bf16_f32 v133, v134, v135
    v_cvt_pk_bf16_f32 v134, v148, v149
    v_cvt_pk_bf16_f32 v135, v150, v151
    buffer_store_dwordx4 v[132:135], v12, s[24:27], s14 offen offset:0 sc1
    v_cvt_pk_bf16_f32 v164, v164, v165
    v_cvt_pk_bf16_f32 v165, v166, v167
    v_cvt_pk_bf16_f32 v166, v180, v181
    v_cvt_pk_bf16_f32 v167, v182, v183
    buffer_store_dwordx4 v[164:167], v12, s[24:27], s14 offen offset:1024 sc1
    v_cvt_pk_bf16_f32 v196, v196, v197
    v_cvt_pk_bf16_f32 v197, v198, v199
    v_cvt_pk_bf16_f32 v198, v212, v213
    v_cvt_pk_bf16_f32 v199, v214, v215
    buffer_store_dwordx4 v[196:199], v12, s[24:27], s14 offen offset:2048 sc1
    s_add_u32 s14, s14, 14336
    v_cvt_pk_bf16_f32 v136, v136, v137
    v_cvt_pk_bf16_f32 v137, v138, v139
    v_cvt_pk_bf16_f32 v138, v152, v153
    v_cvt_pk_bf16_f32 v139, v154, v155
    buffer_store_dwordx4 v[136:139], v12, s[24:27], s14 offen offset:0 sc1
    v_cvt_pk_bf16_f32 v168, v168, v169
    v_cvt_pk_bf16_f32 v169, v170, v171
    v_cvt_pk_bf16_f32 v170, v184, v185
    v_cvt_pk_bf16_f32 v171, v186, v187
    buffer_store_dwordx4 v[168:171], v12, s[24:27], s14 offen offset:1024 sc1
    v_cvt_pk_bf16_f32 v200, v200, v201
    v_cvt_pk_bf16_f32 v201, v202, v203
    v_cvt_pk_bf16_f32 v202, v216, v217
    v_cvt_pk_bf16_f32 v203, v218, v219
    buffer_store_dwordx4 v[200:203], v12, s[24:27], s14 offen offset:2048 sc1
    s_add_u32 s14, s14, 14336
    v_cvt_pk_bf16_f32 v140, v140, v141
    v_cvt_pk_bf16_f32 v141, v142, v143
    v_cvt_pk_bf16_f32 v142, v156, v157
    v_cvt_pk_bf16_f32 v143, v158, v159
    buffer_store_dwordx4 v[140:143], v12, s[24:27], s14 offen offset:0 sc1
    v_cvt_pk_bf16_f32 v172, v172, v173
    v_cvt_pk_bf16_f32 v173, v174, v175
    v_cvt_pk_bf16_f32 v174, v188, v189
    v_cvt_pk_bf16_f32 v175, v190, v191
    buffer_store_dwordx4 v[172:175], v12, s[24:27], s14 offen offset:1024 sc1
    v_cvt_pk_bf16_f32 v204, v204, v205
    v_cvt_pk_bf16_f32 v205, v206, v207
    v_cvt_pk_bf16_f32 v206, v220, v221
    v_cvt_pk_bf16_f32 v207, v222, v223
    buffer_store_dwordx4 v[204:207], v12, s[24:27], s14 offen offset:2048 sc1
    s_waitcnt lgkmcnt(1)
    buffer_store_dwordx4 v[240:243], v12, s[24:27], s15 offen sc1
    s_add_u32 s15, s15, 14336
    s_waitcnt lgkmcnt(0)
    buffer_store_dwordx4 v[244:247], v12, s[24:27], s15 offen sc1
    s_add_u32 s15, s15, 14336
    s_waitcnt vmcnt(22)
    v_cmp_gt_u32 vcc, 56, v15
    s_cbranch_vccnz L_nslowadaLN_cond__gqa_block_cached__mixer_gmlp__prompt_kernel
L_nokadaLN_cond__gqa_block_cached__mixer_gmlp__prompt_kernel:
    s_mov_b32 s16, s10
    s_mov_b32 s17, s11
    s_mov_b32 s18, 1835008
    s_mov_b32 s19, 0x20000
    v_and_b32 v1, 7, v0
    v_bfe_u32 v2, v0, 3, 2
    v_bfe_u32 v3, v0, 5, 1
    v_lshlrev_b32 v4, 10, v3
    v_lshl_add_u32 v4, v2, 8, v4
    v_lshl_add_u32 v4, v1, 4, v4
    s_lshl_b32 s50, s30, 3
    s_add_u32 s50, s50, s29
    s_lshr_b32 s51, s50, 1
    s_mul_i32 s51, s51, 14336
    s_and_b32 s52, s50, 1
    s_lshl_b32 s52, s52, 7
    s_add_u32 s51, s51, s52
    s_lshl_b32 s52, s28, 11
    s_add_u32 s51, s51, s52
    s_cmp_eq_u32 s28, 3
    s_cselect_b32 s53, 0x40000000, 0
    s_cselect_b32 s54, 0, 1.0
    v_add_u32 v5, s53, v4
    v_add_u32 v5, 8192, v5
    v_mul_u32_u24 v6, 896, v1
    v_lshl_add_u32 v6, v3, 6, v6
    v_lshl_add_u32 v6, v2, 3, v6
    v_add_u32 v7, s53, v6
    s_mul_i32 s55, s50, 7168
    s_lshl_b32 s52, s28, 7
    s_add_u32 s55, s55, s52
    v_lshlrev_b32 v8, 7, v3
    v_lshl_add_u32 v8, v2, 4, v8
    v_add_u32 v9, s53, v8
    v_add_u32 v9, 1024, v9
    s_lshl_b32 s52, s28, 8
    s_add_u32 s52, s52, 3584
    buffer_load_dwordx2 v[184:185], v6, s[16:19], s55 offen offset:0
    buffer_load_dwordx2 v[186:187], v6, s[16:19], s55 offen offset:32
    buffer_load_dwordx2 v[188:189], v7, s[16:19], s55 offen offset:512
    buffer_load_dwordx2 v[190:191], v7, s[16:19], s55 offen offset:544
    buffer_load_dwordx4 v[192:195], v8, s[24:27], s52 offen offset:0 sc1
    buffer_load_dwordx4 v[196:199], v8, s[24:27], s52 offen offset:64 sc1
    buffer_load_dwordx4 v[200:203], v8, s[24:27], s52 offen offset:1792 sc1
    buffer_load_dwordx4 v[204:207], v8, s[24:27], s52 offen offset:1856 sc1
    buffer_load_dwordx4 v[208:211], v8, s[24:27], s52 offen offset:3584 sc1
    buffer_load_dwordx4 v[212:215], v8, s[24:27], s52 offen offset:3648 sc1
    buffer_load_dwordx4 v[216:219], v9, s[24:27], s52 offen offset:0 sc1
    buffer_load_dwordx4 v[220:223], v9, s[24:27], s52 offen offset:64 sc1
    buffer_load_dwordx4 v[224:227], v9, s[24:27], s52 offen offset:1792 sc1
    buffer_load_dwordx4 v[228:231], v9, s[24:27], s52 offen offset:1856 sc1
    buffer_load_dwordx4 v[232:235], v9, s[24:27], s52 offen offset:3584 sc1
    buffer_load_dwordx4 v[236:239], v9, s[24:27], s52 offen offset:3648 sc1
    s_waitcnt vmcnt(30)
    v_readfirstlane_b32 s12, v14
    s_nop 0
    s_and_b32 s12, s12, 0xff
    s_mov_b32 s13, s12
    s_add_u32 s55, s51, 4194304
    s_bitcmp1_b32 s12, 0
    s_cbranch_scc0 L_re0adaLN_cond__gqa_block_cached__mixer_gmlp__prompt_kernel
    s_add_u32 s15, s55, 0
    buffer_load_dwordx4 v[16:19], v4, s[24:27], s15 offen sc1
    buffer_load_dwordx4 v[20:23], v5, s[24:27], s15 offen sc1
L_re0adaLN_cond__gqa_block_cached__mixer_gmlp__prompt_kernel:
    s_bitcmp1_b32 s12, 1
    s_cbranch_scc0 L_re1adaLN_cond__gqa_block_cached__mixer_gmlp__prompt_kernel
    s_add_u32 s15, s55, 1835008
    buffer_load_dwordx4 v[24:27], v4, s[24:27], s15 offen sc1
    buffer_load_dwordx4 v[28:31], v5, s[24:27], s15 offen sc1
L_re1adaLN_cond__gqa_block_cached__mixer_gmlp__prompt_kernel:
    s_bitcmp1_b32 s12, 2
    s_cbranch_scc0 L_re2adaLN_cond__gqa_block_cached__mixer_gmlp__prompt_kernel
    s_add_u32 s15, s55, 3670016
    buffer_load_dwordx4 v[32:35], v4, s[24:27], s15 offen sc1
    buffer_load_dwordx4 v[36:39], v5, s[24:27], s15 offen sc1
L_re2adaLN_cond__gqa_block_cached__mixer_gmlp__prompt_kernel:
    s_bitcmp1_b32 s12, 3
    s_cbranch_scc0 L_re3adaLN_cond__gqa_block_cached__mixer_gmlp__prompt_kernel
    s_add_u32 s15, s55, 5505024
    buffer_load_dwordx4 v[40:43], v4, s[24:27], s15 offen sc1
    buffer_load_dwordx4 v[44:47], v5, s[24:27], s15 offen sc1
L_re3adaLN_cond__gqa_block_cached__mixer_gmlp__prompt_kernel:
    s_bitcmp1_b32 s12, 4
    s_cbranch_scc0 L_re4adaLN_cond__gqa_block_cached__mixer_gmlp__prompt_kernel
    s_add_u32 s15, s55, 7340032
    buffer_load_dwordx4 v[48:51], v4, s[24:27], s15 offen sc1
    buffer_load_dwordx4 v[52:55], v5, s[24:27], s15 offen sc1
L_re4adaLN_cond__gqa_block_cached__mixer_gmlp__prompt_kernel:
    s_bitcmp1_b32 s12, 5
    s_cbranch_scc0 L_re5adaLN_cond__gqa_block_cached__mixer_gmlp__prompt_kernel
    s_add_u32 s15, s55, 9175040
    buffer_load_dwordx4 v[56:59], v4, s[24:27], s15 offen sc1
    buffer_load_dwordx4 v[60:63], v5, s[24:27], s15 offen sc1
L_re5adaLN_cond__gqa_block_cached__mixer_gmlp__prompt_kernel:
    s_bitcmp1_b32 s12, 6
    s_cbranch_scc0 L_re6adaLN_cond__gqa_block_cached__mixer_gmlp__prompt_kernel
    s_add_u32 s15, s55, 11010048
    buffer_load_dwordx4 v[64:67], v4, s[24:27], s15 offen sc1
    buffer_load_dwordx4 v[68:71], v5, s[24:27], s15 offen sc1
L_re6adaLN_cond__gqa_block_cached__mixer_gmlp__prompt_kernel:
    s_bitcmp1_b32 s12, 7
    s_cbranch_scc0 L_re7adaLN_cond__gqa_block_cached__mixer_gmlp__prompt_kernel
    s_add_u32 s15, s55, 12845056
    buffer_load_dwordx4 v[72:75], v4, s[24:27], s15 offen sc1
    buffer_load_dwordx4 v[76:79], v5, s[24:27], s15 offen sc1
L_re7adaLN_cond__gqa_block_cached__mixer_gmlp__prompt_kernel:
    s_lshl_b32 s14, s30, 7
    s_add_u32 s14, s14, 114688
    s_lshl_b32 s15, 1, s29
    s_waitcnt vmcnt(16)
    s_barrier
    s_cmp_lg_u32 s28, 0
    s_cbranch_scc1 L_sig_radaLN_cond__gqa_block_cached__mixer_gmlp__prompt_kernel
    v_mov_b32 v10, s15
    v_mov_b32 v11, 0
    s_mov_b64 exec, 1
    buffer_atomic_add v10, v11, s[24:27], s14 offen sc1
    s_mov_b64 exec, -1
L_sig_radaLN_cond__gqa_block_cached__mixer_gmlp__prompt_kernel:
    v_mov_b32 v10, 0
    s_lshl_b32 s52, s30, 7
    s_add_u32 s52, s52, 114688
    v_mov_b32 v80, 0
    v_mov_b32 v81, 0
    v_mov_b32 v82, 0
    v_mov_b32 v83, 0
    v_mov_b32 v84, 0
    v_mov_b32 v85, 0
    v_mov_b32 v86, 0
    v_mov_b32 v87, 0
    v_mov_b32 v88, 0
    v_mov_b32 v89, 0
    v_mov_b32 v90, 0
    v_mov_b32 v91, 0
    v_mov_b32 v92, 0
    v_mov_b32 v93, 0
    v_mov_b32 v94, 0
    v_mov_b32 v95, 0
    s_mov_b32 s56, 0x100000
    s_mov_b32 s54, 0
    s_lshl_b32 s53, 1, s29
    s_waitcnt vmcnt(1)
    s_cmp_eq_u32 s28, 0
    s_cbranch_scc1 L_rjadaLN_cond__gqa_block_cached__mixer_gmlp__prompt_kernel
    s_waitcnt vmcnt(0)
    s_branch L_rjadaLN_cond__gqa_block_cached__mixer_gmlp__prompt_kernel
L_rladaLN_cond__gqa_block_cached__mixer_gmlp__prompt_kernel:
    buffer_load_dword v11, v10, s[24:27], s52 offen sc1
    s_waitcnt vmcnt(0)
    v_readfirstlane_b32 s53, v11
    s_nop 0
    s_andn2_b32 s53, s53, s12
    s_and_b32 s53, s53, 0xff
    s_cbranch_scc0 L_rnadaLN_cond__gqa_block_cached__mixer_gmlp__prompt_kernel
L_rjadaLN_cond__gqa_block_cached__mixer_gmlp__prompt_kernel:
    s_bitcmp1_b32 s53, 0
    s_cbranch_scc0 L_ri0adaLN_cond__gqa_block_cached__mixer_gmlp__prompt_kernel
    s_add_u32 s15, s55, 0
    buffer_load_dwordx4 v[16:19], v4, s[24:27], s15 offen sc1
    buffer_load_dwordx4 v[20:23], v5, s[24:27], s15 offen sc1
L_ri0adaLN_cond__gqa_block_cached__mixer_gmlp__prompt_kernel:
    s_bitcmp1_b32 s53, 1
    s_cbranch_scc0 L_ri1adaLN_cond__gqa_block_cached__mixer_gmlp__prompt_kernel
    s_add_u32 s15, s55, 1835008
    buffer_load_dwordx4 v[24:27], v4, s[24:27], s15 offen sc1
    buffer_load_dwordx4 v[28:31], v5, s[24:27], s15 offen sc1
L_ri1adaLN_cond__gqa_block_cached__mixer_gmlp__prompt_kernel:
    s_bitcmp1_b32 s53, 2
    s_cbranch_scc0 L_ri2adaLN_cond__gqa_block_cached__mixer_gmlp__prompt_kernel
    s_add_u32 s15, s55, 3670016
    buffer_load_dwordx4 v[32:35], v4, s[24:27], s15 offen sc1
    buffer_load_dwordx4 v[36:39], v5, s[24:27], s15 offen sc1
L_ri2adaLN_cond__gqa_block_cached__mixer_gmlp__prompt_kernel:
    s_bitcmp1_b32 s53, 3
    s_cbranch_scc0 L_ri3adaLN_cond__gqa_block_cached__mixer_gmlp__prompt_kernel
    s_add_u32 s15, s55, 5505024
    buffer_load_dwordx4 v[40:43], v4, s[24:27], s15 offen sc1
    buffer_load_dwordx4 v[44:47], v5, s[24:27], s15 offen sc1
L_ri3adaLN_cond__gqa_block_cached__mixer_gmlp__prompt_kernel:
    s_bitcmp1_b32 s53, 4
    s_cbranch_scc0 L_ri4adaLN_cond__gqa_block_cached__mixer_gmlp__prompt_kernel
    s_add_u32 s15, s55, 7340032
    buffer_load_dwordx4 v[48:51], v4, s[24:27], s15 offen sc1
    buffer_load_dwordx4 v[52:55], v5, s[24:27], s15 offen sc1
L_ri4adaLN_cond__gqa_block_cached__mixer_gmlp__prompt_kernel:
    s_bitcmp1_b32 s53, 5
    s_cbranch_scc0 L_ri5adaLN_cond__gqa_block_cached__mixer_gmlp__prompt_kernel
    s_add_u32 s15, s55, 9175040
    buffer_load_dwordx4 v[56:59], v4, s[24:27], s15 offen sc1
    buffer_load_dwordx4 v[60:63], v5, s[24:27], s15 offen sc1
L_ri5adaLN_cond__gqa_block_cached__mixer_gmlp__prompt_kernel:
    s_bitcmp1_b32 s53, 6
    s_cbranch_scc0 L_ri6adaLN_cond__gqa_block_cached__mixer_gmlp__prompt_kernel
    s_add_u32 s15, s55, 11010048
    buffer_load_dwordx4 v[64:67], v4, s[24:27], s15 offen sc1
    buffer_load_dwordx4 v[68:71], v5, s[24:27], s15 offen sc1
L_ri6adaLN_cond__gqa_block_cached__mixer_gmlp__prompt_kernel:
    s_bitcmp1_b32 s53, 7
    s_cbranch_scc0 L_ri7adaLN_cond__gqa_block_cached__mixer_gmlp__prompt_kernel
    s_add_u32 s15, s55, 12845056
    buffer_load_dwordx4 v[72:75], v4, s[24:27], s15 offen sc1
    buffer_load_dwordx4 v[76:79], v5, s[24:27], s15 offen sc1
L_ri7adaLN_cond__gqa_block_cached__mixer_gmlp__prompt_kernel:
L_rnadaLN_cond__gqa_block_cached__mixer_gmlp__prompt_kernel:
    s_cmp_eq_u32 s13, 0
    s_cbranch_scc1 L_raadaLN_cond__gqa_block_cached__mixer_gmlp__prompt_kernel
    s_bitcmp1_b32 s13, 0
    s_cbranch_scc0 L_rp0adaLN_cond__gqa_block_cached__mixer_gmlp__prompt_kernel
    v_lshlrev_b32 v104, 16, v16
    v_and_b32 v105, 0xffff0000, v16
    v_pk_add_f32 v[80:81], v[80:81], v[104:105]
    v_lshlrev_b32 v106, 16, v17
    v_and_b32 v107, 0xffff0000, v17
    v_pk_add_f32 v[82:83], v[82:83], v[106:107]
    v_lshlrev_b32 v108, 16, v18
    v_and_b32 v109, 0xffff0000, v18
    v_pk_add_f32 v[84:85], v[84:85], v[108:109]
    v_lshlrev_b32 v110, 16, v19
    v_and_b32 v111, 0xffff0000, v19
    v_pk_add_f32 v[86:87], v[86:87], v[110:111]
    v_lshlrev_b32 v104, 16, v20
    v_and_b32 v105, 0xffff0000, v20
    v_pk_add_f32 v[88:89], v[88:89], v[104:105]
    v_lshlrev_b32 v106, 16, v21
    v_and_b32 v107, 0xffff0000, v21
    v_pk_add_f32 v[90:91], v[90:91], v[106:107]
    v_lshlrev_b32 v108, 16, v22
    v_and_b32 v109, 0xffff0000, v22
    v_pk_add_f32 v[92:93], v[92:93], v[108:109]
    v_lshlrev_b32 v110, 16, v23
    v_and_b32 v111, 0xffff0000, v23
    v_pk_add_f32 v[94:95], v[94:95], v[110:111]
L_rp0adaLN_cond__gqa_block_cached__mixer_gmlp__prompt_kernel:
    s_bitcmp1_b32 s13, 1
    s_cbranch_scc0 L_rp1adaLN_cond__gqa_block_cached__mixer_gmlp__prompt_kernel
    v_lshlrev_b32 v104, 16, v24
    v_and_b32 v105, 0xffff0000, v24
    v_pk_add_f32 v[80:81], v[80:81], v[104:105]
    v_lshlrev_b32 v106, 16, v25
    v_and_b32 v107, 0xffff0000, v25
    v_pk_add_f32 v[82:83], v[82:83], v[106:107]
    v_lshlrev_b32 v108, 16, v26
    v_and_b32 v109, 0xffff0000, v26
    v_pk_add_f32 v[84:85], v[84:85], v[108:109]
    v_lshlrev_b32 v110, 16, v27
    v_and_b32 v111, 0xffff0000, v27
    v_pk_add_f32 v[86:87], v[86:87], v[110:111]
    v_lshlrev_b32 v104, 16, v28
    v_and_b32 v105, 0xffff0000, v28
    v_pk_add_f32 v[88:89], v[88:89], v[104:105]
    v_lshlrev_b32 v106, 16, v29
    v_and_b32 v107, 0xffff0000, v29
    v_pk_add_f32 v[90:91], v[90:91], v[106:107]
    v_lshlrev_b32 v108, 16, v30
    v_and_b32 v109, 0xffff0000, v30
    v_pk_add_f32 v[92:93], v[92:93], v[108:109]
    v_lshlrev_b32 v110, 16, v31
    v_and_b32 v111, 0xffff0000, v31
    v_pk_add_f32 v[94:95], v[94:95], v[110:111]
L_rp1adaLN_cond__gqa_block_cached__mixer_gmlp__prompt_kernel:
    s_bitcmp1_b32 s13, 2
    s_cbranch_scc0 L_rp2adaLN_cond__gqa_block_cached__mixer_gmlp__prompt_kernel
    v_lshlrev_b32 v104, 16, v32
    v_and_b32 v105, 0xffff0000, v32
    v_pk_add_f32 v[80:81], v[80:81], v[104:105]
    v_lshlrev_b32 v106, 16, v33
    v_and_b32 v107, 0xffff0000, v33
    v_pk_add_f32 v[82:83], v[82:83], v[106:107]
    v_lshlrev_b32 v108, 16, v34
    v_and_b32 v109, 0xffff0000, v34
    v_pk_add_f32 v[84:85], v[84:85], v[108:109]
    v_lshlrev_b32 v110, 16, v35
    v_and_b32 v111, 0xffff0000, v35
    v_pk_add_f32 v[86:87], v[86:87], v[110:111]
    v_lshlrev_b32 v104, 16, v36
    v_and_b32 v105, 0xffff0000, v36
    v_pk_add_f32 v[88:89], v[88:89], v[104:105]
    v_lshlrev_b32 v106, 16, v37
    v_and_b32 v107, 0xffff0000, v37
    v_pk_add_f32 v[90:91], v[90:91], v[106:107]
    v_lshlrev_b32 v108, 16, v38
    v_and_b32 v109, 0xffff0000, v38
    v_pk_add_f32 v[92:93], v[92:93], v[108:109]
    v_lshlrev_b32 v110, 16, v39
    v_and_b32 v111, 0xffff0000, v39
    v_pk_add_f32 v[94:95], v[94:95], v[110:111]
L_rp2adaLN_cond__gqa_block_cached__mixer_gmlp__prompt_kernel:
    s_bitcmp1_b32 s13, 3
    s_cbranch_scc0 L_rp3adaLN_cond__gqa_block_cached__mixer_gmlp__prompt_kernel
    v_lshlrev_b32 v104, 16, v40
    v_and_b32 v105, 0xffff0000, v40
    v_pk_add_f32 v[80:81], v[80:81], v[104:105]
    v_lshlrev_b32 v106, 16, v41
    v_and_b32 v107, 0xffff0000, v41
    v_pk_add_f32 v[82:83], v[82:83], v[106:107]
    v_lshlrev_b32 v108, 16, v42
    v_and_b32 v109, 0xffff0000, v42
    v_pk_add_f32 v[84:85], v[84:85], v[108:109]
    v_lshlrev_b32 v110, 16, v43
    v_and_b32 v111, 0xffff0000, v43
    v_pk_add_f32 v[86:87], v[86:87], v[110:111]
    v_lshlrev_b32 v104, 16, v44
    v_and_b32 v105, 0xffff0000, v44
    v_pk_add_f32 v[88:89], v[88:89], v[104:105]
    v_lshlrev_b32 v106, 16, v45
    v_and_b32 v107, 0xffff0000, v45
    v_pk_add_f32 v[90:91], v[90:91], v[106:107]
    v_lshlrev_b32 v108, 16, v46
    v_and_b32 v109, 0xffff0000, v46
    v_pk_add_f32 v[92:93], v[92:93], v[108:109]
    v_lshlrev_b32 v110, 16, v47
    v_and_b32 v111, 0xffff0000, v47
    v_pk_add_f32 v[94:95], v[94:95], v[110:111]
L_rp3adaLN_cond__gqa_block_cached__mixer_gmlp__prompt_kernel:
    s_bitcmp1_b32 s13, 4
    s_cbranch_scc0 L_rp4adaLN_cond__gqa_block_cached__mixer_gmlp__prompt_kernel
    v_lshlrev_b32 v104, 16, v48
    v_and_b32 v105, 0xffff0000, v48
    v_pk_add_f32 v[80:81], v[80:81], v[104:105]
    v_lshlrev_b32 v106, 16, v49
    v_and_b32 v107, 0xffff0000, v49
    v_pk_add_f32 v[82:83], v[82:83], v[106:107]
    v_lshlrev_b32 v108, 16, v50
    v_and_b32 v109, 0xffff0000, v50
    v_pk_add_f32 v[84:85], v[84:85], v[108:109]
    v_lshlrev_b32 v110, 16, v51
    v_and_b32 v111, 0xffff0000, v51
    v_pk_add_f32 v[86:87], v[86:87], v[110:111]
    v_lshlrev_b32 v104, 16, v52
    v_and_b32 v105, 0xffff0000, v52
    v_pk_add_f32 v[88:89], v[88:89], v[104:105]
    v_lshlrev_b32 v106, 16, v53
    v_and_b32 v107, 0xffff0000, v53
    v_pk_add_f32 v[90:91], v[90:91], v[106:107]
    v_lshlrev_b32 v108, 16, v54
    v_and_b32 v109, 0xffff0000, v54
    v_pk_add_f32 v[92:93], v[92:93], v[108:109]
    v_lshlrev_b32 v110, 16, v55
    v_and_b32 v111, 0xffff0000, v55
    v_pk_add_f32 v[94:95], v[94:95], v[110:111]
L_rp4adaLN_cond__gqa_block_cached__mixer_gmlp__prompt_kernel:
    s_bitcmp1_b32 s13, 5
    s_cbranch_scc0 L_rp5adaLN_cond__gqa_block_cached__mixer_gmlp__prompt_kernel
    v_lshlrev_b32 v104, 16, v56
    v_and_b32 v105, 0xffff0000, v56
    v_pk_add_f32 v[80:81], v[80:81], v[104:105]
    v_lshlrev_b32 v106, 16, v57
    v_and_b32 v107, 0xffff0000, v57
    v_pk_add_f32 v[82:83], v[82:83], v[106:107]
    v_lshlrev_b32 v108, 16, v58
    v_and_b32 v109, 0xffff0000, v58
    v_pk_add_f32 v[84:85], v[84:85], v[108:109]
    v_lshlrev_b32 v110, 16, v59
    v_and_b32 v111, 0xffff0000, v59
    v_pk_add_f32 v[86:87], v[86:87], v[110:111]
    v_lshlrev_b32 v104, 16, v60
    v_and_b32 v105, 0xffff0000, v60
    v_pk_add_f32 v[88:89], v[88:89], v[104:105]
    v_lshlrev_b32 v106, 16, v61
    v_and_b32 v107, 0xffff0000, v61
    v_pk_add_f32 v[90:91], v[90:91], v[106:107]
    v_lshlrev_b32 v108, 16, v62
    v_and_b32 v109, 0xffff0000, v62
    v_pk_add_f32 v[92:93], v[92:93], v[108:109]
    v_lshlrev_b32 v110, 16, v63
    v_and_b32 v111, 0xffff0000, v63
    v_pk_add_f32 v[94:95], v[94:95], v[110:111]
L_rp5adaLN_cond__gqa_block_cached__mixer_gmlp__prompt_kernel:
    s_bitcmp1_b32 s13, 6
    s_cbranch_scc0 L_rp6adaLN_cond__gqa_block_cached__mixer_gmlp__prompt_kernel
    v_lshlrev_b32 v104, 16, v64
    v_and_b32 v105, 0xffff0000, v64
    v_pk_add_f32 v[80:81], v[80:81], v[104:105]
    v_lshlrev_b32 v106, 16, v65
    v_and_b32 v107, 0xffff0000, v65
    v_pk_add_f32 v[82:83], v[82:83], v[106:107]
    v_lshlrev_b32 v108, 16, v66
    v_and_b32 v109, 0xffff0000, v66
    v_pk_add_f32 v[84:85], v[84:85], v[108:109]
    v_lshlrev_b32 v110, 16, v67
    v_and_b32 v111, 0xffff0000, v67
    v_pk_add_f32 v[86:87], v[86:87], v[110:111]
    v_lshlrev_b32 v104, 16, v68
    v_and_b32 v105, 0xffff0000, v68
    v_pk_add_f32 v[88:89], v[88:89], v[104:105]
    v_lshlrev_b32 v106, 16, v69
    v_and_b32 v107, 0xffff0000, v69
    v_pk_add_f32 v[90:91], v[90:91], v[106:107]
    v_lshlrev_b32 v108, 16, v70
    v_and_b32 v109, 0xffff0000, v70
    v_pk_add_f32 v[92:93], v[92:93], v[108:109]
    v_lshlrev_b32 v110, 16, v71
    v_and_b32 v111, 0xffff0000, v71
    v_pk_add_f32 v[94:95], v[94:95], v[110:111]
L_rp6adaLN_cond__gqa_block_cached__mixer_gmlp__prompt_kernel:
    s_bitcmp1_b32 s13, 7
    s_cbranch_scc0 L_rp7adaLN_cond__gqa_block_cached__mixer_gmlp__prompt_kernel
    v_lshlrev_b32 v104, 16, v72
    v_and_b32 v105, 0xffff0000, v72
    v_pk_add_f32 v[80:81], v[80:81], v[104:105]
    v_lshlrev_b32 v106, 16, v73
    v_and_b32 v107, 0xffff0000, v73
    v_pk_add_f32 v[82:83], v[82:83], v[106:107]
    v_lshlrev_b32 v108, 16, v74
    v_and_b32 v109, 0xffff0000, v74
    v_pk_add_f32 v[84:85], v[84:85], v[108:109]
    v_lshlrev_b32 v110, 16, v75
    v_and_b32 v111, 0xffff0000, v75
    v_pk_add_f32 v[86:87], v[86:87], v[110:111]
    v_lshlrev_b32 v104, 16, v76
    v_and_b32 v105, 0xffff0000, v76
    v_pk_add_f32 v[88:89], v[88:89], v[104:105]
    v_lshlrev_b32 v106, 16, v77
    v_and_b32 v107, 0xffff0000, v77
    v_pk_add_f32 v[90:91], v[90:91], v[106:107]
    v_lshlrev_b32 v108, 16, v78
    v_and_b32 v109, 0xffff0000, v78
    v_pk_add_f32 v[92:93], v[92:93], v[108:109]
    v_lshlrev_b32 v110, 16, v79
    v_and_b32 v111, 0xffff0000, v79
    v_pk_add_f32 v[94:95], v[94:95], v[110:111]
L_rp7adaLN_cond__gqa_block_cached__mixer_gmlp__prompt_kernel:
L_raadaLN_cond__gqa_block_cached__mixer_gmlp__prompt_kernel:
    s_mov_b32 s13, s53
    s_or_b32 s12, s12, s53
    s_xor_b32 s15, s12, 0xff
    s_or_b32 s15, s15, s13
    s_cbranch_scc0 L_rdadaLN_cond__gqa_block_cached__mixer_gmlp__prompt_kernel
    s_cmp_eq_u32 s12, 0xff
    s_cbranch_scc1 L_rkadaLN_cond__gqa_block_cached__mixer_gmlp__prompt_kernel
    s_cmp_lg_u32 s54, 0
    s_cbranch_scc1 L_rkadaLN_cond__gqa_block_cached__mixer_gmlp__prompt_kernel
    s_cmp_lg_u32 s53, 0
    s_cbranch_scc1 L_rkadaLN_cond__gqa_block_cached__mixer_gmlp__prompt_kernel
    s_mov_b32 s54, 1
    s_add_u32 m0, s36, 0
    s_nop 0
    buffer_load_dwordx4 v96, s[40:43], s37 offen offset:0 lds
    s_nop 0
    buffer_load_dwordx4 v97, s[40:43], s37 offen offset:1024 lds
    s_nop 0
    buffer_load_dwordx4 v98, s[40:43], s37 offen offset:2048 lds
    s_nop 0
    buffer_load_dwordx4 v99, s[40:43], s37 offen offset:3072 lds
    s_add_u32 m0, s36, 4096
    s_nop 0
    buffer_load_dwordx4 v100, s[40:43], s37 offen offset:0 lds
    s_nop 0
    buffer_load_dwordx4 v101, s[40:43], s37 offen offset:1024 lds
    s_nop 0
    buffer_load_dwordx4 v102, s[40:43], s37 offen offset:2048 lds
    s_add_u32 s37, s37, 458752
    s_add_u32 m0, s36, 133120
    s_nop 0
    buffer_load_dwordx4 v96, s[40:43], s37 offen offset:0 lds
    s_nop 0
    buffer_load_dwordx4 v97, s[40:43], s37 offen offset:1024 lds
    s_nop 0
    buffer_load_dwordx4 v98, s[40:43], s37 offen offset:2048 lds
    s_nop 0
    buffer_load_dwordx4 v99, s[40:43], s37 offen offset:3072 lds
    s_add_u32 m0, s36, 137216
    s_nop 0
    buffer_load_dwordx4 v100, s[40:43], s37 offen offset:0 lds
    s_nop 0
    buffer_load_dwordx4 v101, s[40:43], s37 offen offset:1024 lds
    s_nop 0
    buffer_load_dwordx4 v102, s[40:43], s37 offen offset:2048 lds
    s_add_u32 s37, s37, 458752
    s_add_u32 m0, s36, 66560
    s_nop 0
    buffer_load_dwordx4 v96, s[40:43], s34 offen offset:0 lds
    s_nop 0
    buffer_load_dwordx4 v97, s[40:43], s34 offen offset:1024 lds
    s_nop 0
    buffer_load_dwordx4 v98, s[40:43], s34 offen offset:2048 lds
    s_nop 0
    buffer_load_dwordx4 v99, s[40:43], s34 offen offset:3072 lds
    s_add_u32 m0, s36, 70656
    s_nop 0
    buffer_load_dwordx4 v100, s[40:43], s34 offen offset:0 lds
    s_nop 0
    buffer_load_dwordx4 v101, s[40:43], s34 offen offset:1024 lds
    s_nop 0
    buffer_load_dwordx4 v102, s[40:43], s34 offen offset:2048 lds
    s_add_u32 s34, s34, 458752
L_rkadaLN_cond__gqa_block_cached__mixer_gmlp__prompt_kernel:
    s_sub_u32 s56, s56, 1
    s_cmp_lg_u32 s56, 0
    s_cbranch_scc1 L_rladaLN_cond__gqa_block_cached__mixer_gmlp__prompt_kernel
L_rdadaLN_cond__gqa_block_cached__mixer_gmlp__prompt_kernel:
    s_waitcnt vmcnt(0)
    v_lshlrev_b32 v104, 16, v184
    v_and_b32 v105, 0xffff0000, v184
    v_pk_fma_f32 v[80:81], v[80:81], v[192:193], v[104:105]
    v_cvt_pk_bf16_f32 v116, v80, v81
    v_lshlrev_b32 v80, 16, v116
    v_and_b32 v81, 0xffff0000, v116
    v_lshlrev_b32 v106, 16, v185
    v_and_b32 v107, 0xffff0000, v185
    v_pk_fma_f32 v[82:83], v[82:83], v[194:195], v[106:107]
    v_cvt_pk_bf16_f32 v117, v82, v83
    v_lshlrev_b32 v82, 16, v117
    v_and_b32 v83, 0xffff0000, v117
    v_lshlrev_b32 v108, 16, v186
    v_and_b32 v109, 0xffff0000, v186
    v_pk_fma_f32 v[84:85], v[84:85], v[196:197], v[108:109]
    v_cvt_pk_bf16_f32 v118, v84, v85
    v_lshlrev_b32 v84, 16, v118
    v_and_b32 v85, 0xffff0000, v118
    v_lshlrev_b32 v110, 16, v187
    v_and_b32 v111, 0xffff0000, v187
    v_pk_fma_f32 v[86:87], v[86:87], v[198:199], v[110:111]
    v_cvt_pk_bf16_f32 v119, v86, v87
    v_lshlrev_b32 v86, 16, v119
    v_and_b32 v87, 0xffff0000, v119
    v_lshlrev_b32 v104, 16, v188
    v_and_b32 v105, 0xffff0000, v188
    v_pk_fma_f32 v[88:89], v[88:89], v[216:217], v[104:105]
    v_cvt_pk_bf16_f32 v120, v88, v89
    v_lshlrev_b32 v88, 16, v120
    v_and_b32 v89, 0xffff0000, v120
    v_lshlrev_b32 v106, 16, v189
    v_and_b32 v107, 0xffff0000, v189
    v_pk_fma_f32 v[90:91], v[90:91], v[218:219], v[106:107]
    v_cvt_pk_bf16_f32 v121, v90, v91
    v_lshlrev_b32 v90, 16, v121
    v_and_b32 v91, 0xffff0000, v121
    v_lshlrev_b32 v108, 16, v190
    v_and_b32 v109, 0xffff0000, v190
    v_pk_fma_f32 v[92:93], v[92:93], v[220:221], v[108:109]
    v_cvt_pk_bf16_f32 v122, v92, v93
    v_lshlrev_b32 v92, 16, v122
    v_and_b32 v93, 0xffff0000, v122
    v_lshlrev_b32 v110, 16, v191
    v_and_b32 v111, 0xffff0000, v191
    v_pk_fma_f32 v[94:95], v[94:95], v[222:223], v[110:111]
    v_cvt_pk_bf16_f32 v123, v94, v95
    v_lshlrev_b32 v94, 16, v123
    v_and_b32 v95, 0xffff0000, v123
    s_add_u32 s52, s51, 20971520
    buffer_store_dwordx4 v[116:119], v4, s[24:27], s52 offen sc1
    buffer_store_dwordx4 v[120:123], v5, s[24:27], s52 offen sc1
    v_pk_add_f32 v[104:105], v[80:81], v[82:83]
    v_pk_mul_f32 v[106:107], v[80:81], v[80:81]
    v_pk_fma_f32 v[106:107], v[82:83], v[82:83], v[106:107]
    v_pk_add_f32 v[104:105], v[104:105], v[84:85]
    v_pk_fma_f32 v[106:107], v[84:85], v[84:85], v[106:107]
    v_pk_add_f32 v[104:105], v[104:105], v[86:87]
    v_pk_fma_f32 v[106:107], v[86:87], v[86:87], v[106:107]
    v_pk_add_f32 v[104:105], v[104:105], v[88:89]
    v_pk_fma_f32 v[106:107], v[88:89], v[88:89], v[106:107]
    v_pk_add_f32 v[104:105], v[104:105], v[90:91]
    v_pk_fma_f32 v[106:107], v[90:91], v[90:91], v[106:107]
    v_pk_add_f32 v[104:105], v[104:105], v[92:93]
    v_pk_fma_f32 v[106:107], v[92:93], v[92:93], v[106:107]
    v_pk_add_f32 v[104:105], v[104:105], v[94:95]
    v_pk_fma_f32 v[106:107], v[94:95], v[94:95], v[106:107]
    v_add_f32 v104, v104, v105
    v_add_f32 v105, v106, v107
    s_nop 0
    v_add_f32_dpp v104, v104, v104 row_ror:8 row_mask:0xf bank_mask:0xf
    v_mov_b32 v106, v104
    s_nop 1
    v_permlane32_swap_b32 v104, v106
    v_add_f32 v104, v104, v106
    v_mov_b32 v106, v104
    s_nop 1
    v_permlane16_swap_b32 v104, v106
    v_add_f32 v104, v104, v106
    v_add_f32_dpp v105, v105, v105 row_ror:8 row_mask:0xf bank_mask:0xf
    v_mov_b32 v107, v105
    s_nop 1
    v_permlane32_swap_b32 v105, v107
    v_add_f32 v105, v105, v107
    v_mov_b32 v107, v105
    s_nop 1
    v_permlane16_swap_b32 v105, v107
    v_add_f32 v105, v105, v107
    s_lshl_b32 s52, s28, 6
    v_lshlrev_b32 v12, 3, v1
    v_add_u32 v12, 163328, v12
    v_add_u32 v13, s52, v12
    ds_write_b64 v13, v[104:105]
    s_waitcnt lgkmcnt(0)
    s_barrier
    ds_read_b64 v[108:109], v12 offset:0
    ds_read_b64 v[110:111], v12 offset:64
    ds_read_b64 v[112:113], v12 offset:128
    ds_read_b64 v[114:115], v12 offset:192
    s_waitcnt lgkmcnt(2)
    v_pk_add_f32 v[108:109], v[108:109], v[110:111]
    s_waitcnt lgkmcnt(0)
    v_pk_add_f32 v[112:113], v[112:113], v[114:115]
    v_pk_add_f32 v[104:105], v[108:109], v[112:113]
    v_mul_f32 v104, 991054117, v104
    v_mul_f32 v106, 991054117, v105
    v_fma_f32 v106, -v104, v104, v106
    v_max_f32 v106, 0, v106
    v_add_f32 v106, 925353388, v106
    v_rsq_f32 v106, v106
    s_nop 0
    v_mul_f32 v104, -v104, v106
    v_pk_fma_f32 v[80:81], v[80:81], v[106:107], v[104:105] op_sel_hi:[1,0,0]
    v_pk_fma_f32 v[80:81], v[80:81], v[208:209], v[200:201]
    v_cvt_pk_bf16_f32 v16, v80, v81
    v_pk_fma_f32 v[82:83], v[82:83], v[106:107], v[104:105] op_sel_hi:[1,0,0]
    v_pk_fma_f32 v[82:83], v[82:83], v[210:211], v[202:203]
    v_cvt_pk_bf16_f32 v17, v82, v83
    v_pk_fma_f32 v[84:85], v[84:85], v[106:107], v[104:105] op_sel_hi:[1,0,0]
    v_pk_fma_f32 v[84:85], v[84:85], v[212:213], v[204:205]
    v_cvt_pk_bf16_f32 v18, v84, v85
    v_pk_fma_f32 v[86:87], v[86:87], v[106:107], v[104:105] op_sel_hi:[1,0,0]
    v_pk_fma_f32 v[86:87], v[86:87], v[214:215], v[206:207]
    v_cvt_pk_bf16_f32 v19, v86, v87
    v_pk_fma_f32 v[88:89], v[88:89], v[106:107], v[104:105] op_sel_hi:[1,0,0]
    v_pk_fma_f32 v[88:89], v[88:89], v[232:233], v[224:225]
    v_cvt_pk_bf16_f32 v20, v88, v89
    v_pk_fma_f32 v[90:91], v[90:91], v[106:107], v[104:105] op_sel_hi:[1,0,0]
    v_pk_fma_f32 v[90:91], v[90:91], v[234:235], v[226:227]
    v_cvt_pk_bf16_f32 v21, v90, v91
    v_pk_fma_f32 v[92:93], v[92:93], v[106:107], v[104:105] op_sel_hi:[1,0,0]
    v_pk_fma_f32 v[92:93], v[92:93], v[236:237], v[228:229]
    v_cvt_pk_bf16_f32 v22, v92, v93
    v_pk_fma_f32 v[94:95], v[94:95], v[106:107], v[104:105] op_sel_hi:[1,0,0]
    v_pk_fma_f32 v[94:95], v[94:95], v[238:239], v[230:231]
    v_cvt_pk_bf16_f32 v23, v94, v95
    s_add_u32 s52, s51, 22806528
    buffer_store_dwordx4 v[16:19], v4, s[24:27], s52 offen sc1
    buffer_store_dwordx4 v[20:23], v5, s[24:27], s52 offen sc1
    s_lshr_b32 s15, s29, 1
    s_lshl_b32 s15, s15, 5
    s_add_u32 s14, s14, s15
    s_add_u32 s14, s14, 4096
    v_and_b32 v1, 63, v0
    v_lshlrev_b32 v2, 4, v1
    v_and_b32 v3, 15, v0
    v_bfe_u32 v8, v0, 4, 2
    s_lshl_b32 s58, s33, 2
    s_add_u32 s58, s58, s28
    s_mul_i32 s4, s58, 14336
    s_add_u32 s4, s4, 22806528
    s_add_u32 s5, s4, 4096
    s_add_u32 s12, s4, 8192
    s_add_u32 s13, s4, 12288
    v_lshrrev_b32 v9, 2, v1
    v_mul_u32_u24 v9, 224, v9
    v_and_b32 v12, 3, v0
    v_lshl_add_u32 v12, v12, 3, v9
    v_add_u32 v13, 66560, v12
    v_add_u32 v14, 133120, v12
    v_mov_b32 v15, 0
    s_lshl_b32 s15, s33, 7
    s_lshl_b32 s50, s28, 5
    s_add_u32 s15, s15, s50
    s_add_u32 s15, s15, 118784
    s_waitcnt vmcnt(0)
    s_barrier
    s_cmp_lg_u32 s28, 0
    s_cbranch_scc1 L_sig_zadaLN_cond__gqa_block_cached__mixer_gmlp__prompt_kernel
    v_mov_b32 v48, 1
    v_mov_b32 v49, 0
    s_mov_b64 exec, 1
    buffer_atomic_add v48, v49, s[24:27], s14 offen sc1
    s_mov_b64 exec, -1
L_sig_zadaLN_cond__gqa_block_cached__mixer_gmlp__prompt_kernel:
    s_cmp_lg_u32 s54, 0
    s_cbranch_scc1 L_zfadaLN_cond__gqa_block_cached__mixer_gmlp__prompt_kernel
    s_add_u32 m0, s36, 0
    s_nop 0
    buffer_load_dwordx4 v96, s[40:43], s37 offen offset:0 lds
    buffer_load_dwordx4 v97, s[40:43], s37 offen offset:1024 lds
    buffer_load_dwordx4 v98, s[40:43], s37 offen offset:2048 lds
    buffer_load_dwordx4 v99, s[40:43], s37 offen offset:3072 lds
    s_add_u32 m0, s36, 4096
    s_nop 0
    buffer_load_dwordx4 v100, s[40:43], s37 offen offset:0 lds
    buffer_load_dwordx4 v101, s[40:43], s37 offen offset:1024 lds
    buffer_load_dwordx4 v102, s[40:43], s37 offen offset:2048 lds
    s_add_u32 s37, s37, 458752
    s_add_u32 m0, s36, 133120
    s_nop 0
    buffer_load_dwordx4 v96, s[40:43], s37 offen offset:0 lds
    buffer_load_dwordx4 v97, s[40:43], s37 offen offset:1024 lds
    buffer_load_dwordx4 v98, s[40:43], s37 offen offset:2048 lds
    buffer_load_dwordx4 v99, s[40:43], s37 offen offset:3072 lds
    s_add_u32 m0, s36, 137216
    s_nop 0
    buffer_load_dwordx4 v100, s[40:43], s37 offen offset:0 lds
    buffer_load_dwordx4 v101, s[40:43], s37 offen offset:1024 lds
    buffer_load_dwordx4 v102, s[40:43], s37 offen offset:2048 lds
    s_add_u32 s37, s37, 458752
    s_add_u32 m0, s36, 66560
    s_nop 0
    buffer_load_dwordx4 v96, s[40:43], s34 offen offset:0 lds
    buffer_load_dwordx4 v97, s[40:43], s34 offen offset:1024 lds
    buffer_load_dwordx4 v98, s[40:43], s34 offen offset:2048 lds
    buffer_load_dwordx4 v99, s[40:43], s34 offen offset:3072 lds
    s_add_u32 m0, s36, 70656
    s_nop 0
    buffer_load_dwordx4 v100, s[40:43], s34 offen offset:0 lds
    buffer_load_dwordx4 v101, s[40:43], s34 offen offset:1024 lds
    buffer_load_dwordx4 v102, s[40:43], s34 offen offset:2048 lds
    s_add_u32 s34, s34, 458752
L_zfadaLN_cond__gqa_block_cached__mixer_gmlp__prompt_kernel:
    s_mov_b32 s20, s6
    s_mov_b32 s21, s7
    s_mov_b32 s22, 8392704
    s_mov_b32 s23, 0x20000
    s_sub_u32 s20, s20, 4096
    s_subb_u32 s21, s21, 0
    s_mov_b32 s50, s32
    s_mov_b32 s51, s33
    v_lshrrev_b32 v9, 3, v1
    v_lshlrev_b32 v9, 12, v9
    v_and_b32 v4, 7, v0
    v_xor_b32 v4, v4, v8
    v_lshl_add_u32 v4, v4, 4, v9
    v_xor_b32 v5, 64, v4
    s_add_u32 s52, s28, 0
    s_and_b32 s52, s52, 3
    s_lshl_b32 s52, s52, 16
    s_add_u32 s53, s52, 4096
    v_add_u32 v64, s53, v4
    s_add_u32 s53, s52, 35840
    v_add_u32 v65, s53, v5
    s_add_u32 s52, s28, 1
    s_and_b32 s52, s52, 3
    s_lshl_b32 s52, s52, 16
    s_add_u32 s53, s52, 2048
    v_add_u32 v66, s53, v4
    s_add_u32 s53, s52, 33792
    v_add_u32 v67, s53, v5
    s_add_u32 s52, s28, 2
    s_and_b32 s52, s52, 3
    s_lshl_b32 s52, s52, 16
    s_add_u32 s53, s52, 4096
    v_add_u32 v68, s53, v4
    s_add_u32 s53, s52, 35840
    v_add_u32 v69, s53, v5
    s_add_u32 s52, s28, 3
    s_and_b32 s52, s52, 3
    s_lshl_b32 s52, s52, 16
    s_add_u32 s53, s52, 2048
    v_add_u32 v70, s53, v4
    s_add_u32 s53, s52, 33792
    v_add_u32 v71, s53, v5
    s_lshl_b32 s52, s51, 18
    s_lshl_b32 s53, s28, 10
    s_add_u32 s52, s52, s53
    s_lshl_b32 s54, s50, 6
    s_lshl_b32 s53, s28, 4
    s_add_u32 s54, s54, s53
    s_mul_i32 s54, s54, 7168
    s_add_u32 s54, s54, 31457280
    s_add_u32 s55, s54, 4096
    s_lshl_b32 s53, s28, 13
    v_mov_b32 v4, 3184710632
    v_mov_b32 v6, 3222493025
    s_lshl_b32 s38, s50, 6
    s_lshr_b32 s39, s58, 1
    s_add_u32 s38, s38, s39
    s_mul_i32 s38, s38, 7168
    s_and_b32 s39, s58, 1
    s_lshl_b32 s39, s39, 9
    s_add_u32 s38, s38, s39
    s_add_u32 s38, s38, 31457280
    s_add_u32 s39, s38, 4096
    v_and_b32 v10, 1, v8
    v_lshlrev_b32 v10, 10, v10
    v_lshrrev_b32 v11, 1, v8
    v_lshl_add_u32 v10, v11, 8, v10
    v_lshl_add_u32 v10, v3, 4, v10
    v_lshlrev_b32 v11, 20, v10
    v_and_b32 v11, 0x40000000, v11
    v_or_b32 v11, v11, v10
    ds_read_b64_tr_b16 a[64:65], v12 offset:33280
    ds_read_b64_tr_b16 a[66:67], v12 offset:36864
    ds_read_b64_tr_b16 a[68:69], v12 offset:33312
    ds_read_b64_tr_b16 a[70:71], v12 offset:36896
    ds_read_b64_tr_b16 a[72:73], v12 offset:33344
    ds_read_b64_tr_b16 a[74:75], v12 offset:36928
    ds_read_b64_tr_b16 a[76:77], v12 offset:33376
    ds_read_b64_tr_b16 a[78:79], v12 offset:36960
    ds_read_b64_tr_b16 a[80:81], v12 offset:33408
    ds_read_b64_tr_b16 a[82:83], v12 offset:36992
    ds_read_b64_tr_b16 a[84:85], v12 offset:33440
    ds_read_b64_tr_b16 a[86:87], v12 offset:37024
    s_mov_b32 s56, 0x100000
L_poll_zadaLN_cond__gqa_block_cached__mixer_gmlp__prompt_kernel:
    buffer_load_dword v48, v15, s[24:27], s15 offen sc1
    s_waitcnt vmcnt(0)
    v_cmp_gt_u32 vcc, 2, v48
    s_cbranch_vccz L_polled_zadaLN_cond__gqa_block_cached__mixer_gmlp__prompt_kernel
    s_sleep 1
    s_sub_u32 s56, s56, 1
    s_cmp_lg_u32 s56, 0
    s_cbranch_scc1 L_poll_zadaLN_cond__gqa_block_cached__mixer_gmlp__prompt_kernel
L_polled_zadaLN_cond__gqa_block_cached__mixer_gmlp__prompt_kernel:
    buffer_load_dwordx4 a[0:3], v2, s[24:27], s4 offen offset:0 sc1
    buffer_load_dwordx4 a[4:7], v2, s[24:27], s4 offen offset:1024 sc1
    buffer_load_dwordx4 a[8:11], v2, s[24:27], s4 offen offset:2048 sc1
    buffer_load_dwordx4 a[12:15], v2, s[24:27], s4 offen offset:3072 sc1
    buffer_load_dwordx4 a[16:19], v2, s[24:27], s5 offen offset:0 sc1
    buffer_load_dwordx4 a[20:23], v2, s[24:27], s5 offen offset:1024 sc1
    buffer_load_dwordx4 a[24:27], v2, s[24:27], s5 offen offset:2048 sc1
    buffer_load_dwordx4 a[28:31], v2, s[24:27], s5 offen offset:3072 sc1
    buffer_load_dwordx4 a[32:35], v2, s[24:27], s12 offen offset:0 sc1
    buffer_load_dwordx4 a[36:39], v2, s[24:27], s12 offen offset:1024 sc1
    buffer_load_dwordx4 a[40:43], v2, s[24:27], s12 offen offset:2048 sc1
    buffer_load_dwordx4 a[44:47], v2, s[24:27], s12 offen offset:3072 sc1
    buffer_load_dwordx4 a[48:51], v2, s[24:27], s13 offen offset:0 sc1
    buffer_load_dwordx4 a[52:55], v2, s[24:27], s13 offen offset:1024 sc1
    s_waitcnt vmcnt(13) lgkmcnt(10)
    v_mfma_f32_16x16x32_bf16 v[128:131], a[0:3], a[64:67], 0
    ds_read_b64_tr_b16 a[88:89], v12 offset:33472
    ds_read_b64_tr_b16 a[90:91], v12 offset:37056
    s_waitcnt lgkmcnt(10)
    v_mfma_f32_16x16x32_bf16 v[132:135], a[0:3], a[68:71], 0
    s_waitcnt lgkmcnt(6)
    ds_read_b64_tr_b16 a[92:93], v12 offset:40448
    ds_read_b64_tr_b16 a[94:95], v12 offset:44032
    v_mfma_f32_16x16x32_bf16 v[136:139], a[0:3], a[72:75], 0
    ds_read_b64_tr_b16 a[96:97], v12 offset:40480
    ds_read_b64_tr_b16 a[98:99], v12 offset:44064
    v_mfma_f32_16x16x32_bf16 v[140:143], a[0:3], a[76:79], 0
    s_waitcnt lgkmcnt(6)
    ds_read_b64_tr_b16 a[100:101], v12 offset:40512
    ds_read_b64_tr_b16 a[102:103], v12 offset:44096
    v_mfma_f32_16x16x32_bf16 v[144:147], a[0:3], a[80:83], 0
    ds_read_b64_tr_b16 a[104:105], v12 offset:40544
    ds_read_b64_tr_b16 a[106:107], v12 offset:44128
    v_mfma_f32_16x16x32_bf16 v[148:151], a[0:3], a[84:87], 0
    s_waitcnt vmcnt(12) lgkmcnt(6)
    ds_read_b64_tr_b16 a[108:109], v12 offset:40576
    ds_read_b64_tr_b16 a[110:111], v12 offset:44160
    v_mfma_f32_16x16x32_bf16 v[152:155], a[0:3], a[88:91], 0
    s_waitcnt lgkmcnt(6)
    ds_read_b64_tr_b16 a[112:113], v12 offset:40608
    ds_read_b64_tr_b16 a[114:115], v12 offset:44192
    v_mfma_f32_16x16x32_bf16 v[128:131], a[4:7], a[92:95], v[128:131]
    s_waitcnt lgkmcnt(6)
    ds_read_b64_tr_b16 a[116:117], v12 offset:40640
    ds_read_b64_tr_b16 a[118:119], v12 offset:44224
    v_mfma_f32_16x16x32_bf16 v[132:135], a[4:7], a[96:99], v[132:135]
    ds_read_b64_tr_b16 a[120:121], v12 offset:47616
    ds_read_b64_tr_b16 a[122:123], v12 offset:51200
    v_mfma_f32_16x16x32_bf16 v[136:139], a[4:7], a[100:103], v[136:139]
    s_waitcnt lgkmcnt(6)
    ds_read_b64_tr_b16 a[124:125], v12 offset:47648
    ds_read_b64_tr_b16 a[126:127], v12 offset:51232
    v_mfma_f32_16x16x32_bf16 v[140:143], a[4:7], a[104:107], v[140:143]
    ds_read_b64_tr_b16 a[64:65], v12 offset:47680
    ds_read_b64_tr_b16 a[66:67], v12 offset:51264
    v_mfma_f32_16x16x32_bf16 v[144:147], a[4:7], a[108:111], v[144:147]
    s_waitcnt lgkmcnt(6)
    ds_read_b64_tr_b16 a[68:69], v12 offset:47712
    ds_read_b64_tr_b16 a[70:71], v12 offset:51296
    v_mfma_f32_16x16x32_bf16 v[148:151], a[4:7], a[112:115], v[148:151]
    ds_read_b64_tr_b16 a[72:73], v12 offset:47744
    ds_read_b64_tr_b16 a[74:75], v12 offset:51328
    v_mfma_f32_16x16x32_bf16 v[152:155], a[4:7], a[116:119], v[152:155]
    s_waitcnt vmcnt(11) lgkmcnt(6)
    ds_read_b64_tr_b16 a[76:77], v12 offset:47776
    ds_read_b64_tr_b16 a[78:79], v12 offset:51360
    v_mfma_f32_16x16x32_bf16 v[128:131], a[8:11], a[120:123], v[128:131]
    ds_read_b64_tr_b16 a[80:81], v12 offset:47808
    ds_read_b64_tr_b16 a[82:83], v12 offset:51392
    v_mfma_f32_16x16x32_bf16 v[132:135], a[8:11], a[124:127], v[132:135]
    s_waitcnt lgkmcnt(6)
    ds_read_b64_tr_b16 a[84:85], v12 offset:54784
    ds_read_b64_tr_b16 a[86:87], v12 offset:58368
    v_mfma_f32_16x16x32_bf16 v[136:139], a[8:11], a[64:67], v[136:139]
    ds_read_b64_tr_b16 a[88:89], v12 offset:54816
    ds_read_b64_tr_b16 a[90:91], v12 offset:58400
    v_mfma_f32_16x16x32_bf16 v[140:143], a[8:11], a[68:71], v[140:143]
    s_waitcnt lgkmcnt(6)
    ds_read_b64_tr_b16 a[92:93], v12 offset:54848
    ds_read_b64_tr_b16 a[94:95], v12 offset:58432
    v_mfma_f32_16x16x32_bf16 v[144:147], a[8:11], a[72:75], v[144:147]
    ds_read_b64_tr_b16 a[96:97], v12 offset:54880
    ds_read_b64_tr_b16 a[98:99], v12 offset:58464
    v_mfma_f32_16x16x32_bf16 v[148:151], a[8:11], a[76:79], v[148:151]
    s_waitcnt vmcnt(10) lgkmcnt(6)
    ds_read_b64_tr_b16 a[100:101], v12 offset:54912
    ds_read_b64_tr_b16 a[102:103], v12 offset:58496
    v_mfma_f32_16x16x32_bf16 v[152:155], a[8:11], a[80:83], v[152:155]
    s_waitcnt lgkmcnt(6)
    ds_read_b64_tr_b16 a[104:105], v12 offset:54944
    ds_read_b64_tr_b16 a[106:107], v12 offset:58528
    v_mfma_f32_16x16x32_bf16 v[128:131], a[12:15], a[84:87], v[128:131]
    s_waitcnt lgkmcnt(6)
    ds_read_b64_tr_b16 a[108:109], v12 offset:54976
    ds_read_b64_tr_b16 a[110:111], v12 offset:58560
    v_mfma_f32_16x16x32_bf16 v[132:135], a[12:15], a[88:91], v[132:135]
    ds_read_b64_tr_b16 a[112:113], v13 offset:33280
    ds_read_b64_tr_b16 a[114:115], v13 offset:36864
    v_mfma_f32_16x16x32_bf16 v[136:139], a[12:15], a[92:95], v[136:139]
    s_waitcnt lgkmcnt(6)
    ds_read_b64_tr_b16 a[116:117], v13 offset:33312
    ds_read_b64_tr_b16 a[118:119], v13 offset:36896
    v_mfma_f32_16x16x32_bf16 v[140:143], a[12:15], a[96:99], v[140:143]
    ds_read_b64_tr_b16 a[120:121], v13 offset:33344
    ds_read_b64_tr_b16 a[122:123], v13 offset:36928
    v_mfma_f32_16x16x32_bf16 v[144:147], a[12:15], a[100:103], v[144:147]
    s_waitcnt lgkmcnt(6)
    ds_read_b64_tr_b16 a[124:125], v13 offset:33376
    ds_read_b64_tr_b16 a[126:127], v13 offset:36960
    v_mfma_f32_16x16x32_bf16 v[148:151], a[12:15], a[104:107], v[148:151]
    ds_read_b64_tr_b16 a[64:65], v13 offset:33408
    ds_read_b64_tr_b16 a[66:67], v13 offset:36992
    v_mfma_f32_16x16x32_bf16 v[152:155], a[12:15], a[108:111], v[152:155]
    s_waitcnt vmcnt(9) lgkmcnt(6)
    ds_read_b64_tr_b16 a[68:69], v13 offset:33440
    ds_read_b64_tr_b16 a[70:71], v13 offset:37024
    v_mfma_f32_16x16x32_bf16 v[128:131], a[16:19], a[112:115], v[128:131]
    ds_read_b64_tr_b16 a[72:73], v13 offset:33472
    ds_read_b64_tr_b16 a[74:75], v13 offset:37056
    s_barrier
    v_mfma_f32_16x16x32_bf16 v[132:135], a[16:19], a[116:119], v[132:135]
    s_waitcnt lgkmcnt(6)
    ds_read_b64_tr_b16 a[76:77], v13 offset:40448
    ds_read_b64_tr_b16 a[78:79], v13 offset:44032
    s_add_u32 m0, s36, 33280
    s_nop 0
    buffer_load_dwordx4 v96, s[40:43], s34 offen offset:0 lds
    v_mfma_f32_16x16x32_bf16 v[136:139], a[16:19], a[120:123], v[136:139]
    ds_read_b64_tr_b16 a[80:81], v13 offset:40480
    ds_read_b64_tr_b16 a[82:83], v13 offset:44064
    v_mfma_f32_16x16x32_bf16 v[140:143], a[16:19], a[124:127], v[140:143]
    s_waitcnt lgkmcnt(6)
    ds_read_b64_tr_b16 a[84:85], v13 offset:40512
    ds_read_b64_tr_b16 a[86:87], v13 offset:44096
    v_mfma_f32_16x16x32_bf16 v[144:147], a[16:19], a[64:67], v[144:147]
    ds_read_b64_tr_b16 a[88:89], v13 offset:40544
    ds_read_b64_tr_b16 a[90:91], v13 offset:44128
    buffer_load_dwordx4 v97, s[40:43], s34 offen offset:1024 lds
    v_mfma_f32_16x16x32_bf16 v[148:151], a[16:19], a[68:71], v[148:151]
    s_waitcnt vmcnt(10) lgkmcnt(6)
    ds_read_b64_tr_b16 a[92:93], v13 offset:40576
    ds_read_b64_tr_b16 a[94:95], v13 offset:44160
    v_mfma_f32_16x16x32_bf16 v[152:155], a[16:19], a[72:75], v[152:155]
    s_waitcnt lgkmcnt(6)
    ds_read_b64_tr_b16 a[96:97], v13 offset:40608
    ds_read_b64_tr_b16 a[98:99], v13 offset:44192
    v_mfma_f32_16x16x32_bf16 v[128:131], a[20:23], a[76:79], v[128:131]
    s_waitcnt lgkmcnt(6)
    ds_read_b64_tr_b16 a[100:101], v13 offset:40640
    ds_read_b64_tr_b16 a[102:103], v13 offset:44224
    buffer_load_dwordx4 v98, s[40:43], s34 offen offset:2048 lds
    v_mfma_f32_16x16x32_bf16 v[132:135], a[20:23], a[80:83], v[132:135]
    ds_read_b64_tr_b16 a[104:105], v13 offset:47616
    ds_read_b64_tr_b16 a[106:107], v13 offset:51200
    v_mfma_f32_16x16x32_bf16 v[136:139], a[20:23], a[84:87], v[136:139]
    s_waitcnt lgkmcnt(6)
    ds_read_b64_tr_b16 a[108:109], v13 offset:47648
    ds_read_b64_tr_b16 a[110:111], v13 offset:51232
    v_mfma_f32_16x16x32_bf16 v[140:143], a[20:23], a[88:91], v[140:143]
    ds_read_b64_tr_b16 a[112:113], v13 offset:47680
    ds_read_b64_tr_b16 a[114:115], v13 offset:51264
    buffer_load_dwordx4 v99, s[40:43], s34 offen offset:3072 lds
    v_mfma_f32_16x16x32_bf16 v[144:147], a[20:23], a[92:95], v[144:147]
    s_waitcnt lgkmcnt(6)
    ds_read_b64_tr_b16 a[116:117], v13 offset:47712
    ds_read_b64_tr_b16 a[118:119], v13 offset:51296
    v_mfma_f32_16x16x32_bf16 v[148:151], a[20:23], a[96:99], v[148:151]
    ds_read_b64_tr_b16 a[120:121], v13 offset:47744
    ds_read_b64_tr_b16 a[122:123], v13 offset:51328
    v_mfma_f32_16x16x32_bf16 v[152:155], a[20:23], a[100:103], v[152:155]
    s_waitcnt vmcnt(11) lgkmcnt(6)
    ds_read_b64_tr_b16 a[124:125], v13 offset:47776
    ds_read_b64_tr_b16 a[126:127], v13 offset:51360
    s_add_u32 m0, s36, 37376
    s_nop 0
    buffer_load_dwordx4 v100, s[40:43], s34 offen offset:0 lds
    v_mfma_f32_16x16x32_bf16 v[128:131], a[24:27], a[104:107], v[128:131]
    ds_read_b64_tr_b16 a[64:65], v13 offset:47808
    ds_read_b64_tr_b16 a[66:67], v13 offset:51392
    v_mfma_f32_16x16x32_bf16 v[132:135], a[24:27], a[108:111], v[132:135]
    s_waitcnt lgkmcnt(6)
    ds_read_b64_tr_b16 a[68:69], v13 offset:54784
    ds_read_b64_tr_b16 a[70:71], v13 offset:58368
    v_mfma_f32_16x16x32_bf16 v[136:139], a[24:27], a[112:115], v[136:139]
    ds_read_b64_tr_b16 a[72:73], v13 offset:54816
    ds_read_b64_tr_b16 a[74:75], v13 offset:58400
    buffer_load_dwordx4 v101, s[40:43], s34 offen offset:1024 lds
    v_mfma_f32_16x16x32_bf16 v[140:143], a[24:27], a[116:119], v[140:143]
    s_waitcnt lgkmcnt(6)
    ds_read_b64_tr_b16 a[76:77], v13 offset:54848
    ds_read_b64_tr_b16 a[78:79], v13 offset:58432
    v_mfma_f32_16x16x32_bf16 v[144:147], a[24:27], a[120:123], v[144:147]
    ds_read_b64_tr_b16 a[80:81], v13 offset:54880
    ds_read_b64_tr_b16 a[82:83], v13 offset:58464
    v_mfma_f32_16x16x32_bf16 v[148:151], a[24:27], a[124:127], v[148:151]
    s_waitcnt vmcnt(12) lgkmcnt(6)
    ds_read_b64_tr_b16 a[84:85], v13 offset:54912
    ds_read_b64_tr_b16 a[86:87], v13 offset:58496
    buffer_load_dwordx4 v102, s[40:43], s34 offen offset:2048 lds
    s_add_u32 s34, s34, 458752
    v_mfma_f32_16x16x32_bf16 v[152:155], a[24:27], a[64:67], v[152:155]
    s_waitcnt lgkmcnt(6)
    ds_read_b64_tr_b16 a[88:89], v13 offset:54944
    ds_read_b64_tr_b16 a[90:91], v13 offset:58528
    v_mfma_f32_16x16x32_bf16 v[128:131], a[28:31], a[68:71], v[128:131]
    s_waitcnt lgkmcnt(6)
    ds_read_b64_tr_b16 a[92:93], v13 offset:54976
    ds_read_b64_tr_b16 a[94:95], v13 offset:58560
    v_mfma_f32_16x16x32_bf16 v[132:135], a[28:31], a[72:75], v[132:135]
    ds_read_b64_tr_b16 a[96:97], v12 offset:0
    ds_read_b64_tr_b16 a[98:99], v12 offset:3584
    v_mfma_f32_16x16x32_bf16 v[136:139], a[28:31], a[76:79], v[136:139]
    s_waitcnt lgkmcnt(6)
    ds_read_b64_tr_b16 a[100:101], v12 offset:32
    ds_read_b64_tr_b16 a[102:103], v12 offset:3616
    v_mfma_f32_16x16x32_bf16 v[140:143], a[28:31], a[80:83], v[140:143]
    ds_read_b64_tr_b16 a[104:105], v12 offset:64
    ds_read_b64_tr_b16 a[106:107], v12 offset:3648
    v_mfma_f32_16x16x32_bf16 v[144:147], a[28:31], a[84:87], v[144:147]
    s_waitcnt lgkmcnt(6)
    ds_read_b64_tr_b16 a[108:109], v12 offset:96
    ds_read_b64_tr_b16 a[110:111], v12 offset:3680
    v_mfma_f32_16x16x32_bf16 v[148:151], a[28:31], a[88:91], v[148:151]
    ds_read_b64_tr_b16 a[112:113], v12 offset:128
    ds_read_b64_tr_b16 a[114:115], v12 offset:3712
    v_mfma_f32_16x16x32_bf16 v[152:155], a[28:31], a[92:95], v[152:155]
    s_waitcnt vmcnt(12) lgkmcnt(6)
    ds_read_b64_tr_b16 a[116:117], v12 offset:160
    ds_read_b64_tr_b16 a[118:119], v12 offset:3744
    v_mfma_f32_16x16x32_bf16 v[128:131], a[32:35], a[96:99], v[128:131]
    ds_read_b64_tr_b16 a[120:121], v12 offset:192
    ds_read_b64_tr_b16 a[122:123], v12 offset:3776
    v_mfma_f32_16x16x32_bf16 v[132:135], a[32:35], a[100:103], v[132:135]
    s_waitcnt lgkmcnt(6)
    ds_read_b64_tr_b16 a[124:125], v12 offset:7168
    ds_read_b64_tr_b16 a[126:127], v12 offset:10752
    v_mfma_f32_16x16x32_bf16 v[136:139], a[32:35], a[104:107], v[136:139]
    ds_read_b64_tr_b16 a[64:65], v12 offset:7200
    ds_read_b64_tr_b16 a[66:67], v12 offset:10784
    v_mfma_f32_16x16x32_bf16 v[140:143], a[32:35], a[108:111], v[140:143]
    s_waitcnt lgkmcnt(6)
    ds_read_b64_tr_b16 a[68:69], v12 offset:7232
    ds_read_b64_tr_b16 a[70:71], v12 offset:10816
    v_mfma_f32_16x16x32_bf16 v[144:147], a[32:35], a[112:115], v[144:147]
    ds_read_b64_tr_b16 a[72:73], v12 offset:7264
    ds_read_b64_tr_b16 a[74:75], v12 offset:10848
    v_mfma_f32_16x16x32_bf16 v[148:151], a[32:35], a[116:119], v[148:151]
    s_waitcnt vmcnt(11) lgkmcnt(6)
    ds_read_b64_tr_b16 a[76:77], v12 offset:7296
    ds_read_b64_tr_b16 a[78:79], v12 offset:10880
    v_mfma_f32_16x16x32_bf16 v[152:155], a[32:35], a[120:123], v[152:155]
    s_waitcnt lgkmcnt(6)
    ds_read_b64_tr_b16 a[80:81], v12 offset:7328
    ds_read_b64_tr_b16 a[82:83], v12 offset:10912
    v_mfma_f32_16x16x32_bf16 v[128:131], a[36:39], a[124:127], v[128:131]
    s_waitcnt lgkmcnt(6)
    ds_read_b64_tr_b16 a[84:85], v12 offset:7360
    ds_read_b64_tr_b16 a[86:87], v12 offset:10944
    v_mfma_f32_16x16x32_bf16 v[132:135], a[36:39], a[64:67], v[132:135]
    ds_read_b64_tr_b16 a[88:89], v12 offset:14336
    ds_read_b64_tr_b16 a[90:91], v12 offset:17920
    v_mfma_f32_16x16x32_bf16 v[136:139], a[36:39], a[68:71], v[136:139]
    s_waitcnt lgkmcnt(6)
    ds_read_b64_tr_b16 a[92:93], v12 offset:14368
    ds_read_b64_tr_b16 a[94:95], v12 offset:17952
    v_mfma_f32_16x16x32_bf16 v[140:143], a[36:39], a[72:75], v[140:143]
    ds_read_b64_tr_b16 a[96:97], v12 offset:14400
    ds_read_b64_tr_b16 a[98:99], v12 offset:17984
    v_mfma_f32_16x16x32_bf16 v[144:147], a[36:39], a[76:79], v[144:147]
    s_waitcnt lgkmcnt(6)
    ds_read_b64_tr_b16 a[100:101], v12 offset:14432
    ds_read_b64_tr_b16 a[102:103], v12 offset:18016
    v_mfma_f32_16x16x32_bf16 v[148:151], a[36:39], a[80:83], v[148:151]
    ds_read_b64_tr_b16 a[104:105], v12 offset:14464
    ds_read_b64_tr_b16 a[106:107], v12 offset:18048
    v_mfma_f32_16x16x32_bf16 v[152:155], a[36:39], a[84:87], v[152:155]
    s_waitcnt vmcnt(10) lgkmcnt(6)
    ds_read_b64_tr_b16 a[108:109], v12 offset:14496
    ds_read_b64_tr_b16 a[110:111], v12 offset:18080
    v_mfma_f32_16x16x32_bf16 v[128:131], a[40:43], a[88:91], v[128:131]
    ds_read_b64_tr_b16 a[112:113], v12 offset:14528
    ds_read_b64_tr_b16 a[114:115], v12 offset:18112
    v_mfma_f32_16x16x32_bf16 v[132:135], a[40:43], a[92:95], v[132:135]
    s_waitcnt lgkmcnt(6)
    ds_read_b64_tr_b16 a[116:117], v12 offset:21504
    ds_read_b64_tr_b16 a[118:119], v12 offset:25088
    v_mfma_f32_16x16x32_bf16 v[136:139], a[40:43], a[96:99], v[136:139]
    ds_read_b64_tr_b16 a[120:121], v12 offset:21536
    ds_read_b64_tr_b16 a[122:123], v12 offset:25120
    v_mfma_f32_16x16x32_bf16 v[140:143], a[40:43], a[100:103], v[140:143]
    s_waitcnt lgkmcnt(6)
    ds_read_b64_tr_b16 a[124:125], v12 offset:21568
    ds_read_b64_tr_b16 a[126:127], v12 offset:25152
    v_mfma_f32_16x16x32_bf16 v[144:147], a[40:43], a[104:107], v[144:147]
    ds_read_b64_tr_b16 a[64:65], v12 offset:21600
    ds_read_b64_tr_b16 a[66:67], v12 offset:25184
    v_mfma_f32_16x16x32_bf16 v[148:151], a[40:43], a[108:111], v[148:151]
    s_waitcnt vmcnt(9) lgkmcnt(6)
    ds_read_b64_tr_b16 a[68:69], v12 offset:21632
    ds_read_b64_tr_b16 a[70:71], v12 offset:25216
    v_mfma_f32_16x16x32_bf16 v[152:155], a[40:43], a[112:115], v[152:155]
    s_waitcnt lgkmcnt(6)
    ds_read_b64_tr_b16 a[72:73], v12 offset:21664
    ds_read_b64_tr_b16 a[74:75], v12 offset:25248
    v_mfma_f32_16x16x32_bf16 v[128:131], a[44:47], a[116:119], v[128:131]
    s_waitcnt lgkmcnt(6)
    ds_read_b64_tr_b16 a[76:77], v12 offset:21696
    ds_read_b64_tr_b16 a[78:79], v12 offset:25280
    v_mfma_f32_16x16x32_bf16 v[132:135], a[44:47], a[120:123], v[132:135]
    ds_read_b64_tr_b16 a[80:81], v14 offset:0
    ds_read_b64_tr_b16 a[82:83], v14 offset:3584
    v_mfma_f32_16x16x32_bf16 v[136:139], a[44:47], a[124:127], v[136:139]
    s_waitcnt lgkmcnt(6)
    ds_read_b64_tr_b16 a[84:85], v14 offset:32
    ds_read_b64_tr_b16 a[86:87], v14 offset:3616
    v_mfma_f32_16x16x32_bf16 v[140:143], a[44:47], a[64:67], v[140:143]
    ds_read_b64_tr_b16 a[88:89], v14 offset:64
    ds_read_b64_tr_b16 a[90:91], v14 offset:3648
    v_mfma_f32_16x16x32_bf16 v[144:147], a[44:47], a[68:71], v[144:147]
    s_waitcnt lgkmcnt(6)
    ds_read_b64_tr_b16 a[92:93], v14 offset:96
    ds_read_b64_tr_b16 a[94:95], v14 offset:3680
    v_mfma_f32_16x16x32_bf16 v[148:151], a[44:47], a[72:75], v[148:151]
    ds_read_b64_tr_b16 a[96:97], v14 offset:128
    ds_read_b64_tr_b16 a[98:99], v14 offset:3712
    v_mfma_f32_16x16x32_bf16 v[152:155], a[44:47], a[76:79], v[152:155]
    s_waitcnt vmcnt(8) lgkmcnt(6)
    ds_read_b64_tr_b16 a[100:101], v14 offset:160
    ds_read_b64_tr_b16 a[102:103], v14 offset:3744
    v_mfma_f32_16x16x32_bf16 v[128:131], a[48:51], a[80:83], v[128:131]
    ds_read_b64_tr_b16 a[104:105], v14 offset:192
    ds_read_b64_tr_b16 a[106:107], v14 offset:3776
    v_mfma_f32_16x16x32_bf16 v[132:135], a[48:51], a[84:87], v[132:135]
    s_waitcnt lgkmcnt(6)
    ds_read_b64_tr_b16 a[108:109], v14 offset:7168
    ds_read_b64_tr_b16 a[110:111], v14 offset:10752
    v_mfma_f32_16x16x32_bf16 v[136:139], a[48:51], a[88:91], v[136:139]
    ds_read_b64_tr_b16 a[112:113], v14 offset:7200
    ds_read_b64_tr_b16 a[114:115], v14 offset:10784
    v_mfma_f32_16x16x32_bf16 v[140:143], a[48:51], a[92:95], v[140:143]
    s_waitcnt lgkmcnt(6)
    ds_read_b64_tr_b16 a[116:117], v14 offset:7232
    ds_read_b64_tr_b16 a[118:119], v14 offset:10816
    v_mfma_f32_16x16x32_bf16 v[144:147], a[48:51], a[96:99], v[144:147]
    ds_read_b64_tr_b16 a[120:121], v14 offset:7264
    ds_read_b64_tr_b16 a[122:123], v14 offset:10848
    v_mfma_f32_16x16x32_bf16 v[148:151], a[48:51], a[100:103], v[148:151]
    s_waitcnt vmcnt(7) lgkmcnt(6)
    ds_read_b64_tr_b16 a[124:125], v14 offset:7296
    ds_read_b64_tr_b16 a[126:127], v14 offset:10880
    v_mfma_f32_16x16x32_bf16 v[152:155], a[48:51], a[104:107], v[152:155]
    s_waitcnt lgkmcnt(6)
    ds_read_b64_tr_b16 a[64:65], v14 offset:7328
    ds_read_b64_tr_b16 a[66:67], v14 offset:10912
    v_mfma_f32_16x16x32_bf16 v[128:131], a[52:55], a[108:111], v[128:131]
    s_waitcnt lgkmcnt(6)
    ds_read_b64_tr_b16 a[68:69], v14 offset:7360
    ds_read_b64_tr_b16 a[70:71], v14 offset:10944
    v_mfma_f32_16x16x32_bf16 v[132:135], a[52:55], a[112:115], v[132:135]
    v_mfma_f32_16x16x32_bf16 v[136:139], a[52:55], a[116:119], v[136:139]
    s_waitcnt lgkmcnt(4)
    v_mfma_f32_16x16x32_bf16 v[140:143], a[52:55], a[120:123], v[140:143]
    v_mfma_f32_16x16x32_bf16 v[144:147], a[52:55], a[124:127], v[144:147]
    s_waitcnt lgkmcnt(0)
    v_mfma_f32_16x16x32_bf16 v[148:151], a[52:55], a[64:67], v[148:151]
    v_mfma_f32_16x16x32_bf16 v[152:155], a[52:55], a[68:71], v[152:155]
    s_barrier
    s_add_u32 m0, s36, 99840
    s_nop 0
    buffer_load_dwordx4 v96, s[40:43], s34 offen offset:0 lds
    v_pk_mul_f32 v[24:25], v[128:129], v[128:129]
    v_pk_mul_f32 v[26:27], v[130:131], v[130:131]
    v_pk_mul_f32 v[28:29], v[132:133], v[132:133]
    v_pk_mul_f32 v[30:31], v[134:135], v[134:135]
    v_pk_fma_f32 v[24:25], v[24:25], v[4:5], v[6:7] op_sel_hi:[1,0,0]
    v_pk_fma_f32 v[26:27], v[26:27], v[4:5], v[6:7] op_sel_hi:[1,0,0]
    v_pk_fma_f32 v[28:29], v[28:29], v[4:5], v[6:7] op_sel_hi:[1,0,0]
    v_pk_fma_f32 v[30:31], v[30:31], v[4:5], v[6:7] op_sel_hi:[1,0,0]
    v_pk_mul_f32 v[24:25], v[24:25], v[128:129]
    buffer_load_dwordx4 v97, s[40:43], s34 offen offset:1024 lds
    v_pk_mul_f32 v[26:27], v[26:27], v[130:131]
    v_pk_mul_f32 v[28:29], v[28:29], v[132:133]
    v_pk_mul_f32 v[30:31], v[30:31], v[134:135]
    v_exp_f32 v24, v24
    v_exp_f32 v25, v25
    v_exp_f32 v26, v26
    v_exp_f32 v27, v27
    v_exp_f32 v28, v28
    v_exp_f32 v29, v29
    buffer_load_dwordx4 v98, s[40:43], s34 offen offset:2048 lds
    v_exp_f32 v30, v30
    v_exp_f32 v31, v31
    v_pk_add_f32 v[24:25], v[24:25], 1.0 op_sel_hi:[1,0]
    v_pk_add_f32 v[26:27], v[26:27], 1.0 op_sel_hi:[1,0]
    v_pk_add_f32 v[28:29], v[28:29], 1.0 op_sel_hi:[1,0]
    v_pk_add_f32 v[30:31], v[30:31], 1.0 op_sel_hi:[1,0]
    v_rcp_f32 v24, v24
    v_rcp_f32 v25, v25
    v_rcp_f32 v26, v26
    buffer_load_dwordx4 v99, s[40:43], s34 offen offset:3072 lds
    v_rcp_f32 v27, v27
    v_rcp_f32 v28, v28
    v_rcp_f32 v29, v29
    v_rcp_f32 v30, v30
    v_rcp_f32 v31, v31
    v_pk_mul_f32 v[128:129], v[128:129], v[24:25]
    v_pk_mul_f32 v[130:131], v[130:131], v[26:27]
    v_pk_mul_f32 v[132:133], v[132:133], v[28:29]
    v_pk_mul_f32 v[134:135], v[134:135], v[30:31]
    s_add_u32 m0, s36, 103936
    s_nop 0
    buffer_load_dwordx4 v100, s[40:43], s34 offen offset:0 lds
    v_pk_mul_f32 v[24:25], v[136:137], v[136:137]
    v_pk_mul_f32 v[26:27], v[138:139], v[138:139]
    v_pk_mul_f32 v[28:29], v[140:141], v[140:141]
    v_pk_mul_f32 v[30:31], v[142:143], v[142:143]
    v_pk_fma_f32 v[24:25], v[24:25], v[4:5], v[6:7] op_sel_hi:[1,0,0]
    v_pk_fma_f32 v[26:27], v[26:27], v[4:5], v[6:7] op_sel_hi:[1,0,0]
    v_pk_fma_f32 v[28:29], v[28:29], v[4:5], v[6:7] op_sel_hi:[1,0,0]
    v_pk_fma_f32 v[30:31], v[30:31], v[4:5], v[6:7] op_sel_hi:[1,0,0]
    v_pk_mul_f32 v[24:25], v[24:25], v[136:137]
    buffer_load_dwordx4 v101, s[40:43], s34 offen offset:1024 lds
    v_pk_mul_f32 v[26:27], v[26:27], v[138:139]
    v_pk_mul_f32 v[28:29], v[28:29], v[140:141]
    v_pk_mul_f32 v[30:31], v[30:31], v[142:143]
    v_exp_f32 v24, v24
    v_exp_f32 v25, v25
    v_exp_f32 v26, v26
    v_exp_f32 v27, v27
    v_exp_f32 v28, v28
    v_exp_f32 v29, v29
    buffer_load_dwordx4 v102, s[40:43], s34 offen offset:2048 lds
    s_add_u32 s34, s34, 458752
    v_exp_f32 v30, v30
    v_exp_f32 v31, v31
    v_pk_add_f32 v[24:25], v[24:25], 1.0 op_sel_hi:[1,0]
    v_pk_add_f32 v[26:27], v[26:27], 1.0 op_sel_hi:[1,0]
    v_pk_add_f32 v[28:29], v[28:29], 1.0 op_sel_hi:[1,0]
    v_pk_add_f32 v[30:31], v[30:31], 1.0 op_sel_hi:[1,0]
    v_rcp_f32 v24, v24
    v_rcp_f32 v25, v25
    v_rcp_f32 v26, v26
    s_add_u32 m0, s36, 133120
    s_nop 0
    buffer_load_dwordx4 v96, s[40:43], s34 offen offset:0 lds
    v_rcp_f32 v27, v27
    v_rcp_f32 v28, v28
    v_rcp_f32 v29, v29
    v_rcp_f32 v30, v30
    v_rcp_f32 v31, v31
    v_pk_mul_f32 v[136:137], v[136:137], v[24:25]
    v_pk_mul_f32 v[138:139], v[138:139], v[26:27]
    v_pk_mul_f32 v[140:141], v[140:141], v[28:29]
    v_pk_mul_f32 v[142:143], v[142:143], v[30:31]
    buffer_load_dwordx4 v97, s[40:43], s34 offen offset:1024 lds
    v_pk_mul_f32 v[24:25], v[144:145], v[144:145]
    v_pk_mul_f32 v[26:27], v[146:147], v[146:147]
    v_pk_mul_f32 v[28:29], v[148:149], v[148:149]
    v_pk_mul_f32 v[30:31], v[150:151], v[150:151]
    v_pk_fma_f32 v[24:25], v[24:25], v[4:5], v[6:7] op_sel_hi:[1,0,0]
    v_pk_fma_f32 v[26:27], v[26:27], v[4:5], v[6:7] op_sel_hi:[1,0,0]
    v_pk_fma_f32 v[28:29], v[28:29], v[4:5], v[6:7] op_sel_hi:[1,0,0]
    v_pk_fma_f32 v[30:31], v[30:31], v[4:5], v[6:7] op_sel_hi:[1,0,0]
    v_pk_mul_f32 v[24:25], v[24:25], v[144:145]
    buffer_load_dwordx4 v98, s[40:43], s34 offen offset:2048 lds
    v_pk_mul_f32 v[26:27], v[26:27], v[146:147]
    v_pk_mul_f32 v[28:29], v[28:29], v[148:149]
    v_pk_mul_f32 v[30:31], v[30:31], v[150:151]
    v_exp_f32 v24, v24
    v_exp_f32 v25, v25
    v_exp_f32 v26, v26
    v_exp_f32 v27, v27
    v_exp_f32 v28, v28
    v_exp_f32 v29, v29
    buffer_load_dwordx4 v99, s[40:43], s34 offen offset:3072 lds
    v_exp_f32 v30, v30
    v_exp_f32 v31, v31
    v_pk_add_f32 v[24:25], v[24:25], 1.0 op_sel_hi:[1,0]
    v_pk_add_f32 v[26:27], v[26:27], 1.0 op_sel_hi:[1,0]
    v_pk_add_f32 v[28:29], v[28:29], 1.0 op_sel_hi:[1,0]
    v_pk_add_f32 v[30:31], v[30:31], 1.0 op_sel_hi:[1,0]
    v_rcp_f32 v24, v24
    v_rcp_f32 v25, v25
    v_rcp_f32 v26, v26
    s_add_u32 m0, s36, 137216
    s_nop 0
    buffer_load_dwordx4 v100, s[40:43], s34 offen offset:0 lds
    v_rcp_f32 v27, v27
    v_rcp_f32 v28, v28
    v_rcp_f32 v29, v29
    v_rcp_f32 v30, v30
    v_rcp_f32 v31, v31
    v_pk_mul_f32 v[144:145], v[144:145], v[24:25]
    v_pk_mul_f32 v[146:147], v[146:147], v[26:27]
    v_pk_mul_f32 v[148:149], v[148:149], v[28:29]
    v_pk_mul_f32 v[150:151], v[150:151], v[30:31]
    buffer_load_dwordx4 v101, s[40:43], s34 offen offset:1024 lds
    v_pk_mul_f32 v[24:25], v[152:153], v[152:153]
    v_pk_mul_f32 v[26:27], v[154:155], v[154:155]
    v_pk_fma_f32 v[24:25], v[24:25], v[4:5], v[6:7] op_sel_hi:[1,0,0]
    v_pk_fma_f32 v[26:27], v[26:27], v[4:5], v[6:7] op_sel_hi:[1,0,0]
    v_pk_mul_f32 v[24:25], v[24:25], v[152:153]
    v_pk_mul_f32 v[26:27], v[26:27], v[154:155]
    v_exp_f32 v24, v24
    v_exp_f32 v25, v25
    v_exp_f32 v26, v26
    buffer_load_dwordx4 v102, s[40:43], s34 offen offset:2048 lds
    s_add_u32 s34, s34, 458752
    v_exp_f32 v27, v27
    v_pk_add_f32 v[24:25], v[24:25], 1.0 op_sel_hi:[1,0]
    v_pk_add_f32 v[26:27], v[26:27], 1.0 op_sel_hi:[1,0]
    v_rcp_f32 v24, v24
    v_rcp_f32 v25, v25
    v_rcp_f32 v26, v26
    v_rcp_f32 v27, v27
    v_pk_mul_f32 v[152:153], v[152:153], v[24:25]
    v_pk_mul_f32 v[154:155], v[154:155], v[26:27]
    v_pk_add_f32 v[32:33], v[128:129], v[132:133]
    v_pk_mul_f32 v[36:37], v[128:129], v[128:129]
    v_pk_add_f32 v[34:35], v[130:131], v[134:135]
    v_pk_mul_f32 v[38:39], v[130:131], v[130:131]
    v_pk_fma_f32 v[36:37], v[132:133], v[132:133], v[36:37]
    v_pk_fma_f32 v[38:39], v[134:135], v[134:135], v[38:39]
    v_pk_add_f32 v[32:33], v[32:33], v[136:137]
    v_pk_fma_f32 v[36:37], v[136:137], v[136:137], v[36:37]
    v_pk_add_f32 v[34:35], v[34:35], v[138:139]
    v_pk_fma_f32 v[38:39], v[138:139], v[138:139], v[38:39]
    v_pk_add_f32 v[32:33], v[32:33], v[140:141]
    v_pk_fma_f32 v[36:37], v[140:141], v[140:141], v[36:37]
    v_pk_add_f32 v[34:35], v[34:35], v[142:143]
    v_pk_fma_f32 v[38:39], v[142:143], v[142:143], v[38:39]
    v_pk_add_f32 v[32:33], v[32:33], v[144:145]
    v_pk_fma_f32 v[36:37], v[144:145], v[144:145], v[36:37]
    v_pk_add_f32 v[34:35], v[34:35], v[146:147]
    v_pk_fma_f32 v[38:39], v[146:147], v[146:147], v[38:39]
    v_pk_add_f32 v[32:33], v[32:33], v[148:149]
    v_pk_fma_f32 v[36:37], v[148:149], v[148:149], v[36:37]
    v_pk_add_f32 v[34:35], v[34:35], v[150:151]
    v_pk_fma_f32 v[38:39], v[150:151], v[150:151], v[38:39]
    v_pk_add_f32 v[32:33], v[32:33], v[152:153]
    v_pk_fma_f32 v[36:37], v[152:153], v[152:153], v[36:37]
    v_pk_add_f32 v[34:35], v[34:35], v[154:155]
    v_pk_fma_f32 v[38:39], v[154:155], v[154:155], v[38:39]
    v_add_f32_dpp v32, v32, v32 row_ror:8 row_mask:0xf bank_mask:0xf
    v_add_f32_dpp v33, v33, v33 row_ror:8 row_mask:0xf bank_mask:0xf
    v_add_f32_dpp v34, v34, v34 row_ror:8 row_mask:0xf bank_mask:0xf
    v_add_f32_dpp v35, v35, v35 row_ror:8 row_mask:0xf bank_mask:0xf
    v_add_f32_dpp v36, v36, v36 row_ror:8 row_mask:0xf bank_mask:0xf
    v_add_f32_dpp v37, v37, v37 row_ror:8 row_mask:0xf bank_mask:0xf
    v_add_f32_dpp v38, v38, v38 row_ror:8 row_mask:0xf bank_mask:0xf
    v_add_f32_dpp v39, v39, v39 row_ror:8 row_mask:0xf bank_mask:0xf
    v_add_f32_dpp v32, v32, v32 row_ror:4 row_mask:0xf bank_mask:0xf
    v_add_f32_dpp v33, v33, v33 row_ror:4 row_mask:0xf bank_mask:0xf
    v_add_f32_dpp v34, v34, v34 row_ror:4 row_mask:0xf bank_mask:0xf
    v_add_f32_dpp v35, v35, v35 row_ror:4 row_mask:0xf bank_mask:0xf
    v_add_f32_dpp v36, v36, v36 row_ror:4 row_mask:0xf bank_mask:0xf
    v_add_f32_dpp v37, v37, v37 row_ror:4 row_mask:0xf bank_mask:0xf
    v_add_f32_dpp v38, v38, v38 row_ror:4 row_mask:0xf bank_mask:0xf
    v_add_f32_dpp v39, v39, v39 row_ror:4 row_mask:0xf bank_mask:0xf
    v_add_f32_dpp v32, v32, v32 row_ror:2 row_mask:0xf bank_mask:0xf
    v_add_f32_dpp v33, v33, v33 row_ror:2 row_mask:0xf bank_mask:0xf
    v_add_f32_dpp v34, v34, v34 row_ror:2 row_mask:0xf bank_mask:0xf
    v_add_f32_dpp v35, v35, v35 row_ror:2 row_mask:0xf bank_mask:0xf
    v_add_f32_dpp v36, v36, v36 row_ror:2 row_mask:0xf bank_mask:0xf
    v_add_f32_dpp v37, v37, v37 row_ror:2 row_mask:0xf bank_mask:0xf
    v_add_f32_dpp v38, v38, v38 row_ror:2 row_mask:0xf bank_mask:0xf
    v_add_f32_dpp v39, v39, v39 row_ror:2 row_mask:0xf bank_mask:0xf
    v_add_f32_dpp v32, v32, v32 row_ror:1 row_mask:0xf bank_mask:0xf
    v_add_f32_dpp v33, v33, v33 row_ror:1 row_mask:0xf bank_mask:0xf
    v_add_f32_dpp v34, v34, v34 row_ror:1 row_mask:0xf bank_mask:0xf
    v_add_f32_dpp v35, v35, v35 row_ror:1 row_mask:0xf bank_mask:0xf
    v_add_f32_dpp v36, v36, v36 row_ror:1 row_mask:0xf bank_mask:0xf
    v_add_f32_dpp v37, v37, v37 row_ror:1 row_mask:0xf bank_mask:0xf
    v_add_f32_dpp v38, v38, v38 row_ror:1 row_mask:0xf bank_mask:0xf
    v_add_f32_dpp v39, v39, v39 row_ror:1 row_mask:0xf bank_mask:0xf
    v_cmp_eq_u32 vcc, 0, v3
    s_nop 1
    v_cndmask_b32 v40, v34, v32, vcc
    v_cndmask_b32 v41, v38, v36, vcc
    v_cndmask_b32 v42, v35, v33, vcc
    v_cndmask_b32 v43, v39, v37, vcc
    v_or_b32 v41, 0x80000000, v41
    v_or_b32 v43, 0x80000000, v43
    v_lshlrev_b32 v9, 5, v8
    v_lshl_add_u32 v9, v3, 4, v9
    v_mov_b32 v25, 0x40000000
    v_cmp_gt_u32 vcc, 2, v3
    s_nop 1
    v_cndmask_b32 v9, v25, v9, vcc
    s_lshl_b32 s12, s58, 10
    s_add_u32 s12, s12, 131072
    s_lshl_b32 s13, s50, 7
    s_add_u32 s13, s13, s12
    buffer_store_dwordx4 v[40:43], v9, s[24:27], s13 offen sc1
    v_and_b32 v9, 7, v3
    v_lshlrev_b32 v9, 7, v9
    v_lshl_add_u32 v9, v8, 5, v9
    v_lshrrev_b32 v25, 3, v3
    v_lshl_add_u32 v9, v25, 4, v9
    ds_read_b64_tr_b16 a[72:73], v13 offset:0
    ds_read_b64_tr_b16 a[74:75], v13 offset:3584
    ds_read_b64_tr_b16 a[76:77], v13 offset:32
    ds_read_b64_tr_b16 a[78:79], v13 offset:3616
    ds_read_b64_tr_b16 a[80:81], v13 offset:64
    ds_read_b64_tr_b16 a[82:83], v13 offset:3648
    ds_read_b64_tr_b16 a[84:85], v13 offset:96
    ds_read_b64_tr_b16 a[86:87], v13 offset:3680
    ds_read_b64_tr_b16 a[88:89], v13 offset:128
    ds_read_b64_tr_b16 a[90:91], v13 offset:3712
    ds_read_b64_tr_b16 a[92:93], v13 offset:160
    ds_read_b64_tr_b16 a[94:95], v13 offset:3744
    s_waitcnt vmcnt(8)
    s_barrier
    s_lshl_b32 s15, s50, 9
    s_add_u32 s15, s15, 122880
    s_lshr_b32 s14, s51, 3
    s_lshl_b32 s14, s14, 7
    s_add_u32 s14, s14, s15
    s_lshl_b32 s13, s28, 7
    s_add_u32 s15, s15, s13
    s_waitcnt lgkmcnt(10)
    v_mfma_f32_16x16x32_bf16 v[160:163], a[72:75], a[0:3], 0
    ds_read_b64_tr_b16 a[96:97], v13 offset:192
    ds_read_b64_tr_b16 a[98:99], v13 offset:3776
    s_waitcnt lgkmcnt(10)
    v_mfma_f32_16x16x32_bf16 v[164:167], a[76:79], a[0:3], 0
    s_waitcnt lgkmcnt(6)
    ds_read_b64_tr_b16 a[100:101], v13 offset:7168
    ds_read_b64_tr_b16 a[102:103], v13 offset:10752
    s_add_u32 m0, s53, 0
    s_nop 0
    buffer_load_dwordx4 v64, s[20:23], s52 offen offset:0 lds
    v_mfma_f32_16x16x32_bf16 v[168:171], a[80:83], a[0:3], 0
    ds_read_b64_tr_b16 a[104:105], v13 offset:7200
    ds_read_b64_tr_b16 a[106:107], v13 offset:10784
    v_mfma_f32_16x16x32_bf16 v[172:175], a[84:87], a[0:3], 0
    s_waitcnt lgkmcnt(6)
    ds_read_b64_tr_b16 a[108:109], v13 offset:7232
    ds_read_b64_tr_b16 a[110:111], v13 offset:10816
    v_mfma_f32_16x16x32_bf16 v[176:179], a[88:91], a[0:3], 0
    ds_read_b64_tr_b16 a[112:113], v13 offset:7264
    ds_read_b64_tr_b16 a[114:115], v13 offset:10848
    buffer_load_dwordx4 v65, s[20:23], s52 offen offset:1024 lds
    v_mfma_f32_16x16x32_bf16 v[180:183], a[92:95], a[0:3], 0
    s_waitcnt lgkmcnt(6)
    ds_read_b64_tr_b16 a[116:117], v13 offset:7296
    ds_read_b64_tr_b16 a[118:119], v13 offset:10880
    v_mfma_f32_16x16x32_bf16 v[184:187], a[96:99], a[0:3], 0
    s_waitcnt lgkmcnt(6)
    ds_read_b64_tr_b16 a[120:121], v13 offset:7328
    ds_read_b64_tr_b16 a[122:123], v13 offset:10912
    v_mfma_f32_16x16x32_bf16 v[160:163], a[100:103], a[4:7], v[160:163]
    s_waitcnt lgkmcnt(6)
    ds_read_b64_tr_b16 a[124:125], v13 offset:7360
    ds_read_b64_tr_b16 a[126:127], v13 offset:10944
    buffer_load_dwordx4 v66, s[20:23], s52 offen offset:2048 lds
    v_mfma_f32_16x16x32_bf16 v[164:167], a[104:107], a[4:7], v[164:167]
    ds_read_b64_tr_b16 a[64:65], v13 offset:14336
    ds_read_b64_tr_b16 a[66:67], v13 offset:17920
    v_mfma_f32_16x16x32_bf16 v[168:171], a[108:111], a[4:7], v[168:171]
    s_waitcnt lgkmcnt(6)
    ds_read_b64_tr_b16 a[68:69], v13 offset:14368
    ds_read_b64_tr_b16 a[70:71], v13 offset:17952
    v_mfma_f32_16x16x32_bf16 v[172:175], a[112:115], a[4:7], v[172:175]
    ds_read_b64_tr_b16 a[72:73], v13 offset:14400
    ds_read_b64_tr_b16 a[74:75], v13 offset:17984
    buffer_load_dwordx4 v67, s[20:23], s52 offen offset:3072 lds
    v_mfma_f32_16x16x32_bf16 v[176:179], a[116:119], a[4:7], v[176:179]
    s_waitcnt lgkmcnt(6)
    ds_read_b64_tr_b16 a[76:77], v13 offset:14432
    ds_read_b64_tr_b16 a[78:79], v13 offset:18016
    v_mfma_f32_16x16x32_bf16 v[180:183], a[120:123], a[4:7], v[180:183]
    ds_read_b64_tr_b16 a[80:81], v13 offset:14464
    ds_read_b64_tr_b16 a[82:83], v13 offset:18048
    v_mfma_f32_16x16x32_bf16 v[184:187], a[124:127], a[4:7], v[184:187]
    s_waitcnt lgkmcnt(6)
    ds_read_b64_tr_b16 a[84:85], v13 offset:14496
    ds_read_b64_tr_b16 a[86:87], v13 offset:18080
    s_add_u32 m0, s53, 4096
    s_nop 0
    buffer_load_dwordx4 v68, s[20:23], s52 offen offset:0 lds
    v_mfma_f32_16x16x32_bf16 v[160:163], a[64:67], a[8:11], v[160:163]
    ds_read_b64_tr_b16 a[88:89], v13 offset:14528
    ds_read_b64_tr_b16 a[90:91], v13 offset:18112
    v_mfma_f32_16x16x32_bf16 v[164:167], a[68:71], a[8:11], v[164:167]
    s_waitcnt lgkmcnt(6)
    ds_read_b64_tr_b16 a[92:93], v13 offset:21504
    ds_read_b64_tr_b16 a[94:95], v13 offset:25088
    v_mfma_f32_16x16x32_bf16 v[168:171], a[72:75], a[8:11], v[168:171]
    ds_read_b64_tr_b16 a[96:97], v13 offset:21536
    ds_read_b64_tr_b16 a[98:99], v13 offset:25120
    buffer_load_dwordx4 v69, s[20:23], s52 offen offset:1024 lds
    v_mfma_f32_16x16x32_bf16 v[172:175], a[76:79], a[8:11], v[172:175]
    s_waitcnt lgkmcnt(6)
    ds_read_b64_tr_b16 a[100:101], v13 offset:21568
    ds_read_b64_tr_b16 a[102:103], v13 offset:25152
    v_mfma_f32_16x16x32_bf16 v[176:179], a[80:83], a[8:11], v[176:179]
    ds_read_b64_tr_b16 a[104:105], v13 offset:21600
    ds_read_b64_tr_b16 a[106:107], v13 offset:25184
    v_mfma_f32_16x16x32_bf16 v[180:183], a[84:87], a[8:11], v[180:183]
    s_waitcnt lgkmcnt(6)
    ds_read_b64_tr_b16 a[108:109], v13 offset:21632
    ds_read_b64_tr_b16 a[110:111], v13 offset:25216
    buffer_load_dwordx4 v70, s[20:23], s52 offen offset:2048 lds
    v_mfma_f32_16x16x32_bf16 v[184:187], a[88:91], a[8:11], v[184:187]
    s_waitcnt lgkmcnt(6)
    ds_read_b64_tr_b16 a[112:113], v13 offset:21664
    ds_read_b64_tr_b16 a[114:115], v13 offset:25248
    v_mfma_f32_16x16x32_bf16 v[160:163], a[92:95], a[12:15], v[160:163]
    s_waitcnt lgkmcnt(6)
    ds_read_b64_tr_b16 a[116:117], v13 offset:21696
    ds_read_b64_tr_b16 a[118:119], v13 offset:25280
    v_mfma_f32_16x16x32_bf16 v[164:167], a[96:99], a[12:15], v[164:167]
    ds_read_b64_tr_b16 a[120:121], v12 offset:33280
    ds_read_b64_tr_b16 a[122:123], v12 offset:36864
    buffer_load_dwordx4 v71, s[20:23], s52 offen offset:3072 lds
    s_add_u32 s52, s52, 128
    v_mfma_f32_16x16x32_bf16 v[168:171], a[100:103], a[12:15], v[168:171]
    s_waitcnt lgkmcnt(6)
    ds_read_b64_tr_b16 a[124:125], v12 offset:33312
    ds_read_b64_tr_b16 a[126:127], v12 offset:36896
    v_mfma_f32_16x16x32_bf16 v[172:175], a[104:107], a[12:15], v[172:175]
    ds_read_b64_tr_b16 a[64:65], v12 offset:33344
    ds_read_b64_tr_b16 a[66:67], v12 offset:36928
    v_mfma_f32_16x16x32_bf16 v[176:179], a[108:111], a[12:15], v[176:179]
    s_waitcnt lgkmcnt(6)
    ds_read_b64_tr_b16 a[68:69], v12 offset:33376
    ds_read_b64_tr_b16 a[70:71], v12 offset:36960
    v_mfma_f32_16x16x32_bf16 v[180:183], a[112:115], a[12:15], v[180:183]
    ds_read_b64_tr_b16 a[72:73], v12 offset:33408
    ds_read_b64_tr_b16 a[74:75], v12 offset:36992
    v_mfma_f32_16x16x32_bf16 v[184:187], a[116:119], a[12:15], v[184:187]
    s_waitcnt lgkmcnt(6)
    ds_read_b64_tr_b16 a[76:77], v12 offset:33440
    ds_read_b64_tr_b16 a[78:79], v12 offset:37024
    v_mfma_f32_16x16x32_bf16 v[160:163], a[120:123], a[16:19], v[160:163]
    ds_read_b64_tr_b16 a[80:81], v12 offset:33472
    ds_read_b64_tr_b16 a[82:83], v12 offset:37056
    s_waitcnt vmcnt(9)
    s_barrier
    v_mfma_f32_16x16x32_bf16 v[164:167], a[124:127], a[16:19], v[164:167]
    s_waitcnt lgkmcnt(6)
    ds_read_b64_tr_b16 a[84:85], v12 offset:40448
    ds_read_b64_tr_b16 a[86:87], v12 offset:44032
    s_add_u32 m0, s53, 65536
    s_nop 0
    buffer_load_dwordx4 v64, s[20:23], s52 offen offset:0 lds
    v_mfma_f32_16x16x32_bf16 v[168:171], a[64:67], a[16:19], v[168:171]
    ds_read_b64_tr_b16 a[88:89], v12 offset:40480
    ds_read_b64_tr_b16 a[90:91], v12 offset:44064
    v_mfma_f32_16x16x32_bf16 v[172:175], a[68:71], a[16:19], v[172:175]
    s_waitcnt lgkmcnt(6)
    ds_read_b64_tr_b16 a[92:93], v12 offset:40512
    ds_read_b64_tr_b16 a[94:95], v12 offset:44096
    v_mfma_f32_16x16x32_bf16 v[176:179], a[72:75], a[16:19], v[176:179]
    ds_read_b64_tr_b16 a[96:97], v12 offset:40544
    ds_read_b64_tr_b16 a[98:99], v12 offset:44128
    buffer_load_dwordx4 v65, s[20:23], s52 offen offset:1024 lds
    v_mfma_f32_16x16x32_bf16 v[180:183], a[76:79], a[16:19], v[180:183]
    s_waitcnt lgkmcnt(6)
    ds_read_b64_tr_b16 a[100:101], v12 offset:40576
    ds_read_b64_tr_b16 a[102:103], v12 offset:44160
    v_mfma_f32_16x16x32_bf16 v[184:187], a[80:83], a[16:19], v[184:187]
    s_waitcnt lgkmcnt(6)
    ds_read_b64_tr_b16 a[104:105], v12 offset:40608
    ds_read_b64_tr_b16 a[106:107], v12 offset:44192
    v_mfma_f32_16x16x32_bf16 v[160:163], a[84:87], a[20:23], v[160:163]
    s_waitcnt lgkmcnt(6)
    ds_read_b64_tr_b16 a[108:109], v12 offset:40640
    ds_read_b64_tr_b16 a[110:111], v12 offset:44224
    buffer_load_dwordx4 v66, s[20:23], s52 offen offset:2048 lds
    v_mfma_f32_16x16x32_bf16 v[164:167], a[88:91], a[20:23], v[164:167]
    ds_read_b64_tr_b16 a[112:113], v12 offset:47616
    ds_read_b64_tr_b16 a[114:115], v12 offset:51200
    v_mfma_f32_16x16x32_bf16 v[168:171], a[92:95], a[20:23], v[168:171]
    s_waitcnt lgkmcnt(6)
    ds_read_b64_tr_b16 a[116:117], v12 offset:47648
    ds_read_b64_tr_b16 a[118:119], v12 offset:51232
    v_mfma_f32_16x16x32_bf16 v[172:175], a[96:99], a[20:23], v[172:175]
    ds_read_b64_tr_b16 a[120:121], v12 offset:47680
    ds_read_b64_tr_b16 a[122:123], v12 offset:51264
    buffer_load_dwordx4 v67, s[20:23], s52 offen offset:3072 lds
    v_mfma_f32_16x16x32_bf16 v[176:179], a[100:103], a[20:23], v[176:179]
    s_waitcnt lgkmcnt(6)
    ds_read_b64_tr_b16 a[124:125], v12 offset:47712
    ds_read_b64_tr_b16 a[126:127], v12 offset:51296
    v_mfma_f32_16x16x32_bf16 v[180:183], a[104:107], a[20:23], v[180:183]
    ds_read_b64_tr_b16 a[64:65], v12 offset:47744
    ds_read_b64_tr_b16 a[66:67], v12 offset:51328
    v_mfma_f32_16x16x32_bf16 v[184:187], a[108:111], a[20:23], v[184:187]
    s_waitcnt lgkmcnt(6)
    ds_read_b64_tr_b16 a[68:69], v12 offset:47776
    ds_read_b64_tr_b16 a[70:71], v12 offset:51360
    s_add_u32 m0, s53, 69632
    s_nop 0
    buffer_load_dwordx4 v68, s[20:23], s52 offen offset:0 lds
    v_mfma_f32_16x16x32_bf16 v[160:163], a[112:115], a[24:27], v[160:163]
    ds_read_b64_tr_b16 a[72:73], v12 offset:47808
    ds_read_b64_tr_b16 a[74:75], v12 offset:51392
    v_mfma_f32_16x16x32_bf16 v[164:167], a[116:119], a[24:27], v[164:167]
    s_waitcnt lgkmcnt(6)
    ds_read_b64_tr_b16 a[76:77], v12 offset:54784
    ds_read_b64_tr_b16 a[78:79], v12 offset:58368
    v_mfma_f32_16x16x32_bf16 v[168:171], a[120:123], a[24:27], v[168:171]
    ds_read_b64_tr_b16 a[80:81], v12 offset:54816
    ds_read_b64_tr_b16 a[82:83], v12 offset:58400
    buffer_load_dwordx4 v69, s[20:23], s52 offen offset:1024 lds
    v_mfma_f32_16x16x32_bf16 v[172:175], a[124:127], a[24:27], v[172:175]
    s_waitcnt lgkmcnt(6)
    ds_read_b64_tr_b16 a[84:85], v12 offset:54848
    ds_read_b64_tr_b16 a[86:87], v12 offset:58432
    v_mfma_f32_16x16x32_bf16 v[176:179], a[64:67], a[24:27], v[176:179]
    ds_read_b64_tr_b16 a[88:89], v12 offset:54880
    ds_read_b64_tr_b16 a[90:91], v12 offset:58464
    v_mfma_f32_16x16x32_bf16 v[180:183], a[68:71], a[24:27], v[180:183]
    s_waitcnt lgkmcnt(6)
    ds_read_b64_tr_b16 a[92:93], v12 offset:54912
    ds_read_b64_tr_b16 a[94:95], v12 offset:58496
    buffer_load_dwordx4 v70, s[20:23], s52 offen offset:2048 lds
    v_mfma_f32_16x16x32_bf16 v[184:187], a[72:75], a[24:27], v[184:187]
    s_waitcnt lgkmcnt(6)
    ds_read_b64_tr_b16 a[96:97], v12 offset:54944
    ds_read_b64_tr_b16 a[98:99], v12 offset:58528
    v_mfma_f32_16x16x32_bf16 v[160:163], a[76:79], a[28:31], v[160:163]
    s_waitcnt lgkmcnt(6)
    ds_read_b64_tr_b16 a[100:101], v12 offset:54976
    ds_read_b64_tr_b16 a[102:103], v12 offset:58560
    v_mfma_f32_16x16x32_bf16 v[164:167], a[80:83], a[28:31], v[164:167]
    ds_read_b64_tr_b16 a[104:105], v13 offset:33280
    ds_read_b64_tr_b16 a[106:107], v13 offset:36864
    buffer_load_dwordx4 v71, s[20:23], s52 offen offset:3072 lds
    s_add_u32 s52, s52, 128
    v_mfma_f32_16x16x32_bf16 v[168:171], a[84:87], a[28:31], v[168:171]
    s_waitcnt lgkmcnt(6)
    ds_read_b64_tr_b16 a[108:109], v13 offset:33312
    ds_read_b64_tr_b16 a[110:111], v13 offset:36896
    v_mfma_f32_16x16x32_bf16 v[172:175], a[88:91], a[28:31], v[172:175]
    ds_read_b64_tr_b16 a[112:113], v13 offset:33344
    ds_read_b64_tr_b16 a[114:115], v13 offset:36928
    v_mfma_f32_16x16x32_bf16 v[176:179], a[92:95], a[28:31], v[176:179]
    s_waitcnt lgkmcnt(6)
    ds_read_b64_tr_b16 a[116:117], v13 offset:33376
    ds_read_b64_tr_b16 a[118:119], v13 offset:36960
    v_mfma_f32_16x16x32_bf16 v[180:183], a[96:99], a[28:31], v[180:183]
    ds_read_b64_tr_b16 a[120:121], v13 offset:33408
    ds_read_b64_tr_b16 a[122:123], v13 offset:36992
    v_mfma_f32_16x16x32_bf16 v[184:187], a[100:103], a[28:31], v[184:187]
    s_waitcnt lgkmcnt(6)
    ds_read_b64_tr_b16 a[124:125], v13 offset:33440
    ds_read_b64_tr_b16 a[126:127], v13 offset:37024
    v_mfma_f32_16x16x32_bf16 v[160:163], a[104:107], a[32:35], v[160:163]
    ds_read_b64_tr_b16 a[64:65], v13 offset:33472
    ds_read_b64_tr_b16 a[66:67], v13 offset:37056
    v_mfma_f32_16x16x32_bf16 v[164:167], a[108:111], a[32:35], v[164:167]
    s_waitcnt lgkmcnt(6)
    ds_read_b64_tr_b16 a[68:69], v13 offset:40448
    ds_read_b64_tr_b16 a[70:71], v13 offset:44032
    v_mfma_f32_16x16x32_bf16 v[168:171], a[112:115], a[32:35], v[168:171]
    ds_read_b64_tr_b16 a[72:73], v13 offset:40480
    ds_read_b64_tr_b16 a[74:75], v13 offset:44064
    v_mfma_f32_16x16x32_bf16 v[172:175], a[116:119], a[32:35], v[172:175]
    s_waitcnt lgkmcnt(6)
    ds_read_b64_tr_b16 a[76:77], v13 offset:40512
    ds_read_b64_tr_b16 a[78:79], v13 offset:44096
    v_mfma_f32_16x16x32_bf16 v[176:179], a[120:123], a[32:35], v[176:179]
    ds_read_b64_tr_b16 a[80:81], v13 offset:40544
    ds_read_b64_tr_b16 a[82:83], v13 offset:44128
    v_mfma_f32_16x16x32_bf16 v[180:183], a[124:127], a[32:35], v[180:183]
    s_waitcnt lgkmcnt(6)
    ds_read_b64_tr_b16 a[84:85], v13 offset:40576
    ds_read_b64_tr_b16 a[86:87], v13 offset:44160
    v_mfma_f32_16x16x32_bf16 v[184:187], a[64:67], a[32:35], v[184:187]
    s_waitcnt lgkmcnt(6)
    ds_read_b64_tr_b16 a[88:89], v13 offset:40608
    ds_read_b64_tr_b16 a[90:91], v13 offset:44192
    v_mfma_f32_16x16x32_bf16 v[160:163], a[68:71], a[36:39], v[160:163]
    s_waitcnt lgkmcnt(6)
    ds_read_b64_tr_b16 a[92:93], v13 offset:40640
    ds_read_b64_tr_b16 a[94:95], v13 offset:44224
    v_mfma_f32_16x16x32_bf16 v[164:167], a[72:75], a[36:39], v[164:167]
    ds_read_b64_tr_b16 a[96:97], v13 offset:47616
    ds_read_b64_tr_b16 a[98:99], v13 offset:51200
    v_mfma_f32_16x16x32_bf16 v[168:171], a[76:79], a[36:39], v[168:171]
    s_waitcnt lgkmcnt(6)
    ds_read_b64_tr_b16 a[100:101], v13 offset:47648
    ds_read_b64_tr_b16 a[102:103], v13 offset:51232
    v_mfma_f32_16x16x32_bf16 v[172:175], a[80:83], a[36:39], v[172:175]
    ds_read_b64_tr_b16 a[104:105], v13 offset:47680
    ds_read_b64_tr_b16 a[106:107], v13 offset:51264
    v_mfma_f32_16x16x32_bf16 v[176:179], a[84:87], a[36:39], v[176:179]
    s_waitcnt lgkmcnt(6)
    ds_read_b64_tr_b16 a[108:109], v13 offset:47712
    ds_read_b64_tr_b16 a[110:111], v13 offset:51296
    v_mfma_f32_16x16x32_bf16 v[180:183], a[88:91], a[36:39], v[180:183]
    ds_read_b64_tr_b16 a[112:113], v13 offset:47744
    ds_read_b64_tr_b16 a[114:115], v13 offset:51328
    v_mfma_f32_16x16x32_bf16 v[184:187], a[92:95], a[36:39], v[184:187]
    s_waitcnt lgkmcnt(6)
    ds_read_b64_tr_b16 a[116:117], v13 offset:47776
    ds_read_b64_tr_b16 a[118:119], v13 offset:51360
    v_mfma_f32_16x16x32_bf16 v[160:163], a[96:99], a[40:43], v[160:163]
    ds_read_b64_tr_b16 a[120:121], v13 offset:47808
    ds_read_b64_tr_b16 a[122:123], v13 offset:51392
    v_mfma_f32_16x16x32_bf16 v[164:167], a[100:103], a[40:43], v[164:167]
    s_waitcnt lgkmcnt(6)
    ds_read_b64_tr_b16 a[124:125], v13 offset:54784
    ds_read_b64_tr_b16 a[126:127], v13 offset:58368
    v_mfma_f32_16x16x32_bf16 v[168:171], a[104:107], a[40:43], v[168:171]
    ds_read_b64_tr_b16 a[64:65], v13 offset:54816
    ds_read_b64_tr_b16 a[66:67], v13 offset:58400
    v_mfma_f32_16x16x32_bf16 v[172:175], a[108:111], a[40:43], v[172:175]
    s_waitcnt lgkmcnt(6)
    ds_read_b64_tr_b16 a[68:69], v13 offset:54848
    ds_read_b64_tr_b16 a[70:71], v13 offset:58432
    v_mfma_f32_16x16x32_bf16 v[176:179], a[112:115], a[40:43], v[176:179]
    ds_read_b64_tr_b16 a[72:73], v13 offset:54880
    ds_read_b64_tr_b16 a[74:75], v13 offset:58464
    v_mfma_f32_16x16x32_bf16 v[180:183], a[116:119], a[40:43], v[180:183]
    s_waitcnt lgkmcnt(6)
    ds_read_b64_tr_b16 a[76:77], v13 offset:54912
    ds_read_b64_tr_b16 a[78:79], v13 offset:58496
    buffer_load_dwordx4 v[32:35], v9, s[24:27], s12 offen sc1
    v_mfma_f32_16x16x32_bf16 v[184:187], a[120:123], a[40:43], v[184:187]
    s_waitcnt lgkmcnt(6)
    ds_read_b64_tr_b16 a[80:81], v13 offset:54944
    ds_read_b64_tr_b16 a[82:83], v13 offset:58528
    v_mfma_f32_16x16x32_bf16 v[160:163], a[124:127], a[44:47], v[160:163]
    s_waitcnt lgkmcnt(6)
    ds_read_b64_tr_b16 a[84:85], v13 offset:54976
    ds_read_b64_tr_b16 a[86:87], v13 offset:58560
    v_mfma_f32_16x16x32_bf16 v[164:167], a[64:67], a[44:47], v[164:167]
    ds_read_b64_tr_b16 a[88:89], v14 offset:0
    ds_read_b64_tr_b16 a[90:91], v14 offset:3584
    v_mfma_f32_16x16x32_bf16 v[168:171], a[68:71], a[44:47], v[168:171]
    s_waitcnt lgkmcnt(6)
    ds_read_b64_tr_b16 a[92:93], v14 offset:32
    ds_read_b64_tr_b16 a[94:95], v14 offset:3616
    v_mfma_f32_16x16x32_bf16 v[172:175], a[72:75], a[44:47], v[172:175]
    ds_read_b64_tr_b16 a[96:97], v14 offset:64
    ds_read_b64_tr_b16 a[98:99], v14 offset:3648
    v_mfma_f32_16x16x32_bf16 v[176:179], a[76:79], a[44:47], v[176:179]
    s_waitcnt lgkmcnt(6)
    ds_read_b64_tr_b16 a[100:101], v14 offset:96
    ds_read_b64_tr_b16 a[102:103], v14 offset:3680
    v_mfma_f32_16x16x32_bf16 v[180:183], a[80:83], a[44:47], v[180:183]
    ds_read_b64_tr_b16 a[104:105], v14 offset:128
    ds_read_b64_tr_b16 a[106:107], v14 offset:3712
    v_mfma_f32_16x16x32_bf16 v[184:187], a[84:87], a[44:47], v[184:187]
    s_waitcnt lgkmcnt(6)
    ds_read_b64_tr_b16 a[108:109], v14 offset:160
    ds_read_b64_tr_b16 a[110:111], v14 offset:3744
    v_mfma_f32_16x16x32_bf16 v[160:163], a[88:91], a[48:51], v[160:163]
    ds_read_b64_tr_b16 a[112:113], v14 offset:192
    ds_read_b64_tr_b16 a[114:115], v14 offset:3776
    v_mfma_f32_16x16x32_bf16 v[164:167], a[92:95], a[48:51], v[164:167]
    s_waitcnt lgkmcnt(6)
    ds_read_b64_tr_b16 a[116:117], v14 offset:7168
    ds_read_b64_tr_b16 a[118:119], v14 offset:10752
    v_mfma_f32_16x16x32_bf16 v[168:171], a[96:99], a[48:51], v[168:171]
    ds_read_b64_tr_b16 a[120:121], v14 offset:7200
    ds_read_b64_tr_b16 a[122:123], v14 offset:10784
    v_mfma_f32_16x16x32_bf16 v[172:175], a[100:103], a[48:51], v[172:175]
    s_waitcnt lgkmcnt(6)
    ds_read_b64_tr_b16 a[124:125], v14 offset:7232
    ds_read_b64_tr_b16 a[126:127], v14 offset:10816
    v_mfma_f32_16x16x32_bf16 v[176:179], a[104:107], a[48:51], v[176:179]
    ds_read_b64_tr_b16 a[64:65], v14 offset:7264
    ds_read_b64_tr_b16 a[66:67], v14 offset:10848
    v_mfma_f32_16x16x32_bf16 v[180:183], a[108:111], a[48:51], v[180:183]
    s_waitcnt lgkmcnt(6)
    ds_read_b64_tr_b16 a[68:69], v14 offset:7296
    ds_read_b64_tr_b16 a[70:71], v14 offset:10880
    v_mfma_f32_16x16x32_bf16 v[184:187], a[112:115], a[48:51], v[184:187]
    s_waitcnt lgkmcnt(6)
    ds_read_b64_tr_b16 a[72:73], v14 offset:7328
    ds_read_b64_tr_b16 a[74:75], v14 offset:10912
    v_mfma_f32_16x16x32_bf16 v[160:163], a[116:119], a[52:55], v[160:163]
    s_waitcnt lgkmcnt(6)
    ds_read_b64_tr_b16 a[76:77], v14 offset:7360
    ds_read_b64_tr_b16 a[78:79], v14 offset:10944
    v_mfma_f32_16x16x32_bf16 v[164:167], a[120:123], a[52:55], v[164:167]
    v_mfma_f32_16x16x32_bf16 v[168:171], a[124:127], a[52:55], v[168:171]
    s_waitcnt lgkmcnt(4)
    v_mfma_f32_16x16x32_bf16 v[172:175], a[64:67], a[52:55], v[172:175]
    v_mfma_f32_16x16x32_bf16 v[176:179], a[68:71], a[52:55], v[176:179]
    s_waitcnt lgkmcnt(0)
    v_mfma_f32_16x16x32_bf16 v[180:183], a[72:75], a[52:55], v[180:183]
    v_mfma_f32_16x16x32_bf16 v[184:187], a[76:79], a[52:55], v[184:187]
    s_mov_b32 s56, 0x100000
    s_waitcnt vmcnt(0)
    s_branch L_sp2adaLN_cond__gqa_block_cached__mixer_gmlp__prompt_kernel
L_sp1adaLN_cond__gqa_block_cached__mixer_gmlp__prompt_kernel:
    buffer_load_dwordx4 v[32:35], v9, s[24:27], s12 offen sc1
    s_waitcnt vmcnt(0)
L_sp2adaLN_cond__gqa_block_cached__mixer_gmlp__prompt_kernel:
    v_and_b32 v36, v33, v35
    v_cmp_le_i32 vcc, 0, v36
    s_cbranch_vccz L_sp3adaLN_cond__gqa_block_cached__mixer_gmlp__prompt_kernel
    s_sub_u32 s56, s56, 1
    s_cmp_lg_u32 s56, 0
    s_cbranch_scc1 L_sp1adaLN_cond__gqa_block_cached__mixer_gmlp__prompt_kernel
L_sp3adaLN_cond__gqa_block_cached__mixer_gmlp__prompt_kernel:
    v_add_f32_dpp v32, v32, v32 quad_perm:[1,0,3,2] row_mask:0xf bank_mask:0xf
    v_add_f32_dpp v33, v33, v33 quad_perm:[1,0,3,2] row_mask:0xf bank_mask:0xf
    v_add_f32_dpp v34, v34, v34 quad_perm:[1,0,3,2] row_mask:0xf bank_mask:0xf
    v_add_f32_dpp v35, v35, v35 quad_perm:[1,0,3,2] row_mask:0xf bank_mask:0xf
    v_add_f32_dpp v32, v32, v32 quad_perm:[2,3,0,1] row_mask:0xf bank_mask:0xf
    v_add_f32_dpp v33, v33, v33 quad_perm:[2,3,0,1] row_mask:0xf bank_mask:0xf
    v_add_f32_dpp v34, v34, v34 quad_perm:[2,3,0,1] row_mask:0xf bank_mask:0xf
    v_add_f32_dpp v35, v35, v35 quad_perm:[2,3,0,1] row_mask:0xf bank_mask:0xf
    v_add_f32_dpp v32, v32, v32 row_half_mirror row_mask:0xf bank_mask:0xf
    v_add_f32_dpp v33, v33, v33 row_half_mirror row_mask:0xf bank_mask:0xf
    v_add_f32_dpp v34, v34, v34 row_half_mirror row_mask:0xf bank_mask:0xf
    v_add_f32_dpp v35, v35, v35 row_half_mirror row_mask:0xf bank_mask:0xf
    v_mul_f32 v38, 982665509, v32
    v_mul_f32 v36, 3130149157, v33
    v_fma_f32 v36, -v38, v38, v36
    v_max_f32 v36, 0, v36
    v_add_f32 v36, 925353388, v36
    v_rsq_f32 v36, v36
    s_nop 0
    v_mul_f32 v38, -v38, v36
    v_mul_f32 v39, 982665509, v34
    v_mul_f32 v37, 3130149157, v35
    v_fma_f32 v37, -v39, v39, v37
    v_max_f32 v37, 0, v37
    v_add_f32 v37, 925353388, v37
    v_rsq_f32 v37, v37
    s_nop 0
    v_mul_f32 v39, -v39, v37
    v_mov_b32 v40, v36
    v_mov_b32 v44, v36
    v_mov_b32 v41, v37
    v_mov_b32 v45, v37
    v_mov_b32 v42, v38
    v_mov_b32 v46, v38
    v_mov_b32 v43, v39
    v_mov_b32 v47, v39
    v_mov_b32_dpp v40, v36 row_ror:8 row_mask:0xf bank_mask:0xc
    v_mov_b32_dpp v44, v36 row_ror:8 row_mask:0xf bank_mask:0x3
    v_mov_b32_dpp v41, v37 row_ror:8 row_mask:0xf bank_mask:0xc
    v_mov_b32_dpp v45, v37 row_ror:8 row_mask:0xf bank_mask:0x3
    v_mov_b32_dpp v42, v38 row_ror:8 row_mask:0xf bank_mask:0xc
    v_mov_b32_dpp v46, v38 row_ror:8 row_mask:0xf bank_mask:0x3
    v_mov_b32_dpp v43, v39 row_ror:8 row_mask:0xf bank_mask:0xc
    v_mov_b32_dpp v47, v39 row_ror:8 row_mask:0xf bank_mask:0x3
    v_pk_fma_f32 v[128:129], v[128:129], v[40:41], v[42:43]
    v_pk_fma_f32 v[130:131], v[130:131], v[44:45], v[46:47]
    v_pk_fma_f32 v[132:133], v[132:133], v[40:41], v[42:43]
    v_pk_fma_f32 v[134:135], v[134:135], v[44:45], v[46:47]
    v_cvt_pk_bf16_f32 v24, v128, v129
    v_cvt_pk_bf16_f32 v25, v130, v131
    v_cvt_pk_bf16_f32 v26, v132, v133
    v_cvt_pk_bf16_f32 v27, v134, v135
    s_nop 0
    v_permlane16_swap_b32 v24, v26
    v_permlane16_swap_b32 v25, v27
    buffer_store_dwordx4 v[24:27], v10, s[24:27], s38 offen offset:0 sc1
    v_pk_fma_f32 v[136:137], v[136:137], v[40:41], v[42:43]
    v_pk_fma_f32 v[138:139], v[138:139], v[44:45], v[46:47]
    v_pk_fma_f32 v[140:141], v[140:141], v[40:41], v[42:43]
    v_pk_fma_f32 v[142:143], v[142:143], v[44:45], v[46:47]
    v_cvt_pk_bf16_f32 v28, v136, v137
    v_cvt_pk_bf16_f32 v29, v138, v139
    v_cvt_pk_bf16_f32 v30, v140, v141
    v_cvt_pk_bf16_f32 v31, v142, v143
    s_nop 0
    v_permlane16_swap_b32 v28, v30
    v_permlane16_swap_b32 v29, v31
    buffer_store_dwordx4 v[28:31], v10, s[24:27], s38 offen offset:2048 sc1
    v_pk_fma_f32 v[144:145], v[144:145], v[40:41], v[42:43]
    v_pk_fma_f32 v[146:147], v[146:147], v[44:45], v[46:47]
    v_pk_fma_f32 v[148:149], v[148:149], v[40:41], v[42:43]
    v_pk_fma_f32 v[150:151], v[150:151], v[44:45], v[46:47]
    v_cvt_pk_bf16_f32 v24, v144, v145
    v_cvt_pk_bf16_f32 v25, v146, v147
    v_cvt_pk_bf16_f32 v26, v148, v149
    v_cvt_pk_bf16_f32 v27, v150, v151
    s_nop 0
    v_permlane16_swap_b32 v24, v26
    v_permlane16_swap_b32 v25, v27
    buffer_store_dwordx4 v[24:27], v10, s[24:27], s39 offen offset:0 sc1
    v_pk_fma_f32 v[152:153], v[152:153], v[40:41], v[42:43]
    v_pk_fma_f32 v[154:155], v[154:155], v[44:45], v[46:47]
    v_cvt_pk_bf16_f32 v28, v152, v153
    v_cvt_pk_bf16_f32 v29, v154, v155
    v_cvt_pk_bf16_f32 v30, v152, v153
    v_cvt_pk_bf16_f32 v31, v154, v155
    s_nop 0
    v_permlane16_swap_b32 v28, v30
    v_permlane16_swap_b32 v29, v31
    buffer_store_dwordx4 v[28:31], v11, s[24:27], s39 offen offset:2048 sc1
    s_barrier
    s_add_u32 m0, s53, 32768
    s_nop 0
    buffer_load_dwordx4 v64, s[20:23], s52 offen offset:0 lds
    v_pk_mul_f32 v[96:97], v[160:161], v[160:161]
    v_pk_mul_f32 v[98:99], v[162:163], v[162:163]
    v_pk_mul_f32 v[100:101], v[164:165], v[164:165]
    v_pk_mul_f32 v[102:103], v[166:167], v[166:167]
    v_pk_fma_f32 v[96:97], v[96:97], v[4:5], v[6:7] op_sel_hi:[1,0,0]
    v_pk_fma_f32 v[98:99], v[98:99], v[4:5], v[6:7] op_sel_hi:[1,0,0]
    v_pk_fma_f32 v[100:101], v[100:101], v[4:5], v[6:7] op_sel_hi:[1,0,0]
    v_pk_fma_f32 v[102:103], v[102:103], v[4:5], v[6:7] op_sel_hi:[1,0,0]
    buffer_load_dwordx4 v65, s[20:23], s52 offen offset:1024 lds
    v_pk_mul_f32 v[96:97], v[96:97], v[160:161]
    v_pk_mul_f32 v[98:99], v[98:99], v[162:163]
    v_pk_mul_f32 v[100:101], v[100:101], v[164:165]
    v_pk_mul_f32 v[102:103], v[102:103], v[166:167]
    v_exp_f32 v96, v96
    v_exp_f32 v97, v97
    v_exp_f32 v98, v98
    v_exp_f32 v99, v99
    buffer_load_dwordx4 v66, s[20:23], s52 offen offset:2048 lds
    v_exp_f32 v100, v100
    v_exp_f32 v101, v101
    v_exp_f32 v102, v102
    v_exp_f32 v103, v103
    v_pk_add_f32 v[96:97], v[96:97], 1.0 op_sel_hi:[1,0]
    v_pk_add_f32 v[98:99], v[98:99], 1.0 op_sel_hi:[1,0]
    v_pk_add_f32 v[100:101], v[100:101], 1.0 op_sel_hi:[1,0]
    v_pk_add_f32 v[102:103], v[102:103], 1.0 op_sel_hi:[1,0]
    buffer_load_dwordx4 v67, s[20:23], s52 offen offset:3072 lds
    v_rcp_f32 v96, v96
    v_rcp_f32 v97, v97
    v_rcp_f32 v98, v98
    v_rcp_f32 v99, v99
    v_rcp_f32 v100, v100
    v_rcp_f32 v101, v101
    v_rcp_f32 v102, v102
    v_rcp_f32 v103, v103
    s_add_u32 m0, s53, 36864
    s_nop 0
    buffer_load_dwordx4 v68, s[20:23], s52 offen offset:0 lds
    v_pk_mul_f32 v[160:161], v[160:161], v[96:97]
    v_pk_mul_f32 v[162:163], v[162:163], v[98:99]
    v_pk_mul_f32 v[164:165], v[164:165], v[100:101]
    v_pk_mul_f32 v[166:167], v[166:167], v[102:103]
    v_pk_mul_f32 v[96:97], v[168:169], v[168:169]
    v_pk_mul_f32 v[98:99], v[170:171], v[170:171]
    v_pk_mul_f32 v[100:101], v[172:173], v[172:173]
    v_pk_mul_f32 v[102:103], v[174:175], v[174:175]
    buffer_load_dwordx4 v69, s[20:23], s52 offen offset:1024 lds
    v_pk_fma_f32 v[96:97], v[96:97], v[4:5], v[6:7] op_sel_hi:[1,0,0]
    v_pk_fma_f32 v[98:99], v[98:99], v[4:5], v[6:7] op_sel_hi:[1,0,0]
    v_pk_fma_f32 v[100:101], v[100:101], v[4:5], v[6:7] op_sel_hi:[1,0,0]
    v_pk_fma_f32 v[102:103], v[102:103], v[4:5], v[6:7] op_sel_hi:[1,0,0]
    v_pk_mul_f32 v[96:97], v[96:97], v[168:169]
    v_pk_mul_f32 v[98:99], v[98:99], v[170:171]
    v_pk_mul_f32 v[100:101], v[100:101], v[172:173]
    v_pk_mul_f32 v[102:103], v[102:103], v[174:175]
    buffer_load_dwordx4 v70, s[20:23], s52 offen offset:2048 lds
    v_exp_f32 v96, v96
    v_exp_f32 v97, v97
    v_exp_f32 v98, v98
    v_exp_f32 v99, v99
    v_exp_f32 v100, v100
    v_exp_f32 v101, v101
    v_exp_f32 v102, v102
    v_exp_f32 v103, v103
    buffer_load_dwordx4 v71, s[20:23], s52 offen offset:3072 lds
    s_add_u32 s52, s52, 128
    v_pk_add_f32 v[96:97], v[96:97], 1.0 op_sel_hi:[1,0]
    v_pk_add_f32 v[98:99], v[98:99], 1.0 op_sel_hi:[1,0]
    v_pk_add_f32 v[100:101], v[100:101], 1.0 op_sel_hi:[1,0]
    v_pk_add_f32 v[102:103], v[102:103], 1.0 op_sel_hi:[1,0]
    v_rcp_f32 v96, v96
    v_rcp_f32 v97, v97
    v_rcp_f32 v98, v98
    v_rcp_f32 v99, v99
    s_add_u32 m0, s53, 98304
    s_nop 0
    buffer_load_dwordx4 v64, s[20:23], s52 offen offset:0 lds
    v_rcp_f32 v100, v100
    v_rcp_f32 v101, v101
    v_rcp_f32 v102, v102
    v_rcp_f32 v103, v103
    v_pk_mul_f32 v[168:169], v[168:169], v[96:97]
    v_pk_mul_f32 v[170:171], v[170:171], v[98:99]
    v_pk_mul_f32 v[172:173], v[172:173], v[100:101]
    v_pk_mul_f32 v[174:175], v[174:175], v[102:103]
    buffer_load_dwordx4 v65, s[20:23], s52 offen offset:1024 lds
    v_pk_mul_f32 v[96:97], v[176:177], v[176:177]
    v_pk_mul_f32 v[98:99], v[178:179], v[178:179]
    v_pk_mul_f32 v[100:101], v[180:181], v[180:181]
    v_pk_mul_f32 v[102:103], v[182:183], v[182:183]
    v_pk_fma_f32 v[96:97], v[96:97], v[4:5], v[6:7] op_sel_hi:[1,0,0]
    v_pk_fma_f32 v[98:99], v[98:99], v[4:5], v[6:7] op_sel_hi:[1,0,0]
    v_pk_fma_f32 v[100:101], v[100:101], v[4:5], v[6:7] op_sel_hi:[1,0,0]
    v_pk_fma_f32 v[102:103], v[102:103], v[4:5], v[6:7] op_sel_hi:[1,0,0]
    buffer_load_dwordx4 v66, s[20:23], s52 offen offset:2048 lds
    v_pk_mul_f32 v[96:97], v[96:97], v[176:177]
    v_pk_mul_f32 v[98:99], v[98:99], v[178:179]
    v_pk_mul_f32 v[100:101], v[100:101], v[180:181]
    v_pk_mul_f32 v[102:103], v[102:103], v[182:183]
    v_exp_f32 v96, v96
    v_exp_f32 v97, v97
    v_exp_f32 v98, v98
    v_exp_f32 v99, v99
    buffer_load_dwordx4 v67, s[20:23], s52 offen offset:3072 lds
    v_exp_f32 v100, v100
    v_exp_f32 v101, v101
    v_exp_f32 v102, v102
    v_exp_f32 v103, v103
    v_pk_add_f32 v[96:97], v[96:97], 1.0 op_sel_hi:[1,0]
    v_pk_add_f32 v[98:99], v[98:99], 1.0 op_sel_hi:[1,0]
    v_pk_add_f32 v[100:101], v[100:101], 1.0 op_sel_hi:[1,0]
    v_pk_add_f32 v[102:103], v[102:103], 1.0 op_sel_hi:[1,0]
    s_add_u32 m0, s53, 102400
    s_nop 0
    buffer_load_dwordx4 v68, s[20:23], s52 offen offset:0 lds
    v_rcp_f32 v96, v96
    v_rcp_f32 v97, v97
    v_rcp_f32 v98, v98
    v_rcp_f32 v99, v99
    v_rcp_f32 v100, v100
    v_rcp_f32 v101, v101
    v_rcp_f32 v102, v102
    v_rcp_f32 v103, v103
    buffer_load_dwordx4 v69, s[20:23], s52 offen offset:1024 lds
    v_pk_mul_f32 v[176:177], v[176:177], v[96:97]
    v_pk_mul_f32 v[178:179], v[178:179], v[98:99]
    v_pk_mul_f32 v[180:181], v[180:181], v[100:101]
    v_pk_mul_f32 v[182:183], v[182:183], v[102:103]
    v_pk_mul_f32 v[96:97], v[184:185], v[184:185]
    v_pk_mul_f32 v[98:99], v[186:187], v[186:187]
    v_pk_fma_f32 v[96:97], v[96:97], v[4:5], v[6:7] op_sel_hi:[1,0,0]
    v_pk_fma_f32 v[98:99], v[98:99], v[4:5], v[6:7] op_sel_hi:[1,0,0]
    buffer_load_dwordx4 v70, s[20:23], s52 offen offset:2048 lds
    v_pk_mul_f32 v[96:97], v[96:97], v[184:185]
    v_pk_mul_f32 v[98:99], v[98:99], v[186:187]
    v_exp_f32 v96, v96
    v_exp_f32 v97, v97
    v_exp_f32 v98, v98
    v_exp_f32 v99, v99
    v_pk_add_f32 v[96:97], v[96:97], 1.0 op_sel_hi:[1,0]
    v_pk_add_f32 v[98:99], v[98:99], 1.0 op_sel_hi:[1,0]
    buffer_load_dwordx4 v71, s[20:23], s52 offen offset:3072 lds
    s_add_u32 s52, s52, 128
    v_rcp_f32 v96, v96
    v_rcp_f32 v97, v97
    v_rcp_f32 v98, v98
    v_rcp_f32 v99, v99
    v_pk_mul_f32 v[184:185], v[184:185], v[96:97]
    v_pk_mul_f32 v[186:187], v[186:187], v[98:99]
    v_cvt_pk_bf16_f32 v80, v160, v161
    v_cvt_pk_bf16_f32 v81, v162, v163
    v_cvt_pk_bf16_f32 v82, v164, v165
    v_cvt_pk_bf16_f32 v83, v166, v167
    v_cvt_pk_bf16_f32 v84, v168, v169
    v_cvt_pk_bf16_f32 v85, v170, v171
    v_cvt_pk_bf16_f32 v86, v172, v173
    v_cvt_pk_bf16_f32 v87, v174, v175
    v_cvt_pk_bf16_f32 v88, v176, v177
    v_cvt_pk_bf16_f32 v89, v178, v179
    v_cvt_pk_bf16_f32 v90, v180, v181
    v_cvt_pk_bf16_f32 v91, v182, v183
    v_cvt_pk_bf16_f32 v92, v184, v185
    v_cvt_pk_bf16_f32 v93, v186, v187
    s_waitcnt vmcnt(16)
    s_barrier
    s_cmp_lg_u32 s28, 0
    s_cbranch_scc1 L_sig_gadaLN_cond__gqa_block_cached__mixer_gmlp__prompt_kernel
    v_mov_b32 v48, 1
    v_mov_b32 v49, 0
    s_mov_b64 exec, 1
    buffer_atomic_add v48, v49, s[24:27], s14 offen sc1
    s_mov_b64 exec, -1
L_sig_gadaLN_cond__gqa_block_cached__mixer_gmlp__prompt_kernel:
    s_load_dwordx2 s[4:5], s[0:1], 64
    s_load_dwordx2 s[6:7], s[0:1], 96
    s_add_u32 m0, s53, 131072
    s_nop 0
    buffer_load_dwordx4 v64, s[20:23], s52 offen offset:0 lds
    buffer_load_dwordx4 v65, s[20:23], s52 offen offset:1024 lds
    buffer_load_dwordx4 v66, s[20:23], s52 offen offset:2048 lds
    buffer_load_dwordx4 v67, s[20:23], s52 offen offset:3072 lds
    s_add_u32 m0, s53, 135168
    s_nop 0
    buffer_load_dwordx4 v68, s[20:23], s52 offen offset:0 lds
    buffer_load_dwordx4 v69, s[20:23], s52 offen offset:1024 lds
    buffer_load_dwordx4 v70, s[20:23], s52 offen offset:2048 lds
    buffer_load_dwordx4 v71, s[20:23], s52 offen offset:3072 lds
    s_add_u32 s52, s52, 128
    v_lshrrev_b32 v9, 1, v3
    v_xor_b32 v9, v9, v8
    v_lshlrev_b32 v9, 4, v9
    v_lshl_add_u32 v9, v3, 7, v9
    v_add_u32 v72, s53, v9
    v_xor_b32 v73, 64, v72
    v_add_u32 v74, 0x10000, v72
    v_add_u32 v75, 0x10000, v73
    v_add_u32 v76, 0x20000, v72
    v_add_u32 v77, 0x20000, v73
    s_lshl_b32 s35, s58, 5
    v_lshlrev_b32 v12, 1, v3
    v_mov_b32 v49, 0
    s_waitcnt lgkmcnt(0)
    s_mov_b32 s16, s4
    s_mov_b32 s17, s5
    s_mov_b32 s18, 4096
    s_mov_b32 s19, 0x20000
    s_mov_b32 s44, s8
    s_mov_b32 s45, s9
    s_mov_b32 s46, 802816
    s_mov_b32 s47, 0x20000
    s_mov_b32 s40, s6
    s_mov_b32 s41, s7
    s_mov_b32 s42, 1835008
    s_mov_b32 s43, 0x20000
    buffer_load_ushort v94, v12, s[16:19], s35 offen
    s_lshl_b32 s33, s29, 2
    s_and_b32 s32, s30, 3
    s_add_u32 s33, s33, s32
    s_lshr_b32 s32, s30, 2
    v_lshrrev_b32 v54, 3, v1
    v_mul_u32_u24 v54, 896, v54
    v_lshlrev_b32 v55, 1, v8
    v_and_b32 v50, 7, v0
    v_xor_b32 v55, v55, v50
    v_lshl_add_u32 v50, v55, 4, v54
    v_add_u32 v51, 6144, v50
    v_add_u32 v52, 12288, v50
    v_add_u32 v53, 18432, v50
    s_mul_i32 s59, s28, 200704
    s_lshl_b32 s57, s32, 7
    s_add_u32 s59, s59, s57
    ds_read_b128 a[144:147], v72 offset:0
    ds_read_b128 a[148:151], v72 offset:2048
    ds_read_b128 a[152:155], v72 offset:4096
    ds_read_b128 a[156:159], v72 offset:6144
    ds_read_b128 a[160:163], v73 offset:0
    ds_read_b128 a[164:167], v73 offset:2048
    ds_read_b128 a[168:171], v73 offset:4096
    ds_read_b128 a[172:175], v73 offset:6144
    ds_read_b128 a[176:179], v74 offset:0
    ds_read_b128 a[180:183], v74 offset:2048
    ds_read_b128 a[184:187], v74 offset:4096
    ds_read_b128 a[188:191], v74 offset:6144
    ds_read_b128 a[192:195], v75 offset:0
    ds_read_b128 a[196:199], v75 offset:2048
    ds_read_b128 a[200:203], v75 offset:4096
    ds_read_b128 a[204:207], v75 offset:6144
    s_waitcnt vmcnt(17)
    ds_read_b128 a[208:211], v72 offset:32768
    ds_read_b128 a[212:215], v72 offset:34816
    ds_read_b128 a[216:219], v72 offset:36864
    ds_read_b128 a[220:223], v72 offset:38912
    ds_read_b128 a[224:227], v73 offset:32768
    ds_read_b128 a[228:231], v73 offset:34816
    ds_read_b128 a[232:235], v73 offset:36864
    ds_read_b128 a[236:239], v73 offset:38912
    s_waitcnt lgkmcnt(15)
    s_add_u32 m0, s53, 0
    s_nop 0
    buffer_load_dwordx4 v64, s[20:23], s52 offen offset:0 lds
    buffer_load_dwordx4 v65, s[20:23], s52 offen offset:1024 lds
    buffer_load_dwordx4 v66, s[20:23], s52 offen offset:2048 lds
    buffer_load_dwordx4 v67, s[20:23], s52 offen offset:3072 lds
    s_add_u32 m0, s53, 4096
    s_nop 0
    buffer_load_dwordx4 v68, s[20:23], s52 offen offset:0 lds
    buffer_load_dwordx4 v69, s[20:23], s52 offen offset:1024 lds
    buffer_load_dwordx4 v70, s[20:23], s52 offen offset:2048 lds
    buffer_load_dwordx4 v71, s[20:23], s52 offen offset:3072 lds
    s_add_u32 s52, s52, 128
    s_waitcnt lgkmcnt(8)
    s_add_u32 m0, s53, 65536
    s_nop 0
    buffer_load_dwordx4 v64, s[20:23], s52 offen offset:0 lds
    buffer_load_dwordx4 v65, s[20:23], s52 offen offset:1024 lds
    buffer_load_dwordx4 v66, s[20:23], s52 offen offset:2048 lds
    buffer_load_dwordx4 v67, s[20:23], s52 offen offset:3072 lds
    s_add_u32 m0, s53, 69632
    s_nop 0
    buffer_load_dwordx4 v68, s[20:23], s52 offen offset:0 lds
    buffer_load_dwordx4 v69, s[20:23], s52 offen offset:1024 lds
    buffer_load_dwordx4 v70, s[20:23], s52 offen offset:2048 lds
    buffer_load_dwordx4 v71, s[20:23], s52 offen offset:3072 lds
    s_add_u32 s52, s52, 128
    s_waitcnt lgkmcnt(0)
    s_add_u32 m0, s53, 32768
    s_nop 0
    buffer_load_dwordx4 v64, s[20:23], s52 offen offset:0 lds
    buffer_load_dwordx4 v65, s[20:23], s52 offen offset:1024 lds
    buffer_load_dwordx4 v66, s[20:23], s52 offen offset:2048 lds
    buffer_load_dwordx4 v67, s[20:23], s52 offen offset:3072 lds
    s_add_u32 m0, s53, 36864
    s_nop 0
    buffer_load_dwordx4 v68, s[20:23], s52 offen offset:0 lds
    buffer_load_dwordx4 v69, s[20:23], s52 offen offset:1024 lds
    buffer_load_dwordx4 v70, s[20:23], s52 offen offset:2048 lds
    buffer_load_dwordx4 v71, s[20:23], s52 offen offset:3072 lds
    s_add_u32 s52, s52, 128
    s_mov_b32 s56, 0x100000
L_poll_gadaLN_cond__gqa_block_cached__mixer_gmlp__prompt_kernel:
    buffer_load_dword v48, v49, s[24:27], s15 offen sc1
    s_waitcnt vmcnt(0)
    v_cmp_gt_u32 vcc, 8, v48
    s_cbranch_vccz L_polled_gadaLN_cond__gqa_block_cached__mixer_gmlp__prompt_kernel
    s_sleep 1
    s_sub_u32 s56, s56, 1
    s_cmp_lg_u32 s56, 0
    s_cbranch_scc1 L_poll_gadaLN_cond__gqa_block_cached__mixer_gmlp__prompt_kernel
L_polled_gadaLN_cond__gqa_block_cached__mixer_gmlp__prompt_kernel:
    buffer_load_dwordx4 a[0:3], v2, s[24:27], s54 offen offset:0 sc1
    buffer_load_dwordx4 a[4:7], v2, s[24:27], s54 offen offset:1024 sc1
    buffer_load_dwordx4 a[8:11], v2, s[24:27], s54 offen offset:2048 sc1
    buffer_load_dwordx4 a[12:15], v2, s[24:27], s54 offen offset:3072 sc1
    buffer_load_dwordx4 a[16:19], v2, s[24:27], s55 offen offset:0 sc1
    buffer_load_dwordx4 a[20:23], v2, s[24:27], s55 offen offset:1024 sc1
    buffer_load_dwordx4 a[24:27], v2, s[24:27], s55 offen offset:2048 sc1
    s_add_u32 s54, s54, 7168
    s_add_u32 s55, s55, 7168
    buffer_load_dwordx4 a[28:31], v2, s[24:27], s54 offen offset:0 sc1
    buffer_load_dwordx4 a[32:35], v2, s[24:27], s54 offen offset:1024 sc1
    buffer_load_dwordx4 a[36:39], v2, s[24:27], s54 offen offset:2048 sc1
    buffer_load_dwordx4 a[40:43], v2, s[24:27], s54 offen offset:3072 sc1
    buffer_load_dwordx4 a[44:47], v2, s[24:27], s55 offen offset:0 sc1
    buffer_load_dwordx4 a[48:51], v2, s[24:27], s55 offen offset:1024 sc1
    buffer_load_dwordx4 a[52:55], v2, s[24:27], s55 offen offset:2048 sc1
    s_add_u32 s54, s54, 7168
    s_add_u32 s55, s55, 7168
    buffer_load_dwordx4 a[56:59], v2, s[24:27], s54 offen offset:0 sc1
    buffer_load_dwordx4 a[60:63], v2, s[24:27], s54 offen offset:1024 sc1
    buffer_load_dwordx4 a[64:67], v2, s[24:27], s54 offen offset:2048 sc1
    buffer_load_dwordx4 a[68:71], v2, s[24:27], s54 offen offset:3072 sc1
    buffer_load_dwordx4 a[72:75], v2, s[24:27], s55 offen offset:0 sc1
    buffer_load_dwordx4 a[76:79], v2, s[24:27], s55 offen offset:1024 sc1
    buffer_load_dwordx4 a[80:83], v2, s[24:27], s55 offen offset:2048 sc1
    s_add_u32 s54, s54, 7168
    s_add_u32 s55, s55, 7168
    s_waitcnt vmcnt(20)
    v_mfma_f32_16x16x32_bf16 v[128:131], a[0:3], a[144:147], 0
    buffer_load_dwordx4 a[84:87], v2, s[24:27], s54 offen offset:0 sc1
    v_mfma_f32_16x16x32_bf16 v[132:135], a[0:3], a[148:151], 0
    v_mfma_f32_16x16x32_bf16 v[136:139], a[0:3], a[152:155], 0
    buffer_load_dwordx4 a[88:91], v2, s[24:27], s54 offen offset:1024 sc1
    v_mfma_f32_16x16x32_bf16 v[140:143], a[0:3], a[156:159], 0
    s_waitcnt vmcnt(21)
    v_mfma_f32_16x16x32_bf16 v[144:147], a[4:7], a[144:147], 0
    buffer_load_dwordx4 a[92:95], v2, s[24:27], s54 offen offset:2048 sc1
    v_mfma_f32_16x16x32_bf16 v[148:151], a[4:7], a[148:151], 0
    v_mfma_f32_16x16x32_bf16 v[152:155], a[4:7], a[152:155], 0
    buffer_load_dwordx4 a[96:99], v2, s[24:27], s54 offen offset:3072 sc1
    v_mfma_f32_16x16x32_bf16 v[156:159], a[4:7], a[156:159], 0
    s_waitcnt vmcnt(22)
    v_mfma_f32_16x16x32_bf16 v[160:163], a[8:11], a[144:147], 0
    buffer_load_dwordx4 a[100:103], v2, s[24:27], s55 offen offset:0 sc1
    v_mfma_f32_16x16x32_bf16 v[164:167], a[8:11], a[148:151], 0
    v_mfma_f32_16x16x32_bf16 v[168:171], a[8:11], a[152:155], 0
    buffer_load_dwordx4 a[104:107], v2, s[24:27], s55 offen offset:1024 sc1
    v_mfma_f32_16x16x32_bf16 v[172:175], a[8:11], a[156:159], 0
    s_waitcnt vmcnt(23)
    v_mfma_f32_16x16x32_bf16 v[176:179], a[12:15], a[144:147], 0
    buffer_load_dwordx4 a[108:111], v2, s[24:27], s55 offen offset:2048 sc1
    v_mfma_f32_16x16x32_bf16 v[180:183], a[12:15], a[148:151], 0
    s_add_u32 s54, s54, 7168
    s_add_u32 s55, s55, 7168
    v_mfma_f32_16x16x32_bf16 v[184:187], a[12:15], a[152:155], 0
    buffer_load_dwordx4 a[112:115], v2, s[24:27], s54 offen offset:0 sc1
    v_mfma_f32_16x16x32_bf16 v[188:191], a[12:15], a[156:159], 0
    s_waitcnt vmcnt(24)
    v_mfma_f32_16x16x32_bf16 v[192:195], a[16:19], a[144:147], 0
    buffer_load_dwordx4 a[116:119], v2, s[24:27], s54 offen offset:1024 sc1
    v_mfma_f32_16x16x32_bf16 v[196:199], a[16:19], a[148:151], 0
    v_mfma_f32_16x16x32_bf16 v[200:203], a[16:19], a[152:155], 0
    buffer_load_dwordx4 a[120:123], v2, s[24:27], s54 offen offset:2048 sc1
    v_mfma_f32_16x16x32_bf16 v[204:207], a[16:19], a[156:159], 0
    s_waitcnt vmcnt(25)
    v_mfma_f32_16x16x32_bf16 v[208:211], a[20:23], a[144:147], 0
    buffer_load_dwordx4 a[124:127], v2, s[24:27], s54 offen offset:3072 sc1
    v_mfma_f32_16x16x32_bf16 v[212:215], a[20:23], a[148:151], 0
    v_mfma_f32_16x16x32_bf16 v[216:219], a[20:23], a[152:155], 0
    buffer_load_dwordx4 a[128:131], v2, s[24:27], s55 offen offset:0 sc1
    v_mfma_f32_16x16x32_bf16 v[220:223], a[20:23], a[156:159], 0
    s_waitcnt vmcnt(26)
    v_mfma_f32_16x16x32_bf16 v[224:227], a[24:27], a[144:147], 0
    buffer_load_dwordx4 a[132:135], v2, s[24:27], s55 offen offset:1024 sc1
    v_mfma_f32_16x16x32_bf16 v[228:231], a[24:27], a[148:151], 0
    v_mfma_f32_16x16x32_bf16 v[232:235], a[24:27], a[152:155], 0
    buffer_load_dwordx4 a[136:139], v2, s[24:27], s55 offen offset:2048 sc1
    v_mfma_f32_16x16x32_bf16 v[236:239], a[24:27], a[156:159], 0
    s_add_u32 s54, s54, 7168
    s_add_u32 s55, s55, 7168
    s_waitcnt vmcnt(27)
    v_mfma_f32_16x16x32_bf16 v[128:131], a[28:31], a[160:163], v[128:131]
    v_mfma_f32_16x16x32_bf16 v[132:135], a[28:31], a[164:167], v[132:135]
    buffer_load_dwordx4 a[0:3], v2, s[24:27], s54 offen offset:0 sc1
    v_mfma_f32_16x16x32_bf16 v[136:139], a[28:31], a[168:171], v[136:139]
    v_mfma_f32_16x16x32_bf16 v[140:143], a[28:31], a[172:175], v[140:143]
    s_waitcnt vmcnt(27)
    v_mfma_f32_16x16x32_bf16 v[144:147], a[32:35], a[160:163], v[144:147]
    buffer_load_dwordx4 a[4:7], v2, s[24:27], s54 offen offset:1024 sc1
    v_mfma_f32_16x16x32_bf16 v[148:151], a[32:35], a[164:167], v[148:151]
    v_mfma_f32_16x16x32_bf16 v[152:155], a[32:35], a[168:171], v[152:155]
    s_waitcnt vmcnt(27)
    v_mfma_f32_16x16x32_bf16 v[156:159], a[32:35], a[172:175], v[156:159]
    buffer_load_dwordx4 a[8:11], v2, s[24:27], s54 offen offset:2048 sc1
    v_mfma_f32_16x16x32_bf16 v[160:163], a[36:39], a[160:163], v[160:163]
    v_mfma_f32_16x16x32_bf16 v[164:167], a[36:39], a[164:167], v[164:167]
    v_mfma_f32_16x16x32_bf16 v[168:171], a[36:39], a[168:171], v[168:171]
    buffer_load_dwordx4 a[12:15], v2, s[24:27], s54 offen offset:3072 sc1
    v_mfma_f32_16x16x32_bf16 v[172:175], a[36:39], a[172:175], v[172:175]
    s_waitcnt vmcnt(28)
    v_mfma_f32_16x16x32_bf16 v[176:179], a[40:43], a[160:163], v[176:179]
    v_mfma_f32_16x16x32_bf16 v[180:183], a[40:43], a[164:167], v[180:183]
    buffer_load_dwordx4 a[16:19], v2, s[24:27], s55 offen offset:0 sc1
    v_mfma_f32_16x16x32_bf16 v[184:187], a[40:43], a[168:171], v[184:187]
    v_mfma_f32_16x16x32_bf16 v[188:191], a[40:43], a[172:175], v[188:191]
    s_waitcnt vmcnt(28)
    v_mfma_f32_16x16x32_bf16 v[192:195], a[44:47], a[160:163], v[192:195]
    buffer_load_dwordx4 a[20:23], v2, s[24:27], s55 offen offset:1024 sc1
    v_mfma_f32_16x16x32_bf16 v[196:199], a[44:47], a[164:167], v[196:199]
    v_mfma_f32_16x16x32_bf16 v[200:203], a[44:47], a[168:171], v[200:203]
    s_waitcnt vmcnt(28)
    v_mfma_f32_16x16x32_bf16 v[204:207], a[44:47], a[172:175], v[204:207]
    buffer_load_dwordx4 a[24:27], v2, s[24:27], s55 offen offset:2048 sc1
    v_mfma_f32_16x16x32_bf16 v[208:211], a[48:51], a[160:163], v[208:211]
    s_add_u32 s54, s54, 7168
    s_add_u32 s55, s55, 7168
    v_mfma_f32_16x16x32_bf16 v[212:215], a[48:51], a[164:167], v[212:215]
    v_mfma_f32_16x16x32_bf16 v[216:219], a[48:51], a[168:171], v[216:219]
    v_mfma_f32_16x16x32_bf16 v[220:223], a[48:51], a[172:175], v[220:223]
    s_waitcnt vmcnt(28)
    v_mfma_f32_16x16x32_bf16 v[224:227], a[52:55], a[160:163], v[224:227]
    v_mfma_f32_16x16x32_bf16 v[228:231], a[52:55], a[164:167], v[228:231]
    v_mfma_f32_16x16x32_bf16 v[232:235], a[52:55], a[168:171], v[232:235]
    v_mfma_f32_16x16x32_bf16 v[236:239], a[52:55], a[172:175], v[236:239]
    s_waitcnt vmcnt(27)
    v_mfma_f32_16x16x32_bf16 v[128:131], a[56:59], a[176:179], v[128:131]
    v_mfma_f32_16x16x32_bf16 v[132:135], a[56:59], a[180:183], v[132:135]
    buffer_load_dwordx4 a[28:31], v2, s[24:27], s54 offen offset:0 sc1
    v_mfma_f32_16x16x32_bf16 v[136:139], a[56:59], a[184:187], v[136:139]
    v_mfma_f32_16x16x32_bf16 v[140:143], a[56:59], a[188:191], v[140:143]
    s_waitcnt vmcnt(27)
    v_mfma_f32_16x16x32_bf16 v[144:147], a[60:63], a[176:179], v[144:147]
    buffer_load_dwordx4 a[32:35], v2, s[24:27], s54 offen offset:1024 sc1
    v_mfma_f32_16x16x32_bf16 v[148:151], a[60:63], a[180:183], v[148:151]
    v_mfma_f32_16x16x32_bf16 v[152:155], a[60:63], a[184:187], v[152:155]
    s_waitcnt vmcnt(27)
    v_mfma_f32_16x16x32_bf16 v[156:159], a[60:63], a[188:191], v[156:159]
    buffer_load_dwordx4 a[36:39], v2, s[24:27], s54 offen offset:2048 sc1
    v_mfma_f32_16x16x32_bf16 v[160:163], a[64:67], a[176:179], v[160:163]
    v_mfma_f32_16x16x32_bf16 v[164:167], a[64:67], a[180:183], v[164:167]
    v_mfma_f32_16x16x32_bf16 v[168:171], a[64:67], a[184:187], v[168:171]
    buffer_load_dwordx4 a[40:43], v2, s[24:27], s54 offen offset:3072 sc1
    v_mfma_f32_16x16x32_bf16 v[172:175], a[64:67], a[188:191], v[172:175]
    s_waitcnt vmcnt(28)
    v_mfma_f32_16x16x32_bf16 v[176:179], a[68:71], a[176:179], v[176:179]
    v_mfma_f32_16x16x32_bf16 v[180:183], a[68:71], a[180:183], v[180:183]
    buffer_load_dwordx4 a[44:47], v2, s[24:27], s55 offen offset:0 sc1
    v_mfma_f32_16x16x32_bf16 v[184:187], a[68:71], a[184:187], v[184:187]
    v_mfma_f32_16x16x32_bf16 v[188:191], a[68:71], a[188:191], v[188:191]
    s_waitcnt vmcnt(28)
    v_mfma_f32_16x16x32_bf16 v[192:195], a[72:75], a[176:179], v[192:195]
    buffer_load_dwordx4 a[48:51], v2, s[24:27], s55 offen offset:1024 sc1
    v_mfma_f32_16x16x32_bf16 v[196:199], a[72:75], a[180:183], v[196:199]
    v_mfma_f32_16x16x32_bf16 v[200:203], a[72:75], a[184:187], v[200:203]
    s_waitcnt vmcnt(28)
    v_mfma_f32_16x16x32_bf16 v[204:207], a[72:75], a[188:191], v[204:207]
    buffer_load_dwordx4 a[52:55], v2, s[24:27], s55 offen offset:2048 sc1
    v_mfma_f32_16x16x32_bf16 v[208:211], a[76:79], a[176:179], v[208:211]
    s_add_u32 s54, s54, 7168
    s_add_u32 s55, s55, 7168
    v_mfma_f32_16x16x32_bf16 v[212:215], a[76:79], a[180:183], v[212:215]
    v_mfma_f32_16x16x32_bf16 v[216:219], a[76:79], a[184:187], v[216:219]
    v_mfma_f32_16x16x32_bf16 v[220:223], a[76:79], a[188:191], v[220:223]
    s_waitcnt vmcnt(28)
    v_mfma_f32_16x16x32_bf16 v[224:227], a[80:83], a[176:179], v[224:227]
    v_mfma_f32_16x16x32_bf16 v[228:231], a[80:83], a[180:183], v[228:231]
    v_mfma_f32_16x16x32_bf16 v[232:235], a[80:83], a[184:187], v[232:235]
    v_mfma_f32_16x16x32_bf16 v[236:239], a[80:83], a[188:191], v[236:239]
    s_waitcnt vmcnt(27)
    v_mfma_f32_16x16x32_bf16 v[128:131], a[84:87], a[192:195], v[128:131]
    v_mfma_f32_16x16x32_bf16 v[132:135], a[84:87], a[196:199], v[132:135]
    buffer_load_dwordx4 a[56:59], v2, s[24:27], s54 offen offset:0 sc1
    v_mfma_f32_16x16x32_bf16 v[136:139], a[84:87], a[200:203], v[136:139]
    v_mfma_f32_16x16x32_bf16 v[140:143], a[84:87], a[204:207], v[140:143]
    s_waitcnt vmcnt(27)
    v_mfma_f32_16x16x32_bf16 v[144:147], a[88:91], a[192:195], v[144:147]
    buffer_load_dwordx4 a[60:63], v2, s[24:27], s54 offen offset:1024 sc1
    v_mfma_f32_16x16x32_bf16 v[148:151], a[88:91], a[196:199], v[148:151]
    v_mfma_f32_16x16x32_bf16 v[152:155], a[88:91], a[200:203], v[152:155]
    s_waitcnt vmcnt(27)
    v_mfma_f32_16x16x32_bf16 v[156:159], a[88:91], a[204:207], v[156:159]
    buffer_load_dwordx4 a[64:67], v2, s[24:27], s54 offen offset:2048 sc1
    v_mfma_f32_16x16x32_bf16 v[160:163], a[92:95], a[192:195], v[160:163]
    v_mfma_f32_16x16x32_bf16 v[164:167], a[92:95], a[196:199], v[164:167]
    v_mfma_f32_16x16x32_bf16 v[168:171], a[92:95], a[200:203], v[168:171]
    buffer_load_dwordx4 a[68:71], v2, s[24:27], s54 offen offset:3072 sc1
    v_mfma_f32_16x16x32_bf16 v[172:175], a[92:95], a[204:207], v[172:175]
    s_waitcnt vmcnt(28)
    v_mfma_f32_16x16x32_bf16 v[176:179], a[96:99], a[192:195], v[176:179]
    v_mfma_f32_16x16x32_bf16 v[180:183], a[96:99], a[196:199], v[180:183]
    buffer_load_dwordx4 a[72:75], v2, s[24:27], s55 offen offset:0 sc1
    v_mfma_f32_16x16x32_bf16 v[184:187], a[96:99], a[200:203], v[184:187]
    v_mfma_f32_16x16x32_bf16 v[188:191], a[96:99], a[204:207], v[188:191]
    s_waitcnt vmcnt(28)
    v_mfma_f32_16x16x32_bf16 v[192:195], a[100:103], a[192:195], v[192:195]
    buffer_load_dwordx4 a[76:79], v2, s[24:27], s55 offen offset:1024 sc1
    v_mfma_f32_16x16x32_bf16 v[196:199], a[100:103], a[196:199], v[196:199]
    v_mfma_f32_16x16x32_bf16 v[200:203], a[100:103], a[200:203], v[200:203]
    s_waitcnt vmcnt(28)
    v_mfma_f32_16x16x32_bf16 v[204:207], a[100:103], a[204:207], v[204:207]
    buffer_load_dwordx4 a[80:83], v2, s[24:27], s55 offen offset:2048 sc1
    v_mfma_f32_16x16x32_bf16 v[208:211], a[104:107], a[192:195], v[208:211]
    s_add_u32 s54, s54, 7168
    s_add_u32 s55, s55, 7168
    v_mfma_f32_16x16x32_bf16 v[212:215], a[104:107], a[196:199], v[212:215]
    v_mfma_f32_16x16x32_bf16 v[216:219], a[104:107], a[200:203], v[216:219]
    v_mfma_f32_16x16x32_bf16 v[220:223], a[104:107], a[204:207], v[220:223]
    s_waitcnt vmcnt(28)
    v_mfma_f32_16x16x32_bf16 v[224:227], a[108:111], a[192:195], v[224:227]
    v_mfma_f32_16x16x32_bf16 v[228:231], a[108:111], a[196:199], v[228:231]
    v_mfma_f32_16x16x32_bf16 v[232:235], a[108:111], a[200:203], v[232:235]
    v_mfma_f32_16x16x32_bf16 v[236:239], a[108:111], a[204:207], v[236:239]
    s_waitcnt vmcnt(27)
    v_mfma_f32_16x16x32_bf16 v[128:131], a[112:115], a[208:211], v[128:131]
    v_mfma_f32_16x16x32_bf16 v[132:135], a[112:115], a[212:215], v[132:135]
    buffer_load_dwordx4 a[84:87], v2, s[24:27], s54 offen offset:0 sc1
    v_mfma_f32_16x16x32_bf16 v[136:139], a[112:115], a[216:219], v[136:139]
    v_mfma_f32_16x16x32_bf16 v[140:143], a[112:115], a[220:223], v[140:143]
    s_waitcnt vmcnt(27)
    v_mfma_f32_16x16x32_bf16 v[144:147], a[116:119], a[208:211], v[144:147]
    buffer_load_dwordx4 a[88:91], v2, s[24:27], s54 offen offset:1024 sc1
    v_mfma_f32_16x16x32_bf16 v[148:151], a[116:119], a[212:215], v[148:151]
    v_mfma_f32_16x16x32_bf16 v[152:155], a[116:119], a[216:219], v[152:155]
    s_waitcnt vmcnt(27)
    v_mfma_f32_16x16x32_bf16 v[156:159], a[116:119], a[220:223], v[156:159]
    buffer_load_dwordx4 a[92:95], v2, s[24:27], s54 offen offset:2048 sc1
    v_mfma_f32_16x16x32_bf16 v[160:163], a[120:123], a[208:211], v[160:163]
    v_mfma_f32_16x16x32_bf16 v[164:167], a[120:123], a[212:215], v[164:167]
    v_mfma_f32_16x16x32_bf16 v[168:171], a[120:123], a[216:219], v[168:171]
    buffer_load_dwordx4 a[96:99], v2, s[24:27], s54 offen offset:3072 sc1
    v_mfma_f32_16x16x32_bf16 v[172:175], a[120:123], a[220:223], v[172:175]
    s_waitcnt vmcnt(28)
    v_mfma_f32_16x16x32_bf16 v[176:179], a[124:127], a[208:211], v[176:179]
    v_mfma_f32_16x16x32_bf16 v[180:183], a[124:127], a[212:215], v[180:183]
    buffer_load_dwordx4 a[100:103], v2, s[24:27], s55 offen offset:0 sc1
    v_mfma_f32_16x16x32_bf16 v[184:187], a[124:127], a[216:219], v[184:187]
    v_mfma_f32_16x16x32_bf16 v[188:191], a[124:127], a[220:223], v[188:191]
    s_waitcnt vmcnt(28)
    v_mfma_f32_16x16x32_bf16 v[192:195], a[128:131], a[208:211], v[192:195]
    buffer_load_dwordx4 a[104:107], v2, s[24:27], s55 offen offset:1024 sc1
    v_mfma_f32_16x16x32_bf16 v[196:199], a[128:131], a[212:215], v[196:199]
    v_mfma_f32_16x16x32_bf16 v[200:203], a[128:131], a[216:219], v[200:203]
    s_waitcnt vmcnt(28)
    v_mfma_f32_16x16x32_bf16 v[204:207], a[128:131], a[220:223], v[204:207]
    buffer_load_dwordx4 a[108:111], v2, s[24:27], s55 offen offset:2048 sc1
    v_mfma_f32_16x16x32_bf16 v[208:211], a[132:135], a[208:211], v[208:211]
    s_add_u32 s54, s54, 7168
    s_add_u32 s55, s55, 7168
    v_mfma_f32_16x16x32_bf16 v[212:215], a[132:135], a[212:215], v[212:215]
    v_mfma_f32_16x16x32_bf16 v[216:219], a[132:135], a[216:219], v[216:219]
    v_mfma_f32_16x16x32_bf16 v[220:223], a[132:135], a[220:223], v[220:223]
    s_waitcnt vmcnt(28)
    v_mfma_f32_16x16x32_bf16 v[224:227], a[136:139], a[208:211], v[224:227]
    v_mfma_f32_16x16x32_bf16 v[228:231], a[136:139], a[212:215], v[228:231]
    v_mfma_f32_16x16x32_bf16 v[232:235], a[136:139], a[216:219], v[232:235]
    v_mfma_f32_16x16x32_bf16 v[236:239], a[136:139], a[220:223], v[236:239]
    s_waitcnt vmcnt(27)
    v_mfma_f32_16x16x32_bf16 v[128:131], a[0:3], a[224:227], v[128:131]
    v_mfma_f32_16x16x32_bf16 v[132:135], a[0:3], a[228:231], v[132:135]
    buffer_load_dwordx4 a[112:115], v2, s[24:27], s54 offen offset:0 sc1
    v_mfma_f32_16x16x32_bf16 v[136:139], a[0:3], a[232:235], v[136:139]
    ds_read_b128 v[16:19], v74 offset:32768
    v_mfma_f32_16x16x32_bf16 v[140:143], a[0:3], a[236:239], v[140:143]
    s_waitcnt vmcnt(27)
    ds_read_b128 v[20:23], v74 offset:34816
    v_mfma_f32_16x16x32_bf16 v[144:147], a[4:7], a[224:227], v[144:147]
    buffer_load_dwordx4 a[116:119], v2, s[24:27], s54 offen offset:1024 sc1
    v_mfma_f32_16x16x32_bf16 v[148:151], a[4:7], a[228:231], v[148:151]
    ds_read_b128 v[24:27], v74 offset:36864
    v_mfma_f32_16x16x32_bf16 v[152:155], a[4:7], a[232:235], v[152:155]
    s_waitcnt vmcnt(27)
    ds_read_b128 v[28:31], v74 offset:38912
    v_mfma_f32_16x16x32_bf16 v[156:159], a[4:7], a[236:239], v[156:159]
    buffer_load_dwordx4 a[120:123], v2, s[24:27], s54 offen offset:2048 sc1
    v_mfma_f32_16x16x32_bf16 v[160:163], a[8:11], a[224:227], v[160:163]
    v_mfma_f32_16x16x32_bf16 v[164:167], a[8:11], a[228:231], v[164:167]
    v_mfma_f32_16x16x32_bf16 v[168:171], a[8:11], a[232:235], v[168:171]
    buffer_load_dwordx4 a[124:127], v2, s[24:27], s54 offen offset:3072 sc1
    v_mfma_f32_16x16x32_bf16 v[172:175], a[8:11], a[236:239], v[172:175]
    s_waitcnt vmcnt(28)
    v_mfma_f32_16x16x32_bf16 v[176:179], a[12:15], a[224:227], v[176:179]
    v_mfma_f32_16x16x32_bf16 v[180:183], a[12:15], a[228:231], v[180:183]
    buffer_load_dwordx4 a[128:131], v2, s[24:27], s55 offen offset:0 sc1
    v_mfma_f32_16x16x32_bf16 v[184:187], a[12:15], a[232:235], v[184:187]
    v_mfma_f32_16x16x32_bf16 v[188:191], a[12:15], a[236:239], v[188:191]
    s_waitcnt vmcnt(28)
    v_mfma_f32_16x16x32_bf16 v[192:195], a[16:19], a[224:227], v[192:195]
    buffer_load_dwordx4 a[132:135], v2, s[24:27], s55 offen offset:1024 sc1
    v_mfma_f32_16x16x32_bf16 v[196:199], a[16:19], a[228:231], v[196:199]
    v_mfma_f32_16x16x32_bf16 v[200:203], a[16:19], a[232:235], v[200:203]
    s_waitcnt vmcnt(28)
    v_mfma_f32_16x16x32_bf16 v[204:207], a[16:19], a[236:239], v[204:207]
    buffer_load_dwordx4 a[136:139], v2, s[24:27], s55 offen offset:2048 sc1
    v_mfma_f32_16x16x32_bf16 v[208:211], a[20:23], a[224:227], v[208:211]
    s_add_u32 s54, s54, 7168
    s_add_u32 s55, s55, 7168
    v_mfma_f32_16x16x32_bf16 v[212:215], a[20:23], a[228:231], v[212:215]
    v_mfma_f32_16x16x32_bf16 v[216:219], a[20:23], a[232:235], v[216:219]
    v_mfma_f32_16x16x32_bf16 v[220:223], a[20:23], a[236:239], v[220:223]
    s_waitcnt vmcnt(28)
    v_mfma_f32_16x16x32_bf16 v[224:227], a[24:27], a[224:227], v[224:227]
    v_mfma_f32_16x16x32_bf16 v[228:231], a[24:27], a[228:231], v[228:231]
    v_mfma_f32_16x16x32_bf16 v[232:235], a[24:27], a[232:235], v[232:235]
    v_mfma_f32_16x16x32_bf16 v[236:239], a[24:27], a[236:239], v[236:239]
    s_waitcnt vmcnt(27) lgkmcnt(0)
    v_mfma_f32_16x16x32_bf16 v[128:131], a[28:31], v[16:19], v[128:131]
    v_mfma_f32_16x16x32_bf16 v[132:135], a[28:31], v[20:23], v[132:135]
    buffer_load_dwordx4 a[0:3], v2, s[24:27], s54 offen offset:0 sc1
    v_mfma_f32_16x16x32_bf16 v[136:139], a[28:31], v[24:27], v[136:139]
    ds_read_b128 v[32:35], v75 offset:32768
    v_mfma_f32_16x16x32_bf16 v[140:143], a[28:31], v[28:31], v[140:143]
    s_waitcnt vmcnt(27)
    ds_read_b128 v[36:39], v75 offset:34816
    v_mfma_f32_16x16x32_bf16 v[144:147], a[32:35], v[16:19], v[144:147]
    buffer_load_dwordx4 a[4:7], v2, s[24:27], s54 offen offset:1024 sc1
    v_mfma_f32_16x16x32_bf16 v[148:151], a[32:35], v[20:23], v[148:151]
    ds_read_b128 v[40:43], v75 offset:36864
    v_mfma_f32_16x16x32_bf16 v[152:155], a[32:35], v[24:27], v[152:155]
    s_waitcnt vmcnt(27)
    ds_read_b128 v[44:47], v75 offset:38912
    v_mfma_f32_16x16x32_bf16 v[156:159], a[32:35], v[28:31], v[156:159]
    buffer_load_dwordx4 a[8:11], v2, s[24:27], s54 offen offset:2048 sc1
    v_mfma_f32_16x16x32_bf16 v[160:163], a[36:39], v[16:19], v[160:163]
    v_mfma_f32_16x16x32_bf16 v[164:167], a[36:39], v[20:23], v[164:167]
    v_mfma_f32_16x16x32_bf16 v[168:171], a[36:39], v[24:27], v[168:171]
    buffer_load_dwordx4 a[12:15], v2, s[24:27], s54 offen offset:3072 sc1
    v_mfma_f32_16x16x32_bf16 v[172:175], a[36:39], v[28:31], v[172:175]
    s_waitcnt vmcnt(28)
    v_mfma_f32_16x16x32_bf16 v[176:179], a[40:43], v[16:19], v[176:179]
    v_mfma_f32_16x16x32_bf16 v[180:183], a[40:43], v[20:23], v[180:183]
    buffer_load_dwordx4 a[16:19], v2, s[24:27], s55 offen offset:0 sc1
    v_mfma_f32_16x16x32_bf16 v[184:187], a[40:43], v[24:27], v[184:187]
    v_mfma_f32_16x16x32_bf16 v[188:191], a[40:43], v[28:31], v[188:191]
    s_waitcnt vmcnt(28)
    v_mfma_f32_16x16x32_bf16 v[192:195], a[44:47], v[16:19], v[192:195]
    buffer_load_dwordx4 a[20:23], v2, s[24:27], s55 offen offset:1024 sc1
    v_mfma_f32_16x16x32_bf16 v[196:199], a[44:47], v[20:23], v[196:199]
    v_mfma_f32_16x16x32_bf16 v[200:203], a[44:47], v[24:27], v[200:203]
    s_waitcnt vmcnt(28)
    v_mfma_f32_16x16x32_bf16 v[204:207], a[44:47], v[28:31], v[204:207]
    buffer_load_dwordx4 a[24:27], v2, s[24:27], s55 offen offset:2048 sc1
    v_mfma_f32_16x16x32_bf16 v[208:211], a[48:51], v[16:19], v[208:211]
    s_add_u32 s54, s54, 7168
    s_add_u32 s55, s55, 7168
    v_mfma_f32_16x16x32_bf16 v[212:215], a[48:51], v[20:23], v[212:215]
    v_mfma_f32_16x16x32_bf16 v[216:219], a[48:51], v[24:27], v[216:219]
    v_mfma_f32_16x16x32_bf16 v[220:223], a[48:51], v[28:31], v[220:223]
    s_waitcnt vmcnt(28)
    v_mfma_f32_16x16x32_bf16 v[224:227], a[52:55], v[16:19], v[224:227]
    v_mfma_f32_16x16x32_bf16 v[228:231], a[52:55], v[20:23], v[228:231]
    v_mfma_f32_16x16x32_bf16 v[232:235], a[52:55], v[24:27], v[232:235]
    v_mfma_f32_16x16x32_bf16 v[236:239], a[52:55], v[28:31], v[236:239]
    s_waitcnt vmcnt(27) lgkmcnt(0)
    v_mfma_f32_16x16x32_bf16 v[128:131], a[56:59], v[32:35], v[128:131]
    v_mfma_f32_16x16x32_bf16 v[132:135], a[56:59], v[36:39], v[132:135]
    buffer_load_dwordx4 a[28:31], v2, s[24:27], s54 offen offset:0 sc1
    v_mfma_f32_16x16x32_bf16 v[136:139], a[56:59], v[40:43], v[136:139]
    ds_read_b128 v[16:19], v76 offset:0
    v_mfma_f32_16x16x32_bf16 v[140:143], a[56:59], v[44:47], v[140:143]
    s_waitcnt vmcnt(27)
    ds_read_b128 v[20:23], v76 offset:2048
    v_mfma_f32_16x16x32_bf16 v[144:147], a[60:63], v[32:35], v[144:147]
    buffer_load_dwordx4 a[32:35], v2, s[24:27], s54 offen offset:1024 sc1
    v_mfma_f32_16x16x32_bf16 v[148:151], a[60:63], v[36:39], v[148:151]
    ds_read_b128 v[24:27], v76 offset:4096
    v_mfma_f32_16x16x32_bf16 v[152:155], a[60:63], v[40:43], v[152:155]
    s_waitcnt vmcnt(27)
    ds_read_b128 v[28:31], v76 offset:6144
    v_mfma_f32_16x16x32_bf16 v[156:159], a[60:63], v[44:47], v[156:159]
    buffer_load_dwordx4 a[36:39], v2, s[24:27], s54 offen offset:2048 sc1
    v_mfma_f32_16x16x32_bf16 v[160:163], a[64:67], v[32:35], v[160:163]
    v_mfma_f32_16x16x32_bf16 v[164:167], a[64:67], v[36:39], v[164:167]
    v_mfma_f32_16x16x32_bf16 v[168:171], a[64:67], v[40:43], v[168:171]
    buffer_load_dwordx4 a[40:43], v2, s[24:27], s54 offen offset:3072 sc1
    v_mfma_f32_16x16x32_bf16 v[172:175], a[64:67], v[44:47], v[172:175]
    s_waitcnt vmcnt(28)
    v_mfma_f32_16x16x32_bf16 v[176:179], a[68:71], v[32:35], v[176:179]
    v_mfma_f32_16x16x32_bf16 v[180:183], a[68:71], v[36:39], v[180:183]
    buffer_load_dwordx4 a[44:47], v2, s[24:27], s55 offen offset:0 sc1
    v_mfma_f32_16x16x32_bf16 v[184:187], a[68:71], v[40:43], v[184:187]
    v_mfma_f32_16x16x32_bf16 v[188:191], a[68:71], v[44:47], v[188:191]
    s_waitcnt vmcnt(28)
    v_mfma_f32_16x16x32_bf16 v[192:195], a[72:75], v[32:35], v[192:195]
    buffer_load_dwordx4 a[48:51], v2, s[24:27], s55 offen offset:1024 sc1
    v_mfma_f32_16x16x32_bf16 v[196:199], a[72:75], v[36:39], v[196:199]
    v_mfma_f32_16x16x32_bf16 v[200:203], a[72:75], v[40:43], v[200:203]
    s_waitcnt vmcnt(28)
    v_mfma_f32_16x16x32_bf16 v[204:207], a[72:75], v[44:47], v[204:207]
    buffer_load_dwordx4 a[52:55], v2, s[24:27], s55 offen offset:2048 sc1
    v_mfma_f32_16x16x32_bf16 v[208:211], a[76:79], v[32:35], v[208:211]
    s_add_u32 s54, s54, 7168
    s_add_u32 s55, s55, 7168
    v_mfma_f32_16x16x32_bf16 v[212:215], a[76:79], v[36:39], v[212:215]
    v_mfma_f32_16x16x32_bf16 v[216:219], a[76:79], v[40:43], v[216:219]
    v_mfma_f32_16x16x32_bf16 v[220:223], a[76:79], v[44:47], v[220:223]
    s_waitcnt vmcnt(28)
    v_mfma_f32_16x16x32_bf16 v[224:227], a[80:83], v[32:35], v[224:227]
    v_mfma_f32_16x16x32_bf16 v[228:231], a[80:83], v[36:39], v[228:231]
    v_mfma_f32_16x16x32_bf16 v[232:235], a[80:83], v[40:43], v[232:235]
    v_mfma_f32_16x16x32_bf16 v[236:239], a[80:83], v[44:47], v[236:239]
    s_waitcnt vmcnt(27) lgkmcnt(0)
    v_mfma_f32_16x16x32_bf16 v[128:131], a[84:87], v[16:19], v[128:131]
    v_mfma_f32_16x16x32_bf16 v[132:135], a[84:87], v[20:23], v[132:135]
    buffer_load_dwordx4 a[56:59], v2, s[24:27], s54 offen offset:0 sc1
    v_mfma_f32_16x16x32_bf16 v[136:139], a[84:87], v[24:27], v[136:139]
    ds_read_b128 v[32:35], v77 offset:0
    v_mfma_f32_16x16x32_bf16 v[140:143], a[84:87], v[28:31], v[140:143]
    s_waitcnt vmcnt(27)
    ds_read_b128 v[36:39], v77 offset:2048
    v_mfma_f32_16x16x32_bf16 v[144:147], a[88:91], v[16:19], v[144:147]
    buffer_load_dwordx4 a[60:63], v2, s[24:27], s54 offen offset:1024 sc1
    v_mfma_f32_16x16x32_bf16 v[148:151], a[88:91], v[20:23], v[148:151]
    ds_read_b128 v[40:43], v77 offset:4096
    v_mfma_f32_16x16x32_bf16 v[152:155], a[88:91], v[24:27], v[152:155]
    s_waitcnt vmcnt(27)
    ds_read_b128 v[44:47], v77 offset:6144
    v_mfma_f32_16x16x32_bf16 v[156:159], a[88:91], v[28:31], v[156:159]
    buffer_load_dwordx4 a[64:67], v2, s[24:27], s54 offen offset:2048 sc1
    v_mfma_f32_16x16x32_bf16 v[160:163], a[92:95], v[16:19], v[160:163]
    v_mfma_f32_16x16x32_bf16 v[164:167], a[92:95], v[20:23], v[164:167]
    v_mfma_f32_16x16x32_bf16 v[168:171], a[92:95], v[24:27], v[168:171]
    buffer_load_dwordx4 a[68:71], v2, s[24:27], s54 offen offset:3072 sc1
    v_mfma_f32_16x16x32_bf16 v[172:175], a[92:95], v[28:31], v[172:175]
    s_waitcnt vmcnt(28)
    v_mfma_f32_16x16x32_bf16 v[176:179], a[96:99], v[16:19], v[176:179]
    v_mfma_f32_16x16x32_bf16 v[180:183], a[96:99], v[20:23], v[180:183]
    buffer_load_dwordx4 a[72:75], v2, s[24:27], s55 offen offset:0 sc1
    v_mfma_f32_16x16x32_bf16 v[184:187], a[96:99], v[24:27], v[184:187]
    v_mfma_f32_16x16x32_bf16 v[188:191], a[96:99], v[28:31], v[188:191]
    s_waitcnt vmcnt(28)
    v_mfma_f32_16x16x32_bf16 v[192:195], a[100:103], v[16:19], v[192:195]
    buffer_load_dwordx4 a[76:79], v2, s[24:27], s55 offen offset:1024 sc1
    v_mfma_f32_16x16x32_bf16 v[196:199], a[100:103], v[20:23], v[196:199]
    v_mfma_f32_16x16x32_bf16 v[200:203], a[100:103], v[24:27], v[200:203]
    s_waitcnt vmcnt(28)
    v_mfma_f32_16x16x32_bf16 v[204:207], a[100:103], v[28:31], v[204:207]
    buffer_load_dwordx4 a[80:83], v2, s[24:27], s55 offen offset:2048 sc1
    v_mfma_f32_16x16x32_bf16 v[208:211], a[104:107], v[16:19], v[208:211]
    s_add_u32 s54, s54, 7168
    s_add_u32 s55, s55, 7168
    v_mfma_f32_16x16x32_bf16 v[212:215], a[104:107], v[20:23], v[212:215]
    v_mfma_f32_16x16x32_bf16 v[216:219], a[104:107], v[24:27], v[216:219]
    v_mfma_f32_16x16x32_bf16 v[220:223], a[104:107], v[28:31], v[220:223]
    s_waitcnt vmcnt(28)
    v_mfma_f32_16x16x32_bf16 v[224:227], a[108:111], v[16:19], v[224:227]
    v_mfma_f32_16x16x32_bf16 v[228:231], a[108:111], v[20:23], v[228:231]
    v_mfma_f32_16x16x32_bf16 v[232:235], a[108:111], v[24:27], v[232:235]
    v_mfma_f32_16x16x32_bf16 v[236:239], a[108:111], v[28:31], v[236:239]
    s_waitcnt vmcnt(27) lgkmcnt(0)
    v_mfma_f32_16x16x32_bf16 v[128:131], a[112:115], v[32:35], v[128:131]
    v_mfma_f32_16x16x32_bf16 v[132:135], a[112:115], v[36:39], v[132:135]
    buffer_load_dwordx4 a[84:87], v2, s[24:27], s54 offen offset:0 sc1
    v_mfma_f32_16x16x32_bf16 v[136:139], a[112:115], v[40:43], v[136:139]
    ds_read_b128 v[16:19], v72 offset:0
    v_mfma_f32_16x16x32_bf16 v[140:143], a[112:115], v[44:47], v[140:143]
    s_waitcnt vmcnt(27)
    ds_read_b128 v[20:23], v72 offset:2048
    v_mfma_f32_16x16x32_bf16 v[144:147], a[116:119], v[32:35], v[144:147]
    buffer_load_dwordx4 a[88:91], v2, s[24:27], s54 offen offset:1024 sc1
    v_mfma_f32_16x16x32_bf16 v[148:151], a[116:119], v[36:39], v[148:151]
    ds_read_b128 v[24:27], v72 offset:4096
    v_mfma_f32_16x16x32_bf16 v[152:155], a[116:119], v[40:43], v[152:155]
    s_waitcnt vmcnt(27)
    ds_read_b128 v[28:31], v72 offset:6144
    v_mfma_f32_16x16x32_bf16 v[156:159], a[116:119], v[44:47], v[156:159]
    buffer_load_dwordx4 a[92:95], v2, s[24:27], s54 offen offset:2048 sc1
    v_mfma_f32_16x16x32_bf16 v[160:163], a[120:123], v[32:35], v[160:163]
    v_mfma_f32_16x16x32_bf16 v[164:167], a[120:123], v[36:39], v[164:167]
    v_mfma_f32_16x16x32_bf16 v[168:171], a[120:123], v[40:43], v[168:171]
    buffer_load_dwordx4 a[96:99], v2, s[24:27], s54 offen offset:3072 sc1
    v_mfma_f32_16x16x32_bf16 v[172:175], a[120:123], v[44:47], v[172:175]
    s_waitcnt vmcnt(28)
    v_mfma_f32_16x16x32_bf16 v[176:179], a[124:127], v[32:35], v[176:179]
    v_mfma_f32_16x16x32_bf16 v[180:183], a[124:127], v[36:39], v[180:183]
    buffer_load_dwordx4 a[100:103], v2, s[24:27], s55 offen offset:0 sc1
    v_mfma_f32_16x16x32_bf16 v[184:187], a[124:127], v[40:43], v[184:187]
    v_mfma_f32_16x16x32_bf16 v[188:191], a[124:127], v[44:47], v[188:191]
    s_waitcnt vmcnt(28)
    v_mfma_f32_16x16x32_bf16 v[192:195], a[128:131], v[32:35], v[192:195]
    buffer_load_dwordx4 a[104:107], v2, s[24:27], s55 offen offset:1024 sc1
    v_mfma_f32_16x16x32_bf16 v[196:199], a[128:131], v[36:39], v[196:199]
    v_mfma_f32_16x16x32_bf16 v[200:203], a[128:131], v[40:43], v[200:203]
    s_waitcnt vmcnt(28)
    v_mfma_f32_16x16x32_bf16 v[204:207], a[128:131], v[44:47], v[204:207]
    buffer_load_dwordx4 a[108:111], v2, s[24:27], s55 offen offset:2048 sc1
    v_mfma_f32_16x16x32_bf16 v[208:211], a[132:135], v[32:35], v[208:211]
    s_add_u32 s54, s54, 7168
    s_add_u32 s55, s55, 7168
    v_mfma_f32_16x16x32_bf16 v[212:215], a[132:135], v[36:39], v[212:215]
    v_mfma_f32_16x16x32_bf16 v[216:219], a[132:135], v[40:43], v[216:219]
    v_mfma_f32_16x16x32_bf16 v[220:223], a[132:135], v[44:47], v[220:223]
    s_waitcnt vmcnt(28)
    v_mfma_f32_16x16x32_bf16 v[224:227], a[136:139], v[32:35], v[224:227]
    v_mfma_f32_16x16x32_bf16 v[228:231], a[136:139], v[36:39], v[228:231]
    v_mfma_f32_16x16x32_bf16 v[232:235], a[136:139], v[40:43], v[232:235]
    v_mfma_f32_16x16x32_bf16 v[236:239], a[136:139], v[44:47], v[236:239]
    s_waitcnt vmcnt(27) lgkmcnt(0)
    v_mfma_f32_16x16x32_bf16 v[128:131], a[0:3], v[16:19], v[128:131]
    v_mfma_f32_16x16x32_bf16 v[132:135], a[0:3], v[20:23], v[132:135]
    buffer_load_dwordx4 a[112:115], v2, s[24:27], s54 offen offset:0 sc1
    v_mfma_f32_16x16x32_bf16 v[136:139], a[0:3], v[24:27], v[136:139]
    ds_read_b128 v[32:35], v73 offset:0
    v_mfma_f32_16x16x32_bf16 v[140:143], a[0:3], v[28:31], v[140:143]
    s_waitcnt vmcnt(27)
    ds_read_b128 v[36:39], v73 offset:2048
    v_mfma_f32_16x16x32_bf16 v[144:147], a[4:7], v[16:19], v[144:147]
    buffer_load_dwordx4 a[116:119], v2, s[24:27], s54 offen offset:1024 sc1
    v_mfma_f32_16x16x32_bf16 v[148:151], a[4:7], v[20:23], v[148:151]
    ds_read_b128 v[40:43], v73 offset:4096
    v_mfma_f32_16x16x32_bf16 v[152:155], a[4:7], v[24:27], v[152:155]
    s_waitcnt vmcnt(27)
    ds_read_b128 v[44:47], v73 offset:6144
    v_mfma_f32_16x16x32_bf16 v[156:159], a[4:7], v[28:31], v[156:159]
    buffer_load_dwordx4 a[120:123], v2, s[24:27], s54 offen offset:2048 sc1
    v_mfma_f32_16x16x32_bf16 v[160:163], a[8:11], v[16:19], v[160:163]
    v_mfma_f32_16x16x32_bf16 v[164:167], a[8:11], v[20:23], v[164:167]
    v_mfma_f32_16x16x32_bf16 v[168:171], a[8:11], v[24:27], v[168:171]
    buffer_load_dwordx4 a[124:127], v2, s[24:27], s54 offen offset:3072 sc1
    v_mfma_f32_16x16x32_bf16 v[172:175], a[8:11], v[28:31], v[172:175]
    s_waitcnt vmcnt(28)
    v_mfma_f32_16x16x32_bf16 v[176:179], a[12:15], v[16:19], v[176:179]
    v_mfma_f32_16x16x32_bf16 v[180:183], a[12:15], v[20:23], v[180:183]
    buffer_load_dwordx4 a[128:131], v2, s[24:27], s55 offen offset:0 sc1
    v_mfma_f32_16x16x32_bf16 v[184:187], a[12:15], v[24:27], v[184:187]
    v_mfma_f32_16x16x32_bf16 v[188:191], a[12:15], v[28:31], v[188:191]
    s_waitcnt vmcnt(28)
    v_mfma_f32_16x16x32_bf16 v[192:195], a[16:19], v[16:19], v[192:195]
    buffer_load_dwordx4 a[132:135], v2, s[24:27], s55 offen offset:1024 sc1
    v_mfma_f32_16x16x32_bf16 v[196:199], a[16:19], v[20:23], v[196:199]
    v_mfma_f32_16x16x32_bf16 v[200:203], a[16:19], v[24:27], v[200:203]
    s_waitcnt vmcnt(28)
    v_mfma_f32_16x16x32_bf16 v[204:207], a[16:19], v[28:31], v[204:207]
    buffer_load_dwordx4 a[136:139], v2, s[24:27], s55 offen offset:2048 sc1
    v_mfma_f32_16x16x32_bf16 v[208:211], a[20:23], v[16:19], v[208:211]
    s_add_u32 s54, s54, 7168
    s_add_u32 s55, s55, 7168
    v_mfma_f32_16x16x32_bf16 v[212:215], a[20:23], v[20:23], v[212:215]
    v_mfma_f32_16x16x32_bf16 v[216:219], a[20:23], v[24:27], v[216:219]
    v_mfma_f32_16x16x32_bf16 v[220:223], a[20:23], v[28:31], v[220:223]
    s_waitcnt vmcnt(28)
    v_mfma_f32_16x16x32_bf16 v[224:227], a[24:27], v[16:19], v[224:227]
    v_mfma_f32_16x16x32_bf16 v[228:231], a[24:27], v[20:23], v[228:231]
    v_mfma_f32_16x16x32_bf16 v[232:235], a[24:27], v[24:27], v[232:235]
    v_mfma_f32_16x16x32_bf16 v[236:239], a[24:27], v[28:31], v[236:239]
    s_waitcnt vmcnt(27) lgkmcnt(0)
    v_mfma_f32_16x16x32_bf16 v[128:131], a[28:31], v[32:35], v[128:131]
    v_mfma_f32_16x16x32_bf16 v[132:135], a[28:31], v[36:39], v[132:135]
    buffer_load_dwordx4 a[0:3], v2, s[24:27], s54 offen offset:0 sc1
    v_mfma_f32_16x16x32_bf16 v[136:139], a[28:31], v[40:43], v[136:139]
    ds_read_b128 v[16:19], v74 offset:0
    v_mfma_f32_16x16x32_bf16 v[140:143], a[28:31], v[44:47], v[140:143]
    s_waitcnt vmcnt(27)
    ds_read_b128 v[20:23], v74 offset:2048
    v_mfma_f32_16x16x32_bf16 v[144:147], a[32:35], v[32:35], v[144:147]
    buffer_load_dwordx4 a[4:7], v2, s[24:27], s54 offen offset:1024 sc1
    v_mfma_f32_16x16x32_bf16 v[148:151], a[32:35], v[36:39], v[148:151]
    ds_read_b128 v[24:27], v74 offset:4096
    v_mfma_f32_16x16x32_bf16 v[152:155], a[32:35], v[40:43], v[152:155]
    s_waitcnt vmcnt(27)
    ds_read_b128 v[28:31], v74 offset:6144
    v_mfma_f32_16x16x32_bf16 v[156:159], a[32:35], v[44:47], v[156:159]
    buffer_load_dwordx4 a[8:11], v2, s[24:27], s54 offen offset:2048 sc1
    v_mfma_f32_16x16x32_bf16 v[160:163], a[36:39], v[32:35], v[160:163]
    v_mfma_f32_16x16x32_bf16 v[164:167], a[36:39], v[36:39], v[164:167]
    v_mfma_f32_16x16x32_bf16 v[168:171], a[36:39], v[40:43], v[168:171]
    buffer_load_dwordx4 a[12:15], v2, s[24:27], s54 offen offset:3072 sc1
    v_mfma_f32_16x16x32_bf16 v[172:175], a[36:39], v[44:47], v[172:175]
    s_waitcnt vmcnt(28)
    v_mfma_f32_16x16x32_bf16 v[176:179], a[40:43], v[32:35], v[176:179]
    v_mfma_f32_16x16x32_bf16 v[180:183], a[40:43], v[36:39], v[180:183]
    buffer_load_dwordx4 a[16:19], v2, s[24:27], s55 offen offset:0 sc1
    v_mfma_f32_16x16x32_bf16 v[184:187], a[40:43], v[40:43], v[184:187]
    v_mfma_f32_16x16x32_bf16 v[188:191], a[40:43], v[44:47], v[188:191]
    s_waitcnt vmcnt(28)
    v_mfma_f32_16x16x32_bf16 v[192:195], a[44:47], v[32:35], v[192:195]
    buffer_load_dwordx4 a[20:23], v2, s[24:27], s55 offen offset:1024 sc1
    v_mfma_f32_16x16x32_bf16 v[196:199], a[44:47], v[36:39], v[196:199]
    v_mfma_f32_16x16x32_bf16 v[200:203], a[44:47], v[40:43], v[200:203]
    s_waitcnt vmcnt(28)
    v_mfma_f32_16x16x32_bf16 v[204:207], a[44:47], v[44:47], v[204:207]
    buffer_load_dwordx4 a[24:27], v2, s[24:27], s55 offen offset:2048 sc1
    v_mfma_f32_16x16x32_bf16 v[208:211], a[48:51], v[32:35], v[208:211]
    s_add_u32 s54, s54, 7168
    s_add_u32 s55, s55, 7168
    v_mfma_f32_16x16x32_bf16 v[212:215], a[48:51], v[36:39], v[212:215]
    v_mfma_f32_16x16x32_bf16 v[216:219], a[48:51], v[40:43], v[216:219]
    v_mfma_f32_16x16x32_bf16 v[220:223], a[48:51], v[44:47], v[220:223]
    s_waitcnt vmcnt(28)
    v_mfma_f32_16x16x32_bf16 v[224:227], a[52:55], v[32:35], v[224:227]
    v_mfma_f32_16x16x32_bf16 v[228:231], a[52:55], v[36:39], v[228:231]
    v_mfma_f32_16x16x32_bf16 v[232:235], a[52:55], v[40:43], v[232:235]
    v_mfma_f32_16x16x32_bf16 v[236:239], a[52:55], v[44:47], v[236:239]
    s_waitcnt vmcnt(27) lgkmcnt(0)
    v_mfma_f32_16x16x32_bf16 v[128:131], a[56:59], v[16:19], v[128:131]
    s_add_u32 m0, s53, 98304
    v_mfma_f32_16x16x32_bf16 v[132:135], a[56:59], v[20:23], v[132:135]
    buffer_load_dwordx4 v50, s[44:47], s59 offen offset:0 lds
    v_mfma_f32_16x16x32_bf16 v[136:139], a[56:59], v[24:27], v[136:139]
    ds_read_b128 v[32:35], v75 offset:0
    v_mfma_f32_16x16x32_bf16 v[140:143], a[56:59], v[28:31], v[140:143]
    s_waitcnt vmcnt(27)
    ds_read_b128 v[36:39], v75 offset:2048
    v_mfma_f32_16x16x32_bf16 v[144:147], a[60:63], v[16:19], v[144:147]
    buffer_load_dwordx4 v51, s[44:47], s59 offen offset:1024 lds
    v_mfma_f32_16x16x32_bf16 v[148:151], a[60:63], v[20:23], v[148:151]
    ds_read_b128 v[40:43], v75 offset:4096
    v_mfma_f32_16x16x32_bf16 v[152:155], a[60:63], v[24:27], v[152:155]
    s_waitcnt vmcnt(27)
    ds_read_b128 v[44:47], v75 offset:6144
    v_mfma_f32_16x16x32_bf16 v[156:159], a[60:63], v[28:31], v[156:159]
    buffer_load_dwordx4 v52, s[44:47], s59 offen offset:2048 lds
    v_mfma_f32_16x16x32_bf16 v[160:163], a[64:67], v[16:19], v[160:163]
    v_mfma_f32_16x16x32_bf16 v[164:167], a[64:67], v[20:23], v[164:167]
    v_mfma_f32_16x16x32_bf16 v[168:171], a[64:67], v[24:27], v[168:171]
    buffer_load_dwordx4 v53, s[44:47], s59 offen offset:3072 lds
    v_mfma_f32_16x16x32_bf16 v[172:175], a[64:67], v[28:31], v[172:175]
    s_add_u32 s59, s59, 28672
    s_waitcnt vmcnt(28)
    v_mfma_f32_16x16x32_bf16 v[176:179], a[68:71], v[16:19], v[176:179]
    s_add_u32 m0, s53, 102400
    v_mfma_f32_16x16x32_bf16 v[180:183], a[68:71], v[20:23], v[180:183]
    buffer_load_dwordx4 v50, s[44:47], s59 offen offset:0 lds
    v_mfma_f32_16x16x32_bf16 v[184:187], a[68:71], v[24:27], v[184:187]
    v_mfma_f32_16x16x32_bf16 v[188:191], a[68:71], v[28:31], v[188:191]
    s_waitcnt vmcnt(28)
    v_mfma_f32_16x16x32_bf16 v[192:195], a[72:75], v[16:19], v[192:195]
    buffer_load_dwordx4 v51, s[44:47], s59 offen offset:1024 lds
    v_mfma_f32_16x16x32_bf16 v[196:199], a[72:75], v[20:23], v[196:199]
    v_mfma_f32_16x16x32_bf16 v[200:203], a[72:75], v[24:27], v[200:203]
    s_waitcnt vmcnt(28)
    v_mfma_f32_16x16x32_bf16 v[204:207], a[72:75], v[28:31], v[204:207]
    buffer_load_dwordx4 v52, s[44:47], s59 offen offset:2048 lds
    v_mfma_f32_16x16x32_bf16 v[208:211], a[76:79], v[16:19], v[208:211]
    v_mfma_f32_16x16x32_bf16 v[212:215], a[76:79], v[20:23], v[212:215]
    v_mfma_f32_16x16x32_bf16 v[216:219], a[76:79], v[24:27], v[216:219]
    buffer_load_dwordx4 v53, s[44:47], s59 offen offset:3072 lds
    v_mfma_f32_16x16x32_bf16 v[220:223], a[76:79], v[28:31], v[220:223]
    s_add_u32 s59, s59, 28672
    s_waitcnt vmcnt(29)
    v_mfma_f32_16x16x32_bf16 v[224:227], a[80:83], v[16:19], v[224:227]
    v_mfma_f32_16x16x32_bf16 v[228:231], a[80:83], v[20:23], v[228:231]
    v_mfma_f32_16x16x32_bf16 v[232:235], a[80:83], v[24:27], v[232:235]
    v_mfma_f32_16x16x32_bf16 v[236:239], a[80:83], v[28:31], v[236:239]
    s_waitcnt vmcnt(28) lgkmcnt(0)
    v_mfma_f32_16x16x32_bf16 v[128:131], a[84:87], v[32:35], v[128:131]
    s_add_u32 m0, s53, 131072
    v_mfma_f32_16x16x32_bf16 v[132:135], a[84:87], v[36:39], v[132:135]
    buffer_load_dwordx4 v50, s[44:47], s59 offen offset:0 lds
    v_mfma_f32_16x16x32_bf16 v[136:139], a[84:87], v[40:43], v[136:139]
    ds_read_b128 v[16:19], v72 offset:32768
    v_mfma_f32_16x16x32_bf16 v[140:143], a[84:87], v[44:47], v[140:143]
    s_waitcnt vmcnt(28)
    ds_read_b128 v[20:23], v72 offset:34816
    v_mfma_f32_16x16x32_bf16 v[144:147], a[88:91], v[32:35], v[144:147]
    buffer_load_dwordx4 v51, s[44:47], s59 offen offset:1024 lds
    v_mfma_f32_16x16x32_bf16 v[148:151], a[88:91], v[36:39], v[148:151]
    ds_read_b128 v[24:27], v72 offset:36864
    v_mfma_f32_16x16x32_bf16 v[152:155], a[88:91], v[40:43], v[152:155]
    s_waitcnt vmcnt(28)
    ds_read_b128 v[28:31], v72 offset:38912
    v_mfma_f32_16x16x32_bf16 v[156:159], a[88:91], v[44:47], v[156:159]
    buffer_load_dwordx4 v52, s[44:47], s59 offen offset:2048 lds
    v_mfma_f32_16x16x32_bf16 v[160:163], a[92:95], v[32:35], v[160:163]
    v_mfma_f32_16x16x32_bf16 v[164:167], a[92:95], v[36:39], v[164:167]
    v_mfma_f32_16x16x32_bf16 v[168:171], a[92:95], v[40:43], v[168:171]
    buffer_load_dwordx4 v53, s[44:47], s59 offen offset:3072 lds
    v_mfma_f32_16x16x32_bf16 v[172:175], a[92:95], v[44:47], v[172:175]
    s_add_u32 s59, s59, 28672
    s_waitcnt vmcnt(29)
    v_mfma_f32_16x16x32_bf16 v[176:179], a[96:99], v[32:35], v[176:179]
    s_add_u32 m0, s53, 135168
    v_mfma_f32_16x16x32_bf16 v[180:183], a[96:99], v[36:39], v[180:183]
    buffer_load_dwordx4 v50, s[44:47], s59 offen offset:0 lds
    v_mfma_f32_16x16x32_bf16 v[184:187], a[96:99], v[40:43], v[184:187]
    v_mfma_f32_16x16x32_bf16 v[188:191], a[96:99], v[44:47], v[188:191]
    s_waitcnt vmcnt(29)
    v_mfma_f32_16x16x32_bf16 v[192:195], a[100:103], v[32:35], v[192:195]
    buffer_load_dwordx4 v51, s[44:47], s59 offen offset:1024 lds
    v_mfma_f32_16x16x32_bf16 v[196:199], a[100:103], v[36:39], v[196:199]
    v_mfma_f32_16x16x32_bf16 v[200:203], a[100:103], v[40:43], v[200:203]
    s_waitcnt vmcnt(29)
    v_mfma_f32_16x16x32_bf16 v[204:207], a[100:103], v[44:47], v[204:207]
    buffer_load_dwordx4 v52, s[44:47], s59 offen offset:2048 lds
    v_mfma_f32_16x16x32_bf16 v[208:211], a[104:107], v[32:35], v[208:211]
    v_mfma_f32_16x16x32_bf16 v[212:215], a[104:107], v[36:39], v[212:215]
    v_mfma_f32_16x16x32_bf16 v[216:219], a[104:107], v[40:43], v[216:219]
    buffer_load_dwordx4 v53, s[44:47], s59 offen offset:3072 lds
    v_mfma_f32_16x16x32_bf16 v[220:223], a[104:107], v[44:47], v[220:223]
    s_add_u32 s59, s59, 28672
    s_waitcnt vmcnt(30)
    v_mfma_f32_16x16x32_bf16 v[224:227], a[108:111], v[32:35], v[224:227]
    v_mfma_f32_16x16x32_bf16 v[228:231], a[108:111], v[36:39], v[228:231]
    v_mfma_f32_16x16x32_bf16 v[232:235], a[108:111], v[40:43], v[232:235]
    v_mfma_f32_16x16x32_bf16 v[236:239], a[108:111], v[44:47], v[236:239]
    s_waitcnt vmcnt(29) lgkmcnt(0)
    v_mfma_f32_16x16x32_bf16 v[128:131], a[112:115], v[16:19], v[128:131]
    v_mfma_f32_16x16x32_bf16 v[132:135], a[112:115], v[20:23], v[132:135]
    ds_read_b128 v[32:35], v73 offset:32768
    v_mfma_f32_16x16x32_bf16 v[136:139], a[112:115], v[24:27], v[136:139]
    ds_read_b128 v[36:39], v73 offset:34816
    v_mfma_f32_16x16x32_bf16 v[140:143], a[112:115], v[28:31], v[140:143]
    s_waitcnt vmcnt(28)
    ds_read_b128 v[40:43], v73 offset:36864
    v_mfma_f32_16x16x32_bf16 v[144:147], a[116:119], v[16:19], v[144:147]
    ds_read_b128 v[44:47], v73 offset:38912
    v_mfma_f32_16x16x32_bf16 v[148:151], a[116:119], v[20:23], v[148:151]
    v_mfma_f32_16x16x32_bf16 v[152:155], a[116:119], v[24:27], v[152:155]
    v_mfma_f32_16x16x32_bf16 v[156:159], a[116:119], v[28:31], v[156:159]
    s_waitcnt vmcnt(27)
    v_mfma_f32_16x16x32_bf16 v[160:163], a[120:123], v[16:19], v[160:163]
    v_mfma_f32_16x16x32_bf16 v[164:167], a[120:123], v[20:23], v[164:167]
    v_mfma_f32_16x16x32_bf16 v[168:171], a[120:123], v[24:27], v[168:171]
    v_mfma_f32_16x16x32_bf16 v[172:175], a[120:123], v[28:31], v[172:175]
    s_waitcnt vmcnt(26)
    v_mfma_f32_16x16x32_bf16 v[176:179], a[124:127], v[16:19], v[176:179]
    v_mfma_f32_16x16x32_bf16 v[180:183], a[124:127], v[20:23], v[180:183]
    v_mfma_f32_16x16x32_bf16 v[184:187], a[124:127], v[24:27], v[184:187]
    v_mfma_f32_16x16x32_bf16 v[188:191], a[124:127], v[28:31], v[188:191]
    s_waitcnt vmcnt(25)
    v_mfma_f32_16x16x32_bf16 v[192:195], a[128:131], v[16:19], v[192:195]
    v_mfma_f32_16x16x32_bf16 v[196:199], a[128:131], v[20:23], v[196:199]
    v_mfma_f32_16x16x32_bf16 v[200:203], a[128:131], v[24:27], v[200:203]
    v_mfma_f32_16x16x32_bf16 v[204:207], a[128:131], v[28:31], v[204:207]
    s_waitcnt vmcnt(24)
    v_mfma_f32_16x16x32_bf16 v[208:211], a[132:135], v[16:19], v[208:211]
    v_mfma_f32_16x16x32_bf16 v[212:215], a[132:135], v[20:23], v[212:215]
    v_mfma_f32_16x16x32_bf16 v[216:219], a[132:135], v[24:27], v[216:219]
    v_mfma_f32_16x16x32_bf16 v[220:223], a[132:135], v[28:31], v[220:223]
    s_waitcnt vmcnt(23)
    v_mfma_f32_16x16x32_bf16 v[224:227], a[136:139], v[16:19], v[224:227]
    v_mfma_f32_16x16x32_bf16 v[228:231], a[136:139], v[20:23], v[228:231]
    v_mfma_f32_16x16x32_bf16 v[232:235], a[136:139], v[24:27], v[232:235]
    v_mfma_f32_16x16x32_bf16 v[236:239], a[136:139], v[28:31], v[236:239]
    s_waitcnt vmcnt(22) lgkmcnt(0)
    v_mfma_f32_16x16x32_bf16 v[128:131], a[0:3], v[32:35], v[128:131]
    v_add_u32 v4, s53, v2
    v_add_u32 v13, 0x10000, v4
    v_mfma_f32_16x16x32_bf16 v[132:135], a[0:3], v[36:39], v[132:135]
    v_mfma_f32_16x16x32_bf16 v[136:139], a[0:3], v[40:43], v[136:139]
    v_mfma_f32_16x16x32_bf16 v[140:143], a[0:3], v[44:47], v[140:143]
    s_waitcnt vmcnt(21)
    v_mfma_f32_16x16x32_bf16 v[144:147], a[4:7], v[32:35], v[144:147]
    v_mfma_f32_16x16x32_bf16 v[148:151], a[4:7], v[36:39], v[148:151]
    v_mfma_f32_16x16x32_bf16 v[152:155], a[4:7], v[40:43], v[152:155]
    v_mfma_f32_16x16x32_bf16 v[156:159], a[4:7], v[44:47], v[156:159]
    s_waitcnt vmcnt(20)
    v_mfma_f32_16x16x32_bf16 v[160:163], a[8:11], v[32:35], v[160:163]
    v_mfma_f32_16x16x32_bf16 v[164:167], a[8:11], v[36:39], v[164:167]
    ds_write_b128 v4, v[132:135] offset:0
    v_mfma_f32_16x16x32_bf16 v[168:171], a[8:11], v[40:43], v[168:171]
    ds_write_b128 v4, v[136:139] offset:32768
    v_mfma_f32_16x16x32_bf16 v[172:175], a[8:11], v[44:47], v[172:175]
    s_waitcnt vmcnt(19)
    ds_write_b128 v13, v[140:143] offset:0
    v_mfma_f32_16x16x32_bf16 v[176:179], a[12:15], v[32:35], v[176:179]
    v_mfma_f32_16x16x32_bf16 v[180:183], a[12:15], v[36:39], v[180:183]
    ds_write_b128 v4, v[148:151] offset:1024
    v_mfma_f32_16x16x32_bf16 v[184:187], a[12:15], v[40:43], v[184:187]
    ds_write_b128 v4, v[152:155] offset:33792
    v_mfma_f32_16x16x32_bf16 v[188:191], a[12:15], v[44:47], v[188:191]
    s_waitcnt vmcnt(18)
    ds_write_b128 v13, v[156:159] offset:1024
    v_mfma_f32_16x16x32_bf16 v[192:195], a[16:19], v[32:35], v[192:195]
    v_mfma_f32_16x16x32_bf16 v[196:199], a[16:19], v[36:39], v[196:199]
    ds_write_b128 v4, v[164:167] offset:2048
    v_mfma_f32_16x16x32_bf16 v[200:203], a[16:19], v[40:43], v[200:203]
    ds_write_b128 v4, v[168:171] offset:34816
    v_mfma_f32_16x16x32_bf16 v[204:207], a[16:19], v[44:47], v[204:207]
    s_waitcnt vmcnt(17)
    ds_write_b128 v13, v[172:175] offset:2048
    v_mfma_f32_16x16x32_bf16 v[208:211], a[20:23], v[32:35], v[208:211]
    v_mfma_f32_16x16x32_bf16 v[212:215], a[20:23], v[36:39], v[212:215]
    ds_write_b128 v4, v[180:183] offset:3072
    v_mfma_f32_16x16x32_bf16 v[216:219], a[20:23], v[40:43], v[216:219]
    ds_write_b128 v4, v[184:187] offset:35840
    v_mfma_f32_16x16x32_bf16 v[220:223], a[20:23], v[44:47], v[220:223]
    s_waitcnt vmcnt(16)
    ds_write_b128 v13, v[188:191] offset:3072
    v_mfma_f32_16x16x32_bf16 v[224:227], a[24:27], v[32:35], v[224:227]
    v_mfma_f32_16x16x32_bf16 v[228:231], a[24:27], v[36:39], v[228:231]
    ds_write_b128 v4, v[196:199] offset:4096
    v_mfma_f32_16x16x32_bf16 v[232:235], a[24:27], v[40:43], v[232:235]
    ds_write_b128 v4, v[200:203] offset:36864
    v_mfma_f32_16x16x32_bf16 v[236:239], a[24:27], v[44:47], v[236:239]
    ds_write_b128 v13, v[204:207] offset:4096
    s_sub_u32 s34, s28, 1
    s_and_b32 s34, s34, 3
    s_lshl_b32 s34, s34, 13
    s_add_u32 s34, s34, 0
    v_add_u32 v5, s34, v2
    s_sub_u32 s34, s28, 2
    s_and_b32 s34, s34, 3
    s_lshl_b32 s34, s34, 13
    s_add_u32 s34, s34, 32768
    v_add_u32 v6, s34, v2
    s_sub_u32 s34, s28, 3
    s_and_b32 s34, s34, 3
    s_lshl_b32 s34, s34, 13
    s_add_u32 s34, s34, 65536
    v_add_u32 v7, s34, v2
    ds_write_b128 v4, v[212:215] offset:5120
    ds_write_b128 v4, v[216:219] offset:37888
    ds_write_b128 v13, v[220:223] offset:5120
    ds_write_b128 v4, v[228:231] offset:6144
    ds_write_b128 v4, v[232:235] offset:38912
    ds_write_b128 v13, v[236:239] offset:6144
    s_waitcnt lgkmcnt(0)
    s_barrier
    ds_read_b128 v[132:135], v5 offset:0
    ds_read_b128 v[136:139], v6 offset:0
    ds_read_b128 v[140:143], v7 offset:0
    ds_read_b128 v[148:151], v5 offset:1024
    ds_read_b128 v[152:155], v6 offset:1024
    ds_read_b128 v[156:159], v7 offset:1024
    ds_read_b128 v[164:167], v5 offset:2048
    ds_read_b128 v[168:171], v6 offset:2048
    ds_read_b128 v[172:175], v7 offset:2048
    ds_read_b128 v[180:183], v5 offset:3072
    ds_read_b128 v[184:187], v6 offset:3072
    ds_read_b128 v[188:191], v7 offset:3072
    ds_read_b128 v[196:199], v5 offset:4096
    ds_read_b128 v[200:203], v6 offset:4096
    ds_read_b128 v[204:207], v7 offset:4096
    ds_read_b128 v[212:215], v5 offset:5120
    ds_read_b128 v[216:219], v6 offset:5120
    ds_read_b128 v[220:223], v7 offset:5120
    ds_read_b128 v[228:231], v5 offset:6144
    ds_read_b128 v[232:235], v6 offset:6144
    ds_read_b128 v[236:239], v7 offset:6144
    s_mul_i32 s34, s58, 28672
    s_add_u32 s34, s34, 24641536
    s_mul_i32 s35, s50, 7
    s_add_u32 s36, s35, 1
    s_lshr_b32 s36, s36, 1
    s_lshl_b32 s36, s36, 10
    s_add_u32 s36, s36, s34
    s_and_b32 s37, s50, 1
    s_mul_i32 s37, s37, 3584
    s_sub_u32 s37, s36, s37
    s_add_u32 s37, s37, 3072
    v_lshlrev_b32 v14, 3, v1
    v_lshlrev_b32 v94, 16, v94
    v_mov_b32 v8, v94
    s_waitcnt lgkmcnt(15)
    v_pk_add_f32 v[128:129], v[128:129], v[132:133]
    v_pk_add_f32 v[136:137], v[136:137], v[140:141]
    v_pk_add_f32 v[130:131], v[130:131], v[134:135]
    v_pk_add_f32 v[138:139], v[138:139], v[142:143]
    v_pk_add_f32 v[128:129], v[128:129], v[136:137]
    v_pk_add_f32 v[130:131], v[130:131], v[138:139]
    v_pk_add_f32 v[128:129], v[128:129], v[8:9] op_sel_hi:[1,0]
    v_lshlrev_b32 v10, 16, v80
    v_and_b32 v11, 0xffff0000, v80
    v_pk_mul_f32 v[128:129], v[128:129], v[10:11]
    v_pk_add_f32 v[130:131], v[130:131], v[8:9] op_sel_hi:[1,0]
    v_lshlrev_b32 v12, 16, v81
    v_and_b32 v13, 0xffff0000, v81
    v_pk_mul_f32 v[130:131], v[130:131], v[12:13]
    v_cvt_pk_bf16_f32 v132, v128, v129
    v_cvt_pk_bf16_f32 v133, v130, v131
    v_pk_add_f32 v[144:145], v[144:145], v[148:149]
    v_pk_add_f32 v[152:153], v[152:153], v[156:157]
    v_pk_add_f32 v[146:147], v[146:147], v[150:151]
    v_pk_add_f32 v[154:155], v[154:155], v[158:159]
    v_pk_add_f32 v[144:145], v[144:145], v[152:153]
    v_pk_add_f32 v[146:147], v[146:147], v[154:155]
    v_pk_add_f32 v[144:145], v[144:145], v[8:9] op_sel_hi:[1,0]
    v_lshlrev_b32 v10, 16, v82
    v_and_b32 v11, 0xffff0000, v82
    v_pk_mul_f32 v[144:145], v[144:145], v[10:11]
    v_pk_add_f32 v[146:147], v[146:147], v[8:9] op_sel_hi:[1,0]
    v_lshlrev_b32 v12, 16, v83
    v_and_b32 v13, 0xffff0000, v83
    v_pk_mul_f32 v[146:147], v[146:147], v[12:13]
    v_cvt_pk_bf16_f32 v134, v144, v145
    v_cvt_pk_bf16_f32 v135, v146, v147
    buffer_store_dwordx4 v[132:135], v2, s[24:27], s36 offen offset:0 sc1
    s_waitcnt lgkmcnt(14)
    v_pk_add_f32 v[160:161], v[160:161], v[164:165]
    s_waitcnt lgkmcnt(12)
    v_pk_add_f32 v[168:169], v[168:169], v[172:173]
    v_pk_add_f32 v[162:163], v[162:163], v[166:167]
    v_pk_add_f32 v[170:171], v[170:171], v[174:175]
    v_pk_add_f32 v[160:161], v[160:161], v[168:169]
    v_pk_add_f32 v[162:163], v[162:163], v[170:171]
    v_pk_add_f32 v[160:161], v[160:161], v[8:9] op_sel_hi:[1,0]
    v_lshlrev_b32 v10, 16, v84
    v_and_b32 v11, 0xffff0000, v84
    v_pk_mul_f32 v[160:161], v[160:161], v[10:11]
    v_pk_add_f32 v[162:163], v[162:163], v[8:9] op_sel_hi:[1,0]
    v_lshlrev_b32 v12, 16, v85
    v_and_b32 v13, 0xffff0000, v85
    v_pk_mul_f32 v[162:163], v[162:163], v[12:13]
    v_cvt_pk_bf16_f32 v164, v160, v161
    v_cvt_pk_bf16_f32 v165, v162, v163
    s_waitcnt lgkmcnt(11)
    v_pk_add_f32 v[176:177], v[176:177], v[180:181]
    s_waitcnt lgkmcnt(9)
    v_pk_add_f32 v[184:185], v[184:185], v[188:189]
    v_pk_add_f32 v[178:179], v[178:179], v[182:183]
    v_pk_add_f32 v[186:187], v[186:187], v[190:191]
    v_pk_add_f32 v[176:177], v[176:177], v[184:185]
    v_pk_add_f32 v[178:179], v[178:179], v[186:187]
    v_pk_add_f32 v[176:177], v[176:177], v[8:9] op_sel_hi:[1,0]
    v_lshlrev_b32 v10, 16, v86
    v_and_b32 v11, 0xffff0000, v86
    v_pk_mul_f32 v[176:177], v[176:177], v[10:11]
    v_pk_add_f32 v[178:179], v[178:179], v[8:9] op_sel_hi:[1,0]
    v_lshlrev_b32 v12, 16, v87
    v_and_b32 v13, 0xffff0000, v87
    v_pk_mul_f32 v[178:179], v[178:179], v[12:13]
    v_cvt_pk_bf16_f32 v166, v176, v177
    v_cvt_pk_bf16_f32 v167, v178, v179
    buffer_store_dwordx4 v[164:167], v2, s[24:27], s36 offen offset:1024 sc1
    s_waitcnt lgkmcnt(8)
    v_pk_add_f32 v[192:193], v[192:193], v[196:197]
    s_waitcnt lgkmcnt(6)
    v_pk_add_f32 v[200:201], v[200:201], v[204:205]
    v_pk_add_f32 v[194:195], v[194:195], v[198:199]
    v_pk_add_f32 v[202:203], v[202:203], v[206:207]
    v_pk_add_f32 v[192:193], v[192:193], v[200:201]
    v_pk_add_f32 v[194:195], v[194:195], v[202:203]
    v_pk_add_f32 v[192:193], v[192:193], v[8:9] op_sel_hi:[1,0]
    v_lshlrev_b32 v10, 16, v88
    v_and_b32 v11, 0xffff0000, v88
    v_pk_mul_f32 v[192:193], v[192:193], v[10:11]
    v_pk_add_f32 v[194:195], v[194:195], v[8:9] op_sel_hi:[1,0]
    v_lshlrev_b32 v12, 16, v89
    v_and_b32 v13, 0xffff0000, v89
    v_pk_mul_f32 v[194:195], v[194:195], v[12:13]
    v_cvt_pk_bf16_f32 v196, v192, v193
    v_cvt_pk_bf16_f32 v197, v194, v195
    s_waitcnt lgkmcnt(5)
    v_pk_add_f32 v[208:209], v[208:209], v[212:213]
    s_waitcnt lgkmcnt(3)
    v_pk_add_f32 v[216:217], v[216:217], v[220:221]
    v_pk_add_f32 v[210:211], v[210:211], v[214:215]
    v_pk_add_f32 v[218:219], v[218:219], v[222:223]
    v_pk_add_f32 v[208:209], v[208:209], v[216:217]
    v_pk_add_f32 v[210:211], v[210:211], v[218:219]
    v_pk_add_f32 v[208:209], v[208:209], v[8:9] op_sel_hi:[1,0]
    v_lshlrev_b32 v10, 16, v90
    v_and_b32 v11, 0xffff0000, v90
    v_pk_mul_f32 v[208:209], v[208:209], v[10:11]
    v_pk_add_f32 v[210:211], v[210:211], v[8:9] op_sel_hi:[1,0]
    v_lshlrev_b32 v12, 16, v91
    v_and_b32 v13, 0xffff0000, v91
    v_pk_mul_f32 v[210:211], v[210:211], v[12:13]
    v_cvt_pk_bf16_f32 v198, v208, v209
    v_cvt_pk_bf16_f32 v199, v210, v211
    buffer_store_dwordx4 v[196:199], v2, s[24:27], s36 offen offset:2048 sc1
    s_waitcnt lgkmcnt(2)
    v_pk_add_f32 v[224:225], v[224:225], v[228:229]
    s_waitcnt lgkmcnt(0)
    v_pk_add_f32 v[232:233], v[232:233], v[236:237]
    v_pk_add_f32 v[226:227], v[226:227], v[230:231]
    v_pk_add_f32 v[234:235], v[234:235], v[238:239]
    v_pk_add_f32 v[224:225], v[224:225], v[232:233]
    v_pk_add_f32 v[226:227], v[226:227], v[234:235]
    v_pk_add_f32 v[224:225], v[224:225], v[8:9] op_sel_hi:[1,0]
    v_lshlrev_b32 v10, 16, v92
    v_and_b32 v11, 0xffff0000, v92
    v_pk_mul_f32 v[224:225], v[224:225], v[10:11]
    v_pk_add_f32 v[226:227], v[226:227], v[8:9] op_sel_hi:[1,0]
    v_lshlrev_b32 v12, 16, v93
    v_and_b32 v13, 0xffff0000, v93
    v_pk_mul_f32 v[226:227], v[226:227], v[12:13]
    v_cvt_pk_bf16_f32 v228, v224, v225
    v_cvt_pk_bf16_f32 v229, v226, v227
    buffer_store_dwordx2 v[228:229], v14, s[24:27], s37 offen sc1
    s_barrier
    v_bfe_u32 v8, v0, 4, 2
    s_lshl_b32 s14, s51, 7
    s_add_u32 s14, s14, 126976
    s_add_u32 m0, s53, 0
    s_nop 0
    buffer_load_dwordx4 v50, s[44:47], s59 offen offset:0 lds
    buffer_load_dwordx4 v51, s[44:47], s59 offen offset:1024 lds
    buffer_load_dwordx4 v52, s[44:47], s59 offen offset:2048 lds
    buffer_load_dwordx4 v53, s[44:47], s59 offen offset:3072 lds
    s_add_u32 s59, s59, 28672
    s_lshl_b32 s15, 1, s50
    s_waitcnt vmcnt(4)
    s_barrier
    s_cmp_lg_u32 s28, 0
    s_cbranch_scc1 L_sig_oadaLN_cond__gqa_block_cached__mixer_gmlp__prompt_kernel
    v_mov_b32 v48, s15
    v_mov_b32 v49, 0
    s_mov_b64 exec, 1
    buffer_atomic_add v48, v49, s[24:27], s14 offen sc1
    s_mov_b64 exec, -1
L_sig_oadaLN_cond__gqa_block_cached__mixer_gmlp__prompt_kernel:
    s_cmp_ge_u32 s30, 28
    s_cbranch_scc1 L_bumpadaLN_cond__gqa_block_cached__mixer_gmlp__prompt_kernel
    s_add_u32 m0, s53, 4096
    s_nop 0
    buffer_load_dwordx4 v50, s[44:47], s59 offen offset:0 lds
    buffer_load_dwordx4 v51, s[44:47], s59 offen offset:1024 lds
    buffer_load_dwordx4 v52, s[44:47], s59 offen offset:2048 lds
    buffer_load_dwordx4 v53, s[44:47], s59 offen offset:3072 lds
    s_add_u32 s59, s59, 28672
    s_add_u32 m0, s53, 32768
    s_nop 0
    buffer_load_dwordx4 v50, s[44:47], s59 offen offset:0 lds
    buffer_load_dwordx4 v51, s[44:47], s59 offen offset:1024 lds
    buffer_load_dwordx4 v52, s[44:47], s59 offen offset:2048 lds
    buffer_load_dwordx4 v53, s[44:47], s59 offen offset:3072 lds
    s_add_u32 s59, s59, 28672
    s_add_u32 s36, s28, 0
    s_and_b32 s36, s36, 3
    s_lshl_b32 s37, s33, 2
    s_add_u32 s36, s36, s37
    s_mul_i32 s36, s36, 28672
    s_mul_i32 s37, s28, 7168
    s_add_u32 s36, s36, s37
    s_add_u32 s4, s36, 24641536
    s_add_u32 s8, s4, 4096
    s_add_u32 s36, s28, 1
    s_and_b32 s36, s36, 3
    s_lshl_b32 s37, s33, 2
    s_add_u32 s36, s36, s37
    s_mul_i32 s36, s36, 28672
    s_mul_i32 s37, s28, 7168
    s_add_u32 s36, s36, s37
    s_add_u32 s5, s36, 24641536
    s_add_u32 s9, s5, 4096
    s_add_u32 s36, s28, 2
    s_and_b32 s36, s36, 3
    s_lshl_b32 s37, s33, 2
    s_add_u32 s36, s36, s37
    s_mul_i32 s36, s36, 28672
    s_mul_i32 s37, s28, 7168
    s_add_u32 s36, s36, s37
    s_add_u32 s6, s36, 24641536
    s_add_u32 s10, s6, 4096
    s_add_u32 s36, s28, 3
    s_and_b32 s36, s36, 3
    s_lshl_b32 s37, s33, 2
    s_add_u32 s36, s36, s37
    s_mul_i32 s36, s36, 28672
    s_mul_i32 s37, s28, 7168
    s_add_u32 s36, s36, s37
    s_add_u32 s7, s36, 24641536
    s_add_u32 s11, s7, 4096
    s_lshl_b32 s36, s33, 2
    s_add_u32 s36, s36, s28
    s_mul_i32 s37, s36, 14336
    s_lshl_b32 s38, s32, 11
    s_add_u32 s37, s37, s38
    s_add_u32 s37, s37, 20971520
    buffer_load_dwordx4 v[16:19], v2, s[24:27], s37 offen sc1
    buffer_load_dwordx4 v[20:23], v2, s[24:27], s37 offen offset:1024 sc1
    v_lshlrev_b32 v9, 4, v8
    s_lshl_b32 s38, s32, 8
    s_add_u32 s38, s38, 8960
    buffer_load_dwordx4 v[24:27], v9, s[24:27], s38 offen offset:0 sc1
    buffer_load_dwordx4 v[28:31], v9, s[24:27], s38 offen offset:64 sc1
    buffer_load_dwordx4 v[32:35], v9, s[24:27], s38 offen offset:128 sc1
    buffer_load_dwordx4 v[36:39], v9, s[24:27], s38 offen offset:192 sc1
    v_lshrrev_b32 v3, 2, v1
    v_lshlrev_b32 v3, 7, v3
    v_bfe_u32 v10, v0, 3, 2
    v_lshl_add_u32 v3, v10, 5, v3
    v_and_b32 v10, 3, v0
    v_lshl_add_u32 v3, v10, 3, v3
    v_add_u32 v12, s53, v3
    v_xor_b32 v13, 32, v12
    v_xor_b32 v14, 64, v12
    v_xor_b32 v15, 0x60, v12
    v_add_u32 v56, 98304, v12
    v_add_u32 v57, 98304, v13
    v_add_u32 v58, 98304, v14
    v_add_u32 v59, 98304, v15
    v_mov_b32 v10, 0
    v_lshlrev_b32 v11, 3, v1
    s_lshl_b32 s15, s33, 7
    s_add_u32 s15, s15, 126976
    s_lshl_b32 s36, s28, 1
    s_lshl_b32 s36, 3, s36
    s_mov_b32 s56, 0x100000
L_poll_oadaLN_cond__gqa_block_cached__mixer_gmlp__prompt_kernel:
    buffer_load_dword v48, v10, s[24:27], s15 offen sc1
    s_waitcnt vmcnt(0)
    v_and_b32 v48, s36, v48
    v_cmp_gt_u32 vcc, s36, v48
    s_cbranch_vccz L_polled_oadaLN_cond__gqa_block_cached__mixer_gmlp__prompt_kernel
    s_sleep 1
    s_sub_u32 s56, s56, 1
    s_cmp_lg_u32 s56, 0
    s_cbranch_scc1 L_poll_oadaLN_cond__gqa_block_cached__mixer_gmlp__prompt_kernel
L_polled_oadaLN_cond__gqa_block_cached__mixer_gmlp__prompt_kernel:
    buffer_load_dwordx4 a[0:3], v2, s[24:27], s4 offen offset:0 sc1
    buffer_load_dwordx4 a[4:7], v2, s[24:27], s5 offen offset:0 sc1
    buffer_load_dwordx4 a[8:11], v2, s[24:27], s6 offen offset:0 sc1
    buffer_load_dwordx4 a[12:15], v2, s[24:27], s7 offen offset:0 sc1
    buffer_load_dwordx4 a[16:19], v2, s[24:27], s4 offen offset:1024 sc1
    buffer_load_dwordx4 a[20:23], v2, s[24:27], s5 offen offset:1024 sc1
    buffer_load_dwordx4 a[24:27], v2, s[24:27], s6 offen offset:1024 sc1
    buffer_load_dwordx4 a[28:31], v2, s[24:27], s7 offen offset:1024 sc1
    buffer_load_dwordx4 a[32:35], v2, s[24:27], s4 offen offset:2048 sc1
    buffer_load_dwordx4 a[36:39], v2, s[24:27], s5 offen offset:2048 sc1
    buffer_load_dwordx4 a[40:43], v2, s[24:27], s6 offen offset:2048 sc1
    buffer_load_dwordx4 a[44:47], v2, s[24:27], s7 offen offset:2048 sc1
    buffer_load_dwordx2 a[48:49], v11, s[24:27], s4 offen offset:3072 sc1
    buffer_load_dwordx2 a[50:51], v11, s[24:27], s4 offen offset:3584 sc1
    buffer_load_dwordx2 a[52:53], v11, s[24:27], s5 offen offset:3072 sc1
    buffer_load_dwordx2 a[54:55], v11, s[24:27], s5 offen offset:3584 sc1
    buffer_load_dwordx2 a[56:57], v11, s[24:27], s6 offen offset:3072 sc1
    buffer_load_dwordx2 a[58:59], v11, s[24:27], s6 offen offset:3584 sc1
    buffer_load_dwordx2 a[60:61], v11, s[24:27], s7 offen offset:3072 sc1
    buffer_load_dwordx2 a[62:63], v11, s[24:27], s7 offen offset:3584 sc1
    ds_read_b64_tr_b16 a[112:113], v56 offset:0
    ds_read_b64_tr_b16 a[114:115], v56 offset:2048
    ds_read_b64_tr_b16 a[116:117], v57 offset:0
    ds_read_b64_tr_b16 a[118:119], v57 offset:2048
    ds_read_b64_tr_b16 a[120:121], v58 offset:0
    ds_read_b64_tr_b16 a[122:123], v58 offset:2048
    ds_read_b64_tr_b16 a[124:125], v59 offset:0
    ds_read_b64_tr_b16 a[126:127], v59 offset:2048
    s_waitcnt vmcnt(19) lgkmcnt(6)
    v_mfma_f32_16x16x32_bf16 v[64:67], a[112:115], a[0:3], 0
    ds_read_b64_tr_b16 a[128:129], v56 offset:4096
    s_waitcnt vmcnt(18)
    v_mfma_f32_16x16x32_bf16 v[68:71], a[112:115], a[4:7], 0
    ds_read_b64_tr_b16 a[130:131], v56 offset:6144
    s_waitcnt vmcnt(17)
    v_mfma_f32_16x16x32_bf16 v[72:75], a[112:115], a[8:11], 0
    buffer_load_dwordx4 a[64:67], v2, s[24:27], s8 offen offset:0 sc1
    s_waitcnt vmcnt(17)
    v_mfma_f32_16x16x32_bf16 v[76:79], a[112:115], a[12:15], 0
    s_waitcnt lgkmcnt(6)
    v_mfma_f32_16x16x32_bf16 v[80:83], a[116:119], a[0:3], 0
    ds_read_b64_tr_b16 a[132:133], v57 offset:4096
    v_mfma_f32_16x16x32_bf16 v[84:87], a[116:119], a[4:7], 0
    ds_read_b64_tr_b16 a[134:135], v57 offset:6144
    v_mfma_f32_16x16x32_bf16 v[88:91], a[116:119], a[8:11], 0
    buffer_load_dwordx4 a[68:71], v2, s[24:27], s9 offen offset:0 sc1
    v_mfma_f32_16x16x32_bf16 v[92:95], a[116:119], a[12:15], 0
    s_waitcnt lgkmcnt(6)
    v_mfma_f32_16x16x32_bf16 v[96:99], a[120:123], a[0:3], 0
    ds_read_b64_tr_b16 a[136:137], v58 offset:4096
    v_mfma_f32_16x16x32_bf16 v[100:103], a[120:123], a[4:7], 0
    ds_read_b64_tr_b16 a[138:139], v58 offset:6144
    v_mfma_f32_16x16x32_bf16 v[104:107], a[120:123], a[8:11], 0
    buffer_load_dwordx4 a[72:75], v2, s[24:27], s10 offen offset:0 sc1
    v_mfma_f32_16x16x32_bf16 v[108:111], a[120:123], a[12:15], 0
    s_waitcnt lgkmcnt(6)
    v_mfma_f32_16x16x32_bf16 v[112:115], a[124:127], a[0:3], 0
    ds_read_b64_tr_b16 a[140:141], v59 offset:4096
    v_mfma_f32_16x16x32_bf16 v[116:119], a[124:127], a[4:7], 0
    ds_read_b64_tr_b16 a[142:143], v59 offset:6144
    v_mfma_f32_16x16x32_bf16 v[120:123], a[124:127], a[8:11], 0
    buffer_load_dwordx4 a[76:79], v2, s[24:27], s11 offen offset:0 sc1
    v_mfma_f32_16x16x32_bf16 v[124:127], a[124:127], a[12:15], 0
    s_waitcnt vmcnt(16) lgkmcnt(6)
    v_mfma_f32_16x16x32_bf16 v[64:67], a[128:131], a[16:19], v[64:67]
    ds_read_b64_tr_b16 a[112:113], v56 offset:32768
    v_mfma_f32_16x16x32_bf16 v[68:71], a[128:131], a[20:23], v[68:71]
    ds_read_b64_tr_b16 a[114:115], v56 offset:34816
    v_mfma_f32_16x16x32_bf16 v[72:75], a[128:131], a[24:27], v[72:75]
    buffer_load_dwordx4 a[80:83], v2, s[24:27], s8 offen offset:1024 sc1
    v_mfma_f32_16x16x32_bf16 v[76:79], a[128:131], a[28:31], v[76:79]
    s_waitcnt lgkmcnt(6)
    v_mfma_f32_16x16x32_bf16 v[80:83], a[132:135], a[16:19], v[80:83]
    ds_read_b64_tr_b16 a[116:117], v57 offset:32768
    v_mfma_f32_16x16x32_bf16 v[84:87], a[132:135], a[20:23], v[84:87]
    ds_read_b64_tr_b16 a[118:119], v57 offset:34816
    v_mfma_f32_16x16x32_bf16 v[88:91], a[132:135], a[24:27], v[88:91]
    buffer_load_dwordx4 a[84:87], v2, s[24:27], s9 offen offset:1024 sc1
    v_mfma_f32_16x16x32_bf16 v[92:95], a[132:135], a[28:31], v[92:95]
    s_waitcnt lgkmcnt(6)
    v_mfma_f32_16x16x32_bf16 v[96:99], a[136:139], a[16:19], v[96:99]
    ds_read_b64_tr_b16 a[120:121], v58 offset:32768
    v_mfma_f32_16x16x32_bf16 v[100:103], a[136:139], a[20:23], v[100:103]
    ds_read_b64_tr_b16 a[122:123], v58 offset:34816
    v_mfma_f32_16x16x32_bf16 v[104:107], a[136:139], a[24:27], v[104:107]
    buffer_load_dwordx4 a[88:91], v2, s[24:27], s10 offen offset:1024 sc1
    v_mfma_f32_16x16x32_bf16 v[108:111], a[136:139], a[28:31], v[108:111]
    s_waitcnt lgkmcnt(6)
    v_mfma_f32_16x16x32_bf16 v[112:115], a[140:143], a[16:19], v[112:115]
    ds_read_b64_tr_b16 a[124:125], v59 offset:32768
    v_mfma_f32_16x16x32_bf16 v[116:119], a[140:143], a[20:23], v[116:119]
    ds_read_b64_tr_b16 a[126:127], v59 offset:34816
    v_mfma_f32_16x16x32_bf16 v[120:123], a[140:143], a[24:27], v[120:123]
    buffer_load_dwordx4 a[92:95], v2, s[24:27], s11 offen offset:1024 sc1
    v_mfma_f32_16x16x32_bf16 v[124:127], a[140:143], a[28:31], v[124:127]
    s_waitcnt vmcnt(16) lgkmcnt(6)
    v_mfma_f32_16x16x32_bf16 v[64:67], a[112:115], a[32:35], v[64:67]
    ds_read_b64_tr_b16 a[128:129], v56 offset:36864
    v_mfma_f32_16x16x32_bf16 v[68:71], a[112:115], a[36:39], v[68:71]
    ds_read_b64_tr_b16 a[130:131], v56 offset:38912
    v_mfma_f32_16x16x32_bf16 v[72:75], a[112:115], a[40:43], v[72:75]
    buffer_load_dwordx4 a[96:99], v2, s[24:27], s8 offen offset:2048 sc1
    v_mfma_f32_16x16x32_bf16 v[76:79], a[112:115], a[44:47], v[76:79]
    s_waitcnt lgkmcnt(6)
    v_mfma_f32_16x16x32_bf16 v[80:83], a[116:119], a[32:35], v[80:83]
    ds_read_b64_tr_b16 a[132:133], v57 offset:36864
    v_mfma_f32_16x16x32_bf16 v[84:87], a[116:119], a[36:39], v[84:87]
    ds_read_b64_tr_b16 a[134:135], v57 offset:38912
    v_mfma_f32_16x16x32_bf16 v[88:91], a[116:119], a[40:43], v[88:91]
    buffer_load_dwordx4 a[100:103], v2, s[24:27], s9 offen offset:2048 sc1
    v_mfma_f32_16x16x32_bf16 v[92:95], a[116:119], a[44:47], v[92:95]
    s_waitcnt lgkmcnt(6)
    v_mfma_f32_16x16x32_bf16 v[96:99], a[120:123], a[32:35], v[96:99]
    ds_read_b64_tr_b16 a[136:137], v58 offset:36864
    v_mfma_f32_16x16x32_bf16 v[100:103], a[120:123], a[36:39], v[100:103]
    ds_read_b64_tr_b16 a[138:139], v58 offset:38912
    v_mfma_f32_16x16x32_bf16 v[104:107], a[120:123], a[40:43], v[104:107]
    buffer_load_dwordx4 a[104:107], v2, s[24:27], s10 offen offset:2048 sc1
    v_mfma_f32_16x16x32_bf16 v[108:111], a[120:123], a[44:47], v[108:111]
    s_waitcnt lgkmcnt(6)
    v_mfma_f32_16x16x32_bf16 v[112:115], a[124:127], a[32:35], v[112:115]
    ds_read_b64_tr_b16 a[140:141], v59 offset:36864
    v_mfma_f32_16x16x32_bf16 v[116:119], a[124:127], a[36:39], v[116:119]
    ds_read_b64_tr_b16 a[142:143], v59 offset:38912
    v_mfma_f32_16x16x32_bf16 v[120:123], a[124:127], a[40:43], v[120:123]
    buffer_load_dwordx4 a[108:111], v2, s[24:27], s11 offen offset:2048 sc1
    v_mfma_f32_16x16x32_bf16 v[124:127], a[124:127], a[44:47], v[124:127]
    s_waitcnt vmcnt(12) lgkmcnt(6)
    v_mfma_f32_16x16x32_bf16 v[64:67], a[128:131], a[48:51], v[64:67]
    ds_read_b64_tr_b16 a[112:113], v12 offset:0
    v_mfma_f32_16x16x32_bf16 v[68:71], a[128:131], a[52:55], v[68:71]
    ds_read_b64_tr_b16 a[114:115], v12 offset:2048
    v_mfma_f32_16x16x32_bf16 v[72:75], a[128:131], a[56:59], v[72:75]
    v_mfma_f32_16x16x32_bf16 v[76:79], a[128:131], a[60:63], v[76:79]
    s_waitcnt lgkmcnt(6)
    v_mfma_f32_16x16x32_bf16 v[80:83], a[132:135], a[48:51], v[80:83]
    ds_read_b64_tr_b16 a[116:117], v13 offset:0
    v_mfma_f32_16x16x32_bf16 v[84:87], a[132:135], a[52:55], v[84:87]
    ds_read_b64_tr_b16 a[118:119], v13 offset:2048
    v_mfma_f32_16x16x32_bf16 v[88:91], a[132:135], a[56:59], v[88:91]
    v_mfma_f32_16x16x32_bf16 v[92:95], a[132:135], a[60:63], v[92:95]
    s_waitcnt lgkmcnt(6)
    v_mfma_f32_16x16x32_bf16 v[96:99], a[136:139], a[48:51], v[96:99]
    ds_read_b64_tr_b16 a[120:121], v14 offset:0
    v_mfma_f32_16x16x32_bf16 v[100:103], a[136:139], a[52:55], v[100:103]
    ds_read_b64_tr_b16 a[122:123], v14 offset:2048
    v_mfma_f32_16x16x32_bf16 v[104:107], a[136:139], a[56:59], v[104:107]
    v_mfma_f32_16x16x32_bf16 v[108:111], a[136:139], a[60:63], v[108:111]
    s_waitcnt lgkmcnt(6)
    v_mfma_f32_16x16x32_bf16 v[112:115], a[140:143], a[48:51], v[112:115]
    ds_read_b64_tr_b16 a[124:125], v15 offset:0
    v_mfma_f32_16x16x32_bf16 v[116:119], a[140:143], a[52:55], v[116:119]
    ds_read_b64_tr_b16 a[126:127], v15 offset:2048
    v_mfma_f32_16x16x32_bf16 v[120:123], a[140:143], a[56:59], v[120:123]
    v_mfma_f32_16x16x32_bf16 v[124:127], a[140:143], a[60:63], v[124:127]
    s_waitcnt vmcnt(8) lgkmcnt(6)
    v_mfma_f32_16x16x32_bf16 v[64:67], a[112:115], a[64:67], v[64:67]
    ds_read_b64_tr_b16 a[128:129], v12 offset:4096
    v_mfma_f32_16x16x32_bf16 v[68:71], a[112:115], a[68:71], v[68:71]
    ds_read_b64_tr_b16 a[130:131], v12 offset:6144
    v_mfma_f32_16x16x32_bf16 v[72:75], a[112:115], a[72:75], v[72:75]
    v_mfma_f32_16x16x32_bf16 v[76:79], a[112:115], a[76:79], v[76:79]
    s_waitcnt lgkmcnt(6)
    v_mfma_f32_16x16x32_bf16 v[80:83], a[116:119], a[64:67], v[80:83]
    ds_read_b64_tr_b16 a[132:133], v13 offset:4096
    v_mfma_f32_16x16x32_bf16 v[84:87], a[116:119], a[68:71], v[84:87]
    ds_read_b64_tr_b16 a[134:135], v13 offset:6144
    v_mfma_f32_16x16x32_bf16 v[88:91], a[116:119], a[72:75], v[88:91]
    v_mfma_f32_16x16x32_bf16 v[92:95], a[116:119], a[76:79], v[92:95]
    s_waitcnt lgkmcnt(6)
    v_mfma_f32_16x16x32_bf16 v[96:99], a[120:123], a[64:67], v[96:99]
    ds_read_b64_tr_b16 a[136:137], v14 offset:4096
    v_mfma_f32_16x16x32_bf16 v[100:103], a[120:123], a[68:71], v[100:103]
    ds_read_b64_tr_b16 a[138:139], v14 offset:6144
    v_mfma_f32_16x16x32_bf16 v[104:107], a[120:123], a[72:75], v[104:107]
    v_mfma_f32_16x16x32_bf16 v[108:111], a[120:123], a[76:79], v[108:111]
    s_waitcnt lgkmcnt(6)
    v_mfma_f32_16x16x32_bf16 v[112:115], a[124:127], a[64:67], v[112:115]
    ds_read_b64_tr_b16 a[140:141], v15 offset:4096
    v_mfma_f32_16x16x32_bf16 v[116:119], a[124:127], a[68:71], v[116:119]
    ds_read_b64_tr_b16 a[142:143], v15 offset:6144
    v_mfma_f32_16x16x32_bf16 v[120:123], a[124:127], a[72:75], v[120:123]
    v_mfma_f32_16x16x32_bf16 v[124:127], a[124:127], a[76:79], v[124:127]
    s_waitcnt vmcnt(4) lgkmcnt(6)
    v_mfma_f32_16x16x32_bf16 v[64:67], a[128:131], a[80:83], v[64:67]
    ds_read_b64_tr_b16 a[112:113], v12 offset:32768
    v_mfma_f32_16x16x32_bf16 v[68:71], a[128:131], a[84:87], v[68:71]
    ds_read_b64_tr_b16 a[114:115], v12 offset:34816
    v_mfma_f32_16x16x32_bf16 v[72:75], a[128:131], a[88:91], v[72:75]
    v_add_u32 v4, s53, v2
    v_add_u32 v4, 98304, v4
    v_mfma_f32_16x16x32_bf16 v[76:79], a[128:131], a[92:95], v[76:79]
    s_waitcnt lgkmcnt(6)
    v_mfma_f32_16x16x32_bf16 v[80:83], a[132:135], a[80:83], v[80:83]
    ds_read_b64_tr_b16 a[116:117], v13 offset:32768
    v_mfma_f32_16x16x32_bf16 v[84:87], a[132:135], a[84:87], v[84:87]
    ds_read_b64_tr_b16 a[118:119], v13 offset:34816
    v_mfma_f32_16x16x32_bf16 v[88:91], a[132:135], a[88:91], v[88:91]
    v_mfma_f32_16x16x32_bf16 v[92:95], a[132:135], a[92:95], v[92:95]
    s_waitcnt lgkmcnt(6)
    v_mfma_f32_16x16x32_bf16 v[96:99], a[136:139], a[80:83], v[96:99]
    ds_read_b64_tr_b16 a[120:121], v14 offset:32768
    v_mfma_f32_16x16x32_bf16 v[100:103], a[136:139], a[84:87], v[100:103]
    ds_read_b64_tr_b16 a[122:123], v14 offset:34816
    v_mfma_f32_16x16x32_bf16 v[104:107], a[136:139], a[88:91], v[104:107]
    v_mfma_f32_16x16x32_bf16 v[108:111], a[136:139], a[92:95], v[108:111]
    s_waitcnt lgkmcnt(6)
    v_mfma_f32_16x16x32_bf16 v[112:115], a[140:143], a[80:83], v[112:115]
    ds_read_b64_tr_b16 a[124:125], v15 offset:32768
    v_mfma_f32_16x16x32_bf16 v[116:119], a[140:143], a[84:87], v[116:119]
    ds_read_b64_tr_b16 a[126:127], v15 offset:34816
    v_mfma_f32_16x16x32_bf16 v[120:123], a[140:143], a[88:91], v[120:123]
    v_mfma_f32_16x16x32_bf16 v[124:127], a[140:143], a[92:95], v[124:127]
    s_waitcnt vmcnt(0) lgkmcnt(6)
    v_mfma_f32_16x16x32_bf16 v[64:67], a[112:115], a[96:99], v[64:67]
    v_mfma_f32_16x16x32_bf16 v[68:71], a[112:115], a[100:103], v[68:71]
    v_mfma_f32_16x16x32_bf16 v[72:75], a[112:115], a[104:107], v[72:75]
    v_mfma_f32_16x16x32_bf16 v[76:79], a[112:115], a[108:111], v[76:79]
    s_waitcnt lgkmcnt(4)
    v_mfma_f32_16x16x32_bf16 v[80:83], a[116:119], a[96:99], v[80:83]
    v_mfma_f32_16x16x32_bf16 v[84:87], a[116:119], a[100:103], v[84:87]
    v_mfma_f32_16x16x32_bf16 v[88:91], a[116:119], a[104:107], v[88:91]
    v_mfma_f32_16x16x32_bf16 v[92:95], a[116:119], a[108:111], v[92:95]
    s_waitcnt lgkmcnt(2)
    v_mfma_f32_16x16x32_bf16 v[96:99], a[120:123], a[96:99], v[96:99]
    v_mfma_f32_16x16x32_bf16 v[100:103], a[120:123], a[100:103], v[100:103]
    ds_write_b128 v4, v[68:71] offset:0
    v_mfma_f32_16x16x32_bf16 v[104:107], a[120:123], a[104:107], v[104:107]
    ds_write_b128 v4, v[72:75] offset:4096
    v_mfma_f32_16x16x32_bf16 v[108:111], a[120:123], a[108:111], v[108:111]
    s_waitcnt lgkmcnt(2)
    ds_write_b128 v4, v[76:79] offset:32768
    v_mfma_f32_16x16x32_bf16 v[112:115], a[124:127], a[96:99], v[112:115]
    v_mfma_f32_16x16x32_bf16 v[116:119], a[124:127], a[100:103], v[116:119]
    ds_write_b128 v4, v[84:87] offset:1024
    v_mfma_f32_16x16x32_bf16 v[120:123], a[124:127], a[104:107], v[120:123]
    ds_write_b128 v4, v[88:91] offset:5120
    v_mfma_f32_16x16x32_bf16 v[124:127], a[124:127], a[108:111], v[124:127]
    ds_write_b128 v4, v[92:95] offset:33792
    s_sub_u32 s36, s28, 1
    s_and_b32 s36, s36, 3
    s_lshl_b32 s36, s36, 13
    s_add_u32 s36, s36, 98304
    v_add_u32 v5, s36, v2
    s_sub_u32 s36, s28, 2
    s_and_b32 s36, s36, 3
    s_lshl_b32 s36, s36, 13
    s_add_u32 s36, s36, 98304
    v_add_u32 v6, s36, v2
    s_sub_u32 s36, s28, 3
    s_and_b32 s36, s36, 3
    s_lshl_b32 s36, s36, 13
    s_add_u32 s36, s36, 98304
    v_add_u32 v7, s36, v2
    ds_write_b128 v4, v[100:103] offset:2048
    ds_write_b128 v4, v[104:107] offset:6144
    ds_write_b128 v4, v[108:111] offset:34816
    ds_write_b128 v4, v[116:119] offset:3072
    ds_write_b128 v4, v[120:123] offset:7168
    ds_write_b128 v4, v[124:127] offset:35840
    s_waitcnt lgkmcnt(0)
    s_barrier
    ds_read_b128 v[68:71], v5 offset:0
    ds_read_b128 v[72:75], v6 offset:4096
    ds_read_b128 v[76:79], v7 offset:32768
    ds_read_b128 v[84:87], v5 offset:1024
    ds_read_b128 v[88:91], v6 offset:5120
    ds_read_b128 v[92:95], v7 offset:33792
    ds_read_b128 v[100:103], v5 offset:2048
    ds_read_b128 v[104:107], v6 offset:6144
    ds_read_b128 v[108:111], v7 offset:34816
    ds_read_b128 v[116:119], v5 offset:3072
    ds_read_b128 v[120:123], v6 offset:7168
    ds_read_b128 v[124:127], v7 offset:35840
    v_and_b32 v3, 15, v0
    v_mul_u32_u24 v3, 896, v3
    v_lshl_add_u32 v3, v8, 4, v3
    s_lshl_b32 s36, s33, 2
    s_add_u32 s36, s36, s28
    s_mul_i32 s36, s36, 14336
    s_lshl_b32 s37, s32, 7
    s_add_u32 s36, s36, s37
    s_waitcnt lgkmcnt(11)
    v_pk_add_f32 v[64:65], v[64:65], v[68:69]
    s_waitcnt lgkmcnt(9)
    v_pk_add_f32 v[72:73], v[72:73], v[76:77]
    v_pk_add_f32 v[66:67], v[66:67], v[70:71]
    v_pk_add_f32 v[74:75], v[74:75], v[78:79]
    v_pk_add_f32 v[64:65], v[64:65], v[72:73]
    v_lshlrev_b32 v10, 16, v16
    v_and_b32 v11, 0xffff0000, v16
    v_pk_fma_f32 v[64:65], v[64:65], v[24:25], v[10:11]
    v_pk_add_f32 v[66:67], v[66:67], v[74:75]
    v_lshlrev_b32 v10, 16, v17
    v_and_b32 v11, 0xffff0000, v17
    v_pk_fma_f32 v[66:67], v[66:67], v[26:27], v[10:11]
    v_cvt_pk_bf16_f32 v40, v64, v65
    v_cvt_pk_bf16_f32 v41, v66, v67
    s_waitcnt lgkmcnt(8)
    v_pk_add_f32 v[80:81], v[80:81], v[84:85]
    s_waitcnt lgkmcnt(6)
    v_pk_add_f32 v[88:89], v[88:89], v[92:93]
    v_pk_add_f32 v[82:83], v[82:83], v[86:87]
    v_pk_add_f32 v[90:91], v[90:91], v[94:95]
    v_pk_add_f32 v[80:81], v[80:81], v[88:89]
    v_lshlrev_b32 v10, 16, v18
    v_and_b32 v11, 0xffff0000, v18
    v_pk_fma_f32 v[80:81], v[80:81], v[28:29], v[10:11]
    v_pk_add_f32 v[82:83], v[82:83], v[90:91]
    v_lshlrev_b32 v10, 16, v19
    v_and_b32 v11, 0xffff0000, v19
    v_pk_fma_f32 v[82:83], v[82:83], v[30:31], v[10:11]
    v_cvt_pk_bf16_f32 v42, v80, v81
    v_cvt_pk_bf16_f32 v43, v82, v83
    s_nop 0
    v_permlane32_swap_b32 v40, v42
    v_permlane32_swap_b32 v41, v43
    s_nop 0
    v_permlane16_swap_b32 v40, v42
    v_permlane16_swap_b32 v41, v43
    buffer_store_dwordx4 v[40:43], v3, s[40:43], s36 offen offset:0
    s_waitcnt lgkmcnt(5)
    v_pk_add_f32 v[96:97], v[96:97], v[100:101]
    s_waitcnt lgkmcnt(3)
    v_pk_add_f32 v[104:105], v[104:105], v[108:109]
    v_pk_add_f32 v[98:99], v[98:99], v[102:103]
    v_pk_add_f32 v[106:107], v[106:107], v[110:111]
    v_pk_add_f32 v[96:97], v[96:97], v[104:105]
    v_lshlrev_b32 v10, 16, v20
    v_and_b32 v11, 0xffff0000, v20
    v_pk_fma_f32 v[96:97], v[96:97], v[32:33], v[10:11]
    v_pk_add_f32 v[98:99], v[98:99], v[106:107]
    v_lshlrev_b32 v10, 16, v21
    v_and_b32 v11, 0xffff0000, v21
    v_pk_fma_f32 v[98:99], v[98:99], v[34:35], v[10:11]
    v_cvt_pk_bf16_f32 v44, v96, v97
    v_cvt_pk_bf16_f32 v45, v98, v99
    s_waitcnt lgkmcnt(2)
    v_pk_add_f32 v[112:113], v[112:113], v[116:117]
    s_waitcnt lgkmcnt(0)
    v_pk_add_f32 v[120:121], v[120:121], v[124:125]
    v_pk_add_f32 v[114:115], v[114:115], v[118:119]
    v_pk_add_f32 v[122:123], v[122:123], v[126:127]
    v_pk_add_f32 v[112:113], v[112:113], v[120:121]
    v_lshlrev_b32 v10, 16, v22
    v_and_b32 v11, 0xffff0000, v22
    v_pk_fma_f32 v[112:113], v[112:113], v[36:37], v[10:11]
    v_pk_add_f32 v[114:115], v[114:115], v[122:123]
    v_lshlrev_b32 v10, 16, v23
    v_and_b32 v11, 0xffff0000, v23
    v_pk_fma_f32 v[114:115], v[114:115], v[38:39], v[10:11]
    v_cvt_pk_bf16_f32 v46, v112, v113
    v_cvt_pk_bf16_f32 v47, v114, v115
    s_nop 0
    v_permlane32_swap_b32 v44, v46
    v_permlane32_swap_b32 v45, v47
    s_nop 0
    v_permlane16_swap_b32 v44, v46
    v_permlane16_swap_b32 v45, v47
    buffer_store_dwordx4 v[44:47], v3, s[40:43], s36 offen offset:64
L_endadaLN_cond__gqa_block_cached__mixer_gmlp__prompt_kernel:
    s_endpgm
L_fb1:
    s_nop 15
    v_max3_f32 v54, v96, v97, v98
    v_max3_f32 v54, v54, v99, v104
    v_max3_f32 v54, v54, v105, v106
    v_max_f32 v54, v54, v107
    v_mov_b32 v31, v54
    s_nop 1
    v_permlane32_swap_b32 v54, v31
    v_max_f32 v54, v54, v31
    v_mov_b32 v31, v54
    s_nop 1
    v_permlane16_swap_b32 v54, v31
    v_max_f32 v54, v54, v31
    v_max3_f32 v55, v100, v101, v102
    v_max3_f32 v55, v55, v103, v108
    v_max3_f32 v55, v55, v109, v110
    v_max_f32 v55, v55, v111
    v_mov_b32 v31, v55
    s_nop 1
    v_permlane32_swap_b32 v55, v31
    v_max_f32 v55, v55, v31
    v_mov_b32 v31, v55
    s_nop 1
    v_permlane16_swap_b32 v55, v31
    v_max_f32 v55, v55, v31
    v_max_f32 v54, 0, v54
    v_max_f32 v55, 0, v55
    v_sub_f32 v80, v80, v54
    v_sub_f32 v81, v81, v54
    v_sub_f32 v82, v82, v54
    v_sub_f32 v83, v83, v54
    v_sub_f32 v84, v84, v55
    v_sub_f32 v85, v85, v55
    v_sub_f32 v86, v86, v55
    v_sub_f32 v87, v87, v55
    v_sub_f32 v96, v96, v54
    v_sub_f32 v97, v97, v54
    v_sub_f32 v98, v98, v54
    v_sub_f32 v99, v99, v54
    v_sub_f32 v100, v100, v55
    v_sub_f32 v101, v101, v55
    v_sub_f32 v102, v102, v55
    v_sub_f32 v103, v103, v55
    v_sub_f32 v104, v104, v54
    v_sub_f32 v105, v105, v54
    v_sub_f32 v106, v106, v54
    v_sub_f32 v107, v107, v54
    v_sub_f32 v108, v108, v55
    v_sub_f32 v109, v109, v55
    v_sub_f32 v110, v110, v55
    v_sub_f32 v111, v111, v55
    v_sub_f32 v112, v112, v54
    v_sub_f32 v113, v113, v54
    v_sub_f32 v114, v114, v54
    v_sub_f32 v115, v115, v54
    v_sub_f32 v116, v116, v55
    v_sub_f32 v117, v117, v55
    v_sub_f32 v118, v118, v55
    v_sub_f32 v119, v119, v55
    v_sub_f32 v120, v120, v54
    v_sub_f32 v121, v121, v54
    v_sub_f32 v122, v122, v54
    v_sub_f32 v123, v123, v54
    v_sub_f32 v124, v124, v55
    v_sub_f32 v125, v125, v55
    v_sub_f32 v126, v126, v55
    v_sub_f32 v127, v127, v55
    v_sub_f32 v54, 0, v54
    v_exp_f32 v54, v54
    s_nop 0
    v_mul_f32 v50, v50, v54
    v_sub_f32 v55, 0, v55
    v_exp_f32 v55, v55
    s_nop 0
    v_mul_f32 v51, v51, v55
    v_mul_f32 v128, v128, v54
    v_mul_f32 v129, v129, v54
    v_mul_f32 v130, v130, v54
    v_mul_f32 v131, v131, v54
    v_mul_f32 v132, v132, v55
    v_mul_f32 v133, v133, v55
    v_mul_f32 v134, v134, v55
    v_mul_f32 v135, v135, v55
    v_mul_f32 v136, v136, v54
    v_mul_f32 v137, v137, v54
    v_mul_f32 v138, v138, v54
    v_mul_f32 v139, v139, v54
    v_mul_f32 v140, v140, v55
    v_mul_f32 v141, v141, v55
    v_mul_f32 v142, v142, v55
    v_mul_f32 v143, v143, v55
    v_mul_f32 v144, v144, v54
    v_mul_f32 v145, v145, v54
    v_mul_f32 v146, v146, v54
    v_mul_f32 v147, v147, v54
    v_mul_f32 v148, v148, v55
    v_mul_f32 v149, v149, v55
    v_mul_f32 v150, v150, v55
    v_mul_f32 v151, v151, v55
    v_mul_f32 v152, v152, v54
    v_mul_f32 v153, v153, v54
    v_mul_f32 v154, v154, v54
    v_mul_f32 v155, v155, v54
    v_mul_f32 v156, v156, v55
    v_mul_f32 v157, v157, v55
    v_mul_f32 v158, v158, v55
    v_mul_f32 v159, v159, v55
    v_mul_f32 v160, v160, v54
    v_mul_f32 v161, v161, v54
    v_mul_f32 v162, v162, v54
    v_mul_f32 v163, v163, v54
    v_mul_f32 v164, v164, v55
    v_mul_f32 v165, v165, v55
    v_mul_f32 v166, v166, v55
    v_mul_f32 v167, v167, v55
    v_mul_f32 v168, v168, v54
    v_mul_f32 v169, v169, v54
    v_mul_f32 v170, v170, v54
    v_mul_f32 v171, v171, v54
    v_mul_f32 v172, v172, v55
    v_mul_f32 v173, v173, v55
    v_mul_f32 v174, v174, v55
    v_mul_f32 v175, v175, v55
    v_mul_f32 v176, v176, v54
    v_mul_f32 v177, v177, v54
    v_mul_f32 v178, v178, v54
    v_mul_f32 v179, v179, v54
    v_mul_f32 v180, v180, v55
    v_mul_f32 v181, v181, v55
    v_mul_f32 v182, v182, v55
    v_mul_f32 v183, v183, v55
    v_mul_f32 v184, v184, v54
    v_mul_f32 v185, v185, v54
    v_mul_f32 v186, v186, v54
    v_mul_f32 v187, v187, v54
    v_mul_f32 v188, v188, v55
    v_mul_f32 v189, v189, v55
    v_mul_f32 v190, v190, v55
    v_mul_f32 v191, v191, v55
    v_mul_f32 v192, v192, v54
    v_mul_f32 v193, v193, v54
    v_mul_f32 v194, v194, v54
    v_mul_f32 v195, v195, v54
    v_mul_f32 v196, v196, v55
    v_mul_f32 v197, v197, v55
    v_mul_f32 v198, v198, v55
    v_mul_f32 v199, v199, v55
    v_mul_f32 v200, v200, v54
    v_mul_f32 v201, v201, v54
    v_mul_f32 v202, v202, v54
    v_mul_f32 v203, v203, v54
    v_mul_f32 v204, v204, v55
    v_mul_f32 v205, v205, v55
    v_mul_f32 v206, v206, v55
    v_mul_f32 v207, v207, v55
    v_mul_f32 v208, v208, v54
    v_mul_f32 v209, v209, v54
    v_mul_f32 v210, v210, v54
    v_mul_f32 v211, v211, v54
    v_mul_f32 v212, v212, v55
    v_mul_f32 v213, v213, v55
    v_mul_f32 v214, v214, v55
    v_mul_f32 v215, v215, v55
    v_mul_f32 v216, v216, v54
    v_mul_f32 v217, v217, v54
    v_mul_f32 v218, v218, v54
    v_mul_f32 v219, v219, v54
    v_mul_f32 v220, v220, v55
    v_mul_f32 v221, v221, v55
    v_mul_f32 v222, v222, v55
    v_mul_f32 v223, v223, v55
    v_mul_f32 v224, v224, v54
    v_mul_f32 v225, v225, v54
    v_mul_f32 v226, v226, v54
    v_mul_f32 v227, v227, v54
    v_mul_f32 v228, v228, v55
    v_mul_f32 v229, v229, v55
    v_mul_f32 v230, v230, v55
    v_mul_f32 v231, v231, v55
    v_mul_f32 v232, v232, v54
    v_mul_f32 v233, v233, v54
    v_mul_f32 v234, v234, v54
    v_mul_f32 v235, v235, v54
    v_mul_f32 v236, v236, v55
    v_mul_f32 v237, v237, v55
    v_mul_f32 v238, v238, v55
    v_mul_f32 v239, v239, v55
    v_mul_f32 v240, v240, v54
    v_mul_f32 v241, v241, v54
    v_mul_f32 v242, v242, v54
    v_mul_f32 v243, v243, v54
    v_mul_f32 v244, v244, v55
    v_mul_f32 v245, v245, v55
    v_mul_f32 v246, v246, v55
    v_mul_f32 v247, v247, v55
    v_mul_f32 v248, v248, v54
    v_mul_f32 v249, v249, v54
    v_mul_f32 v250, v250, v54
    v_mul_f32 v251, v251, v54
    v_mul_f32 v252, v252, v55
    v_mul_f32 v253, v253, v55
    v_mul_f32 v254, v254, v55
    v_mul_f32 v255, v255, v55
    v_exp_f32 v56, v96
    v_exp_f32 v57, v97
    v_exp_f32 v58, v98
    v_add_f32 v52, v56, v57
    v_cvt_pk_bf16_f32 v64, v56, v57
    v_exp_f32 v59, v99
    v_add_f32 v52, v52, v58
    v_exp_f32 v60, v100
    v_add_f32 v52, v52, v59
    v_cvt_pk_bf16_f32 v65, v58, v59
    v_exp_f32 v61, v101
    v_exp_f32 v62, v102
    v_add_f32 v53, v60, v61
    v_cvt_pk_bf16_f32 v68, v60, v61
    v_exp_f32 v63, v103
    v_add_f32 v53, v53, v62
    v_exp_f32 v56, v104
    v_add_f32 v53, v53, v63
    v_cvt_pk_bf16_f32 v69, v62, v63
    v_exp_f32 v57, v105
    v_add_f32 v52, v52, v56
    v_exp_f32 v58, v106
    v_add_f32 v52, v52, v57
    v_cvt_pk_bf16_f32 v66, v56, v57
    v_exp_f32 v59, v107
    v_add_f32 v52, v52, v58
    v_exp_f32 v60, v108
    v_add_f32 v52, v52, v59
    v_cvt_pk_bf16_f32 v67, v58, v59
    v_exp_f32 v61, v109
    v_add_f32 v53, v53, v60
    v_exp_f32 v62, v110
    v_add_f32 v53, v53, v61
    v_cvt_pk_bf16_f32 v70, v60, v61
    v_exp_f32 v63, v111
    v_add_f32 v53, v53, v62
    v_add_f32 v53, v53, v63
    v_add_f32 v30, v52, v53
    v_cmp_lt_f32 vcc, s37, v30
    v_cvt_pk_bf16_f32 v71, v62, v63
    s_nop 1
    s_branch L_ret1
L_fb2:
    s_nop 15
    v_max3_f32 v54, v112, v113, v114
    v_max3_f32 v54, v54, v115, v120
    v_max3_f32 v54, v54, v121, v122
    v_max_f32 v54, v54, v123
    v_mov_b32 v31, v54
    s_nop 1
    v_permlane32_swap_b32 v54, v31
    v_max_f32 v54, v54, v31
    v_mov_b32 v31, v54
    s_nop 1
    v_permlane16_swap_b32 v54, v31
    v_max_f32 v54, v54, v31
    v_max3_f32 v55, v116, v117, v118
    v_max3_f32 v55, v55, v119, v124
    v_max3_f32 v55, v55, v125, v126
    v_max_f32 v55, v55, v127
    v_mov_b32 v31, v55
    s_nop 1
    v_permlane32_swap_b32 v55, v31
    v_max_f32 v55, v55, v31
    v_mov_b32 v31, v55
    s_nop 1
    v_permlane16_swap_b32 v55, v31
    v_max_f32 v55, v55, v31
    v_max_f32 v54, 0, v54
    v_max_f32 v55, 0, v55
    v_sub_f32 v80, v80, v54
    v_sub_f32 v81, v81, v54
    v_sub_f32 v82, v82, v54
    v_sub_f32 v83, v83, v54
    v_sub_f32 v84, v84, v55
    v_sub_f32 v85, v85, v55
    v_sub_f32 v86, v86, v55
    v_sub_f32 v87, v87, v55
    v_sub_f32 v112, v112, v54
    v_sub_f32 v113, v113, v54
    v_sub_f32 v114, v114, v54
    v_sub_f32 v115, v115, v54
    v_sub_f32 v116, v116, v55
    v_sub_f32 v117, v117, v55
    v_sub_f32 v118, v118, v55
    v_sub_f32 v119, v119, v55
    v_sub_f32 v120, v120, v54
    v_sub_f32 v121, v121, v54
    v_sub_f32 v122, v122, v54
    v_sub_f32 v123, v123, v54
    v_sub_f32 v124, v124, v55
    v_sub_f32 v125, v125, v55
    v_sub_f32 v126, v126, v55
    v_sub_f32 v127, v127, v55
    v_sub_f32 v96, v96, v54
    v_sub_f32 v97, v97, v54
    v_sub_f32 v98, v98, v54
    v_sub_f32 v99, v99, v54
    v_sub_f32 v100, v100, v55
    v_sub_f32 v101, v101, v55
    v_sub_f32 v102, v102, v55
    v_sub_f32 v103, v103, v55
    v_sub_f32 v104, v104, v54
    v_sub_f32 v105, v105, v54
    v_sub_f32 v106, v106, v54
    v_sub_f32 v107, v107, v54
    v_sub_f32 v108, v108, v55
    v_sub_f32 v109, v109, v55
    v_sub_f32 v110, v110, v55
    v_sub_f32 v111, v111, v55
    v_sub_f32 v54, 0, v54
    v_exp_f32 v54, v54
    s_nop 0
    v_mul_f32 v50, v50, v54
    v_sub_f32 v55, 0, v55
    v_exp_f32 v55, v55
    s_nop 0
    v_mul_f32 v51, v51, v55
    v_mul_f32 v128, v128, v54
    v_mul_f32 v129, v129, v54
    v_mul_f32 v130, v130, v54
    v_mul_f32 v131, v131, v54
    v_mul_f32 v132, v132, v55
    v_mul_f32 v133, v133, v55
    v_mul_f32 v134, v134, v55
    v_mul_f32 v135, v135, v55
    v_mul_f32 v136, v136, v54
    v_mul_f32 v137, v137, v54
    v_mul_f32 v138, v138, v54
    v_mul_f32 v139, v139, v54
    v_mul_f32 v140, v140, v55
    v_mul_f32 v141, v141, v55
    v_mul_f32 v142, v142, v55
    v_mul_f32 v143, v143, v55
    v_mul_f32 v144, v144, v54
    v_mul_f32 v145, v145, v54
    v_mul_f32 v146, v146, v54
    v_mul_f32 v147, v147, v54
    v_mul_f32 v148, v148, v55
    v_mul_f32 v149, v149, v55
    v_mul_f32 v150, v150, v55
    v_mul_f32 v151, v151, v55
    v_mul_f32 v152, v152, v54
    v_mul_f32 v153, v153, v54
    v_mul_f32 v154, v154, v54
    v_mul_f32 v155, v155, v54
    v_mul_f32 v156, v156, v55
    v_mul_f32 v157, v157, v55
    v_mul_f32 v158, v158, v55
    v_mul_f32 v159, v159, v55
    v_mul_f32 v160, v160, v54
    v_mul_f32 v161, v161, v54
    v_mul_f32 v162, v162, v54
    v_mul_f32 v163, v163, v54
    v_mul_f32 v164, v164, v55
    v_mul_f32 v165, v165, v55
    v_mul_f32 v166, v166, v55
    v_mul_f32 v167, v167, v55
    v_mul_f32 v168, v168, v54
    v_mul_f32 v169, v169, v54
    v_mul_f32 v170, v170, v54
    v_mul_f32 v171, v171, v54
    v_mul_f32 v172, v172, v55
    v_mul_f32 v173, v173, v55
    v_mul_f32 v174, v174, v55
    v_mul_f32 v175, v175, v55
    v_mul_f32 v176, v176, v54
    v_mul_f32 v177, v177, v54
    v_mul_f32 v178, v178, v54
    v_mul_f32 v179, v179, v54
    v_mul_f32 v180, v180, v55
    v_mul_f32 v181, v181, v55
    v_mul_f32 v182, v182, v55
    v_mul_f32 v183, v183, v55
    v_mul_f32 v184, v184, v54
    v_mul_f32 v185, v185, v54
    v_mul_f32 v186, v186, v54
    v_mul_f32 v187, v187, v54
    v_mul_f32 v188, v188, v55
    v_mul_f32 v189, v189, v55
    v_mul_f32 v190, v190, v55
    v_mul_f32 v191, v191, v55
    v_mul_f32 v192, v192, v54
    v_mul_f32 v193, v193, v54
    v_mul_f32 v194, v194, v54
    v_mul_f32 v195, v195, v54
    v_mul_f32 v196, v196, v55
    v_mul_f32 v197, v197, v55
    v_mul_f32 v198, v198, v55
    v_mul_f32 v199, v199, v55
    v_mul_f32 v200, v200, v54
    v_mul_f32 v201, v201, v54
    v_mul_f32 v202, v202, v54
    v_mul_f32 v203, v203, v54
    v_mul_f32 v204, v204, v55
    v_mul_f32 v205, v205, v55
    v_mul_f32 v206, v206, v55
    v_mul_f32 v207, v207, v55
    v_mul_f32 v208, v208, v54
    v_mul_f32 v209, v209, v54
    v_mul_f32 v210, v210, v54
    v_mul_f32 v211, v211, v54
    v_mul_f32 v212, v212, v55
    v_mul_f32 v213, v213, v55
    v_mul_f32 v214, v214, v55
    v_mul_f32 v215, v215, v55
    v_mul_f32 v216, v216, v54
    v_mul_f32 v217, v217, v54
    v_mul_f32 v218, v218, v54
    v_mul_f32 v219, v219, v54
    v_mul_f32 v220, v220, v55
    v_mul_f32 v221, v221, v55
    v_mul_f32 v222, v222, v55
    v_mul_f32 v223, v223, v55
    v_mul_f32 v224, v224, v54
    v_mul_f32 v225, v225, v54
    v_mul_f32 v226, v226, v54
    v_mul_f32 v227, v227, v54
    v_mul_f32 v228, v228, v55
    v_mul_f32 v229, v229, v55
    v_mul_f32 v230, v230, v55
    v_mul_f32 v231, v231, v55
    v_mul_f32 v232, v232, v54
    v_mul_f32 v233, v233, v54
    v_mul_f32 v234, v234, v54
    v_mul_f32 v235, v235, v54
    v_mul_f32 v236, v236, v55
    v_mul_f32 v237, v237, v55
    v_mul_f32 v238, v238, v55
    v_mul_f32 v239, v239, v55
    v_mul_f32 v240, v240, v54
    v_mul_f32 v241, v241, v54
    v_mul_f32 v242, v242, v54
    v_mul_f32 v243, v243, v54
    v_mul_f32 v244, v244, v55
    v_mul_f32 v245, v245, v55
    v_mul_f32 v246, v246, v55
    v_mul_f32 v247, v247, v55
    v_mul_f32 v248, v248, v54
    v_mul_f32 v249, v249, v54
    v_mul_f32 v250, v250, v54
    v_mul_f32 v251, v251, v54
    v_mul_f32 v252, v252, v55
    v_mul_f32 v253, v253, v55
    v_mul_f32 v254, v254, v55
    v_mul_f32 v255, v255, v55
    v_exp_f32 v56, v112
    v_exp_f32 v57, v113
    v_exp_f32 v58, v114
    v_add_f32 v52, v56, v57
    v_cvt_pk_bf16_f32 v72, v56, v57
    v_exp_f32 v59, v115
    v_add_f32 v52, v52, v58
    v_exp_f32 v60, v116
    v_add_f32 v52, v52, v59
    v_cvt_pk_bf16_f32 v73, v58, v59
    v_exp_f32 v61, v117
    v_exp_f32 v62, v118
    v_add_f32 v53, v60, v61
    v_cvt_pk_bf16_f32 v76, v60, v61
    v_exp_f32 v63, v119
    v_add_f32 v53, v53, v62
    v_exp_f32 v56, v120
    v_add_f32 v53, v53, v63
    v_cvt_pk_bf16_f32 v77, v62, v63
    v_exp_f32 v57, v121
    v_add_f32 v52, v52, v56
    v_exp_f32 v58, v122
    v_add_f32 v52, v52, v57
    v_cvt_pk_bf16_f32 v74, v56, v57
    v_exp_f32 v59, v123
    v_add_f32 v52, v52, v58
    v_exp_f32 v60, v124
    v_add_f32 v52, v52, v59
    v_cvt_pk_bf16_f32 v75, v58, v59
    v_exp_f32 v61, v125
    v_add_f32 v53, v53, v60
    v_exp_f32 v62, v126
    v_add_f32 v53, v53, v61
    v_cvt_pk_bf16_f32 v78, v60, v61
    v_exp_f32 v63, v127
    v_add_f32 v53, v53, v62
    v_add_f32 v53, v53, v63
    v_add_f32 v30, v52, v53
    v_cmp_lt_f32 vcc, s37, v30
    v_cvt_pk_bf16_f32 v79, v62, v63
    s_nop 1
    s_branch L_ret2
L_fb3:
    s_nop 15
    v_max3_f32 v54, v96, v97, v98
    v_max3_f32 v54, v54, v99, v104
    v_max3_f32 v54, v54, v105, v106
    v_max_f32 v54, v54, v107
    v_mov_b32 v31, v54
    s_nop 1
    v_permlane32_swap_b32 v54, v31
    v_max_f32 v54, v54, v31
    v_mov_b32 v31, v54
    s_nop 1
    v_permlane16_swap_b32 v54, v31
    v_max_f32 v54, v54, v31
    v_max3_f32 v55, v100, v101, v102
    v_max3_f32 v55, v55, v103, v108
    v_max3_f32 v55, v55, v109, v110
    v_max_f32 v55, v55, v111
    v_mov_b32 v31, v55
    s_nop 1
    v_permlane32_swap_b32 v55, v31
    v_max_f32 v55, v55, v31
    v_mov_b32 v31, v55
    s_nop 1
    v_permlane16_swap_b32 v55, v31
    v_max_f32 v55, v55, v31
    v_max_f32 v54, 0, v54
    v_max_f32 v55, 0, v55
    v_sub_f32 v80, v80, v54
    v_sub_f32 v81, v81, v54
    v_sub_f32 v82, v82, v54
    v_sub_f32 v83, v83, v54
    v_sub_f32 v84, v84, v55
    v_sub_f32 v85, v85, v55
    v_sub_f32 v86, v86, v55
    v_sub_f32 v87, v87, v55
    v_sub_f32 v96, v96, v54
    v_sub_f32 v97, v97, v54
    v_sub_f32 v98, v98, v54
    v_sub_f32 v99, v99, v54
    v_sub_f32 v100, v100, v55
    v_sub_f32 v101, v101, v55
    v_sub_f32 v102, v102, v55
    v_sub_f32 v103, v103, v55
    v_sub_f32 v104, v104, v54
    v_sub_f32 v105, v105, v54
    v_sub_f32 v106, v106, v54
    v_sub_f32 v107, v107, v54
    v_sub_f32 v108, v108, v55
    v_sub_f32 v109, v109, v55
    v_sub_f32 v110, v110, v55
    v_sub_f32 v111, v111, v55
    v_sub_f32 v112, v112, v54
    v_sub_f32 v113, v113, v54
    v_sub_f32 v114, v114, v54
    v_sub_f32 v115, v115, v54
    v_sub_f32 v116, v116, v55
    v_sub_f32 v117, v117, v55
    v_sub_f32 v118, v118, v55
    v_sub_f32 v119, v119, v55
    v_sub_f32 v120, v120, v54
    v_sub_f32 v121, v121, v54
    v_sub_f32 v122, v122, v54
    v_sub_f32 v123, v123, v54
    v_sub_f32 v124, v124, v55
    v_sub_f32 v125, v125, v55
    v_sub_f32 v126, v126, v55
    v_sub_f32 v127, v127, v55
    v_sub_f32 v54, 0, v54
    v_exp_f32 v54, v54
    s_nop 0
    v_mul_f32 v50, v50, v54
    v_sub_f32 v55, 0, v55
    v_exp_f32 v55, v55
    s_nop 0
    v_mul_f32 v51, v51, v55
    v_mul_f32 v128, v128, v54
    v_mul_f32 v129, v129, v54
    v_mul_f32 v130, v130, v54
    v_mul_f32 v131, v131, v54
    v_mul_f32 v132, v132, v55
    v_mul_f32 v133, v133, v55
    v_mul_f32 v134, v134, v55
    v_mul_f32 v135, v135, v55
    v_mul_f32 v136, v136, v54
    v_mul_f32 v137, v137, v54
    v_mul_f32 v138, v138, v54
    v_mul_f32 v139, v139, v54
    v_mul_f32 v140, v140, v55
    v_mul_f32 v141, v141, v55
    v_mul_f32 v142, v142, v55
    v_mul_f32 v143, v143, v55
    v_mul_f32 v144, v144, v54
    v_mul_f32 v145, v145, v54
    v_mul_f32 v146, v146, v54
    v_mul_f32 v147, v147, v54
    v_mul_f32 v148, v148, v55
    v_mul_f32 v149, v149, v55
    v_mul_f32 v150, v150, v55
    v_mul_f32 v151, v151, v55
    v_mul_f32 v152, v152, v54
    v_mul_f32 v153, v153, v54
    v_mul_f32 v154, v154, v54
    v_mul_f32 v155, v155, v54
    v_mul_f32 v156, v156, v55
    v_mul_f32 v157, v157, v55
    v_mul_f32 v158, v158, v55
    v_mul_f32 v159, v159, v55
    v_mul_f32 v160, v160, v54
    v_mul_f32 v161, v161, v54
    v_mul_f32 v162, v162, v54
    v_mul_f32 v163, v163, v54
    v_mul_f32 v164, v164, v55
    v_mul_f32 v165, v165, v55
    v_mul_f32 v166, v166, v55
    v_mul_f32 v167, v167, v55
    v_mul_f32 v168, v168, v54
    v_mul_f32 v169, v169, v54
    v_mul_f32 v170, v170, v54
    v_mul_f32 v171, v171, v54
    v_mul_f32 v172, v172, v55
    v_mul_f32 v173, v173, v55
    v_mul_f32 v174, v174, v55
    v_mul_f32 v175, v175, v55
    v_mul_f32 v176, v176, v54
    v_mul_f32 v177, v177, v54
    v_mul_f32 v178, v178, v54
    v_mul_f32 v179, v179, v54
    v_mul_f32 v180, v180, v55
    v_mul_f32 v181, v181, v55
    v_mul_f32 v182, v182, v55
    v_mul_f32 v183, v183, v55
    v_mul_f32 v184, v184, v54
    v_mul_f32 v185, v185, v54
    v_mul_f32 v186, v186, v54
    v_mul_f32 v187, v187, v54
    v_mul_f32 v188, v188, v55
    v_mul_f32 v189, v189, v55
    v_mul_f32 v190, v190, v55
    v_mul_f32 v191, v191, v55
    v_mul_f32 v192, v192, v54
    v_mul_f32 v193, v193, v54
    v_mul_f32 v194, v194, v54
    v_mul_f32 v195, v195, v54
    v_mul_f32 v196, v196, v55
    v_mul_f32 v197, v197, v55
    v_mul_f32 v198, v198, v55
    v_mul_f32 v199, v199, v55
    v_mul_f32 v200, v200, v54
    v_mul_f32 v201, v201, v54
    v_mul_f32 v202, v202, v54
    v_mul_f32 v203, v203, v54
    v_mul_f32 v204, v204, v55
    v_mul_f32 v205, v205, v55
    v_mul_f32 v206, v206, v55
    v_mul_f32 v207, v207, v55
    v_mul_f32 v208, v208, v54
    v_mul_f32 v209, v209, v54
    v_mul_f32 v210, v210, v54
    v_mul_f32 v211, v211, v54
    v_mul_f32 v212, v212, v55
    v_mul_f32 v213, v213, v55
    v_mul_f32 v214, v214, v55
    v_mul_f32 v215, v215, v55
    v_mul_f32 v216, v216, v54
    v_mul_f32 v217, v217, v54
    v_mul_f32 v218, v218, v54
    v_mul_f32 v219, v219, v54
    v_mul_f32 v220, v220, v55
    v_mul_f32 v221, v221, v55
    v_mul_f32 v222, v222, v55
    v_mul_f32 v223, v223, v55
    v_mul_f32 v224, v224, v54
    v_mul_f32 v225, v225, v54
    v_mul_f32 v226, v226, v54
    v_mul_f32 v227, v227, v54
    v_mul_f32 v228, v228, v55
    v_mul_f32 v229, v229, v55
    v_mul_f32 v230, v230, v55
    v_mul_f32 v231, v231, v55
    v_mul_f32 v232, v232, v54
    v_mul_f32 v233, v233, v54
    v_mul_f32 v234, v234, v54
    v_mul_f32 v235, v235, v54
    v_mul_f32 v236, v236, v55
    v_mul_f32 v237, v237, v55
    v_mul_f32 v238, v238, v55
    v_mul_f32 v239, v239, v55
    v_mul_f32 v240, v240, v54
    v_mul_f32 v241, v241, v54
    v_mul_f32 v242, v242, v54
    v_mul_f32 v243, v243, v54
    v_mul_f32 v244, v244, v55
    v_mul_f32 v245, v245, v55
    v_mul_f32 v246, v246, v55
    v_mul_f32 v247, v247, v55
    v_mul_f32 v248, v248, v54
    v_mul_f32 v249, v249, v54
    v_mul_f32 v250, v250, v54
    v_mul_f32 v251, v251, v54
    v_mul_f32 v252, v252, v55
    v_mul_f32 v253, v253, v55
    v_mul_f32 v254, v254, v55
    v_mul_f32 v255, v255, v55
    v_exp_f32 v56, v96
    v_exp_f32 v57, v97
    v_exp_f32 v58, v98
    v_add_f32 v52, v56, v57
    v_cvt_pk_bf16_f32 v64, v56, v57
    v_exp_f32 v59, v99
    v_add_f32 v52, v52, v58
    v_exp_f32 v60, v100
    v_add_f32 v52, v52, v59
    v_cvt_pk_bf16_f32 v65, v58, v59
    v_exp_f32 v61, v101
    v_exp_f32 v62, v102
    v_add_f32 v53, v60, v61
    v_cvt_pk_bf16_f32 v68, v60, v61
    v_exp_f32 v63, v103
    v_add_f32 v53, v53, v62
    v_exp_f32 v56, v104
    v_add_f32 v53, v53, v63
    v_cvt_pk_bf16_f32 v69, v62, v63
    v_exp_f32 v57, v105
    v_add_f32 v52, v52, v56
    v_exp_f32 v58, v106
    v_add_f32 v52, v52, v57
    v_cvt_pk_bf16_f32 v66, v56, v57
    v_exp_f32 v59, v107
    v_add_f32 v52, v52, v58
    v_exp_f32 v60, v108
    v_add_f32 v52, v52, v59
    v_cvt_pk_bf16_f32 v67, v58, v59
    v_exp_f32 v61, v109
    v_add_f32 v53, v53, v60
    v_exp_f32 v62, v110
    v_add_f32 v53, v53, v61
    v_cvt_pk_bf16_f32 v70, v60, v61
    v_exp_f32 v63, v111
    v_add_f32 v53, v53, v62
    v_add_f32 v53, v53, v63
    v_add_f32 v30, v52, v53
    v_cmp_lt_f32 vcc, s37, v30
    v_cvt_pk_bf16_f32 v71, v62, v63
    s_nop 1
    s_branch L_ret3
L_fb4:
    s_nop 15
    v_max3_f32 v54, v112, v113, v114
    v_max3_f32 v54, v54, v115, v120
    v_max3_f32 v54, v54, v121, v122
    v_max_f32 v54, v54, v123
    v_mov_b32 v31, v54
    s_nop 1
    v_permlane32_swap_b32 v54, v31
    v_max_f32 v54, v54, v31
    v_mov_b32 v31, v54
    s_nop 1
    v_permlane16_swap_b32 v54, v31
    v_max_f32 v54, v54, v31
    v_max3_f32 v55, v116, v117, v118
    v_max3_f32 v55, v55, v119, v124
    v_max3_f32 v55, v55, v125, v126
    v_max_f32 v55, v55, v127
    v_mov_b32 v31, v55
    s_nop 1
    v_permlane32_swap_b32 v55, v31
    v_max_f32 v55, v55, v31
    v_mov_b32 v31, v55
    s_nop 1
    v_permlane16_swap_b32 v55, v31
    v_max_f32 v55, v55, v31
    v_max_f32 v54, 0, v54
    v_max_f32 v55, 0, v55
    v_sub_f32 v80, v80, v54
    v_sub_f32 v81, v81, v54
    v_sub_f32 v82, v82, v54
    v_sub_f32 v83, v83, v54
    v_sub_f32 v84, v84, v55
    v_sub_f32 v85, v85, v55
    v_sub_f32 v86, v86, v55
    v_sub_f32 v87, v87, v55
    v_sub_f32 v112, v112, v54
    v_sub_f32 v113, v113, v54
    v_sub_f32 v114, v114, v54
    v_sub_f32 v115, v115, v54
    v_sub_f32 v116, v116, v55
    v_sub_f32 v117, v117, v55
    v_sub_f32 v118, v118, v55
    v_sub_f32 v119, v119, v55
    v_sub_f32 v120, v120, v54
    v_sub_f32 v121, v121, v54
    v_sub_f32 v122, v122, v54
    v_sub_f32 v123, v123, v54
    v_sub_f32 v124, v124, v55
    v_sub_f32 v125, v125, v55
    v_sub_f32 v126, v126, v55
    v_sub_f32 v127, v127, v55
    v_sub_f32 v96, v96, v54
    v_sub_f32 v97, v97, v54
    v_sub_f32 v98, v98, v54
    v_sub_f32 v99, v99, v54
    v_sub_f32 v100, v100, v55
    v_sub_f32 v101, v101, v55
    v_sub_f32 v102, v102, v55
    v_sub_f32 v103, v103, v55
    v_sub_f32 v104, v104, v54
    v_sub_f32 v105, v105, v54
    v_sub_f32 v106, v106, v54
    v_sub_f32 v107, v107, v54
    v_sub_f32 v108, v108, v55
    v_sub_f32 v109, v109, v55
    v_sub_f32 v110, v110, v55
    v_sub_f32 v111, v111, v55
    v_sub_f32 v54, 0, v54
    v_exp_f32 v54, v54
    s_nop 0
    v_mul_f32 v50, v50, v54
    v_sub_f32 v55, 0, v55
    v_exp_f32 v55, v55
    s_nop 0
    v_mul_f32 v51, v51, v55
    v_mul_f32 v128, v128, v54
    v_mul_f32 v129, v129, v54
    v_mul_f32 v130, v130, v54
    v_mul_f32 v131, v131, v54
    v_mul_f32 v132, v132, v55
    v_mul_f32 v133, v133, v55
    v_mul_f32 v134, v134, v55
    v_mul_f32 v135, v135, v55
    v_mul_f32 v136, v136, v54
    v_mul_f32 v137, v137, v54
    v_mul_f32 v138, v138, v54
    v_mul_f32 v139, v139, v54
    v_mul_f32 v140, v140, v55
    v_mul_f32 v141, v141, v55
    v_mul_f32 v142, v142, v55
    v_mul_f32 v143, v143, v55
    v_mul_f32 v144, v144, v54
    v_mul_f32 v145, v145, v54
    v_mul_f32 v146, v146, v54
    v_mul_f32 v147, v147, v54
    v_mul_f32 v148, v148, v55
    v_mul_f32 v149, v149, v55
    v_mul_f32 v150, v150, v55
    v_mul_f32 v151, v151, v55
    v_mul_f32 v152, v152, v54
    v_mul_f32 v153, v153, v54
    v_mul_f32 v154, v154, v54
    v_mul_f32 v155, v155, v54
    v_mul_f32 v156, v156, v55
    v_mul_f32 v157, v157, v55
    v_mul_f32 v158, v158, v55
    v_mul_f32 v159, v159, v55
    v_mul_f32 v160, v160, v54
    v_mul_f32 v161, v161, v54
    v_mul_f32 v162, v162, v54
    v_mul_f32 v163, v163, v54
    v_mul_f32 v164, v164, v55
    v_mul_f32 v165, v165, v55
    v_mul_f32 v166, v166, v55
    v_mul_f32 v167, v167, v55
    v_mul_f32 v168, v168, v54
    v_mul_f32 v169, v169, v54
    v_mul_f32 v170, v170, v54
    v_mul_f32 v171, v171, v54
    v_mul_f32 v172, v172, v55
    v_mul_f32 v173, v173, v55
    v_mul_f32 v174, v174, v55
    v_mul_f32 v175, v175, v55
    v_mul_f32 v176, v176, v54
    v_mul_f32 v177, v177, v54
    v_mul_f32 v178, v178, v54
    v_mul_f32 v179, v179, v54
    v_mul_f32 v180, v180, v55
    v_mul_f32 v181, v181, v55
    v_mul_f32 v182, v182, v55
    v_mul_f32 v183, v183, v55
    v_mul_f32 v184, v184, v54
    v_mul_f32 v185, v185, v54
    v_mul_f32 v186, v186, v54
    v_mul_f32 v187, v187, v54
    v_mul_f32 v188, v188, v55
    v_mul_f32 v189, v189, v55
    v_mul_f32 v190, v190, v55
    v_mul_f32 v191, v191, v55
    v_mul_f32 v192, v192, v54
    v_mul_f32 v193, v193, v54
    v_mul_f32 v194, v194, v54
    v_mul_f32 v195, v195, v54
    v_mul_f32 v196, v196, v55
    v_mul_f32 v197, v197, v55
    v_mul_f32 v198, v198, v55
    v_mul_f32 v199, v199, v55
    v_mul_f32 v200, v200, v54
    v_mul_f32 v201, v201, v54
    v_mul_f32 v202, v202, v54
    v_mul_f32 v203, v203, v54
    v_mul_f32 v204, v204, v55
    v_mul_f32 v205, v205, v55
    v_mul_f32 v206, v206, v55
    v_mul_f32 v207, v207, v55
    v_mul_f32 v208, v208, v54
    v_mul_f32 v209, v209, v54
    v_mul_f32 v210, v210, v54
    v_mul_f32 v211, v211, v54
    v_mul_f32 v212, v212, v55
    v_mul_f32 v213, v213, v55
    v_mul_f32 v214, v214, v55
    v_mul_f32 v215, v215, v55
    v_mul_f32 v216, v216, v54
    v_mul_f32 v217, v217, v54
    v_mul_f32 v218, v218, v54
    v_mul_f32 v219, v219, v54
    v_mul_f32 v220, v220, v55
    v_mul_f32 v221, v221, v55
    v_mul_f32 v222, v222, v55
    v_mul_f32 v223, v223, v55
    v_mul_f32 v224, v224, v54
    v_mul_f32 v225, v225, v54
    v_mul_f32 v226, v226, v54
    v_mul_f32 v227, v227, v54
    v_mul_f32 v228, v228, v55
    v_mul_f32 v229, v229, v55
    v_mul_f32 v230, v230, v55
    v_mul_f32 v231, v231, v55
    v_mul_f32 v232, v232, v54
    v_mul_f32 v233, v233, v54
    v_mul_f32 v234, v234, v54
    v_mul_f32 v235, v235, v54
    v_mul_f32 v236, v236, v55
    v_mul_f32 v237, v237, v55
    v_mul_f32 v238, v238, v55
    v_mul_f32 v239, v239, v55
    v_mul_f32 v240, v240, v54
    v_mul_f32 v241, v241, v54
    v_mul_f32 v242, v242, v54
    v_mul_f32 v243, v243, v54
    v_mul_f32 v244, v244, v55
    v_mul_f32 v245, v245, v55
    v_mul_f32 v246, v246, v55
    v_mul_f32 v247, v247, v55
    v_mul_f32 v248, v248, v54
    v_mul_f32 v249, v249, v54
    v_mul_f32 v250, v250, v54
    v_mul_f32 v251, v251, v54
    v_mul_f32 v252, v252, v55
    v_mul_f32 v253, v253, v55
    v_mul_f32 v254, v254, v55
    v_mul_f32 v255, v255, v55
    v_exp_f32 v56, v112
    v_exp_f32 v57, v113
    v_exp_f32 v58, v114
    v_add_f32 v52, v56, v57
    v_cvt_pk_bf16_f32 v72, v56, v57
    v_exp_f32 v59, v115
    v_add_f32 v52, v52, v58
    v_exp_f32 v60, v116
    v_add_f32 v52, v52, v59
    v_cvt_pk_bf16_f32 v73, v58, v59
    v_exp_f32 v61, v117
    v_exp_f32 v62, v118
    v_add_f32 v53, v60, v61
    v_cvt_pk_bf16_f32 v76, v60, v61
    v_exp_f32 v63, v119
    v_add_f32 v53, v53, v62
    v_exp_f32 v56, v120
    v_add_f32 v53, v53, v63
    v_cvt_pk_bf16_f32 v77, v62, v63
    v_exp_f32 v57, v121
    v_add_f32 v52, v52, v56
    v_exp_f32 v58, v122
    v_add_f32 v52, v52, v57
    v_cvt_pk_bf16_f32 v74, v56, v57
    v_exp_f32 v59, v123
    v_add_f32 v52, v52, v58
    v_exp_f32 v60, v124
    v_add_f32 v52, v52, v59
    v_cvt_pk_bf16_f32 v75, v58, v59
    v_exp_f32 v61, v125
    v_add_f32 v53, v53, v60
    v_exp_f32 v62, v126
    v_add_f32 v53, v53, v61
    v_cvt_pk_bf16_f32 v78, v60, v61
    v_exp_f32 v63, v127
    v_add_f32 v53, v53, v62
    v_add_f32 v53, v53, v63
    v_add_f32 v30, v52, v53
    v_cmp_lt_f32 vcc, s37, v30
    v_cvt_pk_bf16_f32 v79, v62, v63
    s_nop 1
    s_branch L_ret4
L_fb5:
    s_nop 15
    v_max3_f32 v54, v96, v97, v98
    v_max3_f32 v54, v54, v99, v104
    v_max3_f32 v54, v54, v105, v106
    v_max_f32 v54, v54, v107
    v_mov_b32 v31, v54
    s_nop 1
    v_permlane32_swap_b32 v54, v31
    v_max_f32 v54, v54, v31
    v_mov_b32 v31, v54
    s_nop 1
    v_permlane16_swap_b32 v54, v31
    v_max_f32 v54, v54, v31
    v_max3_f32 v55, v100, v101, v102
    v_max3_f32 v55, v55, v103, v108
    v_max3_f32 v55, v55, v109, v110
    v_max_f32 v55, v55, v111
    v_mov_b32 v31, v55
    s_nop 1
    v_permlane32_swap_b32 v55, v31
    v_max_f32 v55, v55, v31
    v_mov_b32 v31, v55
    s_nop 1
    v_permlane16_swap_b32 v55, v31
    v_max_f32 v55, v55, v31
    v_max_f32 v54, 0, v54
    v_max_f32 v55, 0, v55
    v_sub_f32 v80, v80, v54
    v_sub_f32 v81, v81, v54
    v_sub_f32 v82, v82, v54
    v_sub_f32 v83, v83, v54
    v_sub_f32 v84, v84, v55
    v_sub_f32 v85, v85, v55
    v_sub_f32 v86, v86, v55
    v_sub_f32 v87, v87, v55
    v_sub_f32 v96, v96, v54
    v_sub_f32 v97, v97, v54
    v_sub_f32 v98, v98, v54
    v_sub_f32 v99, v99, v54
    v_sub_f32 v100, v100, v55
    v_sub_f32 v101, v101, v55
    v_sub_f32 v102, v102, v55
    v_sub_f32 v103, v103, v55
    v_sub_f32 v104, v104, v54
    v_sub_f32 v105, v105, v54
    v_sub_f32 v106, v106, v54
    v_sub_f32 v107, v107, v54
    v_sub_f32 v108, v108, v55
    v_sub_f32 v109, v109, v55
    v_sub_f32 v110, v110, v55
    v_sub_f32 v111, v111, v55
    v_sub_f32 v112, v112, v54
    v_sub_f32 v113, v113, v54
    v_sub_f32 v114, v114, v54
    v_sub_f32 v115, v115, v54
    v_sub_f32 v116, v116, v55
    v_sub_f32 v117, v117, v55
    v_sub_f32 v118, v118, v55
    v_sub_f32 v119, v119, v55
    v_sub_f32 v120, v120, v54
    v_sub_f32 v121, v121, v54
    v_sub_f32 v122, v122, v54
    v_sub_f32 v123, v123, v54
    v_sub_f32 v124, v124, v55
    v_sub_f32 v125, v125, v55
    v_sub_f32 v126, v126, v55
    v_sub_f32 v127, v127, v55
    v_sub_f32 v54, 0, v54
    v_exp_f32 v54, v54
    s_nop 0
    v_mul_f32 v50, v50, v54
    v_sub_f32 v55, 0, v55
    v_exp_f32 v55, v55
    s_nop 0
    v_mul_f32 v51, v51, v55
    v_mul_f32 v128, v128, v54
    v_mul_f32 v129, v129, v54
    v_mul_f32 v130, v130, v54
    v_mul_f32 v131, v131, v54
    v_mul_f32 v132, v132, v55
    v_mul_f32 v133, v133, v55
    v_mul_f32 v134, v134, v55
    v_mul_f32 v135, v135, v55
    v_mul_f32 v136, v136, v54
    v_mul_f32 v137, v137, v54
    v_mul_f32 v138, v138, v54
    v_mul_f32 v139, v139, v54
    v_mul_f32 v140, v140, v55
    v_mul_f32 v141, v141, v55
    v_mul_f32 v142, v142, v55
    v_mul_f32 v143, v143, v55
    v_mul_f32 v144, v144, v54
    v_mul_f32 v145, v145, v54
    v_mul_f32 v146, v146, v54
    v_mul_f32 v147, v147, v54
    v_mul_f32 v148, v148, v55
    v_mul_f32 v149, v149, v55
    v_mul_f32 v150, v150, v55
    v_mul_f32 v151, v151, v55
    v_mul_f32 v152, v152, v54
    v_mul_f32 v153, v153, v54
    v_mul_f32 v154, v154, v54
    v_mul_f32 v155, v155, v54
    v_mul_f32 v156, v156, v55
    v_mul_f32 v157, v157, v55
    v_mul_f32 v158, v158, v55
    v_mul_f32 v159, v159, v55
    v_mul_f32 v160, v160, v54
    v_mul_f32 v161, v161, v54
    v_mul_f32 v162, v162, v54
    v_mul_f32 v163, v163, v54
    v_mul_f32 v164, v164, v55
    v_mul_f32 v165, v165, v55
    v_mul_f32 v166, v166, v55
    v_mul_f32 v167, v167, v55
    v_mul_f32 v168, v168, v54
    v_mul_f32 v169, v169, v54
    v_mul_f32 v170, v170, v54
    v_mul_f32 v171, v171, v54
    v_mul_f32 v172, v172, v55
    v_mul_f32 v173, v173, v55
    v_mul_f32 v174, v174, v55
    v_mul_f32 v175, v175, v55
    v_mul_f32 v176, v176, v54
    v_mul_f32 v177, v177, v54
    v_mul_f32 v178, v178, v54
    v_mul_f32 v179, v179, v54
    v_mul_f32 v180, v180, v55
    v_mul_f32 v181, v181, v55
    v_mul_f32 v182, v182, v55
    v_mul_f32 v183, v183, v55
    v_mul_f32 v184, v184, v54
    v_mul_f32 v185, v185, v54
    v_mul_f32 v186, v186, v54
    v_mul_f32 v187, v187, v54
    v_mul_f32 v188, v188, v55
    v_mul_f32 v189, v189, v55
    v_mul_f32 v190, v190, v55
    v_mul_f32 v191, v191, v55
    v_mul_f32 v192, v192, v54
    v_mul_f32 v193, v193, v54
    v_mul_f32 v194, v194, v54
    v_mul_f32 v195, v195, v54
    v_mul_f32 v196, v196, v55
    v_mul_f32 v197, v197, v55
    v_mul_f32 v198, v198, v55
    v_mul_f32 v199, v199, v55
    v_mul_f32 v200, v200, v54
    v_mul_f32 v201, v201, v54
    v_mul_f32 v202, v202, v54
    v_mul_f32 v203, v203, v54
    v_mul_f32 v204, v204, v55
    v_mul_f32 v205, v205, v55
    v_mul_f32 v206, v206, v55
    v_mul_f32 v207, v207, v55
    v_mul_f32 v208, v208, v54
    v_mul_f32 v209, v209, v54
    v_mul_f32 v210, v210, v54
    v_mul_f32 v211, v211, v54
    v_mul_f32 v212, v212, v55
    v_mul_f32 v213, v213, v55
    v_mul_f32 v214, v214, v55
    v_mul_f32 v215, v215, v55
    v_mul_f32 v216, v216, v54
    v_mul_f32 v217, v217, v54
    v_mul_f32 v218, v218, v54
    v_mul_f32 v219, v219, v54
    v_mul_f32 v220, v220, v55
    v_mul_f32 v221, v221, v55
    v_mul_f32 v222, v222, v55
    v_mul_f32 v223, v223, v55
    v_mul_f32 v224, v224, v54
    v_mul_f32 v225, v225, v54
    v_mul_f32 v226, v226, v54
    v_mul_f32 v227, v227, v54
    v_mul_f32 v228, v228, v55
    v_mul_f32 v229, v229, v55
    v_mul_f32 v230, v230, v55
    v_mul_f32 v231, v231, v55
    v_mul_f32 v232, v232, v54
    v_mul_f32 v233, v233, v54
    v_mul_f32 v234, v234, v54
    v_mul_f32 v235, v235, v54
    v_mul_f32 v236, v236, v55
    v_mul_f32 v237, v237, v55
    v_mul_f32 v238, v238, v55
    v_mul_f32 v239, v239, v55
    v_mul_f32 v240, v240, v54
    v_mul_f32 v241, v241, v54
    v_mul_f32 v242, v242, v54
    v_mul_f32 v243, v243, v54
    v_mul_f32 v244, v244, v55
    v_mul_f32 v245, v245, v55
    v_mul_f32 v246, v246, v55
    v_mul_f32 v247, v247, v55
    v_mul_f32 v248, v248, v54
    v_mul_f32 v249, v249, v54
    v_mul_f32 v250, v250, v54
    v_mul_f32 v251, v251, v54
    v_mul_f32 v252, v252, v55
    v_mul_f32 v253, v253, v55
    v_mul_f32 v254, v254, v55
    v_mul_f32 v255, v255, v55
    v_exp_f32 v56, v96
    v_exp_f32 v57, v97
    v_exp_f32 v58, v98
    v_add_f32 v52, v56, v57
    v_cvt_pk_bf16_f32 v64, v56, v57
    v_exp_f32 v59, v99
    v_add_f32 v52, v52, v58
    v_exp_f32 v60, v100
    v_add_f32 v52, v52, v59
    v_cvt_pk_bf16_f32 v65, v58, v59
    v_exp_f32 v61, v101
    v_exp_f32 v62, v102
    v_add_f32 v53, v60, v61
    v_cvt_pk_bf16_f32 v68, v60, v61
    v_exp_f32 v63, v103
    v_add_f32 v53, v53, v62
    v_exp_f32 v56, v104
    v_add_f32 v53, v53, v63
    v_cvt_pk_bf16_f32 v69, v62, v63
    v_exp_f32 v57, v105
    v_add_f32 v52, v52, v56
    v_exp_f32 v58, v106
    v_add_f32 v52, v52, v57
    v_cvt_pk_bf16_f32 v66, v56, v57
    v_exp_f32 v59, v107
    v_add_f32 v52, v52, v58
    v_exp_f32 v60, v108
    v_add_f32 v52, v52, v59
    v_cvt_pk_bf16_f32 v67, v58, v59
    v_exp_f32 v61, v109
    v_add_f32 v53, v53, v60
    v_exp_f32 v62, v110
    v_add_f32 v53, v53, v61
    v_cvt_pk_bf16_f32 v70, v60, v61
    v_exp_f32 v63, v111
    v_add_f32 v53, v53, v62
    v_add_f32 v53, v53, v63
    v_add_f32 v30, v52, v53
    v_cmp_lt_f32 vcc, s37, v30
    v_cvt_pk_bf16_f32 v71, v62, v63
    s_nop 1
    s_branch L_ret5
L_fb6:
    s_nop 15
    v_max3_f32 v54, v112, v113, v114
    v_max3_f32 v54, v54, v115, v120
    v_max3_f32 v54, v54, v121, v122
    v_max_f32 v54, v54, v123
    v_mov_b32 v31, v54
    s_nop 1
    v_permlane32_swap_b32 v54, v31
    v_max_f32 v54, v54, v31
    v_mov_b32 v31, v54
    s_nop 1
    v_permlane16_swap_b32 v54, v31
    v_max_f32 v54, v54, v31
    v_max3_f32 v55, v116, v117, v118
    v_max3_f32 v55, v55, v119, v124
    v_max3_f32 v55, v55, v125, v126
    v_max_f32 v55, v55, v127
    v_mov_b32 v31, v55
    s_nop 1
    v_permlane32_swap_b32 v55, v31
    v_max_f32 v55, v55, v31
    v_mov_b32 v31, v55
    s_nop 1
    v_permlane16_swap_b32 v55, v31
    v_max_f32 v55, v55, v31
    v_max_f32 v54, 0, v54
    v_max_f32 v55, 0, v55
    v_sub_f32 v80, v80, v54
    v_sub_f32 v81, v81, v54
    v_sub_f32 v82, v82, v54
    v_sub_f32 v83, v83, v54
    v_sub_f32 v84, v84, v55
    v_sub_f32 v85, v85, v55
    v_sub_f32 v86, v86, v55
    v_sub_f32 v87, v87, v55
    v_sub_f32 v112, v112, v54
    v_sub_f32 v113, v113, v54
    v_sub_f32 v114, v114, v54
    v_sub_f32 v115, v115, v54
    v_sub_f32 v116, v116, v55
    v_sub_f32 v117, v117, v55
    v_sub_f32 v118, v118, v55
    v_sub_f32 v119, v119, v55
    v_sub_f32 v120, v120, v54
    v_sub_f32 v121, v121, v54
    v_sub_f32 v122, v122, v54
    v_sub_f32 v123, v123, v54
    v_sub_f32 v124, v124, v55
    v_sub_f32 v125, v125, v55
    v_sub_f32 v126, v126, v55
    v_sub_f32 v127, v127, v55
    v_sub_f32 v96, v96, v54
    v_sub_f32 v97, v97, v54
    v_sub_f32 v98, v98, v54
    v_sub_f32 v99, v99, v54
    v_sub_f32 v100, v100, v55
    v_sub_f32 v101, v101, v55
    v_sub_f32 v102, v102, v55
    v_sub_f32 v103, v103, v55
    v_sub_f32 v104, v104, v54
    v_sub_f32 v105, v105, v54
    v_sub_f32 v106, v106, v54
    v_sub_f32 v107, v107, v54
    v_sub_f32 v108, v108, v55
    v_sub_f32 v109, v109, v55
    v_sub_f32 v110, v110, v55
    v_sub_f32 v111, v111, v55
    v_sub_f32 v54, 0, v54
    v_exp_f32 v54, v54
    s_nop 0
    v_mul_f32 v50, v50, v54
    v_sub_f32 v55, 0, v55
    v_exp_f32 v55, v55
    s_nop 0
    v_mul_f32 v51, v51, v55
    v_mul_f32 v128, v128, v54
    v_mul_f32 v129, v129, v54
    v_mul_f32 v130, v130, v54
    v_mul_f32 v131, v131, v54
    v_mul_f32 v132, v132, v55
    v_mul_f32 v133, v133, v55
    v_mul_f32 v134, v134, v55
    v_mul_f32 v135, v135, v55
    v_mul_f32 v136, v136, v54
    v_mul_f32 v137, v137, v54
    v_mul_f32 v138, v138, v54
    v_mul_f32 v139, v139, v54
    v_mul_f32 v140, v140, v55
    v_mul_f32 v141, v141, v55
    v_mul_f32 v142, v142, v55
    v_mul_f32 v143, v143, v55
    v_mul_f32 v144, v144, v54
    v_mul_f32 v145, v145, v54
    v_mul_f32 v146, v146, v54
    v_mul_f32 v147, v147, v54
    v_mul_f32 v148, v148, v55
    v_mul_f32 v149, v149, v55
    v_mul_f32 v150, v150, v55
    v_mul_f32 v151, v151, v55
    v_mul_f32 v152, v152, v54
    v_mul_f32 v153, v153, v54
    v_mul_f32 v154, v154, v54
    v_mul_f32 v155, v155, v54
    v_mul_f32 v156, v156, v55
    v_mul_f32 v157, v157, v55
    v_mul_f32 v158, v158, v55
    v_mul_f32 v159, v159, v55
    v_mul_f32 v160, v160, v54
    v_mul_f32 v161, v161, v54
    v_mul_f32 v162, v162, v54
    v_mul_f32 v163, v163, v54
    v_mul_f32 v164, v164, v55
    v_mul_f32 v165, v165, v55
    v_mul_f32 v166, v166, v55
    v_mul_f32 v167, v167, v55
    v_mul_f32 v168, v168, v54
    v_mul_f32 v169, v169, v54
    v_mul_f32 v170, v170, v54
    v_mul_f32 v171, v171, v54
    v_mul_f32 v172, v172, v55
    v_mul_f32 v173, v173, v55
    v_mul_f32 v174, v174, v55
    v_mul_f32 v175, v175, v55
    v_mul_f32 v176, v176, v54
    v_mul_f32 v177, v177, v54
    v_mul_f32 v178, v178, v54
    v_mul_f32 v179, v179, v54
    v_mul_f32 v180, v180, v55
    v_mul_f32 v181, v181, v55
    v_mul_f32 v182, v182, v55
    v_mul_f32 v183, v183, v55
    v_mul_f32 v184, v184, v54
    v_mul_f32 v185, v185, v54
    v_mul_f32 v186, v186, v54
    v_mul_f32 v187, v187, v54
    v_mul_f32 v188, v188, v55
    v_mul_f32 v189, v189, v55
    v_mul_f32 v190, v190, v55
    v_mul_f32 v191, v191, v55
    v_mul_f32 v192, v192, v54
    v_mul_f32 v193, v193, v54
    v_mul_f32 v194, v194, v54
    v_mul_f32 v195, v195, v54
    v_mul_f32 v196, v196, v55
    v_mul_f32 v197, v197, v55
    v_mul_f32 v198, v198, v55
    v_mul_f32 v199, v199, v55
    v_mul_f32 v200, v200, v54
    v_mul_f32 v201, v201, v54
    v_mul_f32 v202, v202, v54
    v_mul_f32 v203, v203, v54
    v_mul_f32 v204, v204, v55
    v_mul_f32 v205, v205, v55
    v_mul_f32 v206, v206, v55
    v_mul_f32 v207, v207, v55
    v_mul_f32 v208, v208, v54
    v_mul_f32 v209, v209, v54
    v_mul_f32 v210, v210, v54
    v_mul_f32 v211, v211, v54
    v_mul_f32 v212, v212, v55
    v_mul_f32 v213, v213, v55
    v_mul_f32 v214, v214, v55
    v_mul_f32 v215, v215, v55
    v_mul_f32 v216, v216, v54
    v_mul_f32 v217, v217, v54
    v_mul_f32 v218, v218, v54
    v_mul_f32 v219, v219, v54
    v_mul_f32 v220, v220, v55
    v_mul_f32 v221, v221, v55
    v_mul_f32 v222, v222, v55
    v_mul_f32 v223, v223, v55
    v_mul_f32 v224, v224, v54
    v_mul_f32 v225, v225, v54
    v_mul_f32 v226, v226, v54
    v_mul_f32 v227, v227, v54
    v_mul_f32 v228, v228, v55
    v_mul_f32 v229, v229, v55
    v_mul_f32 v230, v230, v55
    v_mul_f32 v231, v231, v55
    v_mul_f32 v232, v232, v54
    v_mul_f32 v233, v233, v54
    v_mul_f32 v234, v234, v54
    v_mul_f32 v235, v235, v54
    v_mul_f32 v236, v236, v55
    v_mul_f32 v237, v237, v55
    v_mul_f32 v238, v238, v55
    v_mul_f32 v239, v239, v55
    v_mul_f32 v240, v240, v54
    v_mul_f32 v241, v241, v54
    v_mul_f32 v242, v242, v54
    v_mul_f32 v243, v243, v54
    v_mul_f32 v244, v244, v55
    v_mul_f32 v245, v245, v55
    v_mul_f32 v246, v246, v55
    v_mul_f32 v247, v247, v55
    v_mul_f32 v248, v248, v54
    v_mul_f32 v249, v249, v54
    v_mul_f32 v250, v250, v54
    v_mul_f32 v251, v251, v54
    v_mul_f32 v252, v252, v55
    v_mul_f32 v253, v253, v55
    v_mul_f32 v254, v254, v55
    v_mul_f32 v255, v255, v55
    v_exp_f32 v56, v112
    v_exp_f32 v57, v113
    v_exp_f32 v58, v114
    v_add_f32 v52, v56, v57
    v_cvt_pk_bf16_f32 v72, v56, v57
    v_exp_f32 v59, v115
    v_add_f32 v52, v52, v58
    v_exp_f32 v60, v116
    v_add_f32 v52, v52, v59
    v_cvt_pk_bf16_f32 v73, v58, v59
    v_exp_f32 v61, v117
    v_exp_f32 v62, v118
    v_add_f32 v53, v60, v61
    v_cvt_pk_bf16_f32 v76, v60, v61
    v_exp_f32 v63, v119
    v_add_f32 v53, v53, v62
    v_exp_f32 v56, v120
    v_add_f32 v53, v53, v63
    v_cvt_pk_bf16_f32 v77, v62, v63
    v_exp_f32 v57, v121
    v_add_f32 v52, v52, v56
    v_exp_f32 v58, v122
    v_add_f32 v52, v52, v57
    v_cvt_pk_bf16_f32 v74, v56, v57
    v_exp_f32 v59, v123
    v_add_f32 v52, v52, v58
    v_exp_f32 v60, v124
    v_add_f32 v52, v52, v59
    v_cvt_pk_bf16_f32 v75, v58, v59
    v_exp_f32 v61, v125
    v_add_f32 v53, v53, v60
    v_exp_f32 v62, v126
    v_add_f32 v53, v53, v61
    v_cvt_pk_bf16_f32 v78, v60, v61
    v_exp_f32 v63, v127
    v_add_f32 v53, v53, v62
    v_add_f32 v53, v53, v63
    v_add_f32 v30, v52, v53
    v_cmp_lt_f32 vcc, s37, v30
    v_cvt_pk_bf16_f32 v79, v62, v63
    s_nop 1
    s_branch L_ret6
L_fb7:
    s_nop 15
    v_max3_f32 v54, v96, v97, v98
    v_max3_f32 v54, v54, v99, v104
    v_max3_f32 v54, v54, v105, v106
    v_max_f32 v54, v54, v107
    v_mov_b32 v31, v54
    s_nop 1
    v_permlane32_swap_b32 v54, v31
    v_max_f32 v54, v54, v31
    v_mov_b32 v31, v54
    s_nop 1
    v_permlane16_swap_b32 v54, v31
    v_max_f32 v54, v54, v31
    v_max3_f32 v55, v100, v101, v102
    v_max3_f32 v55, v55, v103, v108
    v_max3_f32 v55, v55, v109, v110
    v_max_f32 v55, v55, v111
    v_mov_b32 v31, v55
    s_nop 1
    v_permlane32_swap_b32 v55, v31
    v_max_f32 v55, v55, v31
    v_mov_b32 v31, v55
    s_nop 1
    v_permlane16_swap_b32 v55, v31
    v_max_f32 v55, v55, v31
    v_max_f32 v54, 0, v54
    v_max_f32 v55, 0, v55
    v_sub_f32 v80, v80, v54
    v_sub_f32 v81, v81, v54
    v_sub_f32 v82, v82, v54
    v_sub_f32 v83, v83, v54
    v_sub_f32 v84, v84, v55
    v_sub_f32 v85, v85, v55
    v_sub_f32 v86, v86, v55
    v_sub_f32 v87, v87, v55
    v_sub_f32 v96, v96, v54
    v_sub_f32 v97, v97, v54
    v_sub_f32 v98, v98, v54
    v_sub_f32 v99, v99, v54
    v_sub_f32 v100, v100, v55
    v_sub_f32 v101, v101, v55
    v_sub_f32 v102, v102, v55
    v_sub_f32 v103, v103, v55
    v_sub_f32 v104, v104, v54
    v_sub_f32 v105, v105, v54
    v_sub_f32 v106, v106, v54
    v_sub_f32 v107, v107, v54
    v_sub_f32 v108, v108, v55
    v_sub_f32 v109, v109, v55
    v_sub_f32 v110, v110, v55
    v_sub_f32 v111, v111, v55
    v_sub_f32 v112, v112, v54
    v_sub_f32 v113, v113, v54
    v_sub_f32 v114, v114, v54
    v_sub_f32 v115, v115, v54
    v_sub_f32 v116, v116, v55
    v_sub_f32 v117, v117, v55
    v_sub_f32 v118, v118, v55
    v_sub_f32 v119, v119, v55
    v_sub_f32 v120, v120, v54
    v_sub_f32 v121, v121, v54
    v_sub_f32 v122, v122, v54
    v_sub_f32 v123, v123, v54
    v_sub_f32 v124, v124, v55
    v_sub_f32 v125, v125, v55
    v_sub_f32 v126, v126, v55
    v_sub_f32 v127, v127, v55
    v_sub_f32 v54, 0, v54
    v_exp_f32 v54, v54
    s_nop 0
    v_mul_f32 v50, v50, v54
    v_sub_f32 v55, 0, v55
    v_exp_f32 v55, v55
    s_nop 0
    v_mul_f32 v51, v51, v55
    v_mul_f32 v128, v128, v54
    v_mul_f32 v129, v129, v54
    v_mul_f32 v130, v130, v54
    v_mul_f32 v131, v131, v54
    v_mul_f32 v132, v132, v55
    v_mul_f32 v133, v133, v55
    v_mul_f32 v134, v134, v55
    v_mul_f32 v135, v135, v55
    v_mul_f32 v136, v136, v54
    v_mul_f32 v137, v137, v54
    v_mul_f32 v138, v138, v54
    v_mul_f32 v139, v139, v54
    v_mul_f32 v140, v140, v55
    v_mul_f32 v141, v141, v55
    v_mul_f32 v142, v142, v55
    v_mul_f32 v143, v143, v55
    v_mul_f32 v144, v144, v54
    v_mul_f32 v145, v145, v54
    v_mul_f32 v146, v146, v54
    v_mul_f32 v147, v147, v54
    v_mul_f32 v148, v148, v55
    v_mul_f32 v149, v149, v55
    v_mul_f32 v150, v150, v55
    v_mul_f32 v151, v151, v55
    v_mul_f32 v152, v152, v54
    v_mul_f32 v153, v153, v54
    v_mul_f32 v154, v154, v54
    v_mul_f32 v155, v155, v54
    v_mul_f32 v156, v156, v55
    v_mul_f32 v157, v157, v55
    v_mul_f32 v158, v158, v55
    v_mul_f32 v159, v159, v55
    v_mul_f32 v160, v160, v54
    v_mul_f32 v161, v161, v54
    v_mul_f32 v162, v162, v54
    v_mul_f32 v163, v163, v54
    v_mul_f32 v164, v164, v55
    v_mul_f32 v165, v165, v55
    v_mul_f32 v166, v166, v55
    v_mul_f32 v167, v167, v55
    v_mul_f32 v168, v168, v54
    v_mul_f32 v169, v169, v54
    v_mul_f32 v170, v170, v54
    v_mul_f32 v171, v171, v54
    v_mul_f32 v172, v172, v55
    v_mul_f32 v173, v173, v55
    v_mul_f32 v174, v174, v55
    v_mul_f32 v175, v175, v55
    v_mul_f32 v176, v176, v54
    v_mul_f32 v177, v177, v54
    v_mul_f32 v178, v178, v54
    v_mul_f32 v179, v179, v54
    v_mul_f32 v180, v180, v55
    v_mul_f32 v181, v181, v55
    v_mul_f32 v182, v182, v55
    v_mul_f32 v183, v183, v55
    v_mul_f32 v184, v184, v54
    v_mul_f32 v185, v185, v54
    v_mul_f32 v186, v186, v54
    v_mul_f32 v187, v187, v54
    v_mul_f32 v188, v188, v55
    v_mul_f32 v189, v189, v55
    v_mul_f32 v190, v190, v55
    v_mul_f32 v191, v191, v55
    v_mul_f32 v192, v192, v54
    v_mul_f32 v193, v193, v54
    v_mul_f32 v194, v194, v54
    v_mul_f32 v195, v195, v54
    v_mul_f32 v196, v196, v55
    v_mul_f32 v197, v197, v55
    v_mul_f32 v198, v198, v55
    v_mul_f32 v199, v199, v55
    v_mul_f32 v200, v200, v54
    v_mul_f32 v201, v201, v54
    v_mul_f32 v202, v202, v54
    v_mul_f32 v203, v203, v54
    v_mul_f32 v204, v204, v55
    v_mul_f32 v205, v205, v55
    v_mul_f32 v206, v206, v55
    v_mul_f32 v207, v207, v55
    v_mul_f32 v208, v208, v54
    v_mul_f32 v209, v209, v54
    v_mul_f32 v210, v210, v54
    v_mul_f32 v211, v211, v54
    v_mul_f32 v212, v212, v55
    v_mul_f32 v213, v213, v55
    v_mul_f32 v214, v214, v55
    v_mul_f32 v215, v215, v55
    v_mul_f32 v216, v216, v54
    v_mul_f32 v217, v217, v54
    v_mul_f32 v218, v218, v54
    v_mul_f32 v219, v219, v54
    v_mul_f32 v220, v220, v55
    v_mul_f32 v221, v221, v55
    v_mul_f32 v222, v222, v55
    v_mul_f32 v223, v223, v55
    v_mul_f32 v224, v224, v54
    v_mul_f32 v225, v225, v54
    v_mul_f32 v226, v226, v54
    v_mul_f32 v227, v227, v54
    v_mul_f32 v228, v228, v55
    v_mul_f32 v229, v229, v55
    v_mul_f32 v230, v230, v55
    v_mul_f32 v231, v231, v55
    v_mul_f32 v232, v232, v54
    v_mul_f32 v233, v233, v54
    v_mul_f32 v234, v234, v54
    v_mul_f32 v235, v235, v54
    v_mul_f32 v236, v236, v55
    v_mul_f32 v237, v237, v55
    v_mul_f32 v238, v238, v55
    v_mul_f32 v239, v239, v55
    v_mul_f32 v240, v240, v54
    v_mul_f32 v241, v241, v54
    v_mul_f32 v242, v242, v54
    v_mul_f32 v243, v243, v54
    v_mul_f32 v244, v244, v55
    v_mul_f32 v245, v245, v55
    v_mul_f32 v246, v246, v55
    v_mul_f32 v247, v247, v55
    v_mul_f32 v248, v248, v54
    v_mul_f32 v249, v249, v54
    v_mul_f32 v250, v250, v54
    v_mul_f32 v251, v251, v54
    v_mul_f32 v252, v252, v55
    v_mul_f32 v253, v253, v55
    v_mul_f32 v254, v254, v55
    v_mul_f32 v255, v255, v55
    v_exp_f32 v56, v96
    v_exp_f32 v57, v97
    v_exp_f32 v58, v98
    v_add_f32 v52, v56, v57
    v_cvt_pk_bf16_f32 v64, v56, v57
    v_exp_f32 v59, v99
    v_add_f32 v52, v52, v58
    v_exp_f32 v60, v100
    v_add_f32 v52, v52, v59
    v_cvt_pk_bf16_f32 v65, v58, v59
    v_exp_f32 v61, v101
    v_exp_f32 v62, v102
    v_add_f32 v53, v60, v61
    v_cvt_pk_bf16_f32 v68, v60, v61
    v_exp_f32 v63, v103
    v_add_f32 v53, v53, v62
    v_exp_f32 v56, v104
    v_add_f32 v53, v53, v63
    v_cvt_pk_bf16_f32 v69, v62, v63
    v_exp_f32 v57, v105
    v_add_f32 v52, v52, v56
    v_exp_f32 v58, v106
    v_add_f32 v52, v52, v57
    v_cvt_pk_bf16_f32 v66, v56, v57
    v_exp_f32 v59, v107
    v_add_f32 v52, v52, v58
    v_exp_f32 v60, v108
    v_add_f32 v52, v52, v59
    v_cvt_pk_bf16_f32 v67, v58, v59
    v_exp_f32 v61, v109
    v_add_f32 v53, v53, v60
    v_exp_f32 v62, v110
    v_add_f32 v53, v53, v61
    v_cvt_pk_bf16_f32 v70, v60, v61
    v_exp_f32 v63, v111
    v_add_f32 v53, v53, v62
    v_add_f32 v53, v53, v63
    v_add_f32 v30, v52, v53
    v_cmp_lt_f32 vcc, s37, v30
    v_cvt_pk_bf16_f32 v71, v62, v63
    s_nop 1
    s_branch L_ret7
L_mslowadaLN_cond__gqa_block_cached__mixer_gmlp__prompt_kernel:
    s_mov_b32 s14, 0
    s_mov_b32 s56, 0x100000
L_poll_m2adaLN_cond__gqa_block_cached__mixer_gmlp__prompt_kernel:
    buffer_load_dword v9, v8, s[92:95], s14 offen sc1
    s_waitcnt vmcnt(0)
    v_cmp_gt_u32 vcc, 36, v9
    s_cbranch_vccz L_polled_m2adaLN_cond__gqa_block_cached__mixer_gmlp__prompt_kernel
    s_sleep 4
    s_sub_u32 s56, s56, 1
    s_cmp_lg_u32 s56, 0
    s_cbranch_scc1 L_poll_m2adaLN_cond__gqa_block_cached__mixer_gmlp__prompt_kernel
L_polled_m2adaLN_cond__gqa_block_cached__mixer_gmlp__prompt_kernel:
    s_branch L_mokadaLN_cond__gqa_block_cached__mixer_gmlp__prompt_kernel
L_fb8:
    s_nop 15
    v_max3_f32 v54, v112, v113, v114
    v_max3_f32 v54, v54, v115, v120
    v_max3_f32 v54, v54, v121, v122
    v_max_f32 v54, v54, v123
    v_mov_b32 v31, v54
    s_nop 1
    v_permlane32_swap_b32 v54, v31
    v_max_f32 v54, v54, v31
    v_mov_b32 v31, v54
    s_nop 1
    v_permlane16_swap_b32 v54, v31
    v_max_f32 v54, v54, v31
    v_max3_f32 v55, v116, v117, v118
    v_max3_f32 v55, v55, v119, v124
    v_max3_f32 v55, v55, v125, v126
    v_max_f32 v55, v55, v127
    v_mov_b32 v31, v55
    s_nop 1
    v_permlane32_swap_b32 v55, v31
    v_max_f32 v55, v55, v31
    v_mov_b32 v31, v55
    s_nop 1
    v_permlane16_swap_b32 v55, v31
    v_max_f32 v55, v55, v31
    v_max_f32 v54, 0, v54
    v_max_f32 v55, 0, v55
    v_sub_f32 v80, v80, v54
    v_sub_f32 v81, v81, v54
    v_sub_f32 v82, v82, v54
    v_sub_f32 v83, v83, v54
    v_sub_f32 v84, v84, v55
    v_sub_f32 v85, v85, v55
    v_sub_f32 v86, v86, v55
    v_sub_f32 v87, v87, v55
    v_sub_f32 v112, v112, v54
    v_sub_f32 v113, v113, v54
    v_sub_f32 v114, v114, v54
    v_sub_f32 v115, v115, v54
    v_sub_f32 v116, v116, v55
    v_sub_f32 v117, v117, v55
    v_sub_f32 v118, v118, v55
    v_sub_f32 v119, v119, v55
    v_sub_f32 v120, v120, v54
    v_sub_f32 v121, v121, v54
    v_sub_f32 v122, v122, v54
    v_sub_f32 v123, v123, v54
    v_sub_f32 v124, v124, v55
    v_sub_f32 v125, v125, v55
    v_sub_f32 v126, v126, v55
    v_sub_f32 v127, v127, v55
    v_sub_f32 v96, v96, v54
    v_sub_f32 v97, v97, v54
    v_sub_f32 v98, v98, v54
    v_sub_f32 v99, v99, v54
    v_sub_f32 v100, v100, v55
    v_sub_f32 v101, v101, v55
    v_sub_f32 v102, v102, v55
    v_sub_f32 v103, v103, v55
    v_sub_f32 v104, v104, v54
    v_sub_f32 v105, v105, v54
    v_sub_f32 v106, v106, v54
    v_sub_f32 v107, v107, v54
    v_sub_f32 v108, v108, v55
    v_sub_f32 v109, v109, v55
    v_sub_f32 v110, v110, v55
    v_sub_f32 v111, v111, v55
    v_sub_f32 v54, 0, v54
    v_exp_f32 v54, v54
    s_nop 0
    v_mul_f32 v50, v50, v54
    v_sub_f32 v55, 0, v55
    v_exp_f32 v55, v55
    s_nop 0
    v_mul_f32 v51, v51, v55
    v_mul_f32 v128, v128, v54
    v_mul_f32 v129, v129, v54
    v_mul_f32 v130, v130, v54
    v_mul_f32 v131, v131, v54
    v_mul_f32 v132, v132, v55
    v_mul_f32 v133, v133, v55
    v_mul_f32 v134, v134, v55
    v_mul_f32 v135, v135, v55
    v_mul_f32 v136, v136, v54
    v_mul_f32 v137, v137, v54
    v_mul_f32 v138, v138, v54
    v_mul_f32 v139, v139, v54
    v_mul_f32 v140, v140, v55
    v_mul_f32 v141, v141, v55
    v_mul_f32 v142, v142, v55
    v_mul_f32 v143, v143, v55
    v_mul_f32 v144, v144, v54
    v_mul_f32 v145, v145, v54
    v_mul_f32 v146, v146, v54
    v_mul_f32 v147, v147, v54
    v_mul_f32 v148, v148, v55
    v_mul_f32 v149, v149, v55
    v_mul_f32 v150, v150, v55
    v_mul_f32 v151, v151, v55
    v_mul_f32 v152, v152, v54
    v_mul_f32 v153, v153, v54
    v_mul_f32 v154, v154, v54
    v_mul_f32 v155, v155, v54
    v_mul_f32 v156, v156, v55
    v_mul_f32 v157, v157, v55
    v_mul_f32 v158, v158, v55
    v_mul_f32 v159, v159, v55
    v_mul_f32 v160, v160, v54
    v_mul_f32 v161, v161, v54
    v_mul_f32 v162, v162, v54
    v_mul_f32 v163, v163, v54
    v_mul_f32 v164, v164, v55
    v_mul_f32 v165, v165, v55
    v_mul_f32 v166, v166, v55
    v_mul_f32 v167, v167, v55
    v_mul_f32 v168, v168, v54
    v_mul_f32 v169, v169, v54
    v_mul_f32 v170, v170, v54
    v_mul_f32 v171, v171, v54
    v_mul_f32 v172, v172, v55
    v_mul_f32 v173, v173, v55
    v_mul_f32 v174, v174, v55
    v_mul_f32 v175, v175, v55
    v_mul_f32 v176, v176, v54
    v_mul_f32 v177, v177, v54
    v_mul_f32 v178, v178, v54
    v_mul_f32 v179, v179, v54
    v_mul_f32 v180, v180, v55
    v_mul_f32 v181, v181, v55
    v_mul_f32 v182, v182, v55
    v_mul_f32 v183, v183, v55
    v_mul_f32 v184, v184, v54
    v_mul_f32 v185, v185, v54
    v_mul_f32 v186, v186, v54
    v_mul_f32 v187, v187, v54
    v_mul_f32 v188, v188, v55
    v_mul_f32 v189, v189, v55
    v_mul_f32 v190, v190, v55
    v_mul_f32 v191, v191, v55
    v_mul_f32 v192, v192, v54
    v_mul_f32 v193, v193, v54
    v_mul_f32 v194, v194, v54
    v_mul_f32 v195, v195, v54
    v_mul_f32 v196, v196, v55
    v_mul_f32 v197, v197, v55
    v_mul_f32 v198, v198, v55
    v_mul_f32 v199, v199, v55
    v_mul_f32 v200, v200, v54
    v_mul_f32 v201, v201, v54
    v_mul_f32 v202, v202, v54
    v_mul_f32 v203, v203, v54
    v_mul_f32 v204, v204, v55
    v_mul_f32 v205, v205, v55
    v_mul_f32 v206, v206, v55
    v_mul_f32 v207, v207, v55
    v_mul_f32 v208, v208, v54
    v_mul_f32 v209, v209, v54
    v_mul_f32 v210, v210, v54
    v_mul_f32 v211, v211, v54
    v_mul_f32 v212, v212, v55
    v_mul_f32 v213, v213, v55
    v_mul_f32 v214, v214, v55
    v_mul_f32 v215, v215, v55
    v_mul_f32 v216, v216, v54
    v_mul_f32 v217, v217, v54
    v_mul_f32 v218, v218, v54
    v_mul_f32 v219, v219, v54
    v_mul_f32 v220, v220, v55
    v_mul_f32 v221, v221, v55
    v_mul_f32 v222, v222, v55
    v_mul_f32 v223, v223, v55
    v_mul_f32 v224, v224, v54
    v_mul_f32 v225, v225, v54
    v_mul_f32 v226, v226, v54
    v_mul_f32 v227, v227, v54
    v_mul_f32 v228, v228, v55
    v_mul_f32 v229, v229, v55
    v_mul_f32 v230, v230, v55
    v_mul_f32 v231, v231, v55
    v_mul_f32 v232, v232, v54
    v_mul_f32 v233, v233, v54
    v_mul_f32 v234, v234, v54
    v_mul_f32 v235, v235, v54
    v_mul_f32 v236, v236, v55
    v_mul_f32 v237, v237, v55
    v_mul_f32 v238, v238, v55
    v_mul_f32 v239, v239, v55
    v_mul_f32 v240, v240, v54
    v_mul_f32 v241, v241, v54
    v_mul_f32 v242, v242, v54
    v_mul_f32 v243, v243, v54
    v_mul_f32 v244, v244, v55
    v_mul_f32 v245, v245, v55
    v_mul_f32 v246, v246, v55
    v_mul_f32 v247, v247, v55
    v_mul_f32 v248, v248, v54
    v_mul_f32 v249, v249, v54
    v_mul_f32 v250, v250, v54
    v_mul_f32 v251, v251, v54
    v_mul_f32 v252, v252, v55
    v_mul_f32 v253, v253, v55
    v_mul_f32 v254, v254, v55
    v_mul_f32 v255, v255, v55
    v_exp_f32 v56, v112
    v_exp_f32 v57, v113
    v_exp_f32 v58, v114
    v_add_f32 v52, v56, v57
    v_cvt_pk_bf16_f32 v72, v56, v57
    v_exp_f32 v59, v115
    v_add_f32 v52, v52, v58
    v_exp_f32 v60, v116
    v_add_f32 v52, v52, v59
    v_cvt_pk_bf16_f32 v73, v58, v59
    v_exp_f32 v61, v117
    v_exp_f32 v62, v118
    v_add_f32 v53, v60, v61
    v_cvt_pk_bf16_f32 v76, v60, v61
    v_exp_f32 v63, v119
    v_add_f32 v53, v53, v62
    v_exp_f32 v56, v120
    v_add_f32 v53, v53, v63
    v_cvt_pk_bf16_f32 v77, v62, v63
    v_exp_f32 v57, v121
    v_add_f32 v52, v52, v56
    v_exp_f32 v58, v122
    v_add_f32 v52, v52, v57
    v_cvt_pk_bf16_f32 v74, v56, v57
    v_exp_f32 v59, v123
    v_add_f32 v52, v52, v58
    v_exp_f32 v60, v124
    v_add_f32 v52, v52, v59
    v_cvt_pk_bf16_f32 v75, v58, v59
    v_exp_f32 v61, v125
    v_add_f32 v53, v53, v60
    v_exp_f32 v62, v126
    v_add_f32 v53, v53, v61
    v_cvt_pk_bf16_f32 v78, v60, v61
    v_exp_f32 v63, v127
    v_add_f32 v53, v53, v62
    v_add_f32 v53, v53, v63
    v_add_f32 v30, v52, v53
    v_cmp_lt_f32 vcc, s37, v30
    v_cvt_pk_bf16_f32 v79, v62, v63
    s_nop 1
    s_branch L_ret8
L_fb9:
    s_nop 15
    v_max3_f32 v54, v96, v97, v98
    v_max3_f32 v54, v54, v99, v104
    v_max3_f32 v54, v54, v105, v106
    v_max_f32 v54, v54, v107
    v_mov_b32 v31, v54
    s_nop 1
    v_permlane32_swap_b32 v54, v31
    v_max_f32 v54, v54, v31
    v_mov_b32 v31, v54
    s_nop 1
    v_permlane16_swap_b32 v54, v31
    v_max_f32 v54, v54, v31
    v_max3_f32 v55, v100, v101, v102
    v_max3_f32 v55, v55, v103, v108
    v_max3_f32 v55, v55, v109, v110
    v_max_f32 v55, v55, v111
    v_mov_b32 v31, v55
    s_nop 1
    v_permlane32_swap_b32 v55, v31
    v_max_f32 v55, v55, v31
    v_mov_b32 v31, v55
    s_nop 1
    v_permlane16_swap_b32 v55, v31
    v_max_f32 v55, v55, v31
    v_max_f32 v54, 0, v54
    v_max_f32 v55, 0, v55
    v_sub_f32 v80, v80, v54
    v_sub_f32 v81, v81, v54
    v_sub_f32 v82, v82, v54
    v_sub_f32 v83, v83, v54
    v_sub_f32 v84, v84, v55
    v_sub_f32 v85, v85, v55
    v_sub_f32 v86, v86, v55
    v_sub_f32 v87, v87, v55
    v_sub_f32 v96, v96, v54
    v_sub_f32 v97, v97, v54
    v_sub_f32 v98, v98, v54
    v_sub_f32 v99, v99, v54
    v_sub_f32 v100, v100, v55
    v_sub_f32 v101, v101, v55
    v_sub_f32 v102, v102, v55
    v_sub_f32 v103, v103, v55
    v_sub_f32 v104, v104, v54
    v_sub_f32 v105, v105, v54
    v_sub_f32 v106, v106, v54
    v_sub_f32 v107, v107, v54
    v_sub_f32 v108, v108, v55
    v_sub_f32 v109, v109, v55
    v_sub_f32 v110, v110, v55
    v_sub_f32 v111, v111, v55
    v_sub_f32 v112, v112, v54
    v_sub_f32 v113, v113, v54
    v_sub_f32 v114, v114, v54
    v_sub_f32 v115, v115, v54
    v_sub_f32 v116, v116, v55
    v_sub_f32 v117, v117, v55
    v_sub_f32 v118, v118, v55
    v_sub_f32 v119, v119, v55
    v_sub_f32 v120, v120, v54
    v_sub_f32 v121, v121, v54
    v_sub_f32 v122, v122, v54
    v_sub_f32 v123, v123, v54
    v_sub_f32 v124, v124, v55
    v_sub_f32 v125, v125, v55
    v_sub_f32 v126, v126, v55
    v_sub_f32 v127, v127, v55
    v_sub_f32 v54, 0, v54
    v_exp_f32 v54, v54
    s_nop 0
    v_mul_f32 v50, v50, v54
    v_sub_f32 v55, 0, v55
    v_exp_f32 v55, v55
    s_nop 0
    v_mul_f32 v51, v51, v55
    v_mul_f32 v128, v128, v54
    v_mul_f32 v129, v129, v54
    v_mul_f32 v130, v130, v54
    v_mul_f32 v131, v131, v54
    v_mul_f32 v132, v132, v55
    v_mul_f32 v133, v133, v55
    v_mul_f32 v134, v134, v55
    v_mul_f32 v135, v135, v55
    v_mul_f32 v136, v136, v54
    v_mul_f32 v137, v137, v54
    v_mul_f32 v138, v138, v54
    v_mul_f32 v139, v139, v54
    v_mul_f32 v140, v140, v55
    v_mul_f32 v141, v141, v55
    v_mul_f32 v142, v142, v55
    v_mul_f32 v143, v143, v55
    v_mul_f32 v144, v144, v54
    v_mul_f32 v145, v145, v54
    v_mul_f32 v146, v146, v54
    v_mul_f32 v147, v147, v54
    v_mul_f32 v148, v148, v55
    v_mul_f32 v149, v149, v55
    v_mul_f32 v150, v150, v55
    v_mul_f32 v151, v151, v55
    v_mul_f32 v152, v152, v54
    v_mul_f32 v153, v153, v54
    v_mul_f32 v154, v154, v54
    v_mul_f32 v155, v155, v54
    v_mul_f32 v156, v156, v55
    v_mul_f32 v157, v157, v55
    v_mul_f32 v158, v158, v55
    v_mul_f32 v159, v159, v55
    v_mul_f32 v160, v160, v54
    v_mul_f32 v161, v161, v54
    v_mul_f32 v162, v162, v54
    v_mul_f32 v163, v163, v54
    v_mul_f32 v164, v164, v55
    v_mul_f32 v165, v165, v55
    v_mul_f32 v166, v166, v55
    v_mul_f32 v167, v167, v55
    v_mul_f32 v168, v168, v54
    v_mul_f32 v169, v169, v54
    v_mul_f32 v170, v170, v54
    v_mul_f32 v171, v171, v54
    v_mul_f32 v172, v172, v55
    v_mul_f32 v173, v173, v55
    v_mul_f32 v174, v174, v55
    v_mul_f32 v175, v175, v55
    v_mul_f32 v176, v176, v54
    v_mul_f32 v177, v177, v54
    v_mul_f32 v178, v178, v54
    v_mul_f32 v179, v179, v54
    v_mul_f32 v180, v180, v55
    v_mul_f32 v181, v181, v55
    v_mul_f32 v182, v182, v55
    v_mul_f32 v183, v183, v55
    v_mul_f32 v184, v184, v54
    v_mul_f32 v185, v185, v54
    v_mul_f32 v186, v186, v54
    v_mul_f32 v187, v187, v54
    v_mul_f32 v188, v188, v55
    v_mul_f32 v189, v189, v55
    v_mul_f32 v190, v190, v55
    v_mul_f32 v191, v191, v55
    v_mul_f32 v192, v192, v54
    v_mul_f32 v193, v193, v54
    v_mul_f32 v194, v194, v54
    v_mul_f32 v195, v195, v54
    v_mul_f32 v196, v196, v55
    v_mul_f32 v197, v197, v55
    v_mul_f32 v198, v198, v55
    v_mul_f32 v199, v199, v55
    v_mul_f32 v200, v200, v54
    v_mul_f32 v201, v201, v54
    v_mul_f32 v202, v202, v54
    v_mul_f32 v203, v203, v54
    v_mul_f32 v204, v204, v55
    v_mul_f32 v205, v205, v55
    v_mul_f32 v206, v206, v55
    v_mul_f32 v207, v207, v55
    v_mul_f32 v208, v208, v54
    v_mul_f32 v209, v209, v54
    v_mul_f32 v210, v210, v54
    v_mul_f32 v211, v211, v54
    v_mul_f32 v212, v212, v55
    v_mul_f32 v213, v213, v55
    v_mul_f32 v214, v214, v55
    v_mul_f32 v215, v215, v55
    v_mul_f32 v216, v216, v54
    v_mul_f32 v217, v217, v54
    v_mul_f32 v218, v218, v54
    v_mul_f32 v219, v219, v54
    v_mul_f32 v220, v220, v55
    v_mul_f32 v221, v221, v55
    v_mul_f32 v222, v222, v55
    v_mul_f32 v223, v223, v55
    v_mul_f32 v224, v224, v54
    v_mul_f32 v225, v225, v54
    v_mul_f32 v226, v226, v54
    v_mul_f32 v227, v227, v54
    v_mul_f32 v228, v228, v55
    v_mul_f32 v229, v229, v55
    v_mul_f32 v230, v230, v55
    v_mul_f32 v231, v231, v55
    v_mul_f32 v232, v232, v54
    v_mul_f32 v233, v233, v54
    v_mul_f32 v234, v234, v54
    v_mul_f32 v235, v235, v54
    v_mul_f32 v236, v236, v55
    v_mul_f32 v237, v237, v55
    v_mul_f32 v238, v238, v55
    v_mul_f32 v239, v239, v55
    v_mul_f32 v240, v240, v54
    v_mul_f32 v241, v241, v54
    v_mul_f32 v242, v242, v54
    v_mul_f32 v243, v243, v54
    v_mul_f32 v244, v244, v55
    v_mul_f32 v245, v245, v55
    v_mul_f32 v246, v246, v55
    v_mul_f32 v247, v247, v55
    v_mul_f32 v248, v248, v54
    v_mul_f32 v249, v249, v54
    v_mul_f32 v250, v250, v54
    v_mul_f32 v251, v251, v54
    v_mul_f32 v252, v252, v55
    v_mul_f32 v253, v253, v55
    v_mul_f32 v254, v254, v55
    v_mul_f32 v255, v255, v55
    v_exp_f32 v56, v96
    v_exp_f32 v57, v97
    v_exp_f32 v58, v98
    v_add_f32 v52, v56, v57
    v_cvt_pk_bf16_f32 v64, v56, v57
    v_exp_f32 v59, v99
    v_add_f32 v52, v52, v58
    v_exp_f32 v60, v100
    v_add_f32 v52, v52, v59
    v_cvt_pk_bf16_f32 v65, v58, v59
    v_exp_f32 v61, v101
    v_exp_f32 v62, v102
    v_add_f32 v53, v60, v61
    v_cvt_pk_bf16_f32 v68, v60, v61
    v_exp_f32 v63, v103
    v_add_f32 v53, v53, v62
    v_exp_f32 v56, v104
    v_add_f32 v53, v53, v63
    v_cvt_pk_bf16_f32 v69, v62, v63
    v_exp_f32 v57, v105
    v_add_f32 v52, v52, v56
    v_exp_f32 v58, v106
    v_add_f32 v52, v52, v57
    v_cvt_pk_bf16_f32 v66, v56, v57
    v_exp_f32 v59, v107
    v_add_f32 v52, v52, v58
    v_exp_f32 v60, v108
    v_add_f32 v52, v52, v59
    v_cvt_pk_bf16_f32 v67, v58, v59
    v_exp_f32 v61, v109
    v_add_f32 v53, v53, v60
    v_exp_f32 v62, v110
    v_add_f32 v53, v53, v61
    v_cvt_pk_bf16_f32 v70, v60, v61
    v_exp_f32 v63, v111
    v_add_f32 v53, v53, v62
    v_add_f32 v53, v53, v63
    v_add_f32 v30, v52, v53
    v_cmp_lt_f32 vcc, s37, v30
    v_cvt_pk_bf16_f32 v71, v62, v63
    s_nop 1
    s_branch L_ret9
L_fb10:
    s_nop 15
    v_max3_f32 v54, v112, v113, v114
    v_max3_f32 v54, v54, v115, v120
    v_max3_f32 v54, v54, v121, v122
    v_max_f32 v54, v54, v123
    v_mov_b32 v31, v54
    s_nop 1
    v_permlane32_swap_b32 v54, v31
    v_max_f32 v54, v54, v31
    v_mov_b32 v31, v54
    s_nop 1
    v_permlane16_swap_b32 v54, v31
    v_max_f32 v54, v54, v31
    v_max3_f32 v55, v116, v117, v118
    v_max3_f32 v55, v55, v119, v124
    v_max3_f32 v55, v55, v125, v126
    v_max_f32 v55, v55, v127
    v_mov_b32 v31, v55
    s_nop 1
    v_permlane32_swap_b32 v55, v31
    v_max_f32 v55, v55, v31
    v_mov_b32 v31, v55
    s_nop 1
    v_permlane16_swap_b32 v55, v31
    v_max_f32 v55, v55, v31
    v_max_f32 v54, 0, v54
    v_max_f32 v55, 0, v55
    v_sub_f32 v80, v80, v54
    v_sub_f32 v81, v81, v54
    v_sub_f32 v82, v82, v54
    v_sub_f32 v83, v83, v54
    v_sub_f32 v84, v84, v55
    v_sub_f32 v85, v85, v55
    v_sub_f32 v86, v86, v55
    v_sub_f32 v87, v87, v55
    v_sub_f32 v112, v112, v54
    v_sub_f32 v113, v113, v54
    v_sub_f32 v114, v114, v54
    v_sub_f32 v115, v115, v54
    v_sub_f32 v116, v116, v55
    v_sub_f32 v117, v117, v55
    v_sub_f32 v118, v118, v55
    v_sub_f32 v119, v119, v55
    v_sub_f32 v120, v120, v54
    v_sub_f32 v121, v121, v54
    v_sub_f32 v122, v122, v54
    v_sub_f32 v123, v123, v54
    v_sub_f32 v124, v124, v55
    v_sub_f32 v125, v125, v55
    v_sub_f32 v126, v126, v55
    v_sub_f32 v127, v127, v55
    v_sub_f32 v96, v96, v54
    v_sub_f32 v97, v97, v54
    v_sub_f32 v98, v98, v54
    v_sub_f32 v99, v99, v54
    v_sub_f32 v100, v100, v55
    v_sub_f32 v101, v101, v55
    v_sub_f32 v102, v102, v55
    v_sub_f32 v103, v103, v55
    v_sub_f32 v104, v104, v54
    v_sub_f32 v105, v105, v54
    v_sub_f32 v106, v106, v54
    v_sub_f32 v107, v107, v54
    v_sub_f32 v108, v108, v55
    v_sub_f32 v109, v109, v55
    v_sub_f32 v110, v110, v55
    v_sub_f32 v111, v111, v55
    v_sub_f32 v54, 0, v54
    v_exp_f32 v54, v54
    s_nop 0
    v_mul_f32 v50, v50, v54
    v_sub_f32 v55, 0, v55
    v_exp_f32 v55, v55
    s_nop 0
    v_mul_f32 v51, v51, v55
    v_mul_f32 v128, v128, v54
    v_mul_f32 v129, v129, v54
    v_mul_f32 v130, v130, v54
    v_mul_f32 v131, v131, v54
    v_mul_f32 v132, v132, v55
    v_mul_f32 v133, v133, v55
    v_mul_f32 v134, v134, v55
    v_mul_f32 v135, v135, v55
    v_mul_f32 v136, v136, v54
    v_mul_f32 v137, v137, v54
    v_mul_f32 v138, v138, v54
    v_mul_f32 v139, v139, v54
    v_mul_f32 v140, v140, v55
    v_mul_f32 v141, v141, v55
    v_mul_f32 v142, v142, v55
    v_mul_f32 v143, v143, v55
    v_mul_f32 v144, v144, v54
    v_mul_f32 v145, v145, v54
    v_mul_f32 v146, v146, v54
    v_mul_f32 v147, v147, v54
    v_mul_f32 v148, v148, v55
    v_mul_f32 v149, v149, v55
    v_mul_f32 v150, v150, v55
    v_mul_f32 v151, v151, v55
    v_mul_f32 v152, v152, v54
    v_mul_f32 v153, v153, v54
    v_mul_f32 v154, v154, v54
    v_mul_f32 v155, v155, v54
    v_mul_f32 v156, v156, v55
    v_mul_f32 v157, v157, v55
    v_mul_f32 v158, v158, v55
    v_mul_f32 v159, v159, v55
    v_mul_f32 v160, v160, v54
    v_mul_f32 v161, v161, v54
    v_mul_f32 v162, v162, v54
    v_mul_f32 v163, v163, v54
    v_mul_f32 v164, v164, v55
    v_mul_f32 v165, v165, v55
    v_mul_f32 v166, v166, v55
    v_mul_f32 v167, v167, v55
    v_mul_f32 v168, v168, v54
    v_mul_f32 v169, v169, v54
    v_mul_f32 v170, v170, v54
    v_mul_f32 v171, v171, v54
    v_mul_f32 v172, v172, v55
    v_mul_f32 v173, v173, v55
    v_mul_f32 v174, v174, v55
    v_mul_f32 v175, v175, v55
    v_mul_f32 v176, v176, v54
    v_mul_f32 v177, v177, v54
    v_mul_f32 v178, v178, v54
    v_mul_f32 v179, v179, v54
    v_mul_f32 v180, v180, v55
    v_mul_f32 v181, v181, v55
    v_mul_f32 v182, v182, v55
    v_mul_f32 v183, v183, v55
    v_mul_f32 v184, v184, v54
    v_mul_f32 v185, v185, v54
    v_mul_f32 v186, v186, v54
    v_mul_f32 v187, v187, v54
    v_mul_f32 v188, v188, v55
    v_mul_f32 v189, v189, v55
    v_mul_f32 v190, v190, v55
    v_mul_f32 v191, v191, v55
    v_mul_f32 v192, v192, v54
    v_mul_f32 v193, v193, v54
    v_mul_f32 v194, v194, v54
    v_mul_f32 v195, v195, v54
    v_mul_f32 v196, v196, v55
    v_mul_f32 v197, v197, v55
    v_mul_f32 v198, v198, v55
    v_mul_f32 v199, v199, v55
    v_mul_f32 v200, v200, v54
    v_mul_f32 v201, v201, v54
    v_mul_f32 v202, v202, v54
    v_mul_f32 v203, v203, v54
    v_mul_f32 v204, v204, v55
    v_mul_f32 v205, v205, v55
    v_mul_f32 v206, v206, v55
    v_mul_f32 v207, v207, v55
    v_mul_f32 v208, v208, v54
    v_mul_f32 v209, v209, v54
    v_mul_f32 v210, v210, v54
    v_mul_f32 v211, v211, v54
    v_mul_f32 v212, v212, v55
    v_mul_f32 v213, v213, v55
    v_mul_f32 v214, v214, v55
    v_mul_f32 v215, v215, v55
    v_mul_f32 v216, v216, v54
    v_mul_f32 v217, v217, v54
    v_mul_f32 v218, v218, v54
    v_mul_f32 v219, v219, v54
    v_mul_f32 v220, v220, v55
    v_mul_f32 v221, v221, v55
    v_mul_f32 v222, v222, v55
    v_mul_f32 v223, v223, v55
    v_mul_f32 v224, v224, v54
    v_mul_f32 v225, v225, v54
    v_mul_f32 v226, v226, v54
    v_mul_f32 v227, v227, v54
    v_mul_f32 v228, v228, v55
    v_mul_f32 v229, v229, v55
    v_mul_f32 v230, v230, v55
    v_mul_f32 v231, v231, v55
    v_mul_f32 v232, v232, v54
    v_mul_f32 v233, v233, v54
    v_mul_f32 v234, v234, v54
    v_mul_f32 v235, v235, v54
    v_mul_f32 v236, v236, v55
    v_mul_f32 v237, v237, v55
    v_mul_f32 v238, v238, v55
    v_mul_f32 v239, v239, v55
    v_mul_f32 v240, v240, v54
    v_mul_f32 v241, v241, v54
    v_mul_f32 v242, v242, v54
    v_mul_f32 v243, v243, v54
    v_mul_f32 v244, v244, v55
    v_mul_f32 v245, v245, v55
    v_mul_f32 v246, v246, v55
    v_mul_f32 v247, v247, v55
    v_mul_f32 v248, v248, v54
    v_mul_f32 v249, v249, v54
    v_mul_f32 v250, v250, v54
    v_mul_f32 v251, v251, v54
    v_mul_f32 v252, v252, v55
    v_mul_f32 v253, v253, v55
    v_mul_f32 v254, v254, v55
    v_mul_f32 v255, v255, v55
    v_exp_f32 v56, v112
    v_exp_f32 v57, v113
    v_exp_f32 v58, v114
    v_add_f32 v52, v56, v57
    v_cvt_pk_bf16_f32 v72, v56, v57
    v_exp_f32 v59, v115
    v_add_f32 v52, v52, v58
    v_exp_f32 v60, v116
    v_add_f32 v52, v52, v59
    v_cvt_pk_bf16_f32 v73, v58, v59
    v_exp_f32 v61, v117
    v_exp_f32 v62, v118
    v_add_f32 v53, v60, v61
    v_cvt_pk_bf16_f32 v76, v60, v61
    v_exp_f32 v63, v119
    v_add_f32 v53, v53, v62
    v_exp_f32 v56, v120
    v_add_f32 v53, v53, v63
    v_cvt_pk_bf16_f32 v77, v62, v63
    v_exp_f32 v57, v121
    v_add_f32 v52, v52, v56
    v_exp_f32 v58, v122
    v_add_f32 v52, v52, v57
    v_cvt_pk_bf16_f32 v74, v56, v57
    v_exp_f32 v59, v123
    v_add_f32 v52, v52, v58
    v_exp_f32 v60, v124
    v_add_f32 v52, v52, v59
    v_cvt_pk_bf16_f32 v75, v58, v59
    v_exp_f32 v61, v125
    v_add_f32 v53, v53, v60
    v_exp_f32 v62, v126
    v_add_f32 v53, v53, v61
    v_cvt_pk_bf16_f32 v78, v60, v61
    v_exp_f32 v63, v127
    v_add_f32 v53, v53, v62
    v_add_f32 v53, v53, v63
    v_add_f32 v30, v52, v53
    v_cmp_lt_f32 vcc, s37, v30
    v_cvt_pk_bf16_f32 v79, v62, v63
    s_nop 1
    s_branch L_ret10
L_fb11:
    s_nop 15
    v_max3_f32 v54, v96, v97, v98
    v_max3_f32 v54, v54, v99, v104
    v_max3_f32 v54, v54, v105, v106
    v_max_f32 v54, v54, v107
    v_mov_b32 v31, v54
    s_nop 1
    v_permlane32_swap_b32 v54, v31
    v_max_f32 v54, v54, v31
    v_mov_b32 v31, v54
    s_nop 1
    v_permlane16_swap_b32 v54, v31
    v_max_f32 v54, v54, v31
    v_max3_f32 v55, v100, v101, v102
    v_max3_f32 v55, v55, v103, v108
    v_max3_f32 v55, v55, v109, v110
    v_max_f32 v55, v55, v111
    v_mov_b32 v31, v55
    s_nop 1
    v_permlane32_swap_b32 v55, v31
    v_max_f32 v55, v55, v31
    v_mov_b32 v31, v55
    s_nop 1
    v_permlane16_swap_b32 v55, v31
    v_max_f32 v55, v55, v31
    v_max_f32 v54, 0, v54
    v_max_f32 v55, 0, v55
    v_sub_f32 v80, v80, v54
    v_sub_f32 v81, v81, v54
    v_sub_f32 v82, v82, v54
    v_sub_f32 v83, v83, v54
    v_sub_f32 v84, v84, v55
    v_sub_f32 v85, v85, v55
    v_sub_f32 v86, v86, v55
    v_sub_f32 v87, v87, v55
    v_sub_f32 v96, v96, v54
    v_sub_f32 v97, v97, v54
    v_sub_f32 v98, v98, v54
    v_sub_f32 v99, v99, v54
    v_sub_f32 v100, v100, v55
    v_sub_f32 v101, v101, v55
    v_sub_f32 v102, v102, v55
    v_sub_f32 v103, v103, v55
    v_sub_f32 v104, v104, v54
    v_sub_f32 v105, v105, v54
    v_sub_f32 v106, v106, v54
    v_sub_f32 v107, v107, v54
    v_sub_f32 v108, v108, v55
    v_sub_f32 v109, v109, v55
    v_sub_f32 v110, v110, v55
    v_sub_f32 v111, v111, v55
    v_sub_f32 v112, v112, v54
    v_sub_f32 v113, v113, v54
    v_sub_f32 v114, v114, v54
    v_sub_f32 v115, v115, v54
    v_sub_f32 v116, v116, v55
    v_sub_f32 v117, v117, v55
    v_sub_f32 v118, v118, v55
    v_sub_f32 v119, v119, v55
    v_sub_f32 v120, v120, v54
    v_sub_f32 v121, v121, v54
    v_sub_f32 v122, v122, v54
    v_sub_f32 v123, v123, v54
    v_sub_f32 v124, v124, v55
    v_sub_f32 v125, v125, v55
    v_sub_f32 v126, v126, v55
    v_sub_f32 v127, v127, v55
    v_sub_f32 v54, 0, v54
    v_exp_f32 v54, v54
    s_nop 0
    v_mul_f32 v50, v50, v54
    v_sub_f32 v55, 0, v55
    v_exp_f32 v55, v55
    s_nop 0
    v_mul_f32 v51, v51, v55
    v_mul_f32 v128, v128, v54
    v_mul_f32 v129, v129, v54
    v_mul_f32 v130, v130, v54
    v_mul_f32 v131, v131, v54
    v_mul_f32 v132, v132, v55
    v_mul_f32 v133, v133, v55
    v_mul_f32 v134, v134, v55
    v_mul_f32 v135, v135, v55
    v_mul_f32 v136, v136, v54
    v_mul_f32 v137, v137, v54
    v_mul_f32 v138, v138, v54
    v_mul_f32 v139, v139, v54
    v_mul_f32 v140, v140, v55
    v_mul_f32 v141, v141, v55
    v_mul_f32 v142, v142, v55
    v_mul_f32 v143, v143, v55
    v_mul_f32 v144, v144, v54
    v_mul_f32 v145, v145, v54
    v_mul_f32 v146, v146, v54
    v_mul_f32 v147, v147, v54
    v_mul_f32 v148, v148, v55
    v_mul_f32 v149, v149, v55
    v_mul_f32 v150, v150, v55
    v_mul_f32 v151, v151, v55
    v_mul_f32 v152, v152, v54
    v_mul_f32 v153, v153, v54
    v_mul_f32 v154, v154, v54
    v_mul_f32 v155, v155, v54
    v_mul_f32 v156, v156, v55
    v_mul_f32 v157, v157, v55
    v_mul_f32 v158, v158, v55
    v_mul_f32 v159, v159, v55
    v_mul_f32 v160, v160, v54
    v_mul_f32 v161, v161, v54
    v_mul_f32 v162, v162, v54
    v_mul_f32 v163, v163, v54
    v_mul_f32 v164, v164, v55
    v_mul_f32 v165, v165, v55
    v_mul_f32 v166, v166, v55
    v_mul_f32 v167, v167, v55
    v_mul_f32 v168, v168, v54
    v_mul_f32 v169, v169, v54
    v_mul_f32 v170, v170, v54
    v_mul_f32 v171, v171, v54
    v_mul_f32 v172, v172, v55
    v_mul_f32 v173, v173, v55
    v_mul_f32 v174, v174, v55
    v_mul_f32 v175, v175, v55
    v_mul_f32 v176, v176, v54
    v_mul_f32 v177, v177, v54
    v_mul_f32 v178, v178, v54
    v_mul_f32 v179, v179, v54
    v_mul_f32 v180, v180, v55
    v_mul_f32 v181, v181, v55
    v_mul_f32 v182, v182, v55
    v_mul_f32 v183, v183, v55
    v_mul_f32 v184, v184, v54
    v_mul_f32 v185, v185, v54
    v_mul_f32 v186, v186, v54
    v_mul_f32 v187, v187, v54
    v_mul_f32 v188, v188, v55
    v_mul_f32 v189, v189, v55
    v_mul_f32 v190, v190, v55
    v_mul_f32 v191, v191, v55
    v_mul_f32 v192, v192, v54
    v_mul_f32 v193, v193, v54
    v_mul_f32 v194, v194, v54
    v_mul_f32 v195, v195, v54
    v_mul_f32 v196, v196, v55
    v_mul_f32 v197, v197, v55
    v_mul_f32 v198, v198, v55
    v_mul_f32 v199, v199, v55
    v_mul_f32 v200, v200, v54
    v_mul_f32 v201, v201, v54
    v_mul_f32 v202, v202, v54
    v_mul_f32 v203, v203, v54
    v_mul_f32 v204, v204, v55
    v_mul_f32 v205, v205, v55
    v_mul_f32 v206, v206, v55
    v_mul_f32 v207, v207, v55
    v_mul_f32 v208, v208, v54
    v_mul_f32 v209, v209, v54
    v_mul_f32 v210, v210, v54
    v_mul_f32 v211, v211, v54
    v_mul_f32 v212, v212, v55
    v_mul_f32 v213, v213, v55
    v_mul_f32 v214, v214, v55
    v_mul_f32 v215, v215, v55
    v_mul_f32 v216, v216, v54
    v_mul_f32 v217, v217, v54
    v_mul_f32 v218, v218, v54
    v_mul_f32 v219, v219, v54
    v_mul_f32 v220, v220, v55
    v_mul_f32 v221, v221, v55
    v_mul_f32 v222, v222, v55
    v_mul_f32 v223, v223, v55
    v_mul_f32 v224, v224, v54
    v_mul_f32 v225, v225, v54
    v_mul_f32 v226, v226, v54
    v_mul_f32 v227, v227, v54
    v_mul_f32 v228, v228, v55
    v_mul_f32 v229, v229, v55
    v_mul_f32 v230, v230, v55
    v_mul_f32 v231, v231, v55
    v_mul_f32 v232, v232, v54
    v_mul_f32 v233, v233, v54
    v_mul_f32 v234, v234, v54
    v_mul_f32 v235, v235, v54
    v_mul_f32 v236, v236, v55
    v_mul_f32 v237, v237, v55
    v_mul_f32 v238, v238, v55
    v_mul_f32 v239, v239, v55
    v_mul_f32 v240, v240, v54
    v_mul_f32 v241, v241, v54
    v_mul_f32 v242, v242, v54
    v_mul_f32 v243, v243, v54
    v_mul_f32 v244, v244, v55
    v_mul_f32 v245, v245, v55
    v_mul_f32 v246, v246, v55
    v_mul_f32 v247, v247, v55
    v_mul_f32 v248, v248, v54
    v_mul_f32 v249, v249, v54
    v_mul_f32 v250, v250, v54
    v_mul_f32 v251, v251, v54
    v_mul_f32 v252, v252, v55
    v_mul_f32 v253, v253, v55
    v_mul_f32 v254, v254, v55
    v_mul_f32 v255, v255, v55
    v_exp_f32 v56, v96
    v_exp_f32 v57, v97
    v_exp_f32 v58, v98
    v_add_f32 v52, v56, v57
    v_cvt_pk_bf16_f32 v64, v56, v57
    v_exp_f32 v59, v99
    v_add_f32 v52, v52, v58
    v_exp_f32 v60, v100
    v_add_f32 v52, v52, v59
    v_cvt_pk_bf16_f32 v65, v58, v59
    v_exp_f32 v61, v101
    v_exp_f32 v62, v102
    v_add_f32 v53, v60, v61
    v_cvt_pk_bf16_f32 v68, v60, v61
    v_exp_f32 v63, v103
    v_add_f32 v53, v53, v62
    v_exp_f32 v56, v104
    v_add_f32 v53, v53, v63
    v_cvt_pk_bf16_f32 v69, v62, v63
    v_exp_f32 v57, v105
    v_add_f32 v52, v52, v56
    v_exp_f32 v58, v106
    v_add_f32 v52, v52, v57
    v_cvt_pk_bf16_f32 v66, v56, v57
    v_exp_f32 v59, v107
    v_add_f32 v52, v52, v58
    v_exp_f32 v60, v108
    v_add_f32 v52, v52, v59
    v_cvt_pk_bf16_f32 v67, v58, v59
    v_exp_f32 v61, v109
    v_add_f32 v53, v53, v60
    v_exp_f32 v62, v110
    v_add_f32 v53, v53, v61
    v_cvt_pk_bf16_f32 v70, v60, v61
    v_exp_f32 v63, v111
    v_add_f32 v53, v53, v62
    v_add_f32 v53, v53, v63
    v_add_f32 v30, v52, v53
    v_cmp_lt_f32 vcc, s37, v30
    v_cvt_pk_bf16_f32 v71, v62, v63
    s_nop 1
    s_branch L_ret11
L_fb12:
    s_nop 15
    v_max3_f32 v54, v112, v113, v114
    v_max3_f32 v54, v54, v115, v120
    v_max3_f32 v54, v54, v121, v122
    v_max_f32 v54, v54, v123
    v_mov_b32 v31, v54
    s_nop 1
    v_permlane32_swap_b32 v54, v31
    v_max_f32 v54, v54, v31
    v_mov_b32 v31, v54
    s_nop 1
    v_permlane16_swap_b32 v54, v31
    v_max_f32 v54, v54, v31
    v_max3_f32 v55, v116, v117, v118
    v_max3_f32 v55, v55, v119, v124
    v_max3_f32 v55, v55, v125, v126
    v_max_f32 v55, v55, v127
    v_mov_b32 v31, v55
    s_nop 1
    v_permlane32_swap_b32 v55, v31
    v_max_f32 v55, v55, v31
    v_mov_b32 v31, v55
    s_nop 1
    v_permlane16_swap_b32 v55, v31
    v_max_f32 v55, v55, v31
    v_max_f32 v54, 0, v54
    v_max_f32 v55, 0, v55
    v_sub_f32 v80, v80, v54
    v_sub_f32 v81, v81, v54
    v_sub_f32 v82, v82, v54
    v_sub_f32 v83, v83, v54
    v_sub_f32 v84, v84, v55
    v_sub_f32 v85, v85, v55
    v_sub_f32 v86, v86, v55
    v_sub_f32 v87, v87, v55
    v_sub_f32 v112, v112, v54
    v_sub_f32 v113, v113, v54
    v_sub_f32 v114, v114, v54
    v_sub_f32 v115, v115, v54
    v_sub_f32 v116, v116, v55
    v_sub_f32 v117, v117, v55
    v_sub_f32 v118, v118, v55
    v_sub_f32 v119, v119, v55
    v_sub_f32 v120, v120, v54
    v_sub_f32 v121, v121, v54
    v_sub_f32 v122, v122, v54
    v_sub_f32 v123, v123, v54
    v_sub_f32 v124, v124, v55
    v_sub_f32 v125, v125, v55
    v_sub_f32 v126, v126, v55
    v_sub_f32 v127, v127, v55
    v_sub_f32 v54, 0, v54
    v_exp_f32 v54, v54
    s_nop 0
    v_mul_f32 v50, v50, v54
    v_sub_f32 v55, 0, v55
    v_exp_f32 v55, v55
    s_nop 0
    v_mul_f32 v51, v51, v55
    v_mul_f32 v128, v128, v54
    v_mul_f32 v129, v129, v54
    v_mul_f32 v130, v130, v54
    v_mul_f32 v131, v131, v54
    v_mul_f32 v132, v132, v55
    v_mul_f32 v133, v133, v55
    v_mul_f32 v134, v134, v55
    v_mul_f32 v135, v135, v55
    v_mul_f32 v136, v136, v54
    v_mul_f32 v137, v137, v54
    v_mul_f32 v138, v138, v54
    v_mul_f32 v139, v139, v54
    v_mul_f32 v140, v140, v55
    v_mul_f32 v141, v141, v55
    v_mul_f32 v142, v142, v55
    v_mul_f32 v143, v143, v55
    v_mul_f32 v144, v144, v54
    v_mul_f32 v145, v145, v54
    v_mul_f32 v146, v146, v54
    v_mul_f32 v147, v147, v54
    v_mul_f32 v148, v148, v55
    v_mul_f32 v149, v149, v55
    v_mul_f32 v150, v150, v55
    v_mul_f32 v151, v151, v55
    v_mul_f32 v152, v152, v54
    v_mul_f32 v153, v153, v54
    v_mul_f32 v154, v154, v54
    v_mul_f32 v155, v155, v54
    v_mul_f32 v156, v156, v55
    v_mul_f32 v157, v157, v55
    v_mul_f32 v158, v158, v55
    v_mul_f32 v159, v159, v55
    v_mul_f32 v160, v160, v54
    v_mul_f32 v161, v161, v54
    v_mul_f32 v162, v162, v54
    v_mul_f32 v163, v163, v54
    v_mul_f32 v164, v164, v55
    v_mul_f32 v165, v165, v55
    v_mul_f32 v166, v166, v55
    v_mul_f32 v167, v167, v55
    v_mul_f32 v168, v168, v54
    v_mul_f32 v169, v169, v54
    v_mul_f32 v170, v170, v54
    v_mul_f32 v171, v171, v54
    v_mul_f32 v172, v172, v55
    v_mul_f32 v173, v173, v55
    v_mul_f32 v174, v174, v55
    v_mul_f32 v175, v175, v55
    v_mul_f32 v176, v176, v54
    v_mul_f32 v177, v177, v54
    v_mul_f32 v178, v178, v54
    v_mul_f32 v179, v179, v54
    v_mul_f32 v180, v180, v55
    v_mul_f32 v181, v181, v55
    v_mul_f32 v182, v182, v55
    v_mul_f32 v183, v183, v55
    v_mul_f32 v184, v184, v54
    v_mul_f32 v185, v185, v54
    v_mul_f32 v186, v186, v54
    v_mul_f32 v187, v187, v54
    v_mul_f32 v188, v188, v55
    v_mul_f32 v189, v189, v55
    v_mul_f32 v190, v190, v55
    v_mul_f32 v191, v191, v55
    v_mul_f32 v192, v192, v54
    v_mul_f32 v193, v193, v54
    v_mul_f32 v194, v194, v54
    v_mul_f32 v195, v195, v54
    v_mul_f32 v196, v196, v55
    v_mul_f32 v197, v197, v55
    v_mul_f32 v198, v198, v55
    v_mul_f32 v199, v199, v55
    v_mul_f32 v200, v200, v54
    v_mul_f32 v201, v201, v54
    v_mul_f32 v202, v202, v54
    v_mul_f32 v203, v203, v54
    v_mul_f32 v204, v204, v55
    v_mul_f32 v205, v205, v55
    v_mul_f32 v206, v206, v55
    v_mul_f32 v207, v207, v55
    v_mul_f32 v208, v208, v54
    v_mul_f32 v209, v209, v54
    v_mul_f32 v210, v210, v54
    v_mul_f32 v211, v211, v54
    v_mul_f32 v212, v212, v55
    v_mul_f32 v213, v213, v55
    v_mul_f32 v214, v214, v55
    v_mul_f32 v215, v215, v55
    v_mul_f32 v216, v216, v54
    v_mul_f32 v217, v217, v54
    v_mul_f32 v218, v218, v54
    v_mul_f32 v219, v219, v54
    v_mul_f32 v220, v220, v55
    v_mul_f32 v221, v221, v55
    v_mul_f32 v222, v222, v55
    v_mul_f32 v223, v223, v55
    v_mul_f32 v224, v224, v54
    v_mul_f32 v225, v225, v54
    v_mul_f32 v226, v226, v54
    v_mul_f32 v227, v227, v54
    v_mul_f32 v228, v228, v55
    v_mul_f32 v229, v229, v55
    v_mul_f32 v230, v230, v55
    v_mul_f32 v231, v231, v55
    v_mul_f32 v232, v232, v54
    v_mul_f32 v233, v233, v54
    v_mul_f32 v234, v234, v54
    v_mul_f32 v235, v235, v54
    v_mul_f32 v236, v236, v55
    v_mul_f32 v237, v237, v55
    v_mul_f32 v238, v238, v55
    v_mul_f32 v239, v239, v55
    v_mul_f32 v240, v240, v54
    v_mul_f32 v241, v241, v54
    v_mul_f32 v242, v242, v54
    v_mul_f32 v243, v243, v54
    v_mul_f32 v244, v244, v55
    v_mul_f32 v245, v245, v55
    v_mul_f32 v246, v246, v55
    v_mul_f32 v247, v247, v55
    v_mul_f32 v248, v248, v54
    v_mul_f32 v249, v249, v54
    v_mul_f32 v250, v250, v54
    v_mul_f32 v251, v251, v54
    v_mul_f32 v252, v252, v55
    v_mul_f32 v253, v253, v55
    v_mul_f32 v254, v254, v55
    v_mul_f32 v255, v255, v55
    v_exp_f32 v56, v112
    v_exp_f32 v57, v113
    v_exp_f32 v58, v114
    v_add_f32 v52, v56, v57
    v_cvt_pk_bf16_f32 v72, v56, v57
    v_exp_f32 v59, v115
    v_add_f32 v52, v52, v58
    v_exp_f32 v60, v116
    v_add_f32 v52, v52, v59
    v_cvt_pk_bf16_f32 v73, v58, v59
    v_exp_f32 v61, v117
    v_exp_f32 v62, v118
    v_add_f32 v53, v60, v61
    v_cvt_pk_bf16_f32 v76, v60, v61
    v_exp_f32 v63, v119
    v_add_f32 v53, v53, v62
    v_exp_f32 v56, v120
    v_add_f32 v53, v53, v63
    v_cvt_pk_bf16_f32 v77, v62, v63
    v_exp_f32 v57, v121
    v_add_f32 v52, v52, v56
    v_exp_f32 v58, v122
    v_add_f32 v52, v52, v57
    v_cvt_pk_bf16_f32 v74, v56, v57
    v_exp_f32 v59, v123
    v_add_f32 v52, v52, v58
    v_exp_f32 v60, v124
    v_add_f32 v52, v52, v59
    v_cvt_pk_bf16_f32 v75, v58, v59
    v_exp_f32 v61, v125
    v_add_f32 v53, v53, v60
    v_exp_f32 v62, v126
    v_add_f32 v53, v53, v61
    v_cvt_pk_bf16_f32 v78, v60, v61
    v_exp_f32 v63, v127
    v_add_f32 v53, v53, v62
    v_add_f32 v53, v53, v63
    v_add_f32 v30, v52, v53
    v_cmp_lt_f32 vcc, s37, v30
    v_cvt_pk_bf16_f32 v79, v62, v63
    s_nop 1
    s_branch L_ret12
L_nslowadaLN_cond__gqa_block_cached__mixer_gmlp__prompt_kernel:
    s_mov_b32 s14, 0
    s_mov_b32 s56, 0x100000
L_poll_m3adaLN_cond__gqa_block_cached__mixer_gmlp__prompt_kernel:
    buffer_load_dword v15, v9, s[92:95], s14 offen sc1
    s_waitcnt vmcnt(0)
    v_cmp_gt_u32 vcc, 56, v15
    s_cbranch_vccz L_polled_m3adaLN_cond__gqa_block_cached__mixer_gmlp__prompt_kernel
    s_sleep 8
    s_sub_u32 s56, s56, 1
    s_cmp_lg_u32 s56, 0
    s_cbranch_scc1 L_poll_m3adaLN_cond__gqa_block_cached__mixer_gmlp__prompt_kernel
L_polled_m3adaLN_cond__gqa_block_cached__mixer_gmlp__prompt_kernel:
    s_branch L_nokadaLN_cond__gqa_block_cached__mixer_gmlp__prompt_kernel
L_bumpadaLN_cond__gqa_block_cached__mixer_gmlp__prompt_kernel:
    s_cmp_lg_u32 s2, 255
    s_cbranch_scc1 L_endadaLN_cond__gqa_block_cached__mixer_gmlp__prompt_kernel
    s_add_u32 s12, s100, 1
    s_add_u32 s13, s101, 1
    v_mov_b32 v4, s12
    v_mov_b32 v5, s13
    v_mov_b32 v6, 32768
    buffer_store_dwordx2 v[4:5], v6, s[24:27], 0 offen sc1
    s_endpgm
.section .rodata,"a"
.p2align 6
.amdhsa_kernel adaLN_cond__gqa_block_cached__mixer_gmlp__prompt_kernel
  .amdhsa_next_free_vgpr 496
  .amdhsa_next_free_sgpr 102
  .amdhsa_accum_offset 256
  .amdhsa_group_segment_fixed_size 0
  .amdhsa_kernarg_size 120
  .amdhsa_user_sgpr_count 2
  .amdhsa_user_sgpr_kernarg_segment_ptr 1
  .amdhsa_system_sgpr_workgroup_id_x 1
.end_amdhsa_kernel
```
